```python
import torch

def _softmax(x, axis=-1):
    return torch.softmax(x, dim=axis)
def _gelu(x):
    return torch.nn.functional.gelu(x, approximate="tanh")
def _silu(x):
    return torch.nn.functional.silu(x)
def _sigmoid(x):
    return torch.sigmoid(x)
def _layernorm(x, axis=-1, eps=1e-5):
    m = x.mean(dim=axis, keepdim=True)
    v = x.var(dim=axis, keepdim=True, unbiased=False)
    return (x - m) / torch.sqrt(v + eps)
def _scatter_add(tgt, idx, src, axis=0):
    return tgt.clone().index_add_(axis, idx, src)
def _segment_sum(src, seg, n):
    out = torch.zeros((n,) + src.shape[1:], dtype=src.dtype)
    return out.index_add_(0, seg, src)
def _pad(x, pw):
    flat = tuple(v for pair in reversed(pw) for v in pair)
    return torch.nn.functional.pad(x, flat)

kernel_name = 'concat_heads__ssm_conv_s5__compressed_kv_cla__prompt'

def setup_inputs():

    _w = (lambda a: (lambda t: t.to(torch.bfloat16) if t.is_floating_point() else t)(torch.as_tensor(a)))
    def _A_setup():
        B, S, D = 1, 2048, 640
        P = D
        Lambda_re = -0.5 * (lambda _x: torch.exp(torch.as_tensor(_x)))((lambda *s: torch.randn(*s, dtype=torch.bfloat16) * 0.2)(P))
        Lambda_im = (lambda *s: torch.randn(*s, dtype=torch.bfloat16) * 0.4)(P) * 1.0
        B_re = (lambda *s: torch.randn(*s, dtype=torch.bfloat16) * 0.2)(P, D) * (D ** -0.5)
        B_im = (lambda *s: torch.randn(*s, dtype=torch.bfloat16) * 0.2)(P, D) * (D ** -0.5)
        C_re = (lambda *s: torch.randn(*s, dtype=torch.bfloat16) * 0.2)(D, P) * (P ** -0.5)
        C_im = (lambda *s: torch.randn(*s, dtype=torch.bfloat16) * 0.2)(D, P) * (P ** -0.5)
        log_dt = (lambda *s: torch.randn(*s, dtype=torch.bfloat16) * 0.2)(P) * 0.3 - 2.0
        Dskip = (lambda *s: torch.randn(*s, dtype=torch.bfloat16) * 0.05)(D)
        return {
            "x": _w((lambda *s: torch.randn(*s, dtype=torch.bfloat16) * 0.05)(B, S, D)),
            "Lambda_re": _w(Lambda_re),
            "Lambda_im": _w(Lambda_im),
            "B_re": _w(B_re),
            "B_im": _w(B_im),
            "C_re": _w(C_re),
            "C_im": _w(C_im),
            "log_dt": _w(log_dt),
            "Dskip": _w(Dskip),
        }
    _A_in = _A_setup()

    def _B_setup():
        B, H, Sq, Sk, D, M = 1, 32, 2048, 2048, 128, 640
        Dc = 4 * D
        return {
            "x": _w((lambda *s: torch.randn(*s, dtype=torch.bfloat16) * 0.8)(B, Sq, M)),
            "c_kv": _w((lambda *s: torch.randn(*s, dtype=torch.bfloat16) * 0.2)(B, Sk, Dc)),
            "w_q": _w((lambda *s: torch.randn(*s, dtype=torch.bfloat16) * 3.2)(M, H, D) * (M ** -0.5)),
            "w_uk": _w((lambda *s: torch.randn(*s, dtype=torch.bfloat16) * 3.2)(Dc, H, D) * (Dc ** -0.5)),
            "w_uv": _w((lambda *s: torch.randn(*s, dtype=torch.bfloat16) * 0.2)(Dc, H, D) * (Dc ** -0.5)),
            "w_o": _w((lambda *s: torch.randn(*s, dtype=torch.bfloat16) * 0.2)(H, D, M) * ((H * D) ** -0.5)),
        }
    _B_in = _B_setup()

    return {
        "A_x": _A_in["x"],
        "A_Lambda_re": _A_in["Lambda_re"],
        "A_Lambda_im": _A_in["Lambda_im"],
        "A_B_re": _A_in["B_re"],
        "A_B_im": _A_in["B_im"],
        "A_C_re": _A_in["C_re"],
        "A_C_im": _A_in["C_im"],
        "A_log_dt": _A_in["log_dt"],
        "A_Dskip": _A_in["Dskip"],
        "B_x": _B_in["x"],
        "B_c_kv": _B_in["c_kv"],
        "B_w_q": _B_in["w_q"],
        "B_w_uk": _B_in["w_uk"],
        "B_w_uv": _B_in["w_uv"],
        "B_w_o": _B_in["w_o"],
    }

def reference(A_x, A_Lambda_re, A_Lambda_im, A_B_re, A_B_im, A_C_re, A_C_im, A_log_dt, A_Dskip, B_x, B_c_kv, B_w_q, B_w_uk, B_w_uv, B_w_o):
    def _A_ref(x, Lambda_re, Lambda_im, B_re, B_im, C_re, C_im, log_dt, Dskip):
        Bsz, L, H = x.shape
        Lam = Lambda_re + 1j * Lambda_im
        Bmat = B_re + 1j * B_im
        Cmat = C_re + 1j * C_im
        dt = torch.exp(log_dt)
        Lam_bar = torch.exp(dt * Lam)
        B_bar = ((Lam_bar - 1.0) / Lam)[:, None] * Bmat
        Bu = torch.einsum("bld,pd->blp", x + 0j, B_bar)
        h = torch.zeros_like(Bu[:, 0, :])
        hs = []
        for t in range(L):
            h = Lam_bar[None, :] * h + Bu[:, t, :]
            hs.append(h)
        hseq = torch.stack(hs, 1)
        y = 2.0 * torch.einsum("blp,dp->bld", hseq, Cmat).real + x * Dskip[None, None, :]
        return y

    def _B_ref(x, c_kv, w_q, w_uk, w_uv, w_o):
        B, Sq, M = x.shape[0], x.shape[1], x.shape[2]
        Sk = c_kv.shape[1]
        H, D = w_q.shape[1], w_q.shape[2]
        q = torch.einsum("bqm,mhd->bhqd", x, w_q)
        k = torch.einsum("bkc,chd->bhkd", c_kv, w_uk)
        v = torch.einsum("bkc,chd->bhkd", c_kv, w_uv)
        scores = torch.einsum("bhqd,bhkd->bhqk", q, k) * (D ** -0.5)
        off = Sk - Sq
        qi = torch.arange(Sq)[:, None]
        kj = torch.arange(Sk)[None, :]
        cmask = kj <= (qi + off)
        scores = torch.where(cmask[None, None], scores, -1e9)
        p = _softmax(scores, axis=-1)
        ctx = torch.einsum("bhqk,bhkd->bhqd", p, v)
        return torch.einsum("bhqd,hdm->bqm", ctx, w_o)

    a = _A_ref(A_x, A_Lambda_re, A_Lambda_im, A_B_re, A_B_im, A_C_re, A_C_im, A_log_dt, A_Dskip)
    b = _B_ref(B_x, B_c_kv, B_w_q, B_w_uk, B_w_uv, B_w_o)
    return torch.concatenate([a, b], axis=-1)
```

```asm
; @launch kernel=f_kernel grid=(256,1,1) block=(512,1,1) lds=163840
.amdgcn_target "amdgcn-amd-amdhsa--gfx950"
.text
.globl f_kernel
.p2align 8
.type f_kernel,@function
f_kernel:
  s_cmp_ge_u32 s2, 256
  s_cbranch_scc1 f_end
  s_load_dwordx16 s[80:95], s[0:1], 64
  s_load_dwordx16 s[64:79], s[0:1], 0
  s_load_dwordx4 s[96:99], s[0:1], 128
  v_lshrrev_b32 v2, 6, v0
  s_nop 0
  v_readfirstlane_b32 s3, v2
  v_and_b32 v1, 63, v0
  s_getpc_b64 s[32:33]
f_pc:
  s_and_b32 s34, s2, 0xf8
  s_add_u32 s34, s34, s3
  s_cmp_ge_u32 s34, 11
  s_cbranch_scc1 f_nocp
  s_lshl_b32 s34, s34, 13
  v_lshl_add_u32 v15, v1, 7, s34
  v_min_u32 v15, f_last-f_pc, v15
  global_load_dword v15, v15, s[32:33]
f_nocp:
  s_and_b32 s34, s2, 7
  s_bfe_u32 s35, s2, 0x20003
  s_lshr_b32 s36, s2, 5
  s_lshl_b32 s32, s34, 2
  s_add_u32 s37, s32, s35
  s_add_u32 s41, s36, 3
  s_and_b32 s41, s41, 7
  v_lshrrev_b32 v34, 4, v1
  s_and_b32 s33, s3, 3
  s_lshl_b32 s33, s33, 3
  v_add_u32 v37, s33, v34
  v_lshlrev_b32 v37, 13, v37
  s_and_b32 s33, s3, 1
  s_lshl_b32 s33, s33, 3
  v_lshl_add_u32 v39, v34, 1, s33
  v_and_b32 v38, 15, v1
  v_xor_b32 v40, v38, v39
  v_lshl_add_u32 v37, v40, 4, v37
  s_lshl_b32 s33, s37, 8
  v_add_u32 v24, s33, v37
  s_lshl_b32 s32, s41, 8
  s_lshl_b32 s33, s3, 5
  s_add_u32 s32, s32, s33
  v_lshrrev_b32 v32, 3, v1
  v_add_u32 v33, s32, v32
  v_lshlrev_b32 v33, 10, v33
  v_and_b32 v35, 7, v1
  v_xor_b32 v35, v34, v35
  v_xor_b32 v36, 4, v35
  v_lshl_add_u32 v25, v35, 4, v33
  v_lshl_add_u32 v26, v36, 4, v33
  v_add_u32 v26, 0x2000, v26
  s_lshl_b32 s58, s3, 12
  s_lshl_b32 s59, s3, 11
  v_lshlrev_b32 v13, 20, v0
  s_cmp_lt_u32 s2, 160
  s_cbranch_scc1 f_U
  s_waitcnt lgkmcnt(0)
  s_mov_b32 s4, s84
  s_and_b32 s5, s85, 0xffff
  s_mov_b32 s6, 0x200000
  s_mov_b32 s7, 0x00020000
  s_cmp_lt_u32 s3, 4
  s_cselect_b32 s8, s88, s90
  s_cselect_b32 s9, s89, s91
  s_and_b32 s9, s9, 0xffff
  s_mov_b32 s10, 0x400000
  s_mov_b32 s11, 0x00020000
  s_add_u32 m0, s59, 0x20000
  s_mov_b32 s32, 0x0
  buffer_load_dwordx4 v24, s[8:11], s32 offen lds
  s_add_u32 m0, s59, 0x20400
  s_mov_b32 s32, 0x8000
  buffer_load_dwordx4 v24, s[8:11], s32 offen lds
  s_add_u32 m0, s58, 0x0
  s_movk_i32 s33, 0x0
  buffer_load_dwordx4 v25, s[4:7], s33 offen lds
  s_add_u32 m0, s58, 0x400
  s_movk_i32 s33, 0x0
  buffer_load_dwordx4 v26, s[4:7], s33 offen lds
  s_add_u32 m0, s58, 0x800
  s_movk_i32 s33, 0x4000
  buffer_load_dwordx4 v25, s[4:7], s33 offen lds
  s_add_u32 m0, s58, 0xc00
  s_movk_i32 s33, 0x4000
  buffer_load_dwordx4 v26, s[4:7], s33 offen lds
  s_add_u32 m0, s59, 0x24000
  s_mov_b32 s32, 0x40000
  buffer_load_dwordx4 v24, s[8:11], s32 offen lds
  s_add_u32 m0, s59, 0x24400
  s_mov_b32 s32, 0x48000
  buffer_load_dwordx4 v24, s[8:11], s32 offen lds
  s_add_u32 m0, s59, 0x18000
  s_mov_b32 s32, 0x80000
  buffer_load_dwordx4 v24, s[8:11], s32 offen lds
  s_add_u32 m0, s59, 0x18400
  s_mov_b32 s32, 0x88000
  buffer_load_dwordx4 v24, s[8:11], s32 offen lds
  s_add_u32 m0, s58, 0x8000
  s_movk_i32 s33, 0x80
  buffer_load_dwordx4 v25, s[4:7], s33 offen lds
  s_add_u32 m0, s58, 0x8400
  s_movk_i32 s33, 0x80
  buffer_load_dwordx4 v26, s[4:7], s33 offen lds
  s_add_u32 m0, s58, 0x8800
  s_movk_i32 s33, 0x4080
  buffer_load_dwordx4 v25, s[4:7], s33 offen lds
  s_add_u32 m0, s58, 0x8c00
  s_movk_i32 s33, 0x4080
  buffer_load_dwordx4 v26, s[4:7], s33 offen lds
  s_add_u32 m0, s59, 0x1c000
  s_mov_b32 s32, 0xc0000
  buffer_load_dwordx4 v24, s[8:11], s32 offen lds
  s_add_u32 m0, s59, 0x1c400
  s_mov_b32 s32, 0xc8000
  buffer_load_dwordx4 v24, s[8:11], s32 offen lds
  s_add_u32 m0, s58, 0x10000
  s_movk_i32 s33, 0x100
  buffer_load_dwordx4 v25, s[4:7], s33 offen lds
  s_add_u32 m0, s58, 0x10400
  s_movk_i32 s33, 0x100
  buffer_load_dwordx4 v26, s[4:7], s33 offen lds
  s_add_u32 m0, s58, 0x10800
  s_movk_i32 s33, 0x4100
  buffer_load_dwordx4 v25, s[4:7], s33 offen lds
  s_add_u32 m0, s58, 0x10c00
  s_movk_i32 s33, 0x4100
  buffer_load_dwordx4 v26, s[4:7], s33 offen lds
  s_sub_u32 s32, s36, 4
  s_lshl_b32 s32, s32, 2
  s_and_b32 s33, s3, 3
  s_add_u32 s32, s32, s33
  s_lshl_b32 s32, s32, 18
  s_lshl_b32 s33, s37, 8
  s_add_u32 s32, s32, s33
  v_lshrrev_b32 v14, 1, v1
  v_lshlrev_b32 v14, 13, v14
  v_and_b32 v31, 1, v1
  v_lshl_add_u32 v14, v31, 7, v14
  buffer_load_dword v15, v14, s[8:11], s32 offen
  s_sub_u32 s32, s3, 5
  s_cmp_gt_u32 s32, 1
  s_cbranch_scc1 fN_nt
  s_lshr_b32 s33, s2, 3
  v_and_b32 v42, 1, v1
  v_lshl_add_u32 v42, s33, 1, v42
  s_min_u32 s33, s33, 4
  s_cmp_eq_u32 s32, 0
  s_cselect_b32 s100, s98, s94
  s_cselect_b32 s101, s99, s95
  s_cbranch_scc1 fN_nt1
  v_mov_b32 v42, s33
fN_nt1:
  v_lshlrev_b32 v42, 21, v42
  global_load_dword v15, v42, s[100:101]
fN_nt:
  v_lshlrev_b32 v2, 4, v1
  v_bfe_u32 v32, v1, 2, 2
  v_lshl_add_u32 v33, v34, 3, v32
  v_and_b32 v35, 3, v1
  v_lshlrev_b32 v35, 3, v35
  v_add_u32 v35, 0x18000, v35
  v_lshl_add_u32 v36, v33, 8, v35
  v_and_b32 v37, 1, v34
  v_lshl_add_u32 v38, v37, 2, v32
  v_xor_b32 v39, 0, v38
  v_lshl_add_u32 v16, v39, 5, v36
  v_xor_b32 v39, 1, v38
  v_lshl_add_u32 v17, v39, 5, v36
  v_xor_b32 v39, 2, v38
  v_lshl_add_u32 v18, v39, 5, v36
  v_xor_b32 v39, 3, v38
  v_lshl_add_u32 v19, v39, 5, v36
  s_lshr_b32 s40, s3, 2
  s_lshl_b32 s40, s40, 7
  v_xor_b32 v16, s40, v16
  v_xor_b32 v17, s40, v17
  v_xor_b32 v18, s40, v18
  v_xor_b32 v19, s40, v19
  v_and_b32 v39, 15, v1
  v_lshrrev_b32 v40, 1, v39
  v_xor_b32 v40, v40, v34
  v_lshlrev_b32 v39, 7, v39
  v_lshl_add_u32 v3, v40, 4, v39
  v_xor_b32 v4, 64, v3
  s_and_b32 s32, s3, 3
  s_lshl_b32 s32, s32, 13
  s_add_u32 s33, s32, 0x10000
  v_add_u32 v27, s32, v3
  v_add_u32 v28, s32, v4
  v_add_u32 v29, s33, v3
  v_add_u32 v30, s33, v4
  s_lshl_b32 s32, s37, 3
  s_add_u32 s32, s32, s41
  s_lshl_b32 s32, s32, 2
  s_and_b32 s33, s3, 3
  s_add_u32 s32, s32, s33
  s_lshl_b32 s32, s32, 15
  s_add_u32 s12, s98, s32
  s_addc_u32 s13, s99, 0
  s_and_b32 s13, s13, 0xffff
  s_mov_b32 s14, 0x8000
  s_mov_b32 s15, 0x00020000
  s_lshl_b32 s44, s40, 4
  s_lshl_b32 s45, s40, 5
  s_add_u32 s45, s45, 0x2000
  s_add_u32 s24, s98, 0x6000000
  s_addc_u32 s25, s99, 0
  s_and_b32 s25, s25, 0xffff
  s_mov_b32 s26, 0x38000
  s_mov_b32 s27, 0x00020000
  v_mov_b32 v44, -1
  v_mov_b32 v45, -1
  v_mov_b32 v46, -1
  v_mov_b32 v47, -1
  s_sub_u32 s32, s2, 242
  s_cselect_b32 s32, 64, s32
  s_lshl_b32 s32, s32, 14
  s_add_u32 s32, s32, s59
  buffer_store_dwordx4 v[44:47], v2, s[24:27], s32 offen offset:0 sc1
  buffer_store_dwordx4 v[44:47], v2, s[24:27], s32 offen offset:1024 sc1
  s_waitcnt vmcnt(17)
  s_barrier
  ds_read_b128 v[192:195], v27 offset:0
  ds_read_b64_tr_b16 v[32:33], v16 offset:32768
  ds_read_b64_tr_b16 v[34:35], v16 offset:33792
  ds_read_b64_tr_b16 v[36:37], v17 offset:32768
  ds_read_b64_tr_b16 v[38:39], v17 offset:33792
  ds_read_b64_tr_b16 v[40:41], v18 offset:32768
  ds_read_b64_tr_b16 v[42:43], v18 offset:33792
  ds_read_b64_tr_b16 v[44:45], v19 offset:32768
  ds_read_b64_tr_b16 v[46:47], v19 offset:33792
  ds_read_b128 v[196:199], v27 offset:2048
  ds_read_b128 v[200:203], v27 offset:4096
  ds_read_b128 v[204:207], v27 offset:6144
  s_waitcnt lgkmcnt(9)
  v_mfma_f32_16x16x32_bf16 v[64:67], v[32:35], v[192:195], 0
  ds_read_b64_tr_b16 v[48:49], v16 offset:40960
  s_waitcnt lgkmcnt(8)
  v_mfma_f32_16x16x32_bf16 v[68:71], v[36:39], v[192:195], 0
  ds_read_b64_tr_b16 v[50:51], v16 offset:41984
  s_waitcnt lgkmcnt(7)
  v_mfma_f32_16x16x32_bf16 v[96:99], v[40:43], v[192:195], 0
  ds_read_b64_tr_b16 v[52:53], v17 offset:40960
  s_waitcnt lgkmcnt(6)
  v_mfma_f32_16x16x32_bf16 v[100:103], v[44:47], v[192:195], 0
  ds_read_b64_tr_b16 v[54:55], v17 offset:41984
  s_waitcnt lgkmcnt(6)
  v_mfma_f32_16x16x32_bf16 v[72:75], v[32:35], v[196:199], 0
  ds_read_b64_tr_b16 v[56:57], v18 offset:40960
  v_mfma_f32_16x16x32_bf16 v[76:79], v[36:39], v[196:199], 0
  ds_read_b64_tr_b16 v[58:59], v18 offset:41984
  v_mfma_f32_16x16x32_bf16 v[104:107], v[40:43], v[196:199], 0
  ds_read_b64_tr_b16 v[60:61], v19 offset:40960
  v_mfma_f32_16x16x32_bf16 v[108:111], v[44:47], v[196:199], 0
  ds_read_b64_tr_b16 v[62:63], v19 offset:41984
  s_waitcnt lgkmcnt(9)
  v_mfma_f32_16x16x32_bf16 v[80:83], v[32:35], v[200:203], 0
  v_mfma_f32_16x16x32_bf16 v[84:87], v[36:39], v[200:203], 0
  v_mfma_f32_16x16x32_bf16 v[112:115], v[40:43], v[200:203], 0
  v_mfma_f32_16x16x32_bf16 v[116:119], v[44:47], v[200:203], 0
  s_waitcnt lgkmcnt(8)
  v_mfma_f32_16x16x32_bf16 v[88:91], v[32:35], v[204:207], 0
  s_waitcnt lgkmcnt(0)
  s_waitcnt vmcnt(15)
  s_barrier
  s_setprio 3
  v_mfma_f32_16x16x32_bf16 v[92:95], v[36:39], v[204:207], 0
  ds_read_b64_tr_b16 v[32:33], v16 offset:49152
  v_mfma_f32_16x16x32_bf16 v[120:123], v[40:43], v[204:207], 0
  ds_read_b64_tr_b16 v[34:35], v16 offset:50176
  s_add_u32 m0, s59, 0x20000
  s_mov_b32 s32, 0x100000
  buffer_load_dwordx4 v24, s[8:11], s32 offen lds
  s_sub_u32 s32, s2, 160
  s_lshl_b32 s32, s32, 3
  s_add_u32 s46, s32, s3
  v_mfma_f32_16x16x32_bf16 v[124:127], v[44:47], v[204:207], 0
  ds_read_b64_tr_b16 v[36:37], v17 offset:49152
  s_add_u32 s28, s98, 0x2600000
  s_addc_u32 s29, s99, 0
  s_and_b32 s29, s29, 0xffff
  s_mov_b32 s30, 0x190000
  s_mov_b32 s31, 0x00020000
  v_mfma_f32_16x16x32_bf16 v[128:131], v[192:195], v[48:51], 0
  ds_read_b64_tr_b16 v[38:39], v17 offset:50176
  v_mfma_f32_16x16x32_bf16 v[144:147], v[192:195], v[52:55], 0
  ds_read_b64_tr_b16 v[40:41], v18 offset:49152
  s_cmp_lt_u32 s46, 400
  s_cselect_b32 s30, s30, 0
  s_cselect_b32 s46, s46, 0
  v_mfma_f32_16x16x32_bf16 v[160:163], v[192:195], v[56:59], 0
  ds_read_b64_tr_b16 v[42:43], v18 offset:50176
  v_mfma_f32_16x16x32_bf16 v[176:179], v[192:195], v[60:63], 0
  ds_read_b128 v[192:195], v28 offset:0
  s_add_u32 m0, s59, 0x20400
  s_mov_b32 s32, 0x108000
  buffer_load_dwordx4 v24, s[8:11], s32 offen lds
  s_mul_i32 s47, s46, 6554
  s_lshr_b32 s47, s47, 16
  v_mfma_f32_16x16x32_bf16 v[132:135], v[196:199], v[48:51], 0
  s_setprio 2
  ds_read_b64_tr_b16 v[44:45], v19 offset:49152
  v_mfma_f32_16x16x32_bf16 v[148:151], v[196:199], v[52:55], 0
  ds_read_b64_tr_b16 v[46:47], v19 offset:50176
  s_mul_i32 s32, s47, 10
  s_sub_u32 s48, s46, s32
  v_mfma_f32_16x16x32_bf16 v[164:167], v[196:199], v[56:59], 0
  s_lshl_b32 s32, s48, 7
  v_lshl_add_u32 v14, v1, 1, s32
  v_mfma_f32_16x16x32_bf16 v[180:183], v[196:199], v[60:63], 0
  ds_read_b128 v[196:199], v28 offset:2048
  v_mfma_f32_16x16x32_bf16 v[136:139], v[200:203], v[48:51], 0
  global_load_ushort v240, v14, s[66:67]
  v_mfma_f32_16x16x32_bf16 v[152:155], v[200:203], v[52:55], 0
  v_mfma_f32_16x16x32_bf16 v[168:171], v[200:203], v[56:59], 0
  global_load_ushort v241, v14, s[68:69]
  v_mfma_f32_16x16x32_bf16 v[184:187], v[200:203], v[60:63], 0
  ds_read_b128 v[200:203], v28 offset:4096
  v_mfma_f32_16x16x32_bf16 v[140:143], v[204:207], v[48:51], 0
  s_setprio 1
  global_load_ushort v242, v14, s[78:79]
  v_mfma_f32_16x16x32_bf16 v[156:159], v[204:207], v[52:55], 0
  v_and_b32 v14, 15, v1
  s_lshl_b32 s33, s47, 4
  v_add_u32 v14, s33, v14
  v_mfma_f32_16x16x32_bf16 v[172:175], v[204:207], v[56:59], 0
  v_mfma_f32_16x16x32_bf16 v[188:191], v[204:207], v[60:63], 0
  ds_read_b128 v[204:207], v28 offset:6144
  v_mul_u32_u24 v14, 1280, v14
  s_waitcnt lgkmcnt(10)
  s_waitcnt lgkmcnt(5)
  v_mfma_f32_16x16x32_bf16 v[64:67], v[32:35], v[192:195], v[64:67]
  ds_read_b64_tr_b16 v[48:49], v16 offset:57344
  v_mfma_f32_16x16x32_bf16 v[68:71], v[36:39], v[192:195], v[68:71]
  ds_read_b64_tr_b16 v[50:51], v16 offset:58368
  v_lshrrev_b32 v6, 4, v1
  v_lshl_add_u32 v14, v6, 5, v14
  v_mfma_f32_16x16x32_bf16 v[96:99], v[40:43], v[192:195], v[96:99]
  ds_read_b64_tr_b16 v[52:53], v17 offset:57344
  s_waitcnt lgkmcnt(6)
  v_mfma_f32_16x16x32_bf16 v[100:103], v[44:47], v[192:195], v[100:103]
  ds_read_b64_tr_b16 v[54:55], v17 offset:58368
  s_lshl_b32 s32, s48, 7
  v_add_u32 v14, s32, v14
  s_waitcnt lgkmcnt(6)
  v_mfma_f32_16x16x32_bf16 v[72:75], v[32:35], v[196:199], v[72:75]
  s_setprio 0
  ds_read_b64_tr_b16 v[56:57], v18 offset:57344
  global_load_dwordx4 v[224:227], v14, s[74:75] offset:0
  v_mfma_f32_16x16x32_bf16 v[76:79], v[36:39], v[196:199], v[76:79]
  ds_read_b64_tr_b16 v[58:59], v18 offset:58368
  v_mfma_f32_16x16x32_bf16 v[104:107], v[40:43], v[196:199], v[104:107]
  ds_read_b64_tr_b16 v[60:61], v19 offset:57344
  global_load_dwordx4 v[228:231], v14, s[74:75] offset:16
  v_mfma_f32_16x16x32_bf16 v[108:111], v[44:47], v[196:199], v[108:111]
  ds_read_b64_tr_b16 v[62:63], v19 offset:58368
  s_waitcnt lgkmcnt(9)
  v_mfma_f32_16x16x32_bf16 v[80:83], v[32:35], v[200:203], v[80:83]
  global_load_dwordx4 v[232:235], v14, s[76:77] offset:0
  v_mfma_f32_16x16x32_bf16 v[84:87], v[36:39], v[200:203], v[84:87]
  v_mfma_f32_16x16x32_bf16 v[112:115], v[40:43], v[200:203], v[112:115]
  global_load_dwordx4 v[236:239], v14, s[76:77] offset:16
  v_mfma_f32_16x16x32_bf16 v[116:119], v[44:47], v[200:203], v[116:119]
  s_waitcnt lgkmcnt(8)
  v_mfma_f32_16x16x32_bf16 v[88:91], v[32:35], v[204:207], v[88:91]
  s_waitcnt lgkmcnt(0)
  s_waitcnt vmcnt(18)
  s_barrier
  s_setprio 3
  v_mfma_f32_16x16x32_bf16 v[92:95], v[36:39], v[204:207], v[92:95]
  ds_read_b64_tr_b16 v[32:33], v16 offset:0
  v_mfma_f32_16x16x32_bf16 v[120:123], v[40:43], v[204:207], v[120:123]
  ds_read_b64_tr_b16 v[34:35], v16 offset:1024
  s_add_u32 m0, s59, 0x24000
  s_mov_b32 s32, 0x140000
  buffer_load_dwordx4 v24, s[8:11], s32 offen lds
  v_mfma_f32_16x16x32_bf16 v[124:127], v[44:47], v[204:207], v[124:127]
  ds_read_b64_tr_b16 v[36:37], v17 offset:0
  v_mfma_f32_16x16x32_bf16 v[128:131], v[192:195], v[48:51], v[128:131]
  ds_read_b64_tr_b16 v[38:39], v17 offset:1024
  v_mfma_f32_16x16x32_bf16 v[144:147], v[192:195], v[52:55], v[144:147]
  ds_read_b64_tr_b16 v[40:41], v18 offset:0
  v_mfma_f32_16x16x32_bf16 v[160:163], v[192:195], v[56:59], v[160:163]
  ds_read_b64_tr_b16 v[42:43], v18 offset:1024
  s_mov_b32 s76, s96
  s_and_b32 s77, s97, 0xffff
  s_mov_b32 s78, 0x100
  s_mov_b32 s79, 0x00020000
  v_mfma_f32_16x16x32_bf16 v[176:179], v[192:195], v[60:63], v[176:179]
  ds_read_b128 v[192:195], v27 offset:32768
  s_add_u32 m0, s59, 0x24400
  s_mov_b32 s32, 0x148000
  buffer_load_dwordx4 v24, s[8:11], s32 offen lds
  v_mfma_f32_16x16x32_bf16 v[132:135], v[196:199], v[48:51], v[132:135]
  s_setprio 2
  ds_read_b64_tr_b16 v[44:45], v19 offset:0
  v_mfma_f32_16x16x32_bf16 v[148:151], v[196:199], v[52:55], v[148:151]
  ds_read_b64_tr_b16 v[46:47], v19 offset:1024
  v_mfma_f32_16x16x32_bf16 v[164:167], v[196:199], v[56:59], v[164:167]
  v_mfma_f32_16x16x32_bf16 v[180:183], v[196:199], v[60:63], v[180:183]
  ds_read_b128 v[196:199], v27 offset:34816
  v_mfma_f32_16x16x32_bf16 v[136:139], v[200:203], v[48:51], v[136:139]
  s_add_u32 m0, s58, 0x0
  s_movk_i32 s33, 0x180
  buffer_load_dwordx4 v25, s[4:7], s33 offen lds
  v_mfma_f32_16x16x32_bf16 v[152:155], v[200:203], v[52:55], v[152:155]
  v_mfma_f32_16x16x32_bf16 v[168:171], v[200:203], v[56:59], v[168:171]
  v_mfma_f32_16x16x32_bf16 v[184:187], v[200:203], v[60:63], v[184:187]
  ds_read_b128 v[200:203], v27 offset:36864
  v_mfma_f32_16x16x32_bf16 v[140:143], v[204:207], v[48:51], v[140:143]
  s_setprio 1
  v_mfma_f32_16x16x32_bf16 v[156:159], v[204:207], v[52:55], v[156:159]
  s_add_u32 m0, s58, 0x400
  s_movk_i32 s33, 0x180
  buffer_load_dwordx4 v26, s[4:7], s33 offen lds
  v_mfma_f32_16x16x32_bf16 v[172:175], v[204:207], v[56:59], v[172:175]
  v_mfma_f32_16x16x32_bf16 v[188:191], v[204:207], v[60:63], v[188:191]
  ds_read_b128 v[204:207], v27 offset:38912
  s_waitcnt lgkmcnt(10)
  s_waitcnt lgkmcnt(5)
  v_mfma_f32_16x16x32_bf16 v[64:67], v[32:35], v[192:195], v[64:67]
  ds_read_b64_tr_b16 v[48:49], v16 offset:8192
  v_mfma_f32_16x16x32_bf16 v[68:71], v[36:39], v[192:195], v[68:71]
  ds_read_b64_tr_b16 v[50:51], v16 offset:9216
  v_mfma_f32_16x16x32_bf16 v[96:99], v[40:43], v[192:195], v[96:99]
  ds_read_b64_tr_b16 v[52:53], v17 offset:8192
  s_waitcnt lgkmcnt(6)
  v_mfma_f32_16x16x32_bf16 v[100:103], v[44:47], v[192:195], v[100:103]
  ds_read_b64_tr_b16 v[54:55], v17 offset:9216
  s_waitcnt lgkmcnt(6)
  v_mfma_f32_16x16x32_bf16 v[72:75], v[32:35], v[196:199], v[72:75]
  s_setprio 0
  ds_read_b64_tr_b16 v[56:57], v18 offset:8192
  v_mfma_f32_16x16x32_bf16 v[76:79], v[36:39], v[196:199], v[76:79]
  ds_read_b64_tr_b16 v[58:59], v18 offset:9216
  v_mfma_f32_16x16x32_bf16 v[104:107], v[40:43], v[196:199], v[104:107]
  ds_read_b64_tr_b16 v[60:61], v19 offset:8192
  v_mfma_f32_16x16x32_bf16 v[108:111], v[44:47], v[196:199], v[108:111]
  ds_read_b64_tr_b16 v[62:63], v19 offset:9216
  s_waitcnt lgkmcnt(9)
  v_mfma_f32_16x16x32_bf16 v[80:83], v[32:35], v[200:203], v[80:83]
  v_mfma_f32_16x16x32_bf16 v[84:87], v[36:39], v[200:203], v[84:87]
  v_mfma_f32_16x16x32_bf16 v[112:115], v[40:43], v[200:203], v[112:115]
  v_mfma_f32_16x16x32_bf16 v[116:119], v[44:47], v[200:203], v[116:119]
  s_waitcnt lgkmcnt(8)
  v_mfma_f32_16x16x32_bf16 v[88:91], v[32:35], v[204:207], v[88:91]
  s_waitcnt lgkmcnt(0)
  s_waitcnt vmcnt(13)
  s_barrier
  s_setprio 3
  s_sub_u32 s33, s2, 242
  s_cselect_b32 s33, 64, s33
  s_lshl_b32 s33, s33, 4
  v_mov_b32 v14, 1
  buffer_store_dword v14, v13, s[76:79], s33 offen sc1
  v_mfma_f32_16x16x32_bf16 v[92:95], v[36:39], v[204:207], v[92:95]
  ds_read_b64_tr_b16 v[32:33], v16 offset:16384
  v_mfma_f32_16x16x32_bf16 v[120:123], v[40:43], v[204:207], v[120:123]
  ds_read_b64_tr_b16 v[34:35], v16 offset:17408
  s_add_u32 m0, s59, 0x18000
  s_mov_b32 s32, 0x180000
  buffer_load_dwordx4 v24, s[8:11], s32 offen lds
  v_mfma_f32_16x16x32_bf16 v[124:127], v[44:47], v[204:207], v[124:127]
  ds_read_b64_tr_b16 v[36:37], v17 offset:16384
  v_mfma_f32_16x16x32_bf16 v[128:131], v[192:195], v[48:51], v[128:131]
  ds_read_b64_tr_b16 v[38:39], v17 offset:17408
  v_mfma_f32_16x16x32_bf16 v[144:147], v[192:195], v[52:55], v[144:147]
  ds_read_b64_tr_b16 v[40:41], v18 offset:16384
  v_mfma_f32_16x16x32_bf16 v[160:163], v[192:195], v[56:59], v[160:163]
  ds_read_b64_tr_b16 v[42:43], v18 offset:17408
  v_mfma_f32_16x16x32_bf16 v[176:179], v[192:195], v[60:63], v[176:179]
  ds_read_b128 v[192:195], v28 offset:32768
  s_add_u32 m0, s59, 0x18400
  s_mov_b32 s32, 0x188000
  buffer_load_dwordx4 v24, s[8:11], s32 offen lds
  v_mfma_f32_16x16x32_bf16 v[132:135], v[196:199], v[48:51], v[132:135]
  s_setprio 2
  ds_read_b64_tr_b16 v[44:45], v19 offset:16384
  v_mfma_f32_16x16x32_bf16 v[148:151], v[196:199], v[52:55], v[148:151]
  ds_read_b64_tr_b16 v[46:47], v19 offset:17408
  v_mfma_f32_16x16x32_bf16 v[164:167], v[196:199], v[56:59], v[164:167]
  v_mfma_f32_16x16x32_bf16 v[180:183], v[196:199], v[60:63], v[180:183]
  ds_read_b128 v[196:199], v28 offset:34816
  v_mfma_f32_16x16x32_bf16 v[136:139], v[200:203], v[48:51], v[136:139]
  s_add_u32 m0, s58, 0x800
  s_movk_i32 s33, 0x4180
  buffer_load_dwordx4 v25, s[4:7], s33 offen lds
  v_mfma_f32_16x16x32_bf16 v[152:155], v[200:203], v[52:55], v[152:155]
  v_mfma_f32_16x16x32_bf16 v[168:171], v[200:203], v[56:59], v[168:171]
  v_mfma_f32_16x16x32_bf16 v[184:187], v[200:203], v[60:63], v[184:187]
  ds_read_b128 v[200:203], v28 offset:36864
  v_mfma_f32_16x16x32_bf16 v[140:143], v[204:207], v[48:51], v[140:143]
  s_setprio 1
  v_mfma_f32_16x16x32_bf16 v[156:159], v[204:207], v[52:55], v[156:159]
  s_add_u32 m0, s58, 0xc00
  s_movk_i32 s33, 0x4180
  buffer_load_dwordx4 v26, s[4:7], s33 offen lds
  v_mfma_f32_16x16x32_bf16 v[172:175], v[204:207], v[56:59], v[172:175]
  v_mfma_f32_16x16x32_bf16 v[188:191], v[204:207], v[60:63], v[188:191]
  ds_read_b128 v[204:207], v28 offset:38912
  s_waitcnt lgkmcnt(10)
  s_waitcnt lgkmcnt(5)
  v_mfma_f32_16x16x32_bf16 v[64:67], v[32:35], v[192:195], v[64:67]
  ds_read_b64_tr_b16 v[48:49], v16 offset:24576
  v_mfma_f32_16x16x32_bf16 v[68:71], v[36:39], v[192:195], v[68:71]
  ds_read_b64_tr_b16 v[50:51], v16 offset:25600
  v_mfma_f32_16x16x32_bf16 v[96:99], v[40:43], v[192:195], v[96:99]
  ds_read_b64_tr_b16 v[52:53], v17 offset:24576
  s_waitcnt lgkmcnt(6)
  v_mfma_f32_16x16x32_bf16 v[100:103], v[44:47], v[192:195], v[100:103]
  ds_read_b64_tr_b16 v[54:55], v17 offset:25600
  s_waitcnt lgkmcnt(6)
  v_mfma_f32_16x16x32_bf16 v[72:75], v[32:35], v[196:199], v[72:75]
  s_setprio 0
  ds_read_b64_tr_b16 v[56:57], v18 offset:24576
  v_mfma_f32_16x16x32_bf16 v[76:79], v[36:39], v[196:199], v[76:79]
  ds_read_b64_tr_b16 v[58:59], v18 offset:25600
  v_mfma_f32_16x16x32_bf16 v[104:107], v[40:43], v[196:199], v[104:107]
  ds_read_b64_tr_b16 v[60:61], v19 offset:24576
  v_mfma_f32_16x16x32_bf16 v[108:111], v[44:47], v[196:199], v[108:111]
  ds_read_b64_tr_b16 v[62:63], v19 offset:25600
  s_waitcnt lgkmcnt(9)
  v_mfma_f32_16x16x32_bf16 v[80:83], v[32:35], v[200:203], v[80:83]
  v_mfma_f32_16x16x32_bf16 v[84:87], v[36:39], v[200:203], v[84:87]
  v_mfma_f32_16x16x32_bf16 v[112:115], v[40:43], v[200:203], v[112:115]
  v_mfma_f32_16x16x32_bf16 v[116:119], v[44:47], v[200:203], v[116:119]
  s_waitcnt lgkmcnt(8)
  v_mfma_f32_16x16x32_bf16 v[88:91], v[32:35], v[204:207], v[88:91]
  s_waitcnt lgkmcnt(0)
  s_waitcnt vmcnt(16)
  s_barrier
  s_setprio 3
  v_mfma_f32_16x16x32_bf16 v[92:95], v[36:39], v[204:207], v[92:95]
  ds_read_b64_tr_b16 v[32:33], v16 offset:32768
  v_mfma_f32_16x16x32_bf16 v[120:123], v[40:43], v[204:207], v[120:123]
  ds_read_b64_tr_b16 v[34:35], v16 offset:33792
  s_add_u32 m0, s59, 0x1c000
  s_mov_b32 s32, 0x1c0000
  buffer_load_dwordx4 v24, s[8:11], s32 offen lds
  v_mfma_f32_16x16x32_bf16 v[124:127], v[44:47], v[204:207], v[124:127]
  ds_read_b64_tr_b16 v[36:37], v17 offset:32768
  v_mfma_f32_16x16x32_bf16 v[128:131], v[192:195], v[48:51], v[128:131]
  ds_read_b64_tr_b16 v[38:39], v17 offset:33792
  v_mfma_f32_16x16x32_bf16 v[144:147], v[192:195], v[52:55], v[144:147]
  ds_read_b64_tr_b16 v[40:41], v18 offset:32768
  v_mfma_f32_16x16x32_bf16 v[160:163], v[192:195], v[56:59], v[160:163]
  ds_read_b64_tr_b16 v[42:43], v18 offset:33792
  v_mfma_f32_16x16x32_bf16 v[176:179], v[192:195], v[60:63], v[176:179]
  ds_read_b128 v[192:195], v29 offset:0
  s_add_u32 m0, s59, 0x1c400
  s_mov_b32 s32, 0x1c8000
  buffer_load_dwordx4 v24, s[8:11], s32 offen lds
  v_mfma_f32_16x16x32_bf16 v[132:135], v[196:199], v[48:51], v[132:135]
  s_setprio 2
  ds_read_b64_tr_b16 v[44:45], v19 offset:32768
  v_mfma_f32_16x16x32_bf16 v[148:151], v[196:199], v[52:55], v[148:151]
  ds_read_b64_tr_b16 v[46:47], v19 offset:33792
  v_mfma_f32_16x16x32_bf16 v[164:167], v[196:199], v[56:59], v[164:167]
  v_mfma_f32_16x16x32_bf16 v[180:183], v[196:199], v[60:63], v[180:183]
  ds_read_b128 v[196:199], v29 offset:2048
  v_mfma_f32_16x16x32_bf16 v[136:139], v[200:203], v[48:51], v[136:139]
  s_add_u32 m0, s58, 0x8000
  s_movk_i32 s33, 0x200
  buffer_load_dwordx4 v25, s[4:7], s33 offen lds
  v_mfma_f32_16x16x32_bf16 v[152:155], v[200:203], v[52:55], v[152:155]
  v_mfma_f32_16x16x32_bf16 v[168:171], v[200:203], v[56:59], v[168:171]
  v_mfma_f32_16x16x32_bf16 v[184:187], v[200:203], v[60:63], v[184:187]
  ds_read_b128 v[200:203], v29 offset:4096
  v_mfma_f32_16x16x32_bf16 v[140:143], v[204:207], v[48:51], v[140:143]
  s_setprio 1
  v_mfma_f32_16x16x32_bf16 v[156:159], v[204:207], v[52:55], v[156:159]
  s_add_u32 m0, s58, 0x8400
  s_movk_i32 s33, 0x200
  buffer_load_dwordx4 v26, s[4:7], s33 offen lds
  v_mfma_f32_16x16x32_bf16 v[172:175], v[204:207], v[56:59], v[172:175]
  v_mfma_f32_16x16x32_bf16 v[188:191], v[204:207], v[60:63], v[188:191]
  ds_read_b128 v[204:207], v29 offset:6144
  s_waitcnt lgkmcnt(10)
  s_waitcnt lgkmcnt(5)
  v_mfma_f32_16x16x32_bf16 v[64:67], v[32:35], v[192:195], v[64:67]
  ds_read_b64_tr_b16 v[48:49], v16 offset:40960
  v_mfma_f32_16x16x32_bf16 v[68:71], v[36:39], v[192:195], v[68:71]
  ds_read_b64_tr_b16 v[50:51], v16 offset:41984
  v_mfma_f32_16x16x32_bf16 v[96:99], v[40:43], v[192:195], v[96:99]
  ds_read_b64_tr_b16 v[52:53], v17 offset:40960
  s_waitcnt lgkmcnt(6)
  v_mfma_f32_16x16x32_bf16 v[100:103], v[44:47], v[192:195], v[100:103]
  ds_read_b64_tr_b16 v[54:55], v17 offset:41984
  s_waitcnt lgkmcnt(6)
  v_mfma_f32_16x16x32_bf16 v[72:75], v[32:35], v[196:199], v[72:75]
  s_setprio 0
  ds_read_b64_tr_b16 v[56:57], v18 offset:40960
  v_mfma_f32_16x16x32_bf16 v[76:79], v[36:39], v[196:199], v[76:79]
  ds_read_b64_tr_b16 v[58:59], v18 offset:41984
  v_mfma_f32_16x16x32_bf16 v[104:107], v[40:43], v[196:199], v[104:107]
  ds_read_b64_tr_b16 v[60:61], v19 offset:40960
  v_mfma_f32_16x16x32_bf16 v[108:111], v[44:47], v[196:199], v[108:111]
  ds_read_b64_tr_b16 v[62:63], v19 offset:41984
  s_waitcnt lgkmcnt(9)
  v_mfma_f32_16x16x32_bf16 v[80:83], v[32:35], v[200:203], v[80:83]
  v_mfma_f32_16x16x32_bf16 v[84:87], v[36:39], v[200:203], v[84:87]
  v_mfma_f32_16x16x32_bf16 v[112:115], v[40:43], v[200:203], v[112:115]
  v_mfma_f32_16x16x32_bf16 v[116:119], v[44:47], v[200:203], v[116:119]
  s_waitcnt lgkmcnt(8)
  v_mfma_f32_16x16x32_bf16 v[88:91], v[32:35], v[204:207], v[88:91]
  s_waitcnt lgkmcnt(0)
  s_waitcnt vmcnt(11)
  s_barrier
  s_setprio 3
  v_mfma_f32_16x16x32_bf16 v[92:95], v[36:39], v[204:207], v[92:95]
  ds_read_b64_tr_b16 v[32:33], v16 offset:49152
  v_mfma_f32_16x16x32_bf16 v[120:123], v[40:43], v[204:207], v[120:123]
  ds_read_b64_tr_b16 v[34:35], v16 offset:50176
  s_add_u32 m0, s59, 0x20000
  s_mov_b32 s32, 0x200000
  buffer_load_dwordx4 v24, s[8:11], s32 offen lds
  v_mfma_f32_16x16x32_bf16 v[124:127], v[44:47], v[204:207], v[124:127]
  ds_read_b64_tr_b16 v[36:37], v17 offset:49152
  v_mfma_f32_16x16x32_bf16 v[128:131], v[192:195], v[48:51], v[128:131]
  ds_read_b64_tr_b16 v[38:39], v17 offset:50176
  v_mfma_f32_16x16x32_bf16 v[144:147], v[192:195], v[52:55], v[144:147]
  ds_read_b64_tr_b16 v[40:41], v18 offset:49152
  v_mfma_f32_16x16x32_bf16 v[160:163], v[192:195], v[56:59], v[160:163]
  ds_read_b64_tr_b16 v[42:43], v18 offset:50176
  v_mfma_f32_16x16x32_bf16 v[176:179], v[192:195], v[60:63], v[176:179]
  ds_read_b128 v[192:195], v30 offset:0
  s_add_u32 m0, s59, 0x20400
  s_mov_b32 s32, 0x208000
  buffer_load_dwordx4 v24, s[8:11], s32 offen lds
  v_mfma_f32_16x16x32_bf16 v[132:135], v[196:199], v[48:51], v[132:135]
  s_setprio 2
  ds_read_b64_tr_b16 v[44:45], v19 offset:49152
  v_mfma_f32_16x16x32_bf16 v[148:151], v[196:199], v[52:55], v[148:151]
  ds_read_b64_tr_b16 v[46:47], v19 offset:50176
  v_mfma_f32_16x16x32_bf16 v[164:167], v[196:199], v[56:59], v[164:167]
  v_mfma_f32_16x16x32_bf16 v[180:183], v[196:199], v[60:63], v[180:183]
  ds_read_b128 v[196:199], v30 offset:2048
  v_lshlrev_b32 v240, 16, v240
  v_mfma_f32_16x16x32_bf16 v[136:139], v[200:203], v[48:51], v[136:139]
  s_add_u32 m0, s58, 0x8800
  s_movk_i32 s33, 0x4200
  buffer_load_dwordx4 v25, s[4:7], s33 offen lds
  v_mfma_f32_16x16x32_bf16 v[152:155], v[200:203], v[52:55], v[152:155]
  v_lshlrev_b32 v241, 16, v241
  v_mfma_f32_16x16x32_bf16 v[168:171], v[200:203], v[56:59], v[168:171]
  v_lshlrev_b32 v242, 16, v242
  v_mfma_f32_16x16x32_bf16 v[184:187], v[200:203], v[60:63], v[184:187]
  ds_read_b128 v[200:203], v30 offset:4096
  v_mfma_f32_16x16x32_bf16 v[140:143], v[204:207], v[48:51], v[140:143]
  s_setprio 1
  v_mul_f32 v242, 0x3fb8aa3b, v242
  v_mfma_f32_16x16x32_bf16 v[156:159], v[204:207], v[52:55], v[156:159]
  s_add_u32 m0, s58, 0x8c00
  s_movk_i32 s33, 0x4200
  buffer_load_dwordx4 v26, s[4:7], s33 offen lds
  v_exp_f32 v242, v242
  v_mfma_f32_16x16x32_bf16 v[172:175], v[204:207], v[56:59], v[172:175]
  v_mfma_f32_16x16x32_bf16 v[188:191], v[204:207], v[60:63], v[188:191]
  ds_read_b128 v[204:207], v30 offset:6144
  v_cvt_pk_bf16_f32 v242, v242, v242
  s_waitcnt lgkmcnt(10)
  s_waitcnt lgkmcnt(5)
  v_mfma_f32_16x16x32_bf16 v[64:67], v[32:35], v[192:195], v[64:67]
  ds_read_b64_tr_b16 v[48:49], v16 offset:57344
  v_lshlrev_b32 v242, 16, v242
  v_mfma_f32_16x16x32_bf16 v[68:71], v[36:39], v[192:195], v[68:71]
  ds_read_b64_tr_b16 v[50:51], v16 offset:58368
  v_mfma_f32_16x16x32_bf16 v[96:99], v[40:43], v[192:195], v[96:99]
  ds_read_b64_tr_b16 v[52:53], v17 offset:57344
  v_mul_f32 v243, v242, v240
  s_waitcnt lgkmcnt(6)
  v_mfma_f32_16x16x32_bf16 v[100:103], v[44:47], v[192:195], v[100:103]
  ds_read_b64_tr_b16 v[54:55], v17 offset:58368
  v_mul_f32 v244, v242, v241
  s_waitcnt lgkmcnt(6)
  v_mfma_f32_16x16x32_bf16 v[72:75], v[32:35], v[196:199], v[72:75]
  s_setprio 0
  ds_read_b64_tr_b16 v[56:57], v18 offset:57344
  v_mfma_f32_16x16x32_bf16 v[76:79], v[36:39], v[196:199], v[76:79]
  ds_read_b64_tr_b16 v[58:59], v18 offset:58368
  v_mul_f32 v243, 0x3fb8aa3b, v243
  v_mfma_f32_16x16x32_bf16 v[104:107], v[40:43], v[196:199], v[104:107]
  ds_read_b64_tr_b16 v[60:61], v19 offset:57344
  v_mul_f32 v244, 0x3e22f983, v244
  v_mfma_f32_16x16x32_bf16 v[108:111], v[44:47], v[196:199], v[108:111]
  ds_read_b64_tr_b16 v[62:63], v19 offset:58368
  s_waitcnt lgkmcnt(9)
  v_mfma_f32_16x16x32_bf16 v[80:83], v[32:35], v[200:203], v[80:83]
  v_exp_f32 v243, v243
  v_mfma_f32_16x16x32_bf16 v[84:87], v[36:39], v[200:203], v[84:87]
  v_cos_f32 v245, v244
  v_mfma_f32_16x16x32_bf16 v[112:115], v[40:43], v[200:203], v[112:115]
  v_mfma_f32_16x16x32_bf16 v[116:119], v[44:47], v[200:203], v[116:119]
  v_sin_f32 v244, v244
  s_waitcnt lgkmcnt(8)
  v_mfma_f32_16x16x32_bf16 v[88:91], v[32:35], v[204:207], v[88:91]
  s_waitcnt lgkmcnt(0)
  s_waitcnt vmcnt(8)
  s_barrier
  s_setprio 3
  v_fma_f32 v245, v243, v245, -1.0
  v_mfma_f32_16x16x32_bf16 v[92:95], v[36:39], v[204:207], v[92:95]
  ds_read_b64_tr_b16 v[32:33], v16 offset:0
  v_mfma_f32_16x16x32_bf16 v[120:123], v[40:43], v[204:207], v[120:123]
  ds_read_b64_tr_b16 v[34:35], v16 offset:1024
  s_add_u32 m0, s59, 0x24000
  s_mov_b32 s32, 0x240000
  buffer_load_dwordx4 v24, s[8:11], s32 offen lds
  v_mul_f32 v244, v243, v244
  v_mfma_f32_16x16x32_bf16 v[124:127], v[44:47], v[204:207], v[124:127]
  ds_read_b64_tr_b16 v[36:37], v17 offset:0
  v_mul_f32 v246, v240, v240
  v_mfma_f32_16x16x32_bf16 v[128:131], v[192:195], v[48:51], v[128:131]
  ds_read_b64_tr_b16 v[38:39], v17 offset:1024
  v_mfma_f32_16x16x32_bf16 v[144:147], v[192:195], v[52:55], v[144:147]
  ds_read_b64_tr_b16 v[40:41], v18 offset:0
  v_fmac_f32 v246, v241, v241
  v_mfma_f32_16x16x32_bf16 v[160:163], v[192:195], v[56:59], v[160:163]
  ds_read_b64_tr_b16 v[42:43], v18 offset:1024
  v_rcp_f32 v246, v246
  v_mfma_f32_16x16x32_bf16 v[176:179], v[192:195], v[60:63], v[176:179]
  ds_read_b128 v[192:195], v27 offset:0
  s_add_u32 m0, s59, 0x24400
  s_mov_b32 s32, 0x248000
  buffer_load_dwordx4 v24, s[8:11], s32 offen lds
  v_mfma_f32_16x16x32_bf16 v[132:135], v[196:199], v[48:51], v[132:135]
  s_setprio 2
  ds_read_b64_tr_b16 v[44:45], v19 offset:0
  v_add_f32 v246, v246, v246
  v_mfma_f32_16x16x32_bf16 v[148:151], v[196:199], v[52:55], v[148:151]
  ds_read_b64_tr_b16 v[46:47], v19 offset:1024
  v_mul_f32 v247, v245, v240
  v_mfma_f32_16x16x32_bf16 v[164:167], v[196:199], v[56:59], v[164:167]
  v_mfma_f32_16x16x32_bf16 v[180:183], v[196:199], v[60:63], v[180:183]
  ds_read_b128 v[196:199], v27 offset:2048
  v_fmac_f32 v247, v244, v241
  v_mfma_f32_16x16x32_bf16 v[136:139], v[200:203], v[48:51], v[136:139]
  s_add_u32 m0, s58, 0x10000
  s_movk_i32 s33, 0x280
  buffer_load_dwordx4 v25, s[4:7], s33 offen lds
  v_mul_f32 v243, v244, v240
  v_mfma_f32_16x16x32_bf16 v[152:155], v[200:203], v[52:55], v[152:155]
  v_mfma_f32_16x16x32_bf16 v[168:171], v[200:203], v[56:59], v[168:171]
  v_fma_f32 v243, -v245, v241, v243
  v_mfma_f32_16x16x32_bf16 v[184:187], v[200:203], v[60:63], v[184:187]
  ds_read_b128 v[200:203], v27 offset:4096
  v_mul_f32 v240, v247, v246
  v_mfma_f32_16x16x32_bf16 v[140:143], v[204:207], v[48:51], v[140:143]
  s_setprio 1
  v_mfma_f32_16x16x32_bf16 v[156:159], v[204:207], v[52:55], v[156:159]
  s_add_u32 m0, s58, 0x10400
  s_movk_i32 s33, 0x280
  buffer_load_dwordx4 v26, s[4:7], s33 offen lds
  v_mul_f32 v241, -v247, v246
  v_mfma_f32_16x16x32_bf16 v[172:175], v[204:207], v[56:59], v[172:175]
  v_mul_f32 v242, -v243, v246
  v_mfma_f32_16x16x32_bf16 v[188:191], v[204:207], v[60:63], v[188:191]
  ds_read_b128 v[204:207], v27 offset:6144
  s_waitcnt lgkmcnt(10)
  s_waitcnt lgkmcnt(5)
  v_mfma_f32_16x16x32_bf16 v[64:67], v[32:35], v[192:195], v[64:67]
  ds_read_b64_tr_b16 v[48:49], v16 offset:8192
  s_mul_i32 s32, s47, 6554
  s_lshr_b32 s32, s32, 16
  s_mul_i32 s33, s32, 390
  s_add_u32 s33, s33, s47
  s_mul_i32 s32, s48, 40
  s_add_u32 s33, s33, s32
  s_lshl_b32 s46, s33, 10
  v_mfma_f32_16x16x32_bf16 v[68:71], v[36:39], v[192:195], v[68:71]
  ds_read_b64_tr_b16 v[50:51], v16 offset:9216
  v_mfma_f32_16x16x32_bf16 v[96:99], v[40:43], v[192:195], v[96:99]
  ds_read_b64_tr_b16 v[52:53], v17 offset:8192
  v_lshlrev_b32 v6, 16, v224
  s_waitcnt lgkmcnt(6)
  v_mfma_f32_16x16x32_bf16 v[100:103], v[44:47], v[192:195], v[100:103]
  ds_read_b64_tr_b16 v[54:55], v17 offset:9216
  v_lshlrev_b32 v7, 16, v232
  s_waitcnt lgkmcnt(6)
  v_mfma_f32_16x16x32_bf16 v[72:75], v[32:35], v[196:199], v[72:75]
  s_setprio 0
  ds_read_b64_tr_b16 v[56:57], v18 offset:8192
  v_mfma_f32_16x16x32_bf16 v[76:79], v[36:39], v[196:199], v[76:79]
  ds_read_b64_tr_b16 v[58:59], v18 offset:9216
  v_mul_f32_dpp v8, v240, v6 row_newbcast:0 row_mask:0xf bank_mask:0xf
  v_mfma_f32_16x16x32_bf16 v[104:107], v[40:43], v[196:199], v[104:107]
  ds_read_b64_tr_b16 v[60:61], v19 offset:8192
  v_mul_f32_dpp v10, v241, v7 row_newbcast:0 row_mask:0xf bank_mask:0xf
  v_mfma_f32_16x16x32_bf16 v[108:111], v[44:47], v[196:199], v[108:111]
  ds_read_b64_tr_b16 v[62:63], v19 offset:9216
  s_waitcnt lgkmcnt(9)
  v_mfma_f32_16x16x32_bf16 v[80:83], v[32:35], v[200:203], v[80:83]
  v_fmac_f32_dpp v8, v242, v7 row_newbcast:0 row_mask:0xf bank_mask:0xf
  v_mfma_f32_16x16x32_bf16 v[84:87], v[36:39], v[200:203], v[84:87]
  v_fmac_f32_dpp v10, v242, v6 row_newbcast:0 row_mask:0xf bank_mask:0xf
  v_mfma_f32_16x16x32_bf16 v[112:115], v[40:43], v[200:203], v[112:115]
  v_mfma_f32_16x16x32_bf16 v[116:119], v[44:47], v[200:203], v[116:119]
  v_and_b32 v6, 0xffff0000, v224
  s_waitcnt lgkmcnt(8)
  v_mfma_f32_16x16x32_bf16 v[88:91], v[32:35], v[204:207], v[88:91]
  s_waitcnt lgkmcnt(0)
  s_waitcnt vmcnt(10)
  s_barrier
  s_setprio 3
  v_and_b32 v7, 0xffff0000, v232
  v_mfma_f32_16x16x32_bf16 v[92:95], v[36:39], v[204:207], v[92:95]
  ds_read_b64_tr_b16 v[32:33], v16 offset:16384
  v_mfma_f32_16x16x32_bf16 v[120:123], v[40:43], v[204:207], v[120:123]
  ds_read_b64_tr_b16 v[34:35], v16 offset:17408
  s_add_u32 m0, s59, 0x18000
  s_mov_b32 s32, 0x280000
  buffer_load_dwordx4 v24, s[8:11], s32 offen lds
  v_mul_f32_dpp v9, v240, v6 row_newbcast:1 row_mask:0xf bank_mask:0xf
  v_mfma_f32_16x16x32_bf16 v[124:127], v[44:47], v[204:207], v[124:127]
  ds_read_b64_tr_b16 v[36:37], v17 offset:16384
  v_mul_f32_dpp v11, v241, v7 row_newbcast:1 row_mask:0xf bank_mask:0xf
  v_mfma_f32_16x16x32_bf16 v[128:131], v[192:195], v[48:51], v[128:131]
  ds_read_b64_tr_b16 v[38:39], v17 offset:17408
  v_mfma_f32_16x16x32_bf16 v[144:147], v[192:195], v[52:55], v[144:147]
  ds_read_b64_tr_b16 v[40:41], v18 offset:16384
  v_fmac_f32_dpp v9, v242, v7 row_newbcast:1 row_mask:0xf bank_mask:0xf
  v_mfma_f32_16x16x32_bf16 v[160:163], v[192:195], v[56:59], v[160:163]
  ds_read_b64_tr_b16 v[42:43], v18 offset:17408
  v_fmac_f32_dpp v11, v242, v6 row_newbcast:1 row_mask:0xf bank_mask:0xf
  v_mfma_f32_16x16x32_bf16 v[176:179], v[192:195], v[60:63], v[176:179]
  ds_read_b128 v[192:195], v28 offset:0
  s_add_u32 m0, s59, 0x18400
  s_mov_b32 s32, 0x288000
  buffer_load_dwordx4 v24, s[8:11], s32 offen lds
  v_mfma_f32_16x16x32_bf16 v[132:135], v[196:199], v[48:51], v[132:135]
  s_setprio 2
  ds_read_b64_tr_b16 v[44:45], v19 offset:16384
  v_cvt_pk_bf16_f32 v248, v8, v9
  v_mfma_f32_16x16x32_bf16 v[148:151], v[196:199], v[52:55], v[148:151]
  ds_read_b64_tr_b16 v[46:47], v19 offset:17408
  v_cvt_pk_bf16_f32 v250, v10, v11
  v_mfma_f32_16x16x32_bf16 v[164:167], v[196:199], v[56:59], v[164:167]
  v_mfma_f32_16x16x32_bf16 v[180:183], v[196:199], v[60:63], v[180:183]
  ds_read_b128 v[196:199], v28 offset:2048
  v_lshlrev_b32 v6, 16, v225
  v_mfma_f32_16x16x32_bf16 v[136:139], v[200:203], v[48:51], v[136:139]
  s_add_u32 m0, s58, 0x10800
  s_movk_i32 s33, 0x4280
  buffer_load_dwordx4 v25, s[4:7], s33 offen lds
  v_lshlrev_b32 v7, 16, v233
  v_mfma_f32_16x16x32_bf16 v[152:155], v[200:203], v[52:55], v[152:155]
  v_mfma_f32_16x16x32_bf16 v[168:171], v[200:203], v[56:59], v[168:171]
  v_mul_f32_dpp v8, v240, v6 row_newbcast:2 row_mask:0xf bank_mask:0xf
  v_mfma_f32_16x16x32_bf16 v[184:187], v[200:203], v[60:63], v[184:187]
  ds_read_b128 v[200:203], v28 offset:4096
  v_mul_f32_dpp v10, v241, v7 row_newbcast:2 row_mask:0xf bank_mask:0xf
  v_mfma_f32_16x16x32_bf16 v[140:143], v[204:207], v[48:51], v[140:143]
  s_setprio 1
  v_mfma_f32_16x16x32_bf16 v[156:159], v[204:207], v[52:55], v[156:159]
  s_add_u32 m0, s58, 0x10c00
  s_movk_i32 s33, 0x4280
  buffer_load_dwordx4 v26, s[4:7], s33 offen lds
  v_fmac_f32_dpp v8, v242, v7 row_newbcast:2 row_mask:0xf bank_mask:0xf
  v_mfma_f32_16x16x32_bf16 v[172:175], v[204:207], v[56:59], v[172:175]
  v_fmac_f32_dpp v10, v242, v6 row_newbcast:2 row_mask:0xf bank_mask:0xf
  v_mfma_f32_16x16x32_bf16 v[188:191], v[204:207], v[60:63], v[188:191]
  ds_read_b128 v[204:207], v28 offset:6144
  s_waitcnt lgkmcnt(10)
  s_waitcnt lgkmcnt(5)
  v_mfma_f32_16x16x32_bf16 v[64:67], v[32:35], v[192:195], v[64:67]
  ds_read_b64_tr_b16 v[48:49], v16 offset:24576
  v_and_b32 v6, 0xffff0000, v225
  v_mfma_f32_16x16x32_bf16 v[68:71], v[36:39], v[192:195], v[68:71]
  ds_read_b64_tr_b16 v[50:51], v16 offset:25600
  v_and_b32 v7, 0xffff0000, v233
  v_mfma_f32_16x16x32_bf16 v[96:99], v[40:43], v[192:195], v[96:99]
  ds_read_b64_tr_b16 v[52:53], v17 offset:24576
  s_waitcnt lgkmcnt(6)
  v_mfma_f32_16x16x32_bf16 v[100:103], v[44:47], v[192:195], v[100:103]
  ds_read_b64_tr_b16 v[54:55], v17 offset:25600
  v_mul_f32_dpp v9, v240, v6 row_newbcast:3 row_mask:0xf bank_mask:0xf
  s_waitcnt lgkmcnt(6)
  v_mfma_f32_16x16x32_bf16 v[72:75], v[32:35], v[196:199], v[72:75]
  s_setprio 0
  ds_read_b64_tr_b16 v[56:57], v18 offset:24576
  v_mul_f32_dpp v11, v241, v7 row_newbcast:3 row_mask:0xf bank_mask:0xf
  v_mfma_f32_16x16x32_bf16 v[76:79], v[36:39], v[196:199], v[76:79]
  ds_read_b64_tr_b16 v[58:59], v18 offset:25600
  v_mfma_f32_16x16x32_bf16 v[104:107], v[40:43], v[196:199], v[104:107]
  ds_read_b64_tr_b16 v[60:61], v19 offset:24576
  v_fmac_f32_dpp v9, v242, v7 row_newbcast:3 row_mask:0xf bank_mask:0xf
  v_mfma_f32_16x16x32_bf16 v[108:111], v[44:47], v[196:199], v[108:111]
  ds_read_b64_tr_b16 v[62:63], v19 offset:25600
  v_fmac_f32_dpp v11, v242, v6 row_newbcast:3 row_mask:0xf bank_mask:0xf
  s_waitcnt lgkmcnt(9)
  v_mfma_f32_16x16x32_bf16 v[80:83], v[32:35], v[200:203], v[80:83]
  v_mfma_f32_16x16x32_bf16 v[84:87], v[36:39], v[200:203], v[84:87]
  v_cvt_pk_bf16_f32 v249, v8, v9
  v_mfma_f32_16x16x32_bf16 v[112:115], v[40:43], v[200:203], v[112:115]
  v_cvt_pk_bf16_f32 v251, v10, v11
  v_mfma_f32_16x16x32_bf16 v[116:119], v[44:47], v[200:203], v[116:119]
  s_waitcnt lgkmcnt(8)
  v_mfma_f32_16x16x32_bf16 v[88:91], v[32:35], v[204:207], v[88:91]
  s_waitcnt lgkmcnt(0)
  s_waitcnt vmcnt(8)
  s_barrier
  s_setprio 3
  s_add_u32 s33, s46, 0
  buffer_store_dwordx4 v[248:251], v2, s[28:31], s33 offen sc1
  v_mfma_f32_16x16x32_bf16 v[92:95], v[36:39], v[204:207], v[92:95]
  ds_read_b64_tr_b16 v[32:33], v16 offset:32768
  v_mfma_f32_16x16x32_bf16 v[120:123], v[40:43], v[204:207], v[120:123]
  ds_read_b64_tr_b16 v[34:35], v16 offset:33792
  s_add_u32 m0, s59, 0x1c000
  s_mov_b32 s32, 0x2c0000
  buffer_load_dwordx4 v24, s[8:11], s32 offen lds
  v_lshlrev_b32 v6, 16, v226
  v_mfma_f32_16x16x32_bf16 v[124:127], v[44:47], v[204:207], v[124:127]
  ds_read_b64_tr_b16 v[36:37], v17 offset:32768
  v_lshlrev_b32 v7, 16, v234
  v_mfma_f32_16x16x32_bf16 v[128:131], v[192:195], v[48:51], v[128:131]
  ds_read_b64_tr_b16 v[38:39], v17 offset:33792
  v_mfma_f32_16x16x32_bf16 v[144:147], v[192:195], v[52:55], v[144:147]
  ds_read_b64_tr_b16 v[40:41], v18 offset:32768
  v_mul_f32_dpp v8, v240, v6 row_newbcast:4 row_mask:0xf bank_mask:0xf
  v_mfma_f32_16x16x32_bf16 v[160:163], v[192:195], v[56:59], v[160:163]
  ds_read_b64_tr_b16 v[42:43], v18 offset:33792
  v_mul_f32_dpp v10, v241, v7 row_newbcast:4 row_mask:0xf bank_mask:0xf
  v_mfma_f32_16x16x32_bf16 v[176:179], v[192:195], v[60:63], v[176:179]
  ds_read_b128 v[192:195], v27 offset:32768
  s_add_u32 m0, s59, 0x1c400
  s_mov_b32 s32, 0x2c8000
  buffer_load_dwordx4 v24, s[8:11], s32 offen lds
  v_mfma_f32_16x16x32_bf16 v[132:135], v[196:199], v[48:51], v[132:135]
  s_setprio 2
  ds_read_b64_tr_b16 v[44:45], v19 offset:32768
  v_fmac_f32_dpp v8, v242, v7 row_newbcast:4 row_mask:0xf bank_mask:0xf
  v_mfma_f32_16x16x32_bf16 v[148:151], v[196:199], v[52:55], v[148:151]
  ds_read_b64_tr_b16 v[46:47], v19 offset:33792
  v_fmac_f32_dpp v10, v242, v6 row_newbcast:4 row_mask:0xf bank_mask:0xf
  v_mfma_f32_16x16x32_bf16 v[164:167], v[196:199], v[56:59], v[164:167]
  v_mfma_f32_16x16x32_bf16 v[180:183], v[196:199], v[60:63], v[180:183]
  ds_read_b128 v[196:199], v27 offset:34816
  v_and_b32 v6, 0xffff0000, v226
  v_mfma_f32_16x16x32_bf16 v[136:139], v[200:203], v[48:51], v[136:139]
  s_add_u32 m0, s58, 0x0
  s_movk_i32 s33, 0x300
  buffer_load_dwordx4 v25, s[4:7], s33 offen lds
  v_and_b32 v7, 0xffff0000, v234
  v_mfma_f32_16x16x32_bf16 v[152:155], v[200:203], v[52:55], v[152:155]
  v_mfma_f32_16x16x32_bf16 v[168:171], v[200:203], v[56:59], v[168:171]
  v_mul_f32_dpp v9, v240, v6 row_newbcast:5 row_mask:0xf bank_mask:0xf
  v_mfma_f32_16x16x32_bf16 v[184:187], v[200:203], v[60:63], v[184:187]
  ds_read_b128 v[200:203], v27 offset:36864
  v_mul_f32_dpp v11, v241, v7 row_newbcast:5 row_mask:0xf bank_mask:0xf
  v_mfma_f32_16x16x32_bf16 v[140:143], v[204:207], v[48:51], v[140:143]
  s_setprio 1
  v_mfma_f32_16x16x32_bf16 v[156:159], v[204:207], v[52:55], v[156:159]
  s_add_u32 m0, s58, 0x400
  s_movk_i32 s33, 0x300
  buffer_load_dwordx4 v26, s[4:7], s33 offen lds
  v_fmac_f32_dpp v9, v242, v7 row_newbcast:5 row_mask:0xf bank_mask:0xf
  v_mfma_f32_16x16x32_bf16 v[172:175], v[204:207], v[56:59], v[172:175]
  v_fmac_f32_dpp v11, v242, v6 row_newbcast:5 row_mask:0xf bank_mask:0xf
  v_mfma_f32_16x16x32_bf16 v[188:191], v[204:207], v[60:63], v[188:191]
  ds_read_b128 v[204:207], v27 offset:38912
  s_waitcnt lgkmcnt(10)
  s_waitcnt lgkmcnt(5)
  v_mfma_f32_16x16x32_bf16 v[64:67], v[32:35], v[192:195], v[64:67]
  ds_read_b64_tr_b16 v[48:49], v16 offset:40960
  v_cvt_pk_bf16_f32 v252, v8, v9
  v_mfma_f32_16x16x32_bf16 v[68:71], v[36:39], v[192:195], v[68:71]
  ds_read_b64_tr_b16 v[50:51], v16 offset:41984
  v_min_u32 v22, 13, v1
  v_cvt_pk_bf16_f32 v254, v10, v11
  v_mfma_f32_16x16x32_bf16 v[96:99], v[40:43], v[192:195], v[96:99]
  ds_read_b64_tr_b16 v[52:53], v17 offset:40960
  v_lshlrev_b32 v22, 4, v22
  s_waitcnt lgkmcnt(6)
  v_mfma_f32_16x16x32_bf16 v[100:103], v[44:47], v[192:195], v[100:103]
  ds_read_b64_tr_b16 v[54:55], v17 offset:41984
  s_lshl_b32 s32, s3, 20
  v_add_u32 v22, s32, v22
  v_lshlrev_b32 v6, 16, v227
  s_waitcnt lgkmcnt(6)
  v_mfma_f32_16x16x32_bf16 v[72:75], v[32:35], v[196:199], v[72:75]
  s_setprio 0
  ds_read_b64_tr_b16 v[56:57], v18 offset:40960
  buffer_load_dword v23, v22, s[76:79], 0 offen sc1
  v_lshlrev_b32 v7, 16, v235
  v_mfma_f32_16x16x32_bf16 v[76:79], v[36:39], v[196:199], v[76:79]
  ds_read_b64_tr_b16 v[58:59], v18 offset:41984
  v_mfma_f32_16x16x32_bf16 v[104:107], v[40:43], v[196:199], v[104:107]
  ds_read_b64_tr_b16 v[60:61], v19 offset:40960
  v_mul_f32_dpp v8, v240, v6 row_newbcast:6 row_mask:0xf bank_mask:0xf
  v_mfma_f32_16x16x32_bf16 v[108:111], v[44:47], v[196:199], v[108:111]
  ds_read_b64_tr_b16 v[62:63], v19 offset:41984
  v_mul_f32_dpp v10, v241, v7 row_newbcast:6 row_mask:0xf bank_mask:0xf
  s_waitcnt lgkmcnt(9)
  v_mfma_f32_16x16x32_bf16 v[80:83], v[32:35], v[200:203], v[80:83]
  v_mfma_f32_16x16x32_bf16 v[84:87], v[36:39], v[200:203], v[84:87]
  v_fmac_f32_dpp v8, v242, v7 row_newbcast:6 row_mask:0xf bank_mask:0xf
  v_mfma_f32_16x16x32_bf16 v[112:115], v[40:43], v[200:203], v[112:115]
  v_fmac_f32_dpp v10, v242, v6 row_newbcast:6 row_mask:0xf bank_mask:0xf
  v_mfma_f32_16x16x32_bf16 v[116:119], v[44:47], v[200:203], v[116:119]
  s_waitcnt lgkmcnt(8)
  v_mfma_f32_16x16x32_bf16 v[88:91], v[32:35], v[204:207], v[88:91]
  s_waitcnt lgkmcnt(0)
  s_waitcnt vmcnt(12)
  s_barrier
  s_setprio 3
  v_and_b32 v6, 0xffff0000, v227
  v_mfma_f32_16x16x32_bf16 v[92:95], v[36:39], v[204:207], v[92:95]
  ds_read_b64_tr_b16 v[32:33], v16 offset:49152
  v_and_b32 v7, 0xffff0000, v235
  v_mfma_f32_16x16x32_bf16 v[120:123], v[40:43], v[204:207], v[120:123]
  ds_read_b64_tr_b16 v[34:35], v16 offset:50176
  s_add_u32 m0, s59, 0x20000
  s_mov_b32 s32, 0x300000
  buffer_load_dwordx4 v24, s[8:11], s32 offen lds
  v_mfma_f32_16x16x32_bf16 v[124:127], v[44:47], v[204:207], v[124:127]
  ds_read_b64_tr_b16 v[36:37], v17 offset:49152
  v_mul_f32_dpp v9, v240, v6 row_newbcast:7 row_mask:0xf bank_mask:0xf
  v_mfma_f32_16x16x32_bf16 v[128:131], v[192:195], v[48:51], v[128:131]
  ds_read_b64_tr_b16 v[38:39], v17 offset:50176
  v_mul_f32_dpp v11, v241, v7 row_newbcast:7 row_mask:0xf bank_mask:0xf
  v_mfma_f32_16x16x32_bf16 v[144:147], v[192:195], v[52:55], v[144:147]
  ds_read_b64_tr_b16 v[40:41], v18 offset:49152
  v_mfma_f32_16x16x32_bf16 v[160:163], v[192:195], v[56:59], v[160:163]
  ds_read_b64_tr_b16 v[42:43], v18 offset:50176
  v_fmac_f32_dpp v9, v242, v7 row_newbcast:7 row_mask:0xf bank_mask:0xf
  v_mfma_f32_16x16x32_bf16 v[176:179], v[192:195], v[60:63], v[176:179]
  ds_read_b128 v[192:195], v28 offset:32768
  s_add_u32 m0, s59, 0x20400
  s_mov_b32 s32, 0x308000
  buffer_load_dwordx4 v24, s[8:11], s32 offen lds
  v_fmac_f32_dpp v11, v242, v6 row_newbcast:7 row_mask:0xf bank_mask:0xf
  v_mfma_f32_16x16x32_bf16 v[132:135], v[196:199], v[48:51], v[132:135]
  s_setprio 2
  ds_read_b64_tr_b16 v[44:45], v19 offset:49152
  v_mfma_f32_16x16x32_bf16 v[148:151], v[196:199], v[52:55], v[148:151]
  ds_read_b64_tr_b16 v[46:47], v19 offset:50176
  v_cvt_pk_bf16_f32 v253, v8, v9
  v_mfma_f32_16x16x32_bf16 v[164:167], v[196:199], v[56:59], v[164:167]
  v_cvt_pk_bf16_f32 v255, v10, v11
  v_mfma_f32_16x16x32_bf16 v[180:183], v[196:199], v[60:63], v[180:183]
  ds_read_b128 v[196:199], v28 offset:34816
  v_mfma_f32_16x16x32_bf16 v[136:139], v[200:203], v[48:51], v[136:139]
  s_add_u32 m0, s58, 0x800
  s_movk_i32 s33, 0x4300
  buffer_load_dwordx4 v25, s[4:7], s33 offen lds
  s_add_u32 s33, s46, 10240
  buffer_store_dwordx4 v[252:255], v2, s[28:31], s33 offen sc1
  v_mfma_f32_16x16x32_bf16 v[152:155], v[200:203], v[52:55], v[152:155]
  v_mfma_f32_16x16x32_bf16 v[168:171], v[200:203], v[56:59], v[168:171]
  v_lshlrev_b32 v6, 16, v228
  v_mfma_f32_16x16x32_bf16 v[184:187], v[200:203], v[60:63], v[184:187]
  ds_read_b128 v[200:203], v28 offset:36864
  v_lshlrev_b32 v7, 16, v236
  v_mfma_f32_16x16x32_bf16 v[140:143], v[204:207], v[48:51], v[140:143]
  s_setprio 1
  v_mfma_f32_16x16x32_bf16 v[156:159], v[204:207], v[52:55], v[156:159]
  s_add_u32 m0, s58, 0xc00
  s_movk_i32 s33, 0x4300
  buffer_load_dwordx4 v26, s[4:7], s33 offen lds
  v_mul_f32_dpp v8, v240, v6 row_newbcast:8 row_mask:0xf bank_mask:0xf
  v_mfma_f32_16x16x32_bf16 v[172:175], v[204:207], v[56:59], v[172:175]
  v_mul_f32_dpp v10, v241, v7 row_newbcast:8 row_mask:0xf bank_mask:0xf
  v_mfma_f32_16x16x32_bf16 v[188:191], v[204:207], v[60:63], v[188:191]
  ds_read_b128 v[204:207], v28 offset:38912
  s_waitcnt lgkmcnt(10)
  s_waitcnt lgkmcnt(5)
  v_mfma_f32_16x16x32_bf16 v[64:67], v[32:35], v[192:195], v[64:67]
  ds_read_b64_tr_b16 v[48:49], v16 offset:57344
  v_fmac_f32_dpp v8, v242, v7 row_newbcast:8 row_mask:0xf bank_mask:0xf
  v_mfma_f32_16x16x32_bf16 v[68:71], v[36:39], v[192:195], v[68:71]
  ds_read_b64_tr_b16 v[50:51], v16 offset:58368
  v_fmac_f32_dpp v10, v242, v6 row_newbcast:8 row_mask:0xf bank_mask:0xf
  v_mfma_f32_16x16x32_bf16 v[96:99], v[40:43], v[192:195], v[96:99]
  ds_read_b64_tr_b16 v[52:53], v17 offset:57344
  s_waitcnt lgkmcnt(6)
  v_mfma_f32_16x16x32_bf16 v[100:103], v[44:47], v[192:195], v[100:103]
  ds_read_b64_tr_b16 v[54:55], v17 offset:58368
  v_and_b32 v6, 0xffff0000, v228
  s_waitcnt lgkmcnt(6)
  v_mfma_f32_16x16x32_bf16 v[72:75], v[32:35], v[196:199], v[72:75]
  s_setprio 0
  ds_read_b64_tr_b16 v[56:57], v18 offset:57344
  v_and_b32 v7, 0xffff0000, v236
  v_mfma_f32_16x16x32_bf16 v[76:79], v[36:39], v[196:199], v[76:79]
  ds_read_b64_tr_b16 v[58:59], v18 offset:58368
  v_mfma_f32_16x16x32_bf16 v[104:107], v[40:43], v[196:199], v[104:107]
  ds_read_b64_tr_b16 v[60:61], v19 offset:57344
  v_mul_f32_dpp v9, v240, v6 row_newbcast:9 row_mask:0xf bank_mask:0xf
  v_mfma_f32_16x16x32_bf16 v[108:111], v[44:47], v[196:199], v[108:111]
  ds_read_b64_tr_b16 v[62:63], v19 offset:58368
  v_mul_f32_dpp v11, v241, v7 row_newbcast:9 row_mask:0xf bank_mask:0xf
  s_waitcnt lgkmcnt(9)
  v_mfma_f32_16x16x32_bf16 v[80:83], v[32:35], v[200:203], v[80:83]
  v_mfma_f32_16x16x32_bf16 v[84:87], v[36:39], v[200:203], v[84:87]
  v_fmac_f32_dpp v9, v242, v7 row_newbcast:9 row_mask:0xf bank_mask:0xf
  v_mfma_f32_16x16x32_bf16 v[112:115], v[40:43], v[200:203], v[112:115]
  v_fmac_f32_dpp v11, v242, v6 row_newbcast:9 row_mask:0xf bank_mask:0xf
  v_mfma_f32_16x16x32_bf16 v[116:119], v[44:47], v[200:203], v[116:119]
  s_waitcnt lgkmcnt(8)
  v_mfma_f32_16x16x32_bf16 v[88:91], v[32:35], v[204:207], v[88:91]
  s_waitcnt lgkmcnt(0)
  s_waitcnt vmcnt(11)
  s_barrier
  s_setprio 3
  v_cvt_pk_bf16_f32 v248, v8, v9
  v_mfma_f32_16x16x32_bf16 v[92:95], v[36:39], v[204:207], v[92:95]
  ds_read_b64_tr_b16 v[32:33], v16 offset:0
  v_cvt_pk_bf16_f32 v250, v10, v11
  v_mfma_f32_16x16x32_bf16 v[120:123], v[40:43], v[204:207], v[120:123]
  ds_read_b64_tr_b16 v[34:35], v16 offset:1024
  s_add_u32 m0, s59, 0x24000
  s_mov_b32 s32, 0x340000
  buffer_load_dwordx4 v24, s[8:11], s32 offen lds
  v_mfma_f32_16x16x32_bf16 v[124:127], v[44:47], v[204:207], v[124:127]
  ds_read_b64_tr_b16 v[36:37], v17 offset:0
  v_lshlrev_b32 v6, 16, v229
  v_mfma_f32_16x16x32_bf16 v[128:131], v[192:195], v[48:51], v[128:131]
  ds_read_b64_tr_b16 v[38:39], v17 offset:1024
  v_lshlrev_b32 v7, 16, v237
  v_mfma_f32_16x16x32_bf16 v[144:147], v[192:195], v[52:55], v[144:147]
  ds_read_b64_tr_b16 v[40:41], v18 offset:0
  v_mfma_f32_16x16x32_bf16 v[160:163], v[192:195], v[56:59], v[160:163]
  ds_read_b64_tr_b16 v[42:43], v18 offset:1024
  v_mul_f32_dpp v8, v240, v6 row_newbcast:10 row_mask:0xf bank_mask:0xf
  v_mfma_f32_16x16x32_bf16 v[176:179], v[192:195], v[60:63], v[176:179]
  ds_read_b128 v[192:195], v29 offset:0
  s_add_u32 m0, s59, 0x24400
  s_mov_b32 s32, 0x348000
  buffer_load_dwordx4 v24, s[8:11], s32 offen lds
  v_mul_f32_dpp v10, v241, v7 row_newbcast:10 row_mask:0xf bank_mask:0xf
  v_mfma_f32_16x16x32_bf16 v[132:135], v[196:199], v[48:51], v[132:135]
  s_setprio 2
  ds_read_b64_tr_b16 v[44:45], v19 offset:0
  v_mfma_f32_16x16x32_bf16 v[148:151], v[196:199], v[52:55], v[148:151]
  ds_read_b64_tr_b16 v[46:47], v19 offset:1024
  v_fmac_f32_dpp v8, v242, v7 row_newbcast:10 row_mask:0xf bank_mask:0xf
  v_mfma_f32_16x16x32_bf16 v[164:167], v[196:199], v[56:59], v[164:167]
  v_fmac_f32_dpp v10, v242, v6 row_newbcast:10 row_mask:0xf bank_mask:0xf
  v_mfma_f32_16x16x32_bf16 v[180:183], v[196:199], v[60:63], v[180:183]
  ds_read_b128 v[196:199], v29 offset:2048
  v_mfma_f32_16x16x32_bf16 v[136:139], v[200:203], v[48:51], v[136:139]
  s_add_u32 m0, s58, 0x8000
  s_movk_i32 s33, 0x380
  buffer_load_dwordx4 v25, s[4:7], s33 offen lds
  v_and_b32 v6, 0xffff0000, v229
  v_mfma_f32_16x16x32_bf16 v[152:155], v[200:203], v[52:55], v[152:155]
  v_and_b32 v7, 0xffff0000, v237
  v_mfma_f32_16x16x32_bf16 v[168:171], v[200:203], v[56:59], v[168:171]
  v_mfma_f32_16x16x32_bf16 v[184:187], v[200:203], v[60:63], v[184:187]
  ds_read_b128 v[200:203], v29 offset:4096
  v_mul_f32_dpp v9, v240, v6 row_newbcast:11 row_mask:0xf bank_mask:0xf
  v_mfma_f32_16x16x32_bf16 v[140:143], v[204:207], v[48:51], v[140:143]
  s_setprio 1
  v_mul_f32_dpp v11, v241, v7 row_newbcast:11 row_mask:0xf bank_mask:0xf
  v_mfma_f32_16x16x32_bf16 v[156:159], v[204:207], v[52:55], v[156:159]
  s_add_u32 m0, s58, 0x8400
  s_movk_i32 s33, 0x380
  buffer_load_dwordx4 v26, s[4:7], s33 offen lds
  v_mfma_f32_16x16x32_bf16 v[172:175], v[204:207], v[56:59], v[172:175]
  v_fmac_f32_dpp v9, v242, v7 row_newbcast:11 row_mask:0xf bank_mask:0xf
  v_mfma_f32_16x16x32_bf16 v[188:191], v[204:207], v[60:63], v[188:191]
  ds_read_b128 v[204:207], v29 offset:6144
  v_fmac_f32_dpp v11, v242, v6 row_newbcast:11 row_mask:0xf bank_mask:0xf
  s_waitcnt lgkmcnt(10)
  s_waitcnt lgkmcnt(5)
  v_mfma_f32_16x16x32_bf16 v[64:67], v[32:35], v[192:195], v[64:67]
  ds_read_b64_tr_b16 v[48:49], v16 offset:8192
  v_mfma_f32_16x16x32_bf16 v[68:71], v[36:39], v[192:195], v[68:71]
  ds_read_b64_tr_b16 v[50:51], v16 offset:9216
  v_cvt_pk_bf16_f32 v249, v8, v9
  v_mfma_f32_16x16x32_bf16 v[96:99], v[40:43], v[192:195], v[96:99]
  ds_read_b64_tr_b16 v[52:53], v17 offset:8192
  v_cvt_pk_bf16_f32 v251, v10, v11
  s_waitcnt lgkmcnt(6)
  v_mfma_f32_16x16x32_bf16 v[100:103], v[44:47], v[192:195], v[100:103]
  ds_read_b64_tr_b16 v[54:55], v17 offset:9216
  s_waitcnt lgkmcnt(6)
  v_mfma_f32_16x16x32_bf16 v[72:75], v[32:35], v[196:199], v[72:75]
  s_setprio 0
  ds_read_b64_tr_b16 v[56:57], v18 offset:8192
  s_add_u32 s33, s46, 20480
  buffer_store_dwordx4 v[248:251], v2, s[28:31], s33 offen sc1
  v_mfma_f32_16x16x32_bf16 v[76:79], v[36:39], v[196:199], v[76:79]
  ds_read_b64_tr_b16 v[58:59], v18 offset:9216
  v_mfma_f32_16x16x32_bf16 v[104:107], v[40:43], v[196:199], v[104:107]
  ds_read_b64_tr_b16 v[60:61], v19 offset:8192
  s_waitcnt vmcnt(10)
  v_lshlrev_b32 v6, 16, v230
  v_mfma_f32_16x16x32_bf16 v[108:111], v[44:47], v[196:199], v[108:111]
  ds_read_b64_tr_b16 v[62:63], v19 offset:9216
  v_cmp_ne_u32 vcc, 1, v23
  s_cmp_lg_u32 s3, 0
  s_cbranch_scc1 fN_in_ret
  s_nop 2
  s_cbranch_vccnz fN_in
fN_in_ret:
  v_lshlrev_b32 v7, 16, v238
  s_waitcnt lgkmcnt(9)
  v_mfma_f32_16x16x32_bf16 v[80:83], v[32:35], v[200:203], v[80:83]
  v_mfma_f32_16x16x32_bf16 v[84:87], v[36:39], v[200:203], v[84:87]
  v_mul_f32_dpp v8, v240, v6 row_newbcast:12 row_mask:0xf bank_mask:0xf
  v_mfma_f32_16x16x32_bf16 v[112:115], v[40:43], v[200:203], v[112:115]
  v_mul_f32_dpp v10, v241, v7 row_newbcast:12 row_mask:0xf bank_mask:0xf
  v_mfma_f32_16x16x32_bf16 v[116:119], v[44:47], v[200:203], v[116:119]
  s_waitcnt lgkmcnt(8)
  v_mfma_f32_16x16x32_bf16 v[88:91], v[32:35], v[204:207], v[88:91]
  s_waitcnt lgkmcnt(0)
  s_barrier
  s_setprio 3
  v_fmac_f32_dpp v8, v242, v7 row_newbcast:12 row_mask:0xf bank_mask:0xf
  v_mfma_f32_16x16x32_bf16 v[92:95], v[36:39], v[204:207], v[92:95]
  ds_read_b64_tr_b16 v[32:33], v16 offset:16384
  v_fmac_f32_dpp v10, v242, v6 row_newbcast:12 row_mask:0xf bank_mask:0xf
  v_mfma_f32_16x16x32_bf16 v[120:123], v[40:43], v[204:207], v[120:123]
  ds_read_b64_tr_b16 v[34:35], v16 offset:17408
  s_add_u32 m0, s59, 0x18000
  s_mov_b32 s32, 0x380000
  buffer_load_dwordx4 v24, s[8:11], s32 offen lds
  v_mfma_f32_16x16x32_bf16 v[124:127], v[44:47], v[204:207], v[124:127]
  ds_read_b64_tr_b16 v[36:37], v17 offset:16384
  v_and_b32 v6, 0xffff0000, v230
  v_mfma_f32_16x16x32_bf16 v[128:131], v[192:195], v[48:51], v[128:131]
  ds_read_b64_tr_b16 v[38:39], v17 offset:17408
  v_and_b32 v7, 0xffff0000, v238
  v_mfma_f32_16x16x32_bf16 v[144:147], v[192:195], v[52:55], v[144:147]
  ds_read_b64_tr_b16 v[40:41], v18 offset:16384
  v_mfma_f32_16x16x32_bf16 v[160:163], v[192:195], v[56:59], v[160:163]
  ds_read_b64_tr_b16 v[42:43], v18 offset:17408
  v_mul_f32_dpp v9, v240, v6 row_newbcast:13 row_mask:0xf bank_mask:0xf
  v_mfma_f32_16x16x32_bf16 v[176:179], v[192:195], v[60:63], v[176:179]
  ds_read_b128 v[192:195], v30 offset:0
  s_add_u32 m0, s59, 0x18400
  s_mov_b32 s32, 0x388000
  buffer_load_dwordx4 v24, s[8:11], s32 offen lds
  v_mul_f32_dpp v11, v241, v7 row_newbcast:13 row_mask:0xf bank_mask:0xf
  v_mfma_f32_16x16x32_bf16 v[132:135], v[196:199], v[48:51], v[132:135]
  s_setprio 2
  ds_read_b64_tr_b16 v[44:45], v19 offset:16384
  v_mfma_f32_16x16x32_bf16 v[148:151], v[196:199], v[52:55], v[148:151]
  ds_read_b64_tr_b16 v[46:47], v19 offset:17408
  v_fmac_f32_dpp v9, v242, v7 row_newbcast:13 row_mask:0xf bank_mask:0xf
  v_mfma_f32_16x16x32_bf16 v[164:167], v[196:199], v[56:59], v[164:167]
  v_fmac_f32_dpp v11, v242, v6 row_newbcast:13 row_mask:0xf bank_mask:0xf
  v_mfma_f32_16x16x32_bf16 v[180:183], v[196:199], v[60:63], v[180:183]
  ds_read_b128 v[196:199], v30 offset:2048
  v_mfma_f32_16x16x32_bf16 v[136:139], v[200:203], v[48:51], v[136:139]
  s_add_u32 m0, s58, 0x8800
  s_movk_i32 s33, 0x4380
  buffer_load_dwordx4 v25, s[4:7], s33 offen lds
  v_cvt_pk_bf16_f32 v252, v8, v9
  v_mfma_f32_16x16x32_bf16 v[152:155], v[200:203], v[52:55], v[152:155]
  v_cvt_pk_bf16_f32 v254, v10, v11
  v_mfma_f32_16x16x32_bf16 v[168:171], v[200:203], v[56:59], v[168:171]
  v_mfma_f32_16x16x32_bf16 v[184:187], v[200:203], v[60:63], v[184:187]
  ds_read_b128 v[200:203], v30 offset:4096
  v_lshlrev_b32 v6, 16, v231
  v_mfma_f32_16x16x32_bf16 v[140:143], v[204:207], v[48:51], v[140:143]
  s_setprio 1
  v_lshlrev_b32 v7, 16, v239
  v_mfma_f32_16x16x32_bf16 v[156:159], v[204:207], v[52:55], v[156:159]
  s_add_u32 m0, s58, 0x8c00
  s_movk_i32 s33, 0x4380
  buffer_load_dwordx4 v26, s[4:7], s33 offen lds
  v_mfma_f32_16x16x32_bf16 v[172:175], v[204:207], v[56:59], v[172:175]
  s_movk_i32 s42, 10240
  v_mul_f32_dpp v8, v240, v6 row_newbcast:14 row_mask:0xf bank_mask:0xf
  v_mfma_f32_16x16x32_bf16 v[188:191], v[204:207], v[60:63], v[188:191]
  ds_read_b128 v[204:207], v30 offset:6144
  s_sub_u32 s32, 15, s36
  s_and_b32 s33, s3, 3
  s_lshl_b32 s43, s32, 2
  s_add_u32 s43, s43, s33
  v_mul_f32_dpp v10, v241, v7 row_newbcast:14 row_mask:0xf bank_mask:0xf
  s_waitcnt lgkmcnt(10)
  s_waitcnt lgkmcnt(5)
  v_mfma_f32_16x16x32_bf16 v[64:67], v[32:35], v[192:195], v[64:67]
  ds_read_b64_tr_b16 v[48:49], v16 offset:24576
  s_lshl_b32 s41, s36, 2
  s_and_b32 s33, s3, 3
  s_add_u32 s41, s41, s33
  v_mfma_f32_16x16x32_bf16 v[68:71], v[36:39], v[192:195], v[68:71]
  ds_read_b64_tr_b16 v[50:51], v16 offset:25600
  s_lshl_b32 s56, s41, 18
  s_lshl_b32 s57, s43, 18
  v_fmac_f32_dpp v8, v242, v7 row_newbcast:14 row_mask:0xf bank_mask:0xf
  v_mfma_f32_16x16x32_bf16 v[96:99], v[40:43], v[192:195], v[96:99]
  ds_read_b64_tr_b16 v[52:53], v17 offset:24576
  s_cmp_ge_u32 s3, 4
  s_cselect_b32 s39, s41, s43
  v_fmac_f32_dpp v10, v242, v6 row_newbcast:14 row_mask:0xf bank_mask:0xf
  s_waitcnt lgkmcnt(6)
  v_mfma_f32_16x16x32_bf16 v[100:103], v[44:47], v[192:195], v[100:103]
  ds_read_b64_tr_b16 v[54:55], v17 offset:25600
  s_lshl_b32 s32, s39, 5
  v_lshrrev_b32 v14, 3, v1
  v_add_u32 v14, s32, v14
  s_waitcnt lgkmcnt(6)
  v_mfma_f32_16x16x32_bf16 v[72:75], v[32:35], v[196:199], v[72:75]
  s_setprio 0
  ds_read_b64_tr_b16 v[56:57], v18 offset:24576
  v_mul_u32_u24 v14, 1280, v14
  v_and_b32 v6, 0xffff0000, v231
  v_mfma_f32_16x16x32_bf16 v[76:79], v[36:39], v[196:199], v[76:79]
  ds_read_b64_tr_b16 v[58:59], v18 offset:25600
  v_and_b32 v7, 0xffff0000, v239
  v_mfma_f32_16x16x32_bf16 v[104:107], v[40:43], v[196:199], v[104:107]
  ds_read_b64_tr_b16 v[60:61], v19 offset:24576
  v_and_b32 v25, 0x70, v25
  v_mfma_f32_16x16x32_bf16 v[108:111], v[44:47], v[196:199], v[108:111]
  ds_read_b64_tr_b16 v[62:63], v19 offset:25600
  v_and_b32 v26, 0x70, v26
  v_mul_f32_dpp v9, v240, v6 row_newbcast:15 row_mask:0xf bank_mask:0xf
  s_waitcnt lgkmcnt(9)
  v_mfma_f32_16x16x32_bf16 v[80:83], v[32:35], v[200:203], v[80:83]
  v_add_u32 v25, v25, v14
  v_mul_f32_dpp v11, v241, v7 row_newbcast:15 row_mask:0xf bank_mask:0xf
  v_mfma_f32_16x16x32_bf16 v[84:87], v[36:39], v[200:203], v[84:87]
  v_add3_u32 v26, v26, v14, s42
  v_mfma_f32_16x16x32_bf16 v[112:115], v[40:43], v[200:203], v[112:115]
  s_mov_b32 s4, s82
  s_and_b32 s5, s83, 0xffff
  s_mov_b32 s6, 0x280000
  s_mov_b32 s7, 0x00020000
  v_fmac_f32_dpp v9, v242, v7 row_newbcast:15 row_mask:0xf bank_mask:0xf
  v_mfma_f32_16x16x32_bf16 v[116:119], v[44:47], v[200:203], v[116:119]
  v_fmac_f32_dpp v11, v242, v6 row_newbcast:15 row_mask:0xf bank_mask:0xf
  s_waitcnt lgkmcnt(8)
  v_mfma_f32_16x16x32_bf16 v[88:91], v[32:35], v[204:207], v[88:91]
  s_waitcnt lgkmcnt(0)
  s_waitcnt vmcnt(9)
  s_barrier
  s_setprio 3
  v_mfma_f32_16x16x32_bf16 v[92:95], v[36:39], v[204:207], v[92:95]
  ds_read_b64_tr_b16 v[32:33], v16 offset:32768
  v_cvt_pk_bf16_f32 v253, v8, v9
  v_mfma_f32_16x16x32_bf16 v[120:123], v[40:43], v[204:207], v[120:123]
  ds_read_b64_tr_b16 v[34:35], v16 offset:33792
  s_add_u32 m0, s59, 0x1c000
  s_mov_b32 s32, 0x3c0000
  buffer_load_dwordx4 v24, s[8:11], s32 offen lds
  v_cvt_pk_bf16_f32 v255, v10, v11
  v_mfma_f32_16x16x32_bf16 v[124:127], v[44:47], v[204:207], v[124:127]
  ds_read_b64_tr_b16 v[36:37], v17 offset:32768
  v_mfma_f32_16x16x32_bf16 v[128:131], v[192:195], v[48:51], v[128:131]
  ds_read_b64_tr_b16 v[38:39], v17 offset:33792
  s_add_u32 s33, s46, 30720
  buffer_store_dwordx4 v[252:255], v2, s[28:31], s33 offen sc1
  v_mfma_f32_16x16x32_bf16 v[144:147], v[192:195], v[52:55], v[144:147]
  ds_read_b64_tr_b16 v[40:41], v18 offset:32768
  v_mfma_f32_16x16x32_bf16 v[160:163], v[192:195], v[56:59], v[160:163]
  ds_read_b64_tr_b16 v[42:43], v18 offset:33792
  v_mfma_f32_16x16x32_bf16 v[176:179], v[192:195], v[60:63], v[176:179]
  ds_read_b128 v[192:195], v27 offset:0
  s_add_u32 m0, s59, 0x1c400
  s_mov_b32 s32, 0x3c8000
  buffer_load_dwordx4 v24, s[8:11], s32 offen lds
  v_mfma_f32_16x16x32_bf16 v[132:135], v[196:199], v[48:51], v[132:135]
  s_setprio 2
  ds_read_b64_tr_b16 v[44:45], v19 offset:32768
  v_mfma_f32_16x16x32_bf16 v[148:151], v[196:199], v[52:55], v[148:151]
  ds_read_b64_tr_b16 v[46:47], v19 offset:33792
  v_mfma_f32_16x16x32_bf16 v[164:167], v[196:199], v[56:59], v[164:167]
  v_mfma_f32_16x16x32_bf16 v[180:183], v[196:199], v[60:63], v[180:183]
  ds_read_b128 v[196:199], v27 offset:2048
  v_mfma_f32_16x16x32_bf16 v[136:139], v[200:203], v[48:51], v[136:139]
  s_add_u32 m0, s58, 0x10000
  s_movk_i32 s33, 0x0
  buffer_load_dwordx4 v25, s[4:7], s33 offen lds
  v_mfma_f32_16x16x32_bf16 v[152:155], v[200:203], v[52:55], v[152:155]
  v_mfma_f32_16x16x32_bf16 v[168:171], v[200:203], v[56:59], v[168:171]
  v_mfma_f32_16x16x32_bf16 v[184:187], v[200:203], v[60:63], v[184:187]
  ds_read_b128 v[200:203], v27 offset:4096
  v_mfma_f32_16x16x32_bf16 v[140:143], v[204:207], v[48:51], v[140:143]
  s_setprio 1
  v_mfma_f32_16x16x32_bf16 v[156:159], v[204:207], v[52:55], v[156:159]
  s_add_u32 m0, s58, 0x10400
  s_movk_i32 s33, 0x0
  buffer_load_dwordx4 v26, s[4:7], s33 offen lds
  v_mfma_f32_16x16x32_bf16 v[172:175], v[204:207], v[56:59], v[172:175]
  v_mfma_f32_16x16x32_bf16 v[188:191], v[204:207], v[60:63], v[188:191]
  ds_read_b128 v[204:207], v27 offset:6144
  s_waitcnt lgkmcnt(10)
  s_waitcnt lgkmcnt(5)
  v_mfma_f32_16x16x32_bf16 v[64:67], v[32:35], v[192:195], v[64:67]
  ds_read_b64_tr_b16 v[48:49], v16 offset:40960
  v_mfma_f32_16x16x32_bf16 v[68:71], v[36:39], v[192:195], v[68:71]
  ds_read_b64_tr_b16 v[50:51], v16 offset:41984
  v_mfma_f32_16x16x32_bf16 v[96:99], v[40:43], v[192:195], v[96:99]
  ds_read_b64_tr_b16 v[52:53], v17 offset:40960
  s_lshr_b32 s32, s3, 2
  s_lshl_b32 s32, s32, 18
  v_add_u32 v24, s32, v24
  s_waitcnt lgkmcnt(6)
  v_mfma_f32_16x16x32_bf16 v[100:103], v[44:47], v[192:195], v[100:103]
  ds_read_b64_tr_b16 v[54:55], v17 offset:41984
  s_waitcnt lgkmcnt(6)
  v_mfma_f32_16x16x32_bf16 v[72:75], v[32:35], v[196:199], v[72:75]
  s_setprio 0
  ds_read_b64_tr_b16 v[56:57], v18 offset:40960
  v_mfma_f32_16x16x32_bf16 v[76:79], v[36:39], v[196:199], v[76:79]
  ds_read_b64_tr_b16 v[58:59], v18 offset:41984
  s_mov_b32 s8, s86
  s_and_b32 s9, s87, 0xffff
  s_mov_b32 s10, 0x500000
  s_mov_b32 s11, 0x00020000
  v_mfma_f32_16x16x32_bf16 v[104:107], v[40:43], v[196:199], v[104:107]
  ds_read_b64_tr_b16 v[60:61], v19 offset:40960
  v_mfma_f32_16x16x32_bf16 v[108:111], v[44:47], v[196:199], v[108:111]
  ds_read_b64_tr_b16 v[62:63], v19 offset:41984
  s_waitcnt lgkmcnt(9)
  v_mfma_f32_16x16x32_bf16 v[80:83], v[32:35], v[200:203], v[80:83]
  v_mfma_f32_16x16x32_bf16 v[84:87], v[36:39], v[200:203], v[84:87]
  v_mfma_f32_16x16x32_bf16 v[112:115], v[40:43], v[200:203], v[112:115]
  v_mfma_f32_16x16x32_bf16 v[116:119], v[44:47], v[200:203], v[116:119]
  s_waitcnt lgkmcnt(8)
  v_mfma_f32_16x16x32_bf16 v[88:91], v[32:35], v[204:207], v[88:91]
  s_waitcnt lgkmcnt(0)
  s_waitcnt vmcnt(12)
  s_barrier
  s_setprio 3
  v_mfma_f32_16x16x32_bf16 v[92:95], v[36:39], v[204:207], v[92:95]
  ds_read_b64_tr_b16 v[32:33], v16 offset:49152
  v_mfma_f32_16x16x32_bf16 v[120:123], v[40:43], v[204:207], v[120:123]
  ds_read_b64_tr_b16 v[34:35], v16 offset:50176
  s_add_u32 m0, s59, 0x20000
  s_mov_b32 s32, 0x0
  buffer_load_dwordx4 v24, s[8:11], s32 offen lds
  v_mfma_f32_16x16x32_bf16 v[124:127], v[44:47], v[204:207], v[124:127]
  ds_read_b64_tr_b16 v[36:37], v17 offset:49152
  v_mfma_f32_16x16x32_bf16 v[128:131], v[192:195], v[48:51], v[128:131]
  ds_read_b64_tr_b16 v[38:39], v17 offset:50176
  v_mfma_f32_16x16x32_bf16 v[144:147], v[192:195], v[52:55], v[144:147]
  ds_read_b64_tr_b16 v[40:41], v18 offset:49152
  v_mfma_f32_16x16x32_bf16 v[160:163], v[192:195], v[56:59], v[160:163]
  ds_read_b64_tr_b16 v[42:43], v18 offset:50176
  v_mfma_f32_16x16x32_bf16 v[176:179], v[192:195], v[60:63], v[176:179]
  ds_read_b128 v[192:195], v28 offset:0
  s_add_u32 m0, s59, 0x20400
  s_mov_b32 s32, 0x8000
  buffer_load_dwordx4 v24, s[8:11], s32 offen lds
  v_mfma_f32_16x16x32_bf16 v[132:135], v[196:199], v[48:51], v[132:135]
  s_setprio 2
  ds_read_b64_tr_b16 v[44:45], v19 offset:49152
  v_mfma_f32_16x16x32_bf16 v[148:151], v[196:199], v[52:55], v[148:151]
  ds_read_b64_tr_b16 v[46:47], v19 offset:50176
  v_mfma_f32_16x16x32_bf16 v[164:167], v[196:199], v[56:59], v[164:167]
  v_mfma_f32_16x16x32_bf16 v[180:183], v[196:199], v[60:63], v[180:183]
  ds_read_b128 v[196:199], v28 offset:2048
  v_mfma_f32_16x16x32_bf16 v[136:139], v[200:203], v[48:51], v[136:139]
  s_add_u32 m0, s58, 0x10800
  s_movk_i32 s33, 0x5000
  buffer_load_dwordx4 v25, s[4:7], s33 offen lds
  v_mfma_f32_16x16x32_bf16 v[152:155], v[200:203], v[52:55], v[152:155]
  v_mfma_f32_16x16x32_bf16 v[168:171], v[200:203], v[56:59], v[168:171]
  v_mfma_f32_16x16x32_bf16 v[184:187], v[200:203], v[60:63], v[184:187]
  ds_read_b128 v[200:203], v28 offset:4096
  v_mfma_f32_16x16x32_bf16 v[140:143], v[204:207], v[48:51], v[140:143]
  s_setprio 1
  v_mfma_f32_16x16x32_bf16 v[156:159], v[204:207], v[52:55], v[156:159]
  s_add_u32 m0, s58, 0x10c00
  s_movk_i32 s33, 0x5000
  buffer_load_dwordx4 v26, s[4:7], s33 offen lds
  v_mfma_f32_16x16x32_bf16 v[172:175], v[204:207], v[56:59], v[172:175]
  v_mfma_f32_16x16x32_bf16 v[188:191], v[204:207], v[60:63], v[188:191]
  ds_read_b128 v[204:207], v28 offset:6144
  s_waitcnt lgkmcnt(10)
  s_waitcnt lgkmcnt(5)
  v_mfma_f32_16x16x32_bf16 v[64:67], v[32:35], v[192:195], v[64:67]
  ds_read_b64_tr_b16 v[48:49], v16 offset:57344
  v_mfma_f32_16x16x32_bf16 v[68:71], v[36:39], v[192:195], v[68:71]
  ds_read_b64_tr_b16 v[50:51], v16 offset:58368
  v_mfma_f32_16x16x32_bf16 v[96:99], v[40:43], v[192:195], v[96:99]
  ds_read_b64_tr_b16 v[52:53], v17 offset:57344
  s_waitcnt lgkmcnt(6)
  v_mfma_f32_16x16x32_bf16 v[100:103], v[44:47], v[192:195], v[100:103]
  ds_read_b64_tr_b16 v[54:55], v17 offset:58368
  s_waitcnt lgkmcnt(6)
  v_mfma_f32_16x16x32_bf16 v[72:75], v[32:35], v[196:199], v[72:75]
  s_setprio 0
  ds_read_b64_tr_b16 v[56:57], v18 offset:57344
  v_mfma_f32_16x16x32_bf16 v[76:79], v[36:39], v[196:199], v[76:79]
  ds_read_b64_tr_b16 v[58:59], v18 offset:58368
  v_mfma_f32_16x16x32_bf16 v[104:107], v[40:43], v[196:199], v[104:107]
  ds_read_b64_tr_b16 v[60:61], v19 offset:57344
  v_mfma_f32_16x16x32_bf16 v[108:111], v[44:47], v[196:199], v[108:111]
  ds_read_b64_tr_b16 v[62:63], v19 offset:58368
  s_waitcnt lgkmcnt(9)
  v_mfma_f32_16x16x32_bf16 v[80:83], v[32:35], v[200:203], v[80:83]
  v_mfma_f32_16x16x32_bf16 v[84:87], v[36:39], v[200:203], v[84:87]
  v_mfma_f32_16x16x32_bf16 v[112:115], v[40:43], v[200:203], v[112:115]
  v_mfma_f32_16x16x32_bf16 v[116:119], v[44:47], v[200:203], v[116:119]
  s_waitcnt lgkmcnt(8)
  v_mfma_f32_16x16x32_bf16 v[88:91], v[32:35], v[204:207], v[88:91]
  s_waitcnt lgkmcnt(0)
  s_waitcnt vmcnt(9)
  s_barrier
  s_setprio 3
  v_mfma_f32_16x16x32_bf16 v[92:95], v[36:39], v[204:207], v[92:95]
  ds_read_b64_tr_b16 v[32:33], v16 offset:0
  v_mfma_f32_16x16x32_bf16 v[120:123], v[40:43], v[204:207], v[120:123]
  ds_read_b64_tr_b16 v[34:35], v16 offset:1024
  s_add_u32 m0, s59, 0x24000
  s_mov_b32 s32, 0x80000
  buffer_load_dwordx4 v24, s[8:11], s32 offen lds
  v_mfma_f32_16x16x32_bf16 v[124:127], v[44:47], v[204:207], v[124:127]
  ds_read_b64_tr_b16 v[36:37], v17 offset:0
  v_mfma_f32_16x16x32_bf16 v[128:131], v[192:195], v[48:51], v[128:131]
  ds_read_b64_tr_b16 v[38:39], v17 offset:1024
  v_mfma_f32_16x16x32_bf16 v[144:147], v[192:195], v[52:55], v[144:147]
  ds_read_b64_tr_b16 v[40:41], v18 offset:0
  v_mfma_f32_16x16x32_bf16 v[160:163], v[192:195], v[56:59], v[160:163]
  ds_read_b64_tr_b16 v[42:43], v18 offset:1024
  v_mfma_f32_16x16x32_bf16 v[176:179], v[192:195], v[60:63], v[176:179]
  ds_read_b128 v[192:195], v27 offset:32768
  s_add_u32 m0, s59, 0x24400
  s_mov_b32 s32, 0x88000
  buffer_load_dwordx4 v24, s[8:11], s32 offen lds
  v_mfma_f32_16x16x32_bf16 v[132:135], v[196:199], v[48:51], v[132:135]
  s_setprio 2
  ds_read_b64_tr_b16 v[44:45], v19 offset:0
  v_mfma_f32_16x16x32_bf16 v[148:151], v[196:199], v[52:55], v[148:151]
  ds_read_b64_tr_b16 v[46:47], v19 offset:1024
  v_mfma_f32_16x16x32_bf16 v[164:167], v[196:199], v[56:59], v[164:167]
  v_mfma_f32_16x16x32_bf16 v[180:183], v[196:199], v[60:63], v[180:183]
  ds_read_b128 v[196:199], v27 offset:34816
  v_mfma_f32_16x16x32_bf16 v[136:139], v[200:203], v[48:51], v[136:139]
  s_add_u32 m0, s58, 0x0
  s_movk_i32 s33, 0x80
  buffer_load_dwordx4 v25, s[4:7], s33 offen lds
  v_mfma_f32_16x16x32_bf16 v[152:155], v[200:203], v[52:55], v[152:155]
  v_mfma_f32_16x16x32_bf16 v[168:171], v[200:203], v[56:59], v[168:171]
  v_mfma_f32_16x16x32_bf16 v[184:187], v[200:203], v[60:63], v[184:187]
  ds_read_b128 v[200:203], v27 offset:36864
  v_mfma_f32_16x16x32_bf16 v[140:143], v[204:207], v[48:51], v[140:143]
  s_setprio 1
  v_mfma_f32_16x16x32_bf16 v[156:159], v[204:207], v[52:55], v[156:159]
  s_add_u32 m0, s58, 0x400
  s_movk_i32 s33, 0x80
  buffer_load_dwordx4 v26, s[4:7], s33 offen lds
  v_mfma_f32_16x16x32_bf16 v[172:175], v[204:207], v[56:59], v[172:175]
  v_mfma_f32_16x16x32_bf16 v[188:191], v[204:207], v[60:63], v[188:191]
  ds_read_b128 v[204:207], v27 offset:38912
  s_waitcnt lgkmcnt(10)
  s_waitcnt lgkmcnt(5)
  v_mfma_f32_16x16x32_bf16 v[64:67], v[32:35], v[192:195], v[64:67]
  ds_read_b64_tr_b16 v[48:49], v16 offset:8192
  v_mfma_f32_16x16x32_bf16 v[68:71], v[36:39], v[192:195], v[68:71]
  ds_read_b64_tr_b16 v[50:51], v16 offset:9216
  v_mfma_f32_16x16x32_bf16 v[96:99], v[40:43], v[192:195], v[96:99]
  ds_read_b64_tr_b16 v[52:53], v17 offset:8192
  s_waitcnt lgkmcnt(6)
  v_mfma_f32_16x16x32_bf16 v[100:103], v[44:47], v[192:195], v[100:103]
  ds_read_b64_tr_b16 v[54:55], v17 offset:9216
  s_waitcnt lgkmcnt(6)
  v_mfma_f32_16x16x32_bf16 v[72:75], v[32:35], v[196:199], v[72:75]
  s_setprio 0
  ds_read_b64_tr_b16 v[56:57], v18 offset:8192
  v_mfma_f32_16x16x32_bf16 v[76:79], v[36:39], v[196:199], v[76:79]
  ds_read_b64_tr_b16 v[58:59], v18 offset:9216
  v_mfma_f32_16x16x32_bf16 v[104:107], v[40:43], v[196:199], v[104:107]
  ds_read_b64_tr_b16 v[60:61], v19 offset:8192
  v_mfma_f32_16x16x32_bf16 v[108:111], v[44:47], v[196:199], v[108:111]
  ds_read_b64_tr_b16 v[62:63], v19 offset:9216
  s_waitcnt lgkmcnt(9)
  v_mfma_f32_16x16x32_bf16 v[80:83], v[32:35], v[200:203], v[80:83]
  v_mfma_f32_16x16x32_bf16 v[84:87], v[36:39], v[200:203], v[84:87]
  v_mfma_f32_16x16x32_bf16 v[112:115], v[40:43], v[200:203], v[112:115]
  v_mfma_f32_16x16x32_bf16 v[116:119], v[44:47], v[200:203], v[116:119]
  s_waitcnt lgkmcnt(8)
  v_mfma_f32_16x16x32_bf16 v[88:91], v[32:35], v[204:207], v[88:91]
  s_waitcnt lgkmcnt(0)
  s_waitcnt vmcnt(10)
  s_barrier
  s_setprio 3
  s_lshl_b32 s33, s2, 5
  s_add_u32 s33, s33, 0xc400
  v_mov_b32 v14, 1
  buffer_store_dword v14, v13, s[24:27], s33 offen sc1
  v_mfma_f32_16x16x32_bf16 v[92:95], v[36:39], v[204:207], v[92:95]
  ds_read_b64_tr_b16 v[32:33], v16 offset:16384
  v_mfma_f32_16x16x32_bf16 v[120:123], v[40:43], v[204:207], v[120:123]
  ds_read_b64_tr_b16 v[34:35], v16 offset:17408
  s_add_u32 m0, s59, 0x18000
  s_mov_b32 s32, 0x100000
  buffer_load_dwordx4 v24, s[8:11], s32 offen lds
  v_mfma_f32_16x16x32_bf16 v[124:127], v[44:47], v[204:207], v[124:127]
  ds_read_b64_tr_b16 v[36:37], v17 offset:16384
  v_mfma_f32_16x16x32_bf16 v[128:131], v[192:195], v[48:51], v[128:131]
  ds_read_b64_tr_b16 v[38:39], v17 offset:17408
  v_mfma_f32_16x16x32_bf16 v[144:147], v[192:195], v[52:55], v[144:147]
  ds_read_b64_tr_b16 v[40:41], v18 offset:16384
  v_mfma_f32_16x16x32_bf16 v[160:163], v[192:195], v[56:59], v[160:163]
  ds_read_b64_tr_b16 v[42:43], v18 offset:17408
  v_mfma_f32_16x16x32_bf16 v[176:179], v[192:195], v[60:63], v[176:179]
  ds_read_b128 v[192:195], v28 offset:32768
  s_add_u32 m0, s59, 0x18400
  s_mov_b32 s32, 0x108000
  buffer_load_dwordx4 v24, s[8:11], s32 offen lds
  v_mfma_f32_16x16x32_bf16 v[132:135], v[196:199], v[48:51], v[132:135]
  s_setprio 2
  ds_read_b64_tr_b16 v[44:45], v19 offset:16384
  v_mfma_f32_16x16x32_bf16 v[148:151], v[196:199], v[52:55], v[148:151]
  ds_read_b64_tr_b16 v[46:47], v19 offset:17408
  v_mfma_f32_16x16x32_bf16 v[164:167], v[196:199], v[56:59], v[164:167]
  v_mfma_f32_16x16x32_bf16 v[180:183], v[196:199], v[60:63], v[180:183]
  ds_read_b128 v[196:199], v28 offset:34816
  v_mfma_f32_16x16x32_bf16 v[136:139], v[200:203], v[48:51], v[136:139]
  s_add_u32 m0, s58, 0x800
  s_movk_i32 s33, 0x5080
  buffer_load_dwordx4 v25, s[4:7], s33 offen lds
  v_mfma_f32_16x16x32_bf16 v[152:155], v[200:203], v[52:55], v[152:155]
  v_mfma_f32_16x16x32_bf16 v[168:171], v[200:203], v[56:59], v[168:171]
  v_mfma_f32_16x16x32_bf16 v[184:187], v[200:203], v[60:63], v[184:187]
  ds_read_b128 v[200:203], v28 offset:36864
  v_mfma_f32_16x16x32_bf16 v[140:143], v[204:207], v[48:51], v[140:143]
  s_setprio 1
  v_mfma_f32_16x16x32_bf16 v[156:159], v[204:207], v[52:55], v[156:159]
  s_add_u32 m0, s58, 0xc00
  s_movk_i32 s33, 0x5080
  buffer_load_dwordx4 v26, s[4:7], s33 offen lds
  v_mfma_f32_16x16x32_bf16 v[172:175], v[204:207], v[56:59], v[172:175]
  v_mfma_f32_16x16x32_bf16 v[188:191], v[204:207], v[60:63], v[188:191]
  ds_read_b128 v[204:207], v28 offset:38912
  s_waitcnt lgkmcnt(10)
  s_waitcnt lgkmcnt(5)
  v_mfma_f32_16x16x32_bf16 v[64:67], v[32:35], v[192:195], v[64:67]
  ds_read_b64_tr_b16 v[48:49], v16 offset:24576
  v_mfma_f32_16x16x32_bf16 v[68:71], v[36:39], v[192:195], v[68:71]
  ds_read_b64_tr_b16 v[50:51], v16 offset:25600
  s_add_u32 s33, s58, 0x10000
  v_add_u32 v29, s33, v3
  v_add_u32 v30, s33, v4
  v_mfma_f32_16x16x32_bf16 v[96:99], v[40:43], v[192:195], v[96:99]
  ds_read_b64_tr_b16 v[52:53], v17 offset:24576
  v_add_u32 v27, s58, v3
  s_waitcnt lgkmcnt(6)
  v_mfma_f32_16x16x32_bf16 v[100:103], v[44:47], v[192:195], v[100:103]
  ds_read_b64_tr_b16 v[54:55], v17 offset:25600
  s_waitcnt lgkmcnt(6)
  v_mfma_f32_16x16x32_bf16 v[72:75], v[32:35], v[196:199], v[72:75]
  s_setprio 0
  ds_read_b64_tr_b16 v[56:57], v18 offset:24576
  v_add_u32 v28, s58, v4
  v_mfma_f32_16x16x32_bf16 v[76:79], v[36:39], v[196:199], v[76:79]
  ds_read_b64_tr_b16 v[58:59], v18 offset:25600
  v_mfma_f32_16x16x32_bf16 v[104:107], v[40:43], v[196:199], v[104:107]
  ds_read_b64_tr_b16 v[60:61], v19 offset:24576
  v_mfma_f32_16x16x32_bf16 v[108:111], v[44:47], v[196:199], v[108:111]
  ds_read_b64_tr_b16 v[62:63], v19 offset:25600
  v_cvt_pk_bf16_f32 v224, v64, v65
  v_cvt_pk_bf16_f32 v225, v66, v67
  s_waitcnt lgkmcnt(9)
  v_mfma_f32_16x16x32_bf16 v[80:83], v[32:35], v[200:203], v[80:83]
  v_xor_b32 v16, s40, v16
  v_cvt_pk_bf16_f32 v226, v68, v69
  v_cvt_pk_bf16_f32 v227, v70, v71
  v_mfma_f32_16x16x32_bf16 v[84:87], v[36:39], v[200:203], v[84:87]
  v_xor_b32 v17, s40, v17
  v_cvt_pk_bf16_f32 v240, v96, v97
  v_mfma_f32_16x16x32_bf16 v[112:115], v[40:43], v[200:203], v[112:115]
  v_xor_b32 v18, s40, v18
  v_cvt_pk_bf16_f32 v241, v98, v99
  v_cvt_pk_bf16_f32 v242, v100, v101
  v_mfma_f32_16x16x32_bf16 v[116:119], v[44:47], v[200:203], v[116:119]
  v_xor_b32 v19, s40, v19
  v_cvt_pk_bf16_f32 v243, v102, v103
  s_waitcnt lgkmcnt(8)
  v_mfma_f32_16x16x32_bf16 v[88:91], v[32:35], v[204:207], v[88:91]
  s_waitcnt lgkmcnt(0)
  s_waitcnt vmcnt(9)
  s_barrier
  s_setprio 3
  s_mov_b32 s40, s39
  v_cvt_pk_bf16_f32 v228, v72, v73
  v_cvt_pk_bf16_f32 v229, v74, v75
  v_mfma_f32_16x16x32_bf16 v[92:95], v[36:39], v[204:207], v[92:95]
  v_xor_b32 v20, 0x80, v16
  v_cvt_pk_bf16_f32 v230, v76, v77
  v_cvt_pk_bf16_f32 v231, v78, v79
  v_mfma_f32_16x16x32_bf16 v[120:123], v[40:43], v[204:207], v[120:123]
  s_add_u32 m0, s59, 0x1c000
  s_mov_b32 s32, 0x180000
  buffer_load_dwordx4 v24, s[8:11], s32 offen lds
  v_xor_b32 v21, 0x80, v17
  v_cvt_pk_bf16_f32 v244, v104, v105
  v_mfma_f32_16x16x32_bf16 v[124:127], v[44:47], v[204:207], v[124:127]
  v_xor_b32 v22, 0x80, v18
  v_cvt_pk_bf16_f32 v245, v106, v107
  v_cvt_pk_bf16_f32 v246, v108, v109
  v_mfma_f32_16x16x32_bf16 v[128:131], v[192:195], v[48:51], v[128:131]
  v_xor_b32 v23, 0x80, v19
  v_cvt_pk_bf16_f32 v247, v110, v111
  ds_read_b64_tr_b16 v[32:33], v16 offset:32768
  v_mfma_f32_16x16x32_bf16 v[144:147], v[192:195], v[52:55], v[144:147]
  v_cvt_pk_bf16_f32 v232, v80, v81
  v_cvt_pk_bf16_f32 v233, v82, v83
  ds_read_b64_tr_b16 v[34:35], v16 offset:33792
  v_mfma_f32_16x16x32_bf16 v[160:163], v[192:195], v[56:59], v[160:163]
  v_cvt_pk_bf16_f32 v234, v84, v85
  v_cvt_pk_bf16_f32 v235, v86, v87
  ds_read_b128 v[208:211], v29 offset:0
  v_mfma_f32_16x16x32_bf16 v[176:179], v[192:195], v[60:63], v[176:179]
  s_add_u32 m0, s59, 0x1c400
  s_mov_b32 s32, 0x188000
  buffer_load_dwordx4 v24, s[8:11], s32 offen lds
  v_cvt_pk_bf16_f32 v248, v112, v113
  ds_read_b128 v[212:215], v29 offset:2048
  v_mfma_f32_16x16x32_bf16 v[132:135], v[196:199], v[48:51], v[132:135]
  s_setprio 2
  v_cvt_pk_bf16_f32 v249, v114, v115
  v_cvt_pk_bf16_f32 v250, v116, v117
  v_mfma_f32_16x16x32_bf16 v[148:151], v[196:199], v[52:55], v[148:151]
  v_cvt_pk_bf16_f32 v251, v118, v119
  ds_read_b64_tr_b16 v[36:37], v16 offset:40960
  v_mfma_f32_16x16x32_bf16 v[164:167], v[196:199], v[56:59], v[164:167]
  v_cvt_pk_bf16_f32 v236, v88, v89
  v_cvt_pk_bf16_f32 v237, v90, v91
  ds_read_b64_tr_b16 v[38:39], v16 offset:41984
  v_mfma_f32_16x16x32_bf16 v[180:183], v[196:199], v[60:63], v[180:183]
  v_cvt_pk_bf16_f32 v238, v92, v93
  v_cvt_pk_bf16_f32 v239, v94, v95
  ds_read_b128 v[216:219], v30 offset:0
  v_mfma_f32_16x16x32_bf16 v[136:139], v[200:203], v[48:51], v[136:139]
  s_add_u32 m0, s58, 0x8000
  s_movk_i32 s33, 0x100
  buffer_load_dwordx4 v25, s[4:7], s33 offen lds
  v_cvt_pk_bf16_f32 v252, v120, v121
  ds_read_b128 v[220:223], v30 offset:2048
  v_mfma_f32_16x16x32_bf16 v[152:155], v[200:203], v[52:55], v[152:155]
  v_cvt_pk_bf16_f32 v253, v122, v123
  v_cvt_pk_bf16_f32 v254, v124, v125
  v_mfma_f32_16x16x32_bf16 v[168:171], v[200:203], v[56:59], v[168:171]
  v_cvt_pk_bf16_f32 v255, v126, v127
  ds_read_b64_tr_b16 v[40:41], v17 offset:32768
  v_mfma_f32_16x16x32_bf16 v[184:187], v[200:203], v[60:63], v[184:187]
  v_cvt_pk_bf16_f32 v128, v128, v129
  v_cvt_pk_bf16_f32 v129, v130, v131
  ds_read_b64_tr_b16 v[42:43], v17 offset:33792
  v_mfma_f32_16x16x32_bf16 v[140:143], v[204:207], v[48:51], v[140:143]
  s_setprio 1
  v_cvt_pk_bf16_f32 v130, v132, v133
  v_cvt_pk_bf16_f32 v131, v134, v135
  ds_read_b64_tr_b16 v[44:45], v17 offset:40960
  v_mfma_f32_16x16x32_bf16 v[156:159], v[204:207], v[52:55], v[156:159]
  s_add_u32 m0, s58, 0x8400
  s_movk_i32 s33, 0x100
  buffer_load_dwordx4 v26, s[4:7], s33 offen lds
  v_cvt_pk_bf16_f32 v144, v144, v145
  ds_read_b64_tr_b16 v[46:47], v17 offset:41984
  v_mfma_f32_16x16x32_bf16 v[172:175], v[204:207], v[56:59], v[172:175]
  v_cvt_pk_bf16_f32 v145, v146, v147
  v_cvt_pk_bf16_f32 v146, v148, v149
  v_mfma_f32_16x16x32_bf16 v[188:191], v[204:207], v[60:63], v[188:191]
  v_cvt_pk_bf16_f32 v147, v150, v151
  s_waitcnt lgkmcnt(10)
  s_waitcnt lgkmcnt(9)
  v_mfma_f32_16x16x32_bf16 v[64:67], v[32:35], v[208:211], 0
  v_cvt_pk_bf16_f32 v160, v160, v161
  v_cvt_pk_bf16_f32 v161, v162, v163
  ds_read_b64_tr_b16 v[48:49], v18 offset:32768
  ds_read_b64_tr_b16 v[50:51], v18 offset:33792
  s_waitcnt lgkmcnt(10)
  v_mfma_f32_16x16x32_bf16 v[68:71], v[32:35], v[212:215], 0
  v_cvt_pk_bf16_f32 v162, v164, v165
  v_cvt_pk_bf16_f32 v163, v166, v167
  s_add_u32 m0, s58, 0x8800
  s_movk_i32 s33, 0x5100
  buffer_load_dwordx4 v25, s[4:7], s33 offen lds
  ds_read_b64_tr_b16 v[52:53], v18 offset:40960
  s_waitcnt lgkmcnt(9)
  s_waitcnt lgkmcnt(8)
  v_mfma_f32_16x16x32_bf16 v[64:67], v[36:39], v[216:219], v[64:67]
  v_cvt_pk_bf16_f32 v176, v176, v177
  ds_read_b64_tr_b16 v[54:55], v18 offset:41984
  s_waitcnt lgkmcnt(8)
  v_mfma_f32_16x16x32_bf16 v[68:71], v[36:39], v[220:223], v[68:71]
  v_cvt_pk_bf16_f32 v177, v178, v179
  v_cvt_pk_bf16_f32 v178, v180, v181
  ds_read_b64_tr_b16 v[56:57], v19 offset:32768
  ds_read_b64_tr_b16 v[58:59], v19 offset:33792
  s_waitcnt lgkmcnt(8)
  v_mfma_f32_16x16x32_bf16 v[72:75], v[40:43], v[208:211], 0
  s_setprio 0
  v_cvt_pk_bf16_f32 v179, v182, v183
  s_add_u32 m0, s58, 0x8c00
  s_movk_i32 s33, 0x5100
  buffer_load_dwordx4 v26, s[4:7], s33 offen lds
  ds_read_b64_tr_b16 v[60:61], v19 offset:40960
  v_mfma_f32_16x16x32_bf16 v[76:79], v[40:43], v[212:215], 0
  v_cvt_pk_bf16_f32 v136, v136, v137
  v_cvt_pk_bf16_f32 v137, v138, v139
  ds_read_b64_tr_b16 v[62:63], v19 offset:41984
  s_waitcnt lgkmcnt(8)
  v_mfma_f32_16x16x32_bf16 v[72:75], v[44:47], v[216:219], v[72:75]
  v_cvt_pk_bf16_f32 v138, v140, v141
  v_cvt_pk_bf16_f32 v139, v142, v143
  v_mfma_f32_16x16x32_bf16 v[76:79], v[44:47], v[220:223], v[76:79]
  v_cvt_pk_bf16_f32 v152, v152, v153
  s_add_u32 s33, s44, 0x0
  buffer_store_dwordx4 v[224:227], v2, s[12:15], s33 offen offset:0 sc1
  s_waitcnt lgkmcnt(6)
  v_mfma_f32_16x16x32_bf16 v[80:83], v[48:51], v[208:211], 0
  v_cvt_pk_bf16_f32 v153, v154, v155
  v_cvt_pk_bf16_f32 v154, v156, v157
  ds_read_b64_tr_b16 v[32:33], v20 offset:32768
  ds_read_b64_tr_b16 v[34:35], v20 offset:33792
  s_add_u32 m0, s58, 0x10000
  s_movk_i32 s33, 0x180
  buffer_load_dwordx4 v25, s[4:7], s33 offen lds
  v_mfma_f32_16x16x32_bf16 v[84:87], v[48:51], v[212:215], 0
  v_cvt_pk_bf16_f32 v155, v158, v159
  ds_read_b64_tr_b16 v[36:37], v20 offset:40960
  s_waitcnt lgkmcnt(7)
  v_mfma_f32_16x16x32_bf16 v[80:83], v[52:55], v[216:219], v[80:83]
  v_cvt_pk_bf16_f32 v168, v168, v169
  v_cvt_pk_bf16_f32 v169, v170, v171
  ds_read_b64_tr_b16 v[38:39], v20 offset:41984
  v_mfma_f32_16x16x32_bf16 v[84:87], v[52:55], v[220:223], v[84:87]
  v_cvt_pk_bf16_f32 v170, v172, v173
  v_cvt_pk_bf16_f32 v171, v174, v175
  ds_read_b64_tr_b16 v[40:41], v21 offset:32768
  ds_read_b64_tr_b16 v[42:43], v21 offset:33792
  s_waitcnt lgkmcnt(8)
  v_mfma_f32_16x16x32_bf16 v[88:91], v[56:59], v[208:211], 0
  v_cvt_pk_bf16_f32 v184, v184, v185
  ds_read_b64_tr_b16 v[44:45], v21 offset:40960
  s_add_u32 m0, s58, 0x10400
  s_movk_i32 s33, 0x180
  buffer_load_dwordx4 v26, s[4:7], s33 offen lds
  v_mfma_f32_16x16x32_bf16 v[92:95], v[56:59], v[212:215], 0
  v_cvt_pk_bf16_f32 v185, v186, v187
  v_cvt_pk_bf16_f32 v186, v188, v189
  ds_read_b64_tr_b16 v[46:47], v21 offset:41984
  s_waitcnt lgkmcnt(8)
  v_mfma_f32_16x16x32_bf16 v[88:91], v[60:63], v[216:219], v[88:91]
  v_cvt_pk_bf16_f32 v187, v190, v191
  v_mfma_f32_16x16x32_bf16 v[92:95], v[60:63], v[220:223], v[92:95]
  s_waitcnt lgkmcnt(6)
  v_mfma_f32_16x16x32_bf16 v[96:99], v[32:35], v[208:211], 0
  ds_read_b64_tr_b16 v[48:49], v22 offset:32768
  ds_read_b64_tr_b16 v[50:51], v22 offset:33792
  s_add_u32 m0, s58, 0x10800
  s_movk_i32 s33, 0x5180
  buffer_load_dwordx4 v25, s[4:7], s33 offen lds
  v_mfma_f32_16x16x32_bf16 v[100:103], v[32:35], v[212:215], 0
  ds_read_b64_tr_b16 v[52:53], v22 offset:40960
  s_waitcnt lgkmcnt(7)
  v_mfma_f32_16x16x32_bf16 v[96:99], v[36:39], v[216:219], v[96:99]
  ds_read_b64_tr_b16 v[54:55], v22 offset:41984
  v_mfma_f32_16x16x32_bf16 v[100:103], v[36:39], v[220:223], v[100:103]
  ds_read_b64_tr_b16 v[56:57], v23 offset:32768
  ds_read_b64_tr_b16 v[58:59], v23 offset:33792
  s_waitcnt lgkmcnt(8)
  v_mfma_f32_16x16x32_bf16 v[104:107], v[40:43], v[208:211], 0
  ds_read_b64_tr_b16 v[60:61], v23 offset:40960
  s_add_u32 m0, s58, 0x10c00
  s_movk_i32 s33, 0x5180
  buffer_load_dwordx4 v26, s[4:7], s33 offen lds
  v_mfma_f32_16x16x32_bf16 v[108:111], v[40:43], v[212:215], 0
  ds_read_b64_tr_b16 v[62:63], v23 offset:41984
  s_waitcnt lgkmcnt(8)
  v_mfma_f32_16x16x32_bf16 v[104:107], v[44:47], v[216:219], v[104:107]
  s_add_u32 s33, s44, 0x1000
  buffer_store_dwordx4 v[228:231], v2, s[12:15], s33 offen offset:0 sc1
  v_mfma_f32_16x16x32_bf16 v[108:111], v[44:47], v[220:223], v[108:111]
  s_waitcnt lgkmcnt(6)
  v_mfma_f32_16x16x32_bf16 v[112:115], v[48:51], v[208:211], 0
  v_mfma_f32_16x16x32_bf16 v[116:119], v[48:51], v[212:215], 0
  s_waitcnt lgkmcnt(0)
  s_waitcnt vmcnt(12)
  s_barrier
  s_setprio 3
  ds_read_b64_tr_b16 v[32:33], v16 offset:49152
  ds_read_b64_tr_b16 v[34:35], v16 offset:50176
  v_mfma_f32_16x16x32_bf16 v[112:115], v[52:55], v[216:219], v[112:115]
  ds_read_b128 v[192:195], v27 offset:0
  ds_read_b128 v[196:199], v27 offset:2048
  v_mfma_f32_16x16x32_bf16 v[116:119], v[52:55], v[220:223], v[116:119]
  ds_read_b64_tr_b16 v[36:37], v16 offset:57344
  ds_read_b64_tr_b16 v[38:39], v16 offset:58368
  v_mfma_f32_16x16x32_bf16 v[120:123], v[56:59], v[208:211], 0
  ds_read_b128 v[200:203], v28 offset:0
  ds_read_b128 v[204:207], v28 offset:2048
  s_add_u32 m0, s59, 0x20000
  s_mov_b32 s32, 0x200000
  buffer_load_dwordx4 v24, s[8:11], s32 offen lds
  v_mfma_f32_16x16x32_bf16 v[124:127], v[56:59], v[212:215], 0
  ds_read_b64_tr_b16 v[40:41], v17 offset:49152
  ds_read_b64_tr_b16 v[42:43], v17 offset:50176
  v_mfma_f32_16x16x32_bf16 v[120:123], v[60:63], v[216:219], v[120:123]
  ds_read_b64_tr_b16 v[44:45], v17 offset:57344
  ds_read_b64_tr_b16 v[46:47], v17 offset:58368
  v_mfma_f32_16x16x32_bf16 v[124:127], v[60:63], v[220:223], v[124:127]
  s_waitcnt lgkmcnt(10)
  s_waitcnt lgkmcnt(9)
  v_mfma_f32_16x16x32_bf16 v[64:67], v[32:35], v[192:195], v[64:67]
  s_add_u32 m0, s59, 0x20400
  s_mov_b32 s32, 0x208000
  buffer_load_dwordx4 v24, s[8:11], s32 offen lds
  ds_read_b64_tr_b16 v[48:49], v18 offset:49152
  ds_read_b64_tr_b16 v[50:51], v18 offset:50176
  s_waitcnt lgkmcnt(10)
  v_mfma_f32_16x16x32_bf16 v[68:71], v[32:35], v[196:199], v[68:71]
  s_setprio 2
  ds_read_b64_tr_b16 v[52:53], v18 offset:57344
  s_waitcnt lgkmcnt(9)
  s_waitcnt lgkmcnt(8)
  v_mfma_f32_16x16x32_bf16 v[64:67], v[36:39], v[200:203], v[64:67]
  ds_read_b64_tr_b16 v[54:55], v18 offset:58368
  s_waitcnt lgkmcnt(8)
  v_mfma_f32_16x16x32_bf16 v[68:71], v[36:39], v[204:207], v[68:71]
  ds_read_b64_tr_b16 v[56:57], v19 offset:49152
  ds_read_b64_tr_b16 v[58:59], v19 offset:50176
  s_waitcnt lgkmcnt(8)
  v_mfma_f32_16x16x32_bf16 v[72:75], v[40:43], v[192:195], v[72:75]
  ds_read_b64_tr_b16 v[60:61], v19 offset:57344
  v_mfma_f32_16x16x32_bf16 v[76:79], v[40:43], v[196:199], v[76:79]
  s_add_u32 s33, s45, 0x0
  buffer_store_dwordx4 v[128:131], v2, s[12:15], s33 offen offset:0 sc1
  ds_read_b64_tr_b16 v[62:63], v19 offset:58368
  s_waitcnt lgkmcnt(8)
  v_mfma_f32_16x16x32_bf16 v[72:75], v[44:47], v[200:203], v[72:75]
  v_mfma_f32_16x16x32_bf16 v[76:79], v[44:47], v[204:207], v[76:79]
  s_waitcnt lgkmcnt(6)
  v_mfma_f32_16x16x32_bf16 v[80:83], v[48:51], v[192:195], v[80:83]
  ds_read_b64_tr_b16 v[32:33], v20 offset:49152
  ds_read_b64_tr_b16 v[34:35], v20 offset:50176
  s_add_u32 m0, s58, 0x0
  s_movk_i32 s33, 0x200
  buffer_load_dwordx4 v25, s[4:7], s33 offen lds
  v_mfma_f32_16x16x32_bf16 v[84:87], v[48:51], v[196:199], v[84:87]
  s_setprio 1
  ds_read_b64_tr_b16 v[36:37], v20 offset:57344
  s_waitcnt lgkmcnt(7)
  v_mfma_f32_16x16x32_bf16 v[80:83], v[52:55], v[200:203], v[80:83]
  ds_read_b64_tr_b16 v[38:39], v20 offset:58368
  v_mfma_f32_16x16x32_bf16 v[84:87], v[52:55], v[204:207], v[84:87]
  ds_read_b64_tr_b16 v[40:41], v21 offset:49152
  ds_read_b64_tr_b16 v[42:43], v21 offset:50176
  s_waitcnt lgkmcnt(8)
  v_mfma_f32_16x16x32_bf16 v[88:91], v[56:59], v[192:195], v[88:91]
  ds_read_b64_tr_b16 v[44:45], v21 offset:57344
  s_add_u32 m0, s58, 0x400
  s_movk_i32 s33, 0x200
  buffer_load_dwordx4 v26, s[4:7], s33 offen lds
  v_mfma_f32_16x16x32_bf16 v[92:95], v[56:59], v[196:199], v[92:95]
  ds_read_b64_tr_b16 v[46:47], v21 offset:58368
  s_waitcnt lgkmcnt(8)
  v_mfma_f32_16x16x32_bf16 v[88:91], v[60:63], v[200:203], v[88:91]
  v_mfma_f32_16x16x32_bf16 v[92:95], v[60:63], v[204:207], v[92:95]
  s_waitcnt lgkmcnt(6)
  v_mfma_f32_16x16x32_bf16 v[96:99], v[32:35], v[192:195], v[96:99]
  ds_read_b64_tr_b16 v[48:49], v22 offset:49152
  ds_read_b64_tr_b16 v[50:51], v22 offset:50176
  s_add_u32 m0, s58, 0x800
  s_movk_i32 s33, 0x5200
  buffer_load_dwordx4 v25, s[4:7], s33 offen lds
  v_mfma_f32_16x16x32_bf16 v[100:103], v[32:35], v[196:199], v[100:103]
  s_setprio 0
  ds_read_b64_tr_b16 v[52:53], v22 offset:57344
  s_waitcnt lgkmcnt(7)
  v_mfma_f32_16x16x32_bf16 v[96:99], v[36:39], v[200:203], v[96:99]
  ds_read_b64_tr_b16 v[54:55], v22 offset:58368
  v_mfma_f32_16x16x32_bf16 v[100:103], v[36:39], v[204:207], v[100:103]
  ds_read_b64_tr_b16 v[56:57], v23 offset:49152
  ds_read_b64_tr_b16 v[58:59], v23 offset:50176
  s_waitcnt lgkmcnt(8)
  v_mfma_f32_16x16x32_bf16 v[104:107], v[40:43], v[192:195], v[104:107]
  s_add_u32 s33, s45, 0x4000
  buffer_store_dwordx4 v[136:139], v2, s[12:15], s33 offen offset:0 sc1
  ds_read_b64_tr_b16 v[60:61], v23 offset:57344
  s_add_u32 m0, s58, 0xc00
  s_movk_i32 s33, 0x5200
  buffer_load_dwordx4 v26, s[4:7], s33 offen lds
  v_mfma_f32_16x16x32_bf16 v[108:111], v[40:43], v[196:199], v[108:111]
  ds_read_b64_tr_b16 v[62:63], v23 offset:58368
  s_waitcnt lgkmcnt(8)
  v_mfma_f32_16x16x32_bf16 v[104:107], v[44:47], v[200:203], v[104:107]
  v_mfma_f32_16x16x32_bf16 v[108:111], v[44:47], v[204:207], v[108:111]
  s_waitcnt lgkmcnt(6)
  v_mfma_f32_16x16x32_bf16 v[112:115], v[48:51], v[192:195], v[112:115]
  v_mfma_f32_16x16x32_bf16 v[116:119], v[48:51], v[196:199], v[116:119]
  s_waitcnt lgkmcnt(0)
  s_waitcnt vmcnt(14)
  s_barrier
  s_setprio 3
  ds_read_b64_tr_b16 v[32:33], v16 offset:0
  ds_read_b64_tr_b16 v[34:35], v16 offset:1024
  v_mfma_f32_16x16x32_bf16 v[112:115], v[52:55], v[200:203], v[112:115]
  ds_read_b128 v[208:211], v27 offset:32768
  ds_read_b128 v[212:215], v27 offset:34816
  v_mfma_f32_16x16x32_bf16 v[116:119], v[52:55], v[204:207], v[116:119]
  ds_read_b64_tr_b16 v[36:37], v16 offset:8192
  ds_read_b64_tr_b16 v[38:39], v16 offset:9216
  v_mfma_f32_16x16x32_bf16 v[120:123], v[56:59], v[192:195], v[120:123]
  ds_read_b128 v[216:219], v28 offset:32768
  ds_read_b128 v[220:223], v28 offset:34816
  s_add_u32 m0, s59, 0x24000
  s_mov_b32 s32, 0x280000
  buffer_load_dwordx4 v24, s[8:11], s32 offen lds
  v_mfma_f32_16x16x32_bf16 v[124:127], v[56:59], v[196:199], v[124:127]
  ds_read_b64_tr_b16 v[40:41], v17 offset:0
  ds_read_b64_tr_b16 v[42:43], v17 offset:1024
  v_mfma_f32_16x16x32_bf16 v[120:123], v[60:63], v[200:203], v[120:123]
  ds_read_b64_tr_b16 v[44:45], v17 offset:8192
  ds_read_b64_tr_b16 v[46:47], v17 offset:9216
  v_mfma_f32_16x16x32_bf16 v[124:127], v[60:63], v[204:207], v[124:127]
  s_waitcnt lgkmcnt(10)
  s_waitcnt lgkmcnt(9)
  v_mfma_f32_16x16x32_bf16 v[64:67], v[32:35], v[208:211], v[64:67]
  s_add_u32 m0, s59, 0x24400
  s_mov_b32 s32, 0x288000
  buffer_load_dwordx4 v24, s[8:11], s32 offen lds
  ds_read_b64_tr_b16 v[48:49], v18 offset:0
  ds_read_b64_tr_b16 v[50:51], v18 offset:1024
  s_waitcnt lgkmcnt(10)
  v_mfma_f32_16x16x32_bf16 v[68:71], v[32:35], v[212:215], v[68:71]
  s_setprio 2
  ds_read_b64_tr_b16 v[52:53], v18 offset:8192
  s_waitcnt lgkmcnt(9)
  s_waitcnt lgkmcnt(8)
  v_mfma_f32_16x16x32_bf16 v[64:67], v[36:39], v[216:219], v[64:67]
  ds_read_b64_tr_b16 v[54:55], v18 offset:9216
  s_waitcnt lgkmcnt(8)
  v_mfma_f32_16x16x32_bf16 v[68:71], v[36:39], v[220:223], v[68:71]
  s_add_u32 s33, s45, 0x0
  buffer_store_dwordx4 v[144:147], v2, s[12:15], s33 offen offset:1024 sc1
  ds_read_b64_tr_b16 v[56:57], v19 offset:0
  ds_read_b64_tr_b16 v[58:59], v19 offset:1024
  s_waitcnt lgkmcnt(8)
  v_mfma_f32_16x16x32_bf16 v[72:75], v[40:43], v[208:211], v[72:75]
  ds_read_b64_tr_b16 v[60:61], v19 offset:8192
  v_mfma_f32_16x16x32_bf16 v[76:79], v[40:43], v[212:215], v[76:79]
  ds_read_b64_tr_b16 v[62:63], v19 offset:9216
  s_waitcnt lgkmcnt(8)
  v_mfma_f32_16x16x32_bf16 v[72:75], v[44:47], v[216:219], v[72:75]
  v_mfma_f32_16x16x32_bf16 v[76:79], v[44:47], v[220:223], v[76:79]
  s_waitcnt lgkmcnt(6)
  v_mfma_f32_16x16x32_bf16 v[80:83], v[48:51], v[208:211], v[80:83]
  ds_read_b64_tr_b16 v[32:33], v20 offset:0
  ds_read_b64_tr_b16 v[34:35], v20 offset:1024
  s_add_u32 m0, s58, 0x8000
  s_movk_i32 s33, 0x280
  buffer_load_dwordx4 v25, s[4:7], s33 offen lds
  v_mfma_f32_16x16x32_bf16 v[84:87], v[48:51], v[212:215], v[84:87]
  s_setprio 1
  ds_read_b64_tr_b16 v[36:37], v20 offset:8192
  s_waitcnt lgkmcnt(7)
  v_mfma_f32_16x16x32_bf16 v[80:83], v[52:55], v[216:219], v[80:83]
  ds_read_b64_tr_b16 v[38:39], v20 offset:9216
  v_mfma_f32_16x16x32_bf16 v[84:87], v[52:55], v[220:223], v[84:87]
  ds_read_b64_tr_b16 v[40:41], v21 offset:0
  ds_read_b64_tr_b16 v[42:43], v21 offset:1024
  s_waitcnt lgkmcnt(8)
  v_mfma_f32_16x16x32_bf16 v[88:91], v[56:59], v[208:211], v[88:91]
  ds_read_b64_tr_b16 v[44:45], v21 offset:8192
  s_add_u32 m0, s58, 0x8400
  s_movk_i32 s33, 0x280
  buffer_load_dwordx4 v26, s[4:7], s33 offen lds
  v_mfma_f32_16x16x32_bf16 v[92:95], v[56:59], v[212:215], v[92:95]
  ds_read_b64_tr_b16 v[46:47], v21 offset:9216
  s_waitcnt lgkmcnt(8)
  v_mfma_f32_16x16x32_bf16 v[88:91], v[60:63], v[216:219], v[88:91]
  v_mfma_f32_16x16x32_bf16 v[92:95], v[60:63], v[220:223], v[92:95]
  s_waitcnt lgkmcnt(6)
  v_mfma_f32_16x16x32_bf16 v[96:99], v[32:35], v[208:211], v[96:99]
  ds_read_b64_tr_b16 v[48:49], v22 offset:0
  ds_read_b64_tr_b16 v[50:51], v22 offset:1024
  s_add_u32 m0, s58, 0x8800
  s_movk_i32 s33, 0x5280
  buffer_load_dwordx4 v25, s[4:7], s33 offen lds
  v_mfma_f32_16x16x32_bf16 v[100:103], v[32:35], v[212:215], v[100:103]
  s_setprio 0
  ds_read_b64_tr_b16 v[52:53], v22 offset:8192
  s_waitcnt lgkmcnt(7)
  v_mfma_f32_16x16x32_bf16 v[96:99], v[36:39], v[216:219], v[96:99]
  s_add_u32 s33, s45, 0x4000
  buffer_store_dwordx4 v[152:155], v2, s[12:15], s33 offen offset:1024 sc1
  ds_read_b64_tr_b16 v[54:55], v22 offset:9216
  v_mfma_f32_16x16x32_bf16 v[100:103], v[36:39], v[220:223], v[100:103]
  ds_read_b64_tr_b16 v[56:57], v23 offset:0
  ds_read_b64_tr_b16 v[58:59], v23 offset:1024
  s_waitcnt lgkmcnt(8)
  v_mfma_f32_16x16x32_bf16 v[104:107], v[40:43], v[208:211], v[104:107]
  ds_read_b64_tr_b16 v[60:61], v23 offset:8192
  s_add_u32 m0, s58, 0x8c00
  s_movk_i32 s33, 0x5280
  buffer_load_dwordx4 v26, s[4:7], s33 offen lds
  v_mfma_f32_16x16x32_bf16 v[108:111], v[40:43], v[212:215], v[108:111]
  ds_read_b64_tr_b16 v[62:63], v23 offset:9216
  s_waitcnt lgkmcnt(8)
  v_mfma_f32_16x16x32_bf16 v[104:107], v[44:47], v[216:219], v[104:107]
  v_mfma_f32_16x16x32_bf16 v[108:111], v[44:47], v[220:223], v[108:111]
  s_waitcnt lgkmcnt(6)
  v_mfma_f32_16x16x32_bf16 v[112:115], v[48:51], v[208:211], v[112:115]
  v_mfma_f32_16x16x32_bf16 v[116:119], v[48:51], v[212:215], v[116:119]
  s_waitcnt lgkmcnt(0)
  s_waitcnt vmcnt(17)
  s_barrier
  s_setprio 3
  ds_read_b64_tr_b16 v[32:33], v16 offset:16384
  ds_read_b64_tr_b16 v[34:35], v16 offset:17408
  v_mfma_f32_16x16x32_bf16 v[112:115], v[52:55], v[216:219], v[112:115]
  ds_read_b128 v[192:195], v29 offset:0
  ds_read_b128 v[196:199], v29 offset:2048
  v_mfma_f32_16x16x32_bf16 v[116:119], v[52:55], v[220:223], v[116:119]
  ds_read_b64_tr_b16 v[36:37], v16 offset:24576
  ds_read_b64_tr_b16 v[38:39], v16 offset:25600
  v_mfma_f32_16x16x32_bf16 v[120:123], v[56:59], v[208:211], v[120:123]
  ds_read_b128 v[200:203], v30 offset:0
  ds_read_b128 v[204:207], v30 offset:2048
  s_add_u32 m0, s59, 0x18000
  s_mov_b32 s32, 0x300000
  buffer_load_dwordx4 v24, s[8:11], s32 offen lds
  v_mfma_f32_16x16x32_bf16 v[124:127], v[56:59], v[212:215], v[124:127]
  ds_read_b64_tr_b16 v[40:41], v17 offset:16384
  ds_read_b64_tr_b16 v[42:43], v17 offset:17408
  v_mfma_f32_16x16x32_bf16 v[120:123], v[60:63], v[216:219], v[120:123]
  ds_read_b64_tr_b16 v[44:45], v17 offset:24576
  ds_read_b64_tr_b16 v[46:47], v17 offset:25600
  v_mfma_f32_16x16x32_bf16 v[124:127], v[60:63], v[220:223], v[124:127]
  s_waitcnt lgkmcnt(10)
  s_waitcnt lgkmcnt(9)
  v_mfma_f32_16x16x32_bf16 v[64:67], v[32:35], v[192:195], v[64:67]
  s_add_u32 m0, s59, 0x18400
  s_mov_b32 s32, 0x308000
  buffer_load_dwordx4 v24, s[8:11], s32 offen lds
  ds_read_b64_tr_b16 v[48:49], v18 offset:16384
  ds_read_b64_tr_b16 v[50:51], v18 offset:17408
  s_waitcnt lgkmcnt(10)
  v_mfma_f32_16x16x32_bf16 v[68:71], v[32:35], v[196:199], v[68:71]
  s_setprio 2
  ds_read_b64_tr_b16 v[52:53], v18 offset:24576
  s_waitcnt lgkmcnt(9)
  s_waitcnt lgkmcnt(8)
  v_mfma_f32_16x16x32_bf16 v[64:67], v[36:39], v[200:203], v[64:67]
  s_add_u32 s33, s45, 0x0
  buffer_store_dwordx4 v[160:163], v2, s[12:15], s33 offen offset:2048 sc1
  ds_read_b64_tr_b16 v[54:55], v18 offset:25600
  s_waitcnt lgkmcnt(8)
  v_mfma_f32_16x16x32_bf16 v[68:71], v[36:39], v[204:207], v[68:71]
  ds_read_b64_tr_b16 v[56:57], v19 offset:16384
  ds_read_b64_tr_b16 v[58:59], v19 offset:17408
  s_waitcnt lgkmcnt(8)
  v_mfma_f32_16x16x32_bf16 v[72:75], v[40:43], v[192:195], v[72:75]
  ds_read_b64_tr_b16 v[60:61], v19 offset:24576
  s_lshl_b32 s32, s37, 20
  s_add_u32 s16, s98, s32
  s_addc_u32 s17, s99, 0
  s_and_b32 s17, s17, 0xffff
  v_mfma_f32_16x16x32_bf16 v[76:79], v[40:43], v[196:199], v[76:79]
  ds_read_b64_tr_b16 v[62:63], v19 offset:25600
  s_waitcnt lgkmcnt(8)
  v_mfma_f32_16x16x32_bf16 v[72:75], v[44:47], v[200:203], v[72:75]
  v_mfma_f32_16x16x32_bf16 v[76:79], v[44:47], v[204:207], v[76:79]
  s_sub_u32 s32, 16, s36
  s_lshl_b32 s18, s32, 16
  s_mov_b32 s19, 0x00020000
  s_mov_b32 s63, s18
  s_waitcnt lgkmcnt(6)
  v_mfma_f32_16x16x32_bf16 v[80:83], v[48:51], v[192:195], v[80:83]
  ds_read_b64_tr_b16 v[32:33], v20 offset:16384
  ds_read_b64_tr_b16 v[34:35], v20 offset:17408
  s_add_u32 m0, s58, 0x10000
  s_movk_i32 s33, 0x300
  buffer_load_dwordx4 v25, s[4:7], s33 offen lds
  v_mfma_f32_16x16x32_bf16 v[84:87], v[48:51], v[196:199], v[84:87]
  s_setprio 1
  ds_read_b64_tr_b16 v[36:37], v20 offset:24576
  s_waitcnt lgkmcnt(7)
  v_mfma_f32_16x16x32_bf16 v[80:83], v[52:55], v[200:203], v[80:83]
  ds_read_b64_tr_b16 v[38:39], v20 offset:25600
  s_lshl_b32 s32, s37, 13
  s_add_u32 s56, s56, s32
  s_add_u32 s57, s57, s32
  v_mfma_f32_16x16x32_bf16 v[84:87], v[52:55], v[204:207], v[84:87]
  ds_read_b64_tr_b16 v[40:41], v21 offset:16384
  ds_read_b64_tr_b16 v[42:43], v21 offset:17408
  s_waitcnt lgkmcnt(8)
  v_mfma_f32_16x16x32_bf16 v[88:91], v[56:59], v[192:195], v[88:91]
  ds_read_b64_tr_b16 v[44:45], v21 offset:24576
  s_add_u32 m0, s58, 0x10400
  s_movk_i32 s33, 0x300
  buffer_load_dwordx4 v26, s[4:7], s33 offen lds
  v_mfma_f32_16x16x32_bf16 v[92:95], v[56:59], v[196:199], v[92:95]
  ds_read_b64_tr_b16 v[46:47], v21 offset:25600
  s_lshr_b32 s32, s3, 1
  s_lshl_b32 s32, s32, 14
  s_and_b32 s33, s3, 1
  s_lshl_b32 s33, s33, 12
  s_add_u32 s32, s32, s33
  v_add_u32 v12, s32, v2
  s_waitcnt lgkmcnt(8)
  v_mfma_f32_16x16x32_bf16 v[88:91], v[60:63], v[200:203], v[88:91]
  v_mfma_f32_16x16x32_bf16 v[92:95], v[60:63], v[204:207], v[92:95]
  s_waitcnt lgkmcnt(6)
  v_mfma_f32_16x16x32_bf16 v[96:99], v[32:35], v[192:195], v[96:99]
  ds_read_b64_tr_b16 v[48:49], v22 offset:16384
  ds_read_b64_tr_b16 v[50:51], v22 offset:17408
  s_add_u32 m0, s58, 0x10800
  s_movk_i32 s33, 0x5300
  buffer_load_dwordx4 v25, s[4:7], s33 offen lds
  s_lshr_b32 s32, s3, 2
  s_lshl_b32 s32, s32, 14
  s_and_b32 s33, s3, 3
  s_lshl_b32 s33, s33, 11
  s_add_u32 s32, s32, s33
  v_add_u32 v5, s32, v2
  v_mfma_f32_16x16x32_bf16 v[100:103], v[32:35], v[196:199], v[100:103]
  s_add_u32 s33, s45, 0x4000
  buffer_store_dwordx4 v[168:171], v2, s[12:15], s33 offen offset:2048 sc1
  s_setprio 0
  ds_read_b64_tr_b16 v[52:53], v22 offset:24576
  s_waitcnt lgkmcnt(7)
  v_mfma_f32_16x16x32_bf16 v[96:99], v[36:39], v[200:203], v[96:99]
  ds_read_b64_tr_b16 v[54:55], v22 offset:25600
  v_mfma_f32_16x16x32_bf16 v[100:103], v[36:39], v[204:207], v[100:103]
  ds_read_b64_tr_b16 v[56:57], v23 offset:16384
  ds_read_b64_tr_b16 v[58:59], v23 offset:17408
  s_mov_b32 s52, s59
  s_add_u32 s54, s59, 0x8000
  s_waitcnt lgkmcnt(8)
  v_mfma_f32_16x16x32_bf16 v[104:107], v[40:43], v[192:195], v[104:107]
  ds_read_b64_tr_b16 v[60:61], v23 offset:24576
  s_add_u32 m0, s58, 0x10c00
  s_movk_i32 s33, 0x5300
  buffer_load_dwordx4 v26, s[4:7], s33 offen lds
  v_mfma_f32_16x16x32_bf16 v[108:111], v[40:43], v[196:199], v[108:111]
  ds_read_b64_tr_b16 v[62:63], v23 offset:25600
  s_waitcnt lgkmcnt(8)
  v_mfma_f32_16x16x32_bf16 v[104:107], v[44:47], v[200:203], v[104:107]
  s_mov_b32 s53, 0x20000
  s_mov_b32 s55, 0x12000
  v_mfma_f32_16x16x32_bf16 v[108:111], v[44:47], v[204:207], v[108:111]
  s_waitcnt lgkmcnt(6)
  v_mfma_f32_16x16x32_bf16 v[112:115], v[48:51], v[192:195], v[112:115]
  v_mfma_f32_16x16x32_bf16 v[116:119], v[48:51], v[196:199], v[116:119]
  s_waitcnt lgkmcnt(0)
  s_waitcnt vmcnt(16)
  s_barrier
  s_setprio 3
  ds_read_b64_tr_b16 v[32:33], v16 offset:32768
  ds_read_b64_tr_b16 v[34:35], v16 offset:33792
  s_lshl_b32 s32, s36, 1
  s_add_u32 s39, s32, 2
  v_mfma_f32_16x16x32_bf16 v[112:115], v[52:55], v[200:203], v[112:115]
  ds_read_b128 v[208:211], v27 offset:0
  ds_read_b128 v[212:215], v27 offset:2048
  v_mfma_f32_16x16x32_bf16 v[116:119], v[52:55], v[204:207], v[116:119]
  ds_read_b64_tr_b16 v[36:37], v16 offset:40960
  ds_read_b64_tr_b16 v[38:39], v16 offset:41984
  v_mfma_f32_16x16x32_bf16 v[120:123], v[56:59], v[192:195], v[120:123]
  ds_read_b128 v[216:219], v28 offset:0
  ds_read_b128 v[220:223], v28 offset:2048
  s_add_u32 m0, s59, 0x1c000
  s_mov_b32 s32, 0x380000
  buffer_load_dwordx4 v24, s[8:11], s32 offen lds
  s_mov_b32 s38, 0
  s_mov_b32 s41, 0
  v_mfma_f32_16x16x32_bf16 v[124:127], v[56:59], v[196:199], v[124:127]
  ds_read_b64_tr_b16 v[40:41], v17 offset:32768
  ds_read_b64_tr_b16 v[42:43], v17 offset:33792
  v_mfma_f32_16x16x32_bf16 v[120:123], v[60:63], v[200:203], v[120:123]
  ds_read_b64_tr_b16 v[44:45], v17 offset:40960
  ds_read_b64_tr_b16 v[46:47], v17 offset:41984
  v_mfma_f32_16x16x32_bf16 v[124:127], v[60:63], v[204:207], v[124:127]
  s_mov_b32 s42, 0x4e800000
  s_waitcnt lgkmcnt(10)
  s_waitcnt lgkmcnt(9)
  v_mfma_f32_16x16x32_bf16 v[64:67], v[32:35], v[208:211], v[64:67]
  s_add_u32 s33, s45, 0x0
  buffer_store_dwordx4 v[176:179], v2, s[12:15], s33 offen offset:3072 sc1
  s_add_u32 m0, s59, 0x1c400
  s_mov_b32 s32, 0x388000
  buffer_load_dwordx4 v24, s[8:11], s32 offen lds
  ds_read_b64_tr_b16 v[48:49], v18 offset:32768
  ds_read_b64_tr_b16 v[50:51], v18 offset:33792
  s_waitcnt lgkmcnt(10)
  v_mfma_f32_16x16x32_bf16 v[68:71], v[32:35], v[212:215], v[68:71]
  s_setprio 2
  ds_read_b64_tr_b16 v[52:53], v18 offset:40960
  s_waitcnt lgkmcnt(9)
  s_waitcnt lgkmcnt(8)
  v_mfma_f32_16x16x32_bf16 v[64:67], v[36:39], v[216:219], v[64:67]
  ds_read_b64_tr_b16 v[54:55], v18 offset:41984
  s_cmp_eq_u32 s3, 0
  s_cselect_b32 s60, 0x6003, 0
  s_waitcnt lgkmcnt(8)
  v_mfma_f32_16x16x32_bf16 v[68:71], v[36:39], v[220:223], v[68:71]
  ds_read_b64_tr_b16 v[56:57], v19 offset:32768
  ds_read_b64_tr_b16 v[58:59], v19 offset:33792
  s_waitcnt lgkmcnt(8)
  v_mfma_f32_16x16x32_bf16 v[72:75], v[40:43], v[208:211], v[72:75]
  ds_read_b64_tr_b16 v[60:61], v19 offset:40960
  v_mfma_f32_16x16x32_bf16 v[76:79], v[40:43], v[212:215], v[76:79]
  ds_read_b64_tr_b16 v[62:63], v19 offset:41984
  s_waitcnt lgkmcnt(8)
  v_mfma_f32_16x16x32_bf16 v[72:75], v[44:47], v[216:219], v[72:75]
  v_mfma_f32_16x16x32_bf16 v[76:79], v[44:47], v[220:223], v[76:79]
  s_waitcnt lgkmcnt(6)
  v_mfma_f32_16x16x32_bf16 v[80:83], v[48:51], v[208:211], v[80:83]
  ds_read_b64_tr_b16 v[32:33], v20 offset:32768
  ds_read_b64_tr_b16 v[34:35], v20 offset:33792
  s_add_u32 m0, s58, 0x0
  s_movk_i32 s33, 0x380
  buffer_load_dwordx4 v25, s[4:7], s33 offen lds
  s_movk_i32 s32, 10240
  s_cmp_lt_u32 s3, 4
  s_cselect_b32 s50, 0x4000, s32
  s_cselect_b32 s49, s34, s35
  v_mfma_f32_16x16x32_bf16 v[84:87], v[48:51], v[212:215], v[84:87]
  s_setprio 1
  ds_read_b64_tr_b16 v[36:37], v20 offset:40960
  s_waitcnt lgkmcnt(7)
  v_mfma_f32_16x16x32_bf16 v[80:83], v[52:55], v[216:219], v[80:83]
  ds_read_b64_tr_b16 v[38:39], v20 offset:41984
  v_mfma_f32_16x16x32_bf16 v[84:87], v[52:55], v[220:223], v[84:87]
  ds_read_b64_tr_b16 v[40:41], v21 offset:32768
  ds_read_b64_tr_b16 v[42:43], v21 offset:33792
  s_mul_i32 s49, s49, 40
  s_sub_u32 s32, s36, 5
  s_mul_i32 s32, s32, 14
  s_add_u32 s49, s49, s32
  s_mul_i32 s49, s49, s50
  s_waitcnt lgkmcnt(8)
  v_mfma_f32_16x16x32_bf16 v[88:91], v[56:59], v[208:211], v[88:91]
  ds_read_b64_tr_b16 v[44:45], v21 offset:40960
  s_add_u32 m0, s58, 0x400
  s_movk_i32 s33, 0x380
  buffer_load_dwordx4 v26, s[4:7], s33 offen lds
  v_mfma_f32_16x16x32_bf16 v[92:95], v[56:59], v[212:215], v[92:95]
  ds_read_b64_tr_b16 v[46:47], v21 offset:41984
  s_waitcnt lgkmcnt(8)
  v_mfma_f32_16x16x32_bf16 v[88:91], v[60:63], v[216:219], v[88:91]
  s_mov_b32 s32, 0x2600000
  s_cmp_lt_u32 s3, 4
  s_cselect_b32 s32, 0x2800000, s32
  s_add_u32 s32, s32, s49
  s_add_u32 s20, s98, s32
  s_addc_u32 s21, s99, 0
  s_and_b32 s21, s21, 0xffff
  v_mfma_f32_16x16x32_bf16 v[92:95], v[60:63], v[220:223], v[92:95]
  s_add_u32 s33, s45, 0x4000
  buffer_store_dwordx4 v[184:187], v2, s[12:15], s33 offen offset:3072 sc1
  s_waitcnt lgkmcnt(6)
  v_mfma_f32_16x16x32_bf16 v[96:99], v[32:35], v[208:211], v[96:99]
  ds_read_b64_tr_b16 v[48:49], v22 offset:32768
  ds_read_b64_tr_b16 v[50:51], v22 offset:33792
  s_add_u32 m0, s58, 0x800
  s_movk_i32 s33, 0x5380
  buffer_load_dwordx4 v25, s[4:7], s33 offen lds
  v_mfma_f32_16x16x32_bf16 v[100:103], v[32:35], v[212:215], v[100:103]
  s_setprio 0
  ds_read_b64_tr_b16 v[52:53], v22 offset:40960
  s_mov_b32 s22, s50
  s_mov_b32 s23, 0x00020000
  s_waitcnt lgkmcnt(7)
  v_mfma_f32_16x16x32_bf16 v[96:99], v[36:39], v[216:219], v[96:99]
  ds_read_b64_tr_b16 v[54:55], v22 offset:41984
  v_mfma_f32_16x16x32_bf16 v[100:103], v[36:39], v[220:223], v[100:103]
  ds_read_b64_tr_b16 v[56:57], v23 offset:32768
  ds_read_b64_tr_b16 v[58:59], v23 offset:33792
  s_waitcnt lgkmcnt(8)
  v_mfma_f32_16x16x32_bf16 v[104:107], v[40:43], v[208:211], v[104:107]
  ds_read_b64_tr_b16 v[60:61], v23 offset:40960
  s_add_u32 m0, s58, 0xc00
  s_movk_i32 s33, 0x5380
  buffer_load_dwordx4 v26, s[4:7], s33 offen lds
  s_and_b32 s32, s58, 0x3fff
  v_add_u32 v6, s32, v2
  v_mfma_f32_16x16x32_bf16 v[108:111], v[40:43], v[212:215], v[108:111]
  ds_read_b64_tr_b16 v[62:63], v23 offset:41984
  s_waitcnt lgkmcnt(8)
  v_mfma_f32_16x16x32_bf16 v[104:107], v[44:47], v[216:219], v[104:107]
  v_mfma_f32_16x16x32_bf16 v[108:111], v[44:47], v[220:223], v[108:111]
  v_and_b32 v8, 3, v1
  s_waitcnt lgkmcnt(6)
  v_mfma_f32_16x16x32_bf16 v[112:115], v[48:51], v[208:211], v[112:115]
  v_mfma_f32_16x16x32_bf16 v[116:119], v[48:51], v[212:215], v[116:119]
  s_waitcnt lgkmcnt(0)
  s_waitcnt vmcnt(16)
  s_barrier
  s_setprio 3
  ds_read_b64_tr_b16 v[32:33], v16 offset:49152
  ds_read_b64_tr_b16 v[34:35], v16 offset:50176
  v_mfma_f32_16x16x32_bf16 v[112:115], v[52:55], v[216:219], v[112:115]
  ds_read_b128 v[192:195], v27 offset:32768
  ds_read_b128 v[196:199], v27 offset:34816
  v_lshrrev_b32 v9, 2, v1
  v_mfma_f32_16x16x32_bf16 v[116:119], v[52:55], v[220:223], v[116:119]
  ds_read_b64_tr_b16 v[36:37], v16 offset:57344
  ds_read_b64_tr_b16 v[38:39], v16 offset:58368
  v_mfma_f32_16x16x32_bf16 v[120:123], v[56:59], v[208:211], v[120:123]
  ds_read_b128 v[200:203], v28 offset:32768
  ds_read_b128 v[204:207], v28 offset:34816
  s_add_u32 m0, s59, 0x20000
  s_mov_b32 s32, 0x400000
  buffer_load_dwordx4 v24, s[8:11], s32 offen lds
  v_mfma_f32_16x16x32_bf16 v[124:127], v[56:59], v[212:215], v[124:127]
  ds_read_b64_tr_b16 v[40:41], v17 offset:49152
  ds_read_b64_tr_b16 v[42:43], v17 offset:50176
  v_lshrrev_b32 v10, 1, v8
  v_mfma_f32_16x16x32_bf16 v[120:123], v[60:63], v[216:219], v[120:123]
  s_add_u32 s33, s44, 0x4000
  buffer_store_dwordx4 v[232:235], v2, s[12:15], s33 offen offset:0 sc1
  ds_read_b64_tr_b16 v[44:45], v17 offset:57344
  ds_read_b64_tr_b16 v[46:47], v17 offset:58368
  v_mfma_f32_16x16x32_bf16 v[124:127], v[60:63], v[220:223], v[124:127]
  s_waitcnt lgkmcnt(10)
  s_waitcnt lgkmcnt(9)
  v_mfma_f32_16x16x32_bf16 v[64:67], v[32:35], v[192:195], v[64:67]
  s_add_u32 m0, s59, 0x20400
  s_mov_b32 s32, 0x408000
  buffer_load_dwordx4 v24, s[8:11], s32 offen lds
  ds_read_b64_tr_b16 v[48:49], v18 offset:49152
  ds_read_b64_tr_b16 v[50:51], v18 offset:50176
  v_lshlrev_b32 v11, 3, v10
  s_waitcnt lgkmcnt(10)
  v_mfma_f32_16x16x32_bf16 v[68:71], v[32:35], v[196:199], v[68:71]
  s_setprio 2
  ds_read_b64_tr_b16 v[52:53], v18 offset:57344
  s_waitcnt lgkmcnt(9)
  s_waitcnt lgkmcnt(8)
  v_mfma_f32_16x16x32_bf16 v[64:67], v[36:39], v[200:203], v[64:67]
  ds_read_b64_tr_b16 v[54:55], v18 offset:58368
  s_waitcnt lgkmcnt(8)
  v_mfma_f32_16x16x32_bf16 v[68:71], v[36:39], v[204:207], v[68:71]
  ds_read_b64_tr_b16 v[56:57], v19 offset:49152
  ds_read_b64_tr_b16 v[58:59], v19 offset:50176
  v_xor_b32 v9, v9, v11
  s_waitcnt lgkmcnt(8)
  v_mfma_f32_16x16x32_bf16 v[72:75], v[40:43], v[192:195], v[72:75]
  ds_read_b64_tr_b16 v[60:61], v19 offset:57344
  v_and_b32 v14, 31, v1
  s_mul_i32 s32, s35, 25
  s_lshr_b32 s32, s32, 1
  v_min_u32 v14, 12, v14
  v_add_lshl_u32 v14, v14, s32, 5
  v_mfma_f32_16x16x32_bf16 v[76:79], v[40:43], v[196:199], v[76:79]
  ds_read_b64_tr_b16 v[62:63], v19 offset:58368
  v_min_u32 v31, 19, v1
  s_lshl_b32 s32, s34, 5
  v_add_lshl_u32 v31, v31, s32, 2
  s_waitcnt lgkmcnt(8)
  v_mfma_f32_16x16x32_bf16 v[72:75], v[44:47], v[200:203], v[72:75]
  v_add_u32 v14, 0x800, v14
  v_lshlrev_b32 v9, 4, v9
  v_mfma_f32_16x16x32_bf16 v[76:79], v[44:47], v[204:207], v[76:79]
  v_cmp_lt_u32 vcc, 31, v1
  s_nop 1
  v_cndmask_b32 v31, v31, v14, vcc
  s_waitcnt lgkmcnt(6)
  v_mfma_f32_16x16x32_bf16 v[80:83], v[48:51], v[192:195], v[80:83]
  ds_read_b64_tr_b16 v[32:33], v20 offset:49152
  ds_read_b64_tr_b16 v[34:35], v20 offset:50176
  s_add_u32 m0, s58, 0x8000
  s_movk_i32 s33, 0x400
  buffer_load_dwordx4 v25, s[4:7], s33 offen lds
  v_add_u32 v31, 0xd000, v31
  v_mfma_f32_16x16x32_bf16 v[84:87], v[48:51], v[196:199], v[84:87]
  s_setprio 1
  ds_read_b64_tr_b16 v[36:37], v20 offset:57344
  s_lshl_b32 s32, s3, 20
  v_add_u32 v31, s32, v31
  v_lshl_add_u32 v9, v10, 10, v9
  s_waitcnt lgkmcnt(7)
  v_mfma_f32_16x16x32_bf16 v[80:83], v[52:55], v[200:203], v[80:83]
  ds_read_b64_tr_b16 v[38:39], v20 offset:58368
  buffer_load_dword v14, v31, s[24:27], 0 offen sc1
  v_mfma_f32_16x16x32_bf16 v[84:87], v[52:55], v[204:207], v[84:87]
  ds_read_b64_tr_b16 v[40:41], v21 offset:49152
  ds_read_b64_tr_b16 v[42:43], v21 offset:50176
  s_waitcnt lgkmcnt(8)
  v_mfma_f32_16x16x32_bf16 v[88:91], v[56:59], v[192:195], v[88:91]
  ds_read_b64_tr_b16 v[44:45], v21 offset:57344
  s_add_u32 m0, s58, 0x8400
  s_movk_i32 s33, 0x400
  buffer_load_dwordx4 v26, s[4:7], s33 offen lds
  v_and_b32 v8, 1, v8
  v_mfma_f32_16x16x32_bf16 v[92:95], v[56:59], v[196:199], v[92:95]
  ds_read_b64_tr_b16 v[46:47], v21 offset:58368
  s_waitcnt lgkmcnt(8)
  v_mfma_f32_16x16x32_bf16 v[88:91], v[60:63], v[200:203], v[88:91]
  s_add_u32 s33, s44, 0x5000
  buffer_store_dwordx4 v[236:239], v2, s[12:15], s33 offen offset:0 sc1
  v_mfma_f32_16x16x32_bf16 v[92:95], v[60:63], v[204:207], v[92:95]
  v_lshl_add_u32 v9, v8, 3, v9
  s_waitcnt lgkmcnt(6)
  v_mfma_f32_16x16x32_bf16 v[96:99], v[32:35], v[192:195], v[96:99]
  ds_read_b64_tr_b16 v[48:49], v22 offset:49152
  ds_read_b64_tr_b16 v[50:51], v22 offset:50176
  s_add_u32 m0, s58, 0x8800
  s_movk_i32 s33, 0x5400
  buffer_load_dwordx4 v25, s[4:7], s33 offen lds
  v_mfma_f32_16x16x32_bf16 v[100:103], v[32:35], v[196:199], v[100:103]
  s_setprio 0
  ds_read_b64_tr_b16 v[52:53], v22 offset:57344
  s_waitcnt lgkmcnt(7)
  v_mfma_f32_16x16x32_bf16 v[96:99], v[36:39], v[200:203], v[96:99]
  ds_read_b64_tr_b16 v[54:55], v22 offset:58368
  s_lshr_b32 s32, s3, 1
  s_lshl_b32 s32, s32, 12
  v_add_u32 v7, s32, v9
  v_mfma_f32_16x16x32_bf16 v[100:103], v[36:39], v[204:207], v[100:103]
  ds_read_b64_tr_b16 v[56:57], v23 offset:49152
  ds_read_b64_tr_b16 v[58:59], v23 offset:50176
  s_waitcnt lgkmcnt(8)
  v_mfma_f32_16x16x32_bf16 v[104:107], v[40:43], v[192:195], v[104:107]
  ds_read_b64_tr_b16 v[60:61], v23 offset:57344
  s_add_u32 m0, s58, 0x8c00
  s_movk_i32 s33, 0x5400
  buffer_load_dwordx4 v26, s[4:7], s33 offen lds
  v_mfma_f32_16x16x32_bf16 v[108:111], v[40:43], v[196:199], v[108:111]
  ds_read_b64_tr_b16 v[62:63], v23 offset:58368
  v_add_u32 v8, 0x10000, v7
  s_waitcnt lgkmcnt(8)
  v_mfma_f32_16x16x32_bf16 v[104:107], v[44:47], v[200:203], v[104:107]
  v_mfma_f32_16x16x32_bf16 v[108:111], v[44:47], v[204:207], v[108:111]
  s_waitcnt lgkmcnt(6)
  v_mfma_f32_16x16x32_bf16 v[112:115], v[48:51], v[192:195], v[112:115]
  v_add_u32 v9, 0x20000, v7
  v_mfma_f32_16x16x32_bf16 v[116:119], v[48:51], v[196:199], v[116:119]
  s_waitcnt lgkmcnt(0)
  s_waitcnt vmcnt(17)
  s_barrier
  s_setprio 3
  ds_read_b64_tr_b16 v[32:33], v16 offset:0
  ds_read_b64_tr_b16 v[34:35], v16 offset:1024
  v_mfma_f32_16x16x32_bf16 v[112:115], v[52:55], v[200:203], v[112:115]
  ds_read_b128 v[208:211], v29 offset:0
  ds_read_b128 v[212:215], v29 offset:2048
  v_mfma_f32_16x16x32_bf16 v[116:119], v[52:55], v[204:207], v[116:119]
  ds_read_b64_tr_b16 v[36:37], v16 offset:8192
  ds_read_b64_tr_b16 v[38:39], v16 offset:9216
  s_and_b32 s33, s3, 1
  s_mul_i32 s33, s33, 5120
  s_add_u32 s33, s33, 0x4000
  v_add_u32 v10, s33, v2
  v_mfma_f32_16x16x32_bf16 v[120:123], v[56:59], v[192:195], v[120:123]
  ds_read_b128 v[216:219], v30 offset:0
  ds_read_b128 v[220:223], v30 offset:2048
  s_add_u32 m0, s59, 0x24000
  s_mov_b32 s32, 0x480000
  buffer_load_dwordx4 v24, s[8:11], s32 offen lds
  v_mfma_f32_16x16x32_bf16 v[124:127], v[56:59], v[196:199], v[124:127]
  s_add_u32 s33, s44, 0x0
  buffer_store_dwordx4 v[240:243], v2, s[12:15], s33 offen offset:1024 sc1
  ds_read_b64_tr_b16 v[40:41], v17 offset:0
  ds_read_b64_tr_b16 v[42:43], v17 offset:1024
  v_mfma_f32_16x16x32_bf16 v[120:123], v[60:63], v[200:203], v[120:123]
  ds_read_b64_tr_b16 v[44:45], v17 offset:8192
  ds_read_b64_tr_b16 v[46:47], v17 offset:9216
  v_add_u32 v11, 0x10000, v10
  v_mfma_f32_16x16x32_bf16 v[124:127], v[60:63], v[204:207], v[124:127]
  s_waitcnt lgkmcnt(10)
  s_waitcnt lgkmcnt(9)
  v_mfma_f32_16x16x32_bf16 v[64:67], v[32:35], v[208:211], v[64:67]
  s_add_u32 m0, s59, 0x24400
  s_mov_b32 s32, 0x488000
  buffer_load_dwordx4 v24, s[8:11], s32 offen lds
  ds_read_b64_tr_b16 v[48:49], v18 offset:0
  ds_read_b64_tr_b16 v[50:51], v18 offset:1024
  s_waitcnt lgkmcnt(10)
  v_mfma_f32_16x16x32_bf16 v[68:71], v[32:35], v[212:215], v[68:71]
  s_setprio 2
  ds_read_b64_tr_b16 v[52:53], v18 offset:8192
  s_add_u32 s28, s98, 0x5800000
  s_addc_u32 s29, s99, 0
  s_and_b32 s29, s29, 0xffff
  s_mov_b32 s30, 0x800000
  s_mov_b32 s31, 0x00020000
  s_waitcnt lgkmcnt(9)
  s_waitcnt lgkmcnt(8)
  v_mfma_f32_16x16x32_bf16 v[64:67], v[36:39], v[216:219], v[64:67]
  ds_read_b64_tr_b16 v[54:55], v18 offset:9216
  s_waitcnt lgkmcnt(8)
  v_mfma_f32_16x16x32_bf16 v[68:71], v[36:39], v[220:223], v[68:71]
  ds_read_b64_tr_b16 v[56:57], v19 offset:0
  ds_read_b64_tr_b16 v[58:59], v19 offset:1024
  s_waitcnt lgkmcnt(8)
  v_mfma_f32_16x16x32_bf16 v[72:75], v[40:43], v[208:211], v[72:75]
  ds_read_b64_tr_b16 v[60:61], v19 offset:8192
  s_lshl_b32 s32, s37, 3
  s_add_u32 s32, s32, s3
  s_mul_i32 s32, s32, 3
  s_add_u32 s32, s32, s36
  s_sub_u32 s32, s32, 5
  s_mul_i32 s51, s32, 10240
  v_mfma_f32_16x16x32_bf16 v[76:79], v[40:43], v[212:215], v[76:79]
  ds_read_b64_tr_b16 v[62:63], v19 offset:9216
  s_waitcnt lgkmcnt(8)
  v_mfma_f32_16x16x32_bf16 v[72:75], v[44:47], v[216:219], v[72:75]
  v_mfma_f32_16x16x32_bf16 v[76:79], v[44:47], v[220:223], v[76:79]
  s_waitcnt lgkmcnt(6)
  v_mfma_f32_16x16x32_bf16 v[80:83], v[48:51], v[208:211], v[80:83]
  ds_read_b64_tr_b16 v[32:33], v20 offset:0
  ds_read_b64_tr_b16 v[34:35], v20 offset:1024
  s_add_u32 m0, s58, 0x10000
  s_movk_i32 s33, 0x480
  buffer_load_dwordx4 v25, s[4:7], s33 offen lds
  v_mfma_f32_16x16x32_bf16 v[84:87], v[48:51], v[212:215], v[84:87]
  s_setprio 1
  ds_read_b64_tr_b16 v[36:37], v20 offset:8192
  s_waitcnt lgkmcnt(7)
  v_mfma_f32_16x16x32_bf16 v[80:83], v[52:55], v[216:219], v[80:83]
  ds_read_b64_tr_b16 v[38:39], v20 offset:9216
  v_mfma_f32_16x16x32_bf16 v[84:87], v[52:55], v[220:223], v[84:87]
  ds_read_b64_tr_b16 v[40:41], v21 offset:0
  ds_read_b64_tr_b16 v[42:43], v21 offset:1024
  s_waitcnt lgkmcnt(8)
  v_mfma_f32_16x16x32_bf16 v[88:91], v[56:59], v[208:211], v[88:91]
  s_add_u32 s33, s44, 0x1000
  buffer_store_dwordx4 v[244:247], v2, s[12:15], s33 offen offset:1024 sc1
  ds_read_b64_tr_b16 v[44:45], v21 offset:8192
  s_add_u32 m0, s58, 0x10400
  s_movk_i32 s33, 0x480
  buffer_load_dwordx4 v26, s[4:7], s33 offen lds
  v_mfma_f32_16x16x32_bf16 v[92:95], v[56:59], v[212:215], v[92:95]
  ds_read_b64_tr_b16 v[46:47], v21 offset:9216
  s_waitcnt lgkmcnt(8)
  v_mfma_f32_16x16x32_bf16 v[88:91], v[60:63], v[216:219], v[88:91]
  v_mfma_f32_16x16x32_bf16 v[92:95], v[60:63], v[220:223], v[92:95]
  s_waitcnt lgkmcnt(6)
  v_mfma_f32_16x16x32_bf16 v[96:99], v[32:35], v[208:211], v[96:99]
  ds_read_b64_tr_b16 v[48:49], v22 offset:0
  ds_read_b64_tr_b16 v[50:51], v22 offset:1024
  s_add_u32 m0, s58, 0x10800
  s_movk_i32 s33, 0x5480
  buffer_load_dwordx4 v25, s[4:7], s33 offen lds
  v_mfma_f32_16x16x32_bf16 v[100:103], v[32:35], v[212:215], v[100:103]
  s_setprio 0
  ds_read_b64_tr_b16 v[52:53], v22 offset:8192
  s_waitcnt lgkmcnt(7)
  v_mfma_f32_16x16x32_bf16 v[96:99], v[36:39], v[216:219], v[96:99]
  ds_read_b64_tr_b16 v[54:55], v22 offset:9216
  v_mfma_f32_16x16x32_bf16 v[100:103], v[36:39], v[220:223], v[100:103]
  ds_read_b64_tr_b16 v[56:57], v23 offset:0
  ds_read_b64_tr_b16 v[58:59], v23 offset:1024
  s_waitcnt lgkmcnt(8)
  v_mfma_f32_16x16x32_bf16 v[104:107], v[40:43], v[208:211], v[104:107]
  ds_read_b64_tr_b16 v[60:61], v23 offset:8192
  s_add_u32 m0, s58, 0x10c00
  s_movk_i32 s33, 0x5480
  buffer_load_dwordx4 v26, s[4:7], s33 offen lds
  s_waitcnt vmcnt(12)
  v_mfma_f32_16x16x32_bf16 v[108:111], v[40:43], v[212:215], v[108:111]
  ds_read_b64_tr_b16 v[62:63], v23 offset:9216
  v_cmp_ne_u32 vcc, 1, v14
  s_cmp_lg_u32 s3, 0
  s_cbranch_scc1 fN_ht_ret
  s_nop 2
  s_cbranch_vccnz fN_ht
fN_ht_ret:
  s_waitcnt lgkmcnt(8)
  v_mfma_f32_16x16x32_bf16 v[104:107], v[44:47], v[216:219], v[104:107]
  v_mfma_f32_16x16x32_bf16 v[108:111], v[44:47], v[220:223], v[108:111]
  s_waitcnt lgkmcnt(6)
  v_mfma_f32_16x16x32_bf16 v[112:115], v[48:51], v[208:211], v[112:115]
  v_mfma_f32_16x16x32_bf16 v[116:119], v[48:51], v[212:215], v[116:119]
  s_waitcnt lgkmcnt(0)
  s_barrier
  s_setprio 3
  ds_read_b64_tr_b16 v[32:33], v16 offset:16384
  ds_read_b64_tr_b16 v[34:35], v16 offset:17408
  v_mfma_f32_16x16x32_bf16 v[112:115], v[52:55], v[216:219], v[112:115]
  ds_read_b128 v[192:195], v27 offset:0
  ds_read_b128 v[196:199], v27 offset:2048
  v_mfma_f32_16x16x32_bf16 v[116:119], v[52:55], v[220:223], v[116:119]
  s_add_u32 s33, s44, 0x4000
  buffer_store_dwordx4 v[248:251], v2, s[12:15], s33 offen offset:1024 sc1
  ds_read_b64_tr_b16 v[36:37], v16 offset:24576
  ds_read_b64_tr_b16 v[38:39], v16 offset:25600
  v_mfma_f32_16x16x32_bf16 v[120:123], v[56:59], v[208:211], v[120:123]
  ds_read_b128 v[200:203], v28 offset:0
  ds_read_b128 v[204:207], v28 offset:2048
  v_mfma_f32_16x16x32_bf16 v[124:127], v[56:59], v[212:215], v[124:127]
  ds_read_b64_tr_b16 v[40:41], v17 offset:16384
  ds_read_b64_tr_b16 v[42:43], v17 offset:17408
  v_mfma_f32_16x16x32_bf16 v[120:123], v[60:63], v[216:219], v[120:123]
  ds_read_b64_tr_b16 v[44:45], v17 offset:24576
  ds_read_b64_tr_b16 v[46:47], v17 offset:25600
  v_mfma_f32_16x16x32_bf16 v[124:127], v[60:63], v[220:223], v[124:127]
  s_waitcnt lgkmcnt(10)
  s_waitcnt lgkmcnt(9)
  v_mfma_f32_16x16x32_bf16 v[64:67], v[32:35], v[192:195], v[64:67]
  ds_read_b64_tr_b16 v[48:49], v18 offset:16384
  ds_read_b64_tr_b16 v[50:51], v18 offset:17408
  s_waitcnt lgkmcnt(10)
  v_mfma_f32_16x16x32_bf16 v[68:71], v[32:35], v[196:199], v[68:71]
  s_setprio 2
  ds_read_b64_tr_b16 v[52:53], v18 offset:24576
  s_waitcnt lgkmcnt(9)
  s_waitcnt lgkmcnt(8)
  v_mfma_f32_16x16x32_bf16 v[64:67], v[36:39], v[200:203], v[64:67]
  ds_read_b64_tr_b16 v[54:55], v18 offset:25600
  s_waitcnt lgkmcnt(8)
  v_mfma_f32_16x16x32_bf16 v[68:71], v[36:39], v[204:207], v[68:71]
  ds_read_b64_tr_b16 v[56:57], v19 offset:16384
  ds_read_b64_tr_b16 v[58:59], v19 offset:17408
  s_waitcnt lgkmcnt(8)
  v_mfma_f32_16x16x32_bf16 v[72:75], v[40:43], v[192:195], v[72:75]
  ds_read_b64_tr_b16 v[60:61], v19 offset:24576
  v_mfma_f32_16x16x32_bf16 v[76:79], v[40:43], v[196:199], v[76:79]
  ds_read_b64_tr_b16 v[62:63], v19 offset:25600
  s_waitcnt lgkmcnt(8)
  v_mfma_f32_16x16x32_bf16 v[72:75], v[44:47], v[200:203], v[72:75]
  v_add_u32 v24, 0x20000, v10
  v_mfma_f32_16x16x32_bf16 v[76:79], v[44:47], v[204:207], v[76:79]
  s_waitcnt lgkmcnt(6)
  v_mfma_f32_16x16x32_bf16 v[80:83], v[48:51], v[192:195], v[80:83]
  ds_read_b64_tr_b16 v[32:33], v20 offset:16384
  ds_read_b64_tr_b16 v[34:35], v20 offset:17408
  s_add_u32 m0, s58, 0x0
  s_nop 0
  buffer_load_dwordx4 v6, s[20:23], 0 offen offset:0 lds
  v_mfma_f32_16x16x32_bf16 v[84:87], v[48:51], v[196:199], v[84:87]
  s_setprio 1
  ds_read_b64_tr_b16 v[36:37], v20 offset:24576
  s_waitcnt lgkmcnt(7)
  v_mfma_f32_16x16x32_bf16 v[80:83], v[52:55], v[200:203], v[80:83]
  s_add_u32 s33, s44, 0x5000
  buffer_store_dwordx4 v[252:255], v2, s[12:15], s33 offen offset:1024 sc1
  ds_read_b64_tr_b16 v[38:39], v20 offset:25600
  v_mfma_f32_16x16x32_bf16 v[84:87], v[52:55], v[204:207], v[84:87]
  ds_read_b64_tr_b16 v[40:41], v21 offset:16384
  ds_read_b64_tr_b16 v[42:43], v21 offset:17408
  s_waitcnt lgkmcnt(8)
  v_mfma_f32_16x16x32_bf16 v[88:91], v[56:59], v[192:195], v[88:91]
  ds_read_b64_tr_b16 v[44:45], v21 offset:24576
  s_add_u32 m0, s58, 0x0
  s_nop 0
  buffer_load_dwordx4 v6, s[20:23], 0 offen offset:1024 lds
  v_mfma_f32_16x16x32_bf16 v[92:95], v[56:59], v[196:199], v[92:95]
  ds_read_b64_tr_b16 v[46:47], v21 offset:25600
  s_waitcnt lgkmcnt(8)
  v_mfma_f32_16x16x32_bf16 v[88:91], v[60:63], v[200:203], v[88:91]
  v_mfma_f32_16x16x32_bf16 v[92:95], v[60:63], v[204:207], v[92:95]
  s_waitcnt lgkmcnt(6)
  v_mfma_f32_16x16x32_bf16 v[96:99], v[32:35], v[192:195], v[96:99]
  ds_read_b64_tr_b16 v[48:49], v22 offset:16384
  ds_read_b64_tr_b16 v[50:51], v22 offset:17408
  s_add_u32 m0, s58, 0x0
  s_nop 0
  buffer_load_dwordx4 v6, s[20:23], 0 offen offset:2048 lds
  v_mfma_f32_16x16x32_bf16 v[100:103], v[32:35], v[196:199], v[100:103]
  s_setprio 0
  ds_read_b64_tr_b16 v[52:53], v22 offset:24576
  s_waitcnt lgkmcnt(7)
  v_mfma_f32_16x16x32_bf16 v[96:99], v[36:39], v[200:203], v[96:99]
  ds_read_b64_tr_b16 v[54:55], v22 offset:25600
  v_mfma_f32_16x16x32_bf16 v[100:103], v[36:39], v[204:207], v[100:103]
  ds_read_b64_tr_b16 v[56:57], v23 offset:16384
  ds_read_b64_tr_b16 v[58:59], v23 offset:17408
  s_waitcnt lgkmcnt(8)
  v_mfma_f32_16x16x32_bf16 v[104:107], v[40:43], v[192:195], v[104:107]
  ds_read_b64_tr_b16 v[60:61], v23 offset:24576
  s_add_u32 m0, s58, 0x0
  s_nop 0
  buffer_load_dwordx4 v6, s[20:23], 0 offen offset:3072 lds
  s_add_u32 s20, s20, s50
  s_addc_u32 s21, s21, 0
  v_mfma_f32_16x16x32_bf16 v[108:111], v[40:43], v[196:199], v[108:111]
  ds_read_b64_tr_b16 v[62:63], v23 offset:25600
  s_waitcnt lgkmcnt(8)
  v_mfma_f32_16x16x32_bf16 v[104:107], v[44:47], v[200:203], v[104:107]
  v_mfma_f32_16x16x32_bf16 v[108:111], v[44:47], v[204:207], v[108:111]
  s_waitcnt lgkmcnt(6)
  v_mfma_f32_16x16x32_bf16 v[112:115], v[48:51], v[192:195], v[112:115]
  v_mfma_f32_16x16x32_bf16 v[116:119], v[48:51], v[196:199], v[116:119]
  s_waitcnt lgkmcnt(0)
  s_waitcnt vmcnt(14)
  s_barrier
  s_setprio 3
  ds_read_b64_tr_b16 v[32:33], v16 offset:32768
  ds_read_b64_tr_b16 v[34:35], v16 offset:33792
  v_mfma_f32_16x16x32_bf16 v[112:115], v[52:55], v[200:203], v[112:115]
  ds_read_b128 v[208:211], v27 offset:32768
  ds_read_b128 v[212:215], v27 offset:34816
  v_mfma_f32_16x16x32_bf16 v[116:119], v[52:55], v[204:207], v[116:119]
  ds_read_b64_tr_b16 v[36:37], v16 offset:40960
  ds_read_b64_tr_b16 v[38:39], v16 offset:41984
  s_add_u32 m0, s58, 0x18000
  s_nop 0
  buffer_load_dwordx4 v6, s[20:23], 0 offen offset:0 lds
  v_mfma_f32_16x16x32_bf16 v[120:123], v[56:59], v[192:195], v[120:123]
  ds_read_b128 v[216:219], v28 offset:32768
  ds_read_b128 v[220:223], v28 offset:34816
  v_mfma_f32_16x16x32_bf16 v[124:127], v[56:59], v[196:199], v[124:127]
  ds_read_b64_tr_b16 v[40:41], v17 offset:32768
  ds_read_b64_tr_b16 v[42:43], v17 offset:33792
  v_mfma_f32_16x16x32_bf16 v[120:123], v[60:63], v[200:203], v[120:123]
  ds_read_b64_tr_b16 v[44:45], v17 offset:40960
  ds_read_b64_tr_b16 v[46:47], v17 offset:41984
  s_add_u32 m0, s58, 0x18000
  s_nop 0
  buffer_load_dwordx4 v6, s[20:23], 0 offen offset:1024 lds
  v_mfma_f32_16x16x32_bf16 v[124:127], v[60:63], v[204:207], v[124:127]
  s_waitcnt lgkmcnt(10)
  s_waitcnt lgkmcnt(9)
  v_mfma_f32_16x16x32_bf16 v[64:67], v[32:35], v[208:211], v[64:67]
  ds_read_b64_tr_b16 v[48:49], v18 offset:32768
  ds_read_b64_tr_b16 v[50:51], v18 offset:33792
  s_waitcnt lgkmcnt(10)
  v_mfma_f32_16x16x32_bf16 v[68:71], v[32:35], v[212:215], v[68:71]
  s_setprio 2
  s_add_u32 m0, s58, 0x18000
  s_nop 0
  buffer_load_dwordx4 v6, s[20:23], 0 offen offset:2048 lds
  ds_read_b64_tr_b16 v[52:53], v18 offset:40960
  s_waitcnt lgkmcnt(9)
  s_waitcnt lgkmcnt(8)
  v_mfma_f32_16x16x32_bf16 v[64:67], v[36:39], v[216:219], v[64:67]
  ds_read_b64_tr_b16 v[54:55], v18 offset:41984
  s_waitcnt lgkmcnt(8)
  v_mfma_f32_16x16x32_bf16 v[68:71], v[36:39], v[220:223], v[68:71]
  ds_read_b64_tr_b16 v[56:57], v19 offset:32768
  ds_read_b64_tr_b16 v[58:59], v19 offset:33792
  s_waitcnt lgkmcnt(8)
  v_mfma_f32_16x16x32_bf16 v[72:75], v[40:43], v[208:211], v[72:75]
  s_add_u32 m0, s58, 0x18000
  s_nop 0
  buffer_load_dwordx4 v6, s[20:23], 0 offen offset:3072 lds
  s_add_u32 s20, s20, s50
  s_addc_u32 s21, s21, 0
  ds_read_b64_tr_b16 v[60:61], v19 offset:40960
  v_mfma_f32_16x16x32_bf16 v[76:79], v[40:43], v[212:215], v[76:79]
  ds_read_b64_tr_b16 v[62:63], v19 offset:41984
  s_waitcnt lgkmcnt(8)
  v_mfma_f32_16x16x32_bf16 v[72:75], v[44:47], v[216:219], v[72:75]
  v_mfma_f32_16x16x32_bf16 v[76:79], v[44:47], v[220:223], v[76:79]
  s_waitcnt lgkmcnt(6)
  v_mfma_f32_16x16x32_bf16 v[80:83], v[48:51], v[208:211], v[80:83]
  ds_read_b64_tr_b16 v[32:33], v20 offset:32768
  ds_read_b64_tr_b16 v[34:35], v20 offset:33792
  s_add_u32 m0, s58, 0x8000
  s_nop 0
  buffer_load_dwordx4 v6, s[20:23], 0 offen offset:0 lds
  v_mfma_f32_16x16x32_bf16 v[84:87], v[48:51], v[212:215], v[84:87]
  s_setprio 1
  ds_read_b64_tr_b16 v[36:37], v20 offset:40960
  s_waitcnt lgkmcnt(7)
  v_mfma_f32_16x16x32_bf16 v[80:83], v[52:55], v[216:219], v[80:83]
  ds_read_b64_tr_b16 v[38:39], v20 offset:41984
  v_mfma_f32_16x16x32_bf16 v[84:87], v[52:55], v[220:223], v[84:87]
  ds_read_b64_tr_b16 v[40:41], v21 offset:32768
  ds_read_b64_tr_b16 v[42:43], v21 offset:33792
  s_waitcnt lgkmcnt(8)
  v_mfma_f32_16x16x32_bf16 v[88:91], v[56:59], v[208:211], v[88:91]
  ds_read_b64_tr_b16 v[44:45], v21 offset:40960
  s_add_u32 m0, s58, 0x8000
  s_nop 0
  buffer_load_dwordx4 v6, s[20:23], 0 offen offset:1024 lds
  v_mfma_f32_16x16x32_bf16 v[92:95], v[56:59], v[212:215], v[92:95]
  ds_read_b64_tr_b16 v[46:47], v21 offset:41984
  s_waitcnt lgkmcnt(8)
  v_mfma_f32_16x16x32_bf16 v[88:91], v[60:63], v[216:219], v[88:91]
  v_mfma_f32_16x16x32_bf16 v[92:95], v[60:63], v[220:223], v[92:95]
  s_waitcnt lgkmcnt(6)
  v_mfma_f32_16x16x32_bf16 v[96:99], v[32:35], v[208:211], v[96:99]
  ds_read_b64_tr_b16 v[48:49], v22 offset:32768
  ds_read_b64_tr_b16 v[50:51], v22 offset:33792
  s_add_u32 m0, s58, 0x8000
  s_nop 0
  buffer_load_dwordx4 v6, s[20:23], 0 offen offset:2048 lds
  v_mfma_f32_16x16x32_bf16 v[100:103], v[32:35], v[212:215], v[100:103]
  s_setprio 0
  ds_read_b64_tr_b16 v[52:53], v22 offset:40960
  s_waitcnt lgkmcnt(7)
  v_mfma_f32_16x16x32_bf16 v[96:99], v[36:39], v[216:219], v[96:99]
  ds_read_b64_tr_b16 v[54:55], v22 offset:41984
  v_mfma_f32_16x16x32_bf16 v[100:103], v[36:39], v[220:223], v[100:103]
  ds_read_b64_tr_b16 v[56:57], v23 offset:32768
  ds_read_b64_tr_b16 v[58:59], v23 offset:33792
  s_waitcnt lgkmcnt(8)
  v_mfma_f32_16x16x32_bf16 v[104:107], v[40:43], v[208:211], v[104:107]
  ds_read_b64_tr_b16 v[60:61], v23 offset:40960
  s_add_u32 m0, s58, 0x8000
  s_nop 0
  buffer_load_dwordx4 v6, s[20:23], 0 offen offset:3072 lds
  s_add_u32 s20, s20, s50
  s_addc_u32 s21, s21, 0
  v_mfma_f32_16x16x32_bf16 v[108:111], v[40:43], v[212:215], v[108:111]
  ds_read_b64_tr_b16 v[62:63], v23 offset:41984
  s_waitcnt lgkmcnt(8)
  v_mfma_f32_16x16x32_bf16 v[104:107], v[44:47], v[216:219], v[104:107]
  v_mfma_f32_16x16x32_bf16 v[108:111], v[44:47], v[220:223], v[108:111]
  s_waitcnt lgkmcnt(6)
  v_mfma_f32_16x16x32_bf16 v[112:115], v[48:51], v[208:211], v[112:115]
  v_mfma_f32_16x16x32_bf16 v[116:119], v[48:51], v[212:215], v[116:119]
  s_waitcnt lgkmcnt(0)
  s_waitcnt vmcnt(14)
  s_barrier
  s_setprio 3
  ds_read_b64_tr_b16 v[32:33], v16 offset:49152
  ds_read_b64_tr_b16 v[34:35], v16 offset:50176
  v_mfma_f32_16x16x32_bf16 v[112:115], v[52:55], v[216:219], v[112:115]
  ds_read_b128 v[192:195], v29 offset:0
  ds_read_b128 v[196:199], v29 offset:2048
  v_mfma_f32_16x16x32_bf16 v[116:119], v[52:55], v[220:223], v[116:119]
  ds_read_b64_tr_b16 v[36:37], v16 offset:57344
  ds_read_b64_tr_b16 v[38:39], v16 offset:58368
  v_mfma_f32_16x16x32_bf16 v[120:123], v[56:59], v[208:211], v[120:123]
  ds_read_b128 v[200:203], v30 offset:0
  ds_read_b128 v[204:207], v30 offset:2048
  v_mfma_f32_16x16x32_bf16 v[124:127], v[56:59], v[212:215], v[124:127]
  ds_read_b64_tr_b16 v[40:41], v17 offset:49152
  ds_read_b64_tr_b16 v[42:43], v17 offset:50176
  v_mfma_f32_16x16x32_bf16 v[120:123], v[60:63], v[216:219], v[120:123]
  ds_read_b64_tr_b16 v[44:45], v17 offset:57344
  ds_read_b64_tr_b16 v[46:47], v17 offset:58368
  v_mfma_f32_16x16x32_bf16 v[124:127], v[60:63], v[220:223], v[124:127]
  s_waitcnt lgkmcnt(10)
  s_waitcnt lgkmcnt(9)
  v_mfma_f32_16x16x32_bf16 v[64:67], v[32:35], v[192:195], v[64:67]
  ds_read_b64_tr_b16 v[48:49], v18 offset:49152
  ds_read_b64_tr_b16 v[50:51], v18 offset:50176
  s_waitcnt lgkmcnt(10)
  v_mfma_f32_16x16x32_bf16 v[68:71], v[32:35], v[196:199], v[68:71]
  s_setprio 2
  ds_read_b64_tr_b16 v[52:53], v18 offset:57344
  s_waitcnt lgkmcnt(9)
  s_waitcnt lgkmcnt(8)
  v_mfma_f32_16x16x32_bf16 v[64:67], v[36:39], v[200:203], v[64:67]
  ds_read_b64_tr_b16 v[54:55], v18 offset:58368
  s_waitcnt lgkmcnt(8)
  v_mfma_f32_16x16x32_bf16 v[68:71], v[36:39], v[204:207], v[68:71]
  ds_read_b64_tr_b16 v[56:57], v19 offset:49152
  ds_read_b64_tr_b16 v[58:59], v19 offset:50176
  s_waitcnt lgkmcnt(8)
  v_mfma_f32_16x16x32_bf16 v[72:75], v[40:43], v[192:195], v[72:75]
  ds_read_b64_tr_b16 v[60:61], v19 offset:57344
  v_mfma_f32_16x16x32_bf16 v[76:79], v[40:43], v[196:199], v[76:79]
  ds_read_b64_tr_b16 v[62:63], v19 offset:58368
  s_waitcnt lgkmcnt(8)
  v_mfma_f32_16x16x32_bf16 v[72:75], v[44:47], v[200:203], v[72:75]
  v_mfma_f32_16x16x32_bf16 v[76:79], v[44:47], v[204:207], v[76:79]
  s_waitcnt lgkmcnt(6)
  v_mfma_f32_16x16x32_bf16 v[80:83], v[48:51], v[192:195], v[80:83]
  ds_read_b64_tr_b16 v[32:33], v20 offset:49152
  ds_read_b64_tr_b16 v[34:35], v20 offset:50176
  s_add_u32 m0, s58, 0x10000
  s_nop 0
  buffer_load_dwordx4 v6, s[20:23], 0 offen offset:0 lds
  v_mfma_f32_16x16x32_bf16 v[84:87], v[48:51], v[196:199], v[84:87]
  s_setprio 1
  ds_read_b64_tr_b16 v[36:37], v20 offset:57344
  s_waitcnt lgkmcnt(7)
  v_mfma_f32_16x16x32_bf16 v[80:83], v[52:55], v[200:203], v[80:83]
  ds_read_b64_tr_b16 v[38:39], v20 offset:58368
  v_mfma_f32_16x16x32_bf16 v[84:87], v[52:55], v[204:207], v[84:87]
  ds_read_b64_tr_b16 v[40:41], v21 offset:49152
  ds_read_b64_tr_b16 v[42:43], v21 offset:50176
  s_waitcnt lgkmcnt(8)
  v_mfma_f32_16x16x32_bf16 v[88:91], v[56:59], v[192:195], v[88:91]
  ds_read_b64_tr_b16 v[44:45], v21 offset:57344
  s_add_u32 m0, s58, 0x10000
  s_nop 0
  buffer_load_dwordx4 v6, s[20:23], 0 offen offset:1024 lds
  v_mfma_f32_16x16x32_bf16 v[92:95], v[56:59], v[196:199], v[92:95]
  ds_read_b64_tr_b16 v[46:47], v21 offset:58368
  s_waitcnt lgkmcnt(8)
  v_mfma_f32_16x16x32_bf16 v[88:91], v[60:63], v[200:203], v[88:91]
  v_mfma_f32_16x16x32_bf16 v[92:95], v[60:63], v[204:207], v[92:95]
  s_waitcnt lgkmcnt(6)
  v_mfma_f32_16x16x32_bf16 v[96:99], v[32:35], v[192:195], v[96:99]
  ds_read_b64_tr_b16 v[48:49], v22 offset:49152
  ds_read_b64_tr_b16 v[50:51], v22 offset:50176
  s_add_u32 m0, s58, 0x10000
  s_nop 0
  buffer_load_dwordx4 v6, s[20:23], 0 offen offset:2048 lds
  v_mfma_f32_16x16x32_bf16 v[100:103], v[32:35], v[196:199], v[100:103]
  s_setprio 0
  ds_read_b64_tr_b16 v[52:53], v22 offset:57344
  s_waitcnt lgkmcnt(7)
  v_mfma_f32_16x16x32_bf16 v[96:99], v[36:39], v[200:203], v[96:99]
  ds_read_b64_tr_b16 v[54:55], v22 offset:58368
  v_mfma_f32_16x16x32_bf16 v[100:103], v[36:39], v[204:207], v[100:103]
  ds_read_b64_tr_b16 v[56:57], v23 offset:49152
  ds_read_b64_tr_b16 v[58:59], v23 offset:50176
  s_waitcnt lgkmcnt(8)
  v_mfma_f32_16x16x32_bf16 v[104:107], v[40:43], v[192:195], v[104:107]
  ds_read_b64_tr_b16 v[60:61], v23 offset:57344
  s_add_u32 m0, s58, 0x10000
  s_nop 0
  buffer_load_dwordx4 v6, s[20:23], 0 offen offset:3072 lds
  s_add_u32 s20, s20, s50
  s_addc_u32 s21, s21, 0
  v_mfma_f32_16x16x32_bf16 v[108:111], v[40:43], v[196:199], v[108:111]
  ds_read_b64_tr_b16 v[62:63], v23 offset:58368
  s_waitcnt lgkmcnt(8)
  v_mfma_f32_16x16x32_bf16 v[104:107], v[44:47], v[200:203], v[104:107]
  v_mfma_f32_16x16x32_bf16 v[108:111], v[44:47], v[204:207], v[108:111]
  s_waitcnt lgkmcnt(6)
  v_mfma_f32_16x16x32_bf16 v[112:115], v[48:51], v[192:195], v[112:115]
  v_mfma_f32_16x16x32_bf16 v[116:119], v[48:51], v[196:199], v[116:119]
  s_waitcnt lgkmcnt(0)
  s_waitcnt vmcnt(12)
  s_barrier
  s_setprio 3
  ds_read_b64_tr_b16 v[32:33], v7 offset:0
  ds_read_b64_tr_b16 v[34:35], v7 offset:2048
  v_mfma_f32_16x16x32_bf16 v[112:115], v[52:55], v[200:203], v[112:115]
  ds_read_b128 v[240:243], v10 offset:0
  ds_read_b64_tr_b16 v[36:37], v7 offset:256
  v_mfma_f32_16x16x32_bf16 v[116:119], v[52:55], v[204:207], v[116:119]
  ds_read_b64_tr_b16 v[38:39], v7 offset:2304
  ds_read_b64_tr_b16 v[40:41], v7 offset:512
  s_add_u32 m0, s58, 0x20000
  s_nop 0
  buffer_load_dwordx4 v6, s[20:23], 0 offen offset:0 lds
  v_mfma_f32_16x16x32_bf16 v[120:123], v[56:59], v[192:195], v[120:123]
  ds_read_b64_tr_b16 v[42:43], v7 offset:2560
  ds_read_b64_tr_b16 v[44:45], v7 offset:768
  v_mfma_f32_16x16x32_bf16 v[124:127], v[56:59], v[196:199], v[124:127]
  s_setprio 2
  ds_read_b64_tr_b16 v[46:47], v7 offset:2816
  ds_read_b128 v[244:247], v10 offset:1024
  s_add_u32 m0, s58, 0x20000
  s_nop 0
  buffer_load_dwordx4 v6, s[20:23], 0 offen offset:1024 lds
  v_mfma_f32_16x16x32_bf16 v[120:123], v[60:63], v[200:203], v[120:123]
  ds_read_b128 v[248:251], v10 offset:2048
  ds_read_b128 v[252:255], v10 offset:3072
  v_mfma_f32_16x16x32_bf16 v[124:127], v[60:63], v[204:207], v[124:127]
  ds_read_b128 v[20:23], v10 offset:4096
  s_add_u32 m0, s58, 0x20000
  s_nop 0
  buffer_load_dwordx4 v6, s[20:23], 0 offen offset:2048 lds
  s_waitcnt lgkmcnt(11)
  s_waitcnt lgkmcnt(10)
  v_mfma_f32_16x16x32_bf16 v[160:163], v[32:35], v[240:243], 0
  s_waitcnt lgkmcnt(8)
  v_mfma_f32_16x16x32_bf16 v[164:167], v[36:39], v[240:243], 0
  s_add_u32 m0, s58, 0x20000
  s_nop 0
  buffer_load_dwordx4 v6, s[20:23], 0 offen offset:3072 lds
  s_add_u32 s20, s20, s50
  s_addc_u32 s21, s21, 0
  s_waitcnt lgkmcnt(6)
  v_mfma_f32_16x16x32_bf16 v[168:171], v[40:43], v[240:243], 0
  s_waitcnt lgkmcnt(4)
  v_mfma_f32_16x16x32_bf16 v[172:175], v[44:47], v[240:243], 0
  s_waitcnt lgkmcnt(0)
  s_waitcnt vmcnt(12)
  s_barrier
  s_setprio 3
  ds_read_b128 v[240:243], v11 offset:32768
  v_mfma_f32_16x16x32_bf16 v[176:179], v[32:35], v[244:247], 0
  v_mul_f32 v64, 0x3e0293ee, v64
  v_mul_f32 v65, 0x3e0293ee, v65
  ds_read_b64_tr_b16 v[48:49], v8 offset:32768
  v_mfma_f32_16x16x32_bf16 v[180:183], v[36:39], v[244:247], 0
  v_mul_f32 v66, 0x3e0293ee, v66
  ds_read_b64_tr_b16 v[50:51], v8 offset:34816
  s_add_u32 m0, s58, 0x0
  s_nop 0
  buffer_load_dwordx4 v6, s[20:23], 0 offen offset:0 lds
  v_mfma_f32_16x16x32_bf16 v[184:187], v[40:43], v[244:247], 0
  v_mul_f32 v67, 0x3e0293ee, v67
  ds_read_b64_tr_b16 v[52:53], v8 offset:33024
  v_mfma_f32_16x16x32_bf16 v[188:191], v[44:47], v[244:247], 0
  v_cvt_pk_bf16_f32 v128, v64, v65
  v_cvt_pk_bf16_f32 v129, v66, v67
  ds_read_b64_tr_b16 v[54:55], v8 offset:35072
  ds_read_b128 v[244:247], v11 offset:33792
  v_mfma_f32_16x16x32_bf16 v[192:195], v[32:35], v[248:251], 0
  v_mul_f32 v72, 0x3e0293ee, v72
  s_setprio 2
  ds_read_b64_tr_b16 v[56:57], v8 offset:33280
  s_add_u32 m0, s58, 0x0
  s_nop 0
  buffer_load_dwordx4 v6, s[20:23], 0 offen offset:1024 lds
  v_mfma_f32_16x16x32_bf16 v[196:199], v[36:39], v[248:251], 0
  v_mul_f32 v73, 0x3e0293ee, v73
  ds_read_b64_tr_b16 v[58:59], v8 offset:35328
  v_mfma_f32_16x16x32_bf16 v[200:203], v[40:43], v[248:251], 0
  v_mul_f32 v74, 0x3e0293ee, v74
  v_mul_f32 v75, 0x3e0293ee, v75
  ds_read_b64_tr_b16 v[60:61], v8 offset:33536
  v_mfma_f32_16x16x32_bf16 v[204:207], v[44:47], v[248:251], 0
  v_cvt_pk_bf16_f32 v130, v72, v73
  ds_read_b64_tr_b16 v[62:63], v8 offset:35584
  ds_read_b128 v[248:251], v11 offset:34816
  s_add_u32 m0, s58, 0x0
  s_nop 0
  buffer_load_dwordx4 v6, s[20:23], 0 offen offset:2048 lds
  v_mfma_f32_16x16x32_bf16 v[208:211], v[32:35], v[252:255], 0
  v_cvt_pk_bf16_f32 v131, v74, v75
  v_mfma_f32_16x16x32_bf16 v[212:215], v[36:39], v[252:255], 0
  v_mul_f32 v68, 0x3e0293ee, v68
  v_mul_f32 v69, 0x3e0293ee, v69
  s_setprio 1
  v_mfma_f32_16x16x32_bf16 v[216:219], v[40:43], v[252:255], 0
  v_mul_f32 v70, 0x3e0293ee, v70
  s_add_u32 m0, s58, 0x0
  s_nop 0
  buffer_load_dwordx4 v6, s[20:23], 0 offen offset:3072 lds
  s_add_u32 s20, s20, s50
  s_addc_u32 s21, s21, 0
  v_mfma_f32_16x16x32_bf16 v[220:223], v[44:47], v[252:255], 0
  v_mul_f32 v71, 0x3e0293ee, v71
  ds_read_b128 v[252:255], v11 offset:35840
  v_mfma_f32_16x16x32_bf16 v[224:227], v[32:35], v[20:23], 0
  v_cvt_pk_bf16_f32 v132, v68, v69
  v_cvt_pk_bf16_f32 v133, v70, v71
  v_mfma_f32_16x16x32_bf16 v[228:231], v[36:39], v[20:23], 0
  v_mul_f32 v76, 0x3e0293ee, v76
  v_mfma_f32_16x16x32_bf16 v[232:235], v[40:43], v[20:23], 0
  v_mul_f32 v77, 0x3e0293ee, v77
  s_setprio 0
  v_mfma_f32_16x16x32_bf16 v[236:239], v[44:47], v[20:23], 0
  v_mul_f32 v78, 0x3e0293ee, v78
  v_mul_f32 v79, 0x3e0293ee, v79
  ds_read_b128 v[20:23], v11 offset:36864
  s_waitcnt lgkmcnt(10)
  v_mfma_f32_16x16x32_bf16 v[160:163], v[48:51], v[240:243], v[160:163]
  v_cvt_pk_bf16_f32 v134, v76, v77
  s_waitcnt lgkmcnt(8)
  v_mfma_f32_16x16x32_bf16 v[164:167], v[52:55], v[240:243], v[164:167]
  v_cvt_pk_bf16_f32 v135, v78, v79
  s_waitcnt lgkmcnt(5)
  v_mfma_f32_16x16x32_bf16 v[168:171], v[56:59], v[240:243], v[168:171]
  v_mul_f32 v80, 0x3e0293ee, v80
  v_mul_f32 v81, 0x3e0293ee, v81
  s_waitcnt lgkmcnt(3)
  v_mfma_f32_16x16x32_bf16 v[172:175], v[60:63], v[240:243], v[172:175]
  v_mul_f32 v82, 0x3e0293ee, v82
  s_waitcnt lgkmcnt(0)
  s_waitcnt vmcnt(12)
  s_barrier
  s_setprio 3
  s_add_u32 s33, s36, 3
  s_and_b32 s33, s33, 7
  s_lshl_b32 s32, s37, 7
  s_add_u32 s33, s33, s32
  s_add_u32 s33, s33, 0xc000
  v_mov_b32 v15, 0
  buffer_store_byte v15, v13, s[24:27], s33 offen sc1
  ds_read_b128 v[240:243], v10 offset:32768
  v_mfma_f32_16x16x32_bf16 v[176:179], v[48:51], v[244:247], v[176:179]
  v_mul_f32 v83, 0x3e0293ee, v83
  ds_read_b64_tr_b16 v[32:33], v7 offset:32768
  v_mfma_f32_16x16x32_bf16 v[180:183], v[52:55], v[244:247], v[180:183]
  v_cvt_pk_bf16_f32 v136, v80, v81
  v_cvt_pk_bf16_f32 v137, v82, v83
  ds_read_b64_tr_b16 v[34:35], v7 offset:34816
  s_add_u32 m0, s58, 0x18000
  s_nop 0
  buffer_load_dwordx4 v6, s[20:23], 0 offen offset:0 lds
  v_mfma_f32_16x16x32_bf16 v[184:187], v[56:59], v[244:247], v[184:187]
  v_mul_f32 v88, 0x3e0293ee, v88
  ds_read_b64_tr_b16 v[36:37], v7 offset:33024
  v_mfma_f32_16x16x32_bf16 v[188:191], v[60:63], v[244:247], v[188:191]
  v_mul_f32 v89, 0x3e0293ee, v89
  ds_read_b64_tr_b16 v[38:39], v7 offset:35072
  ds_read_b128 v[244:247], v10 offset:33792
  v_mfma_f32_16x16x32_bf16 v[192:195], v[48:51], v[248:251], v[192:195]
  v_mul_f32 v90, 0x3e0293ee, v90
  v_mul_f32 v91, 0x3e0293ee, v91
  s_setprio 2
  ds_read_b64_tr_b16 v[40:41], v7 offset:33280
  s_add_u32 m0, s58, 0x18000
  s_nop 0
  buffer_load_dwordx4 v6, s[20:23], 0 offen offset:1024 lds
  v_mfma_f32_16x16x32_bf16 v[196:199], v[52:55], v[248:251], v[196:199]
  v_cvt_pk_bf16_f32 v138, v88, v89
  ds_read_b64_tr_b16 v[42:43], v7 offset:35328
  v_mfma_f32_16x16x32_bf16 v[200:203], v[56:59], v[248:251], v[200:203]
  v_cvt_pk_bf16_f32 v139, v90, v91
  ds_read_b64_tr_b16 v[44:45], v7 offset:33536
  v_mfma_f32_16x16x32_bf16 v[204:207], v[60:63], v[248:251], v[204:207]
  v_mul_f32 v84, 0x3e0293ee, v84
  v_mul_f32 v85, 0x3e0293ee, v85
  ds_read_b64_tr_b16 v[46:47], v7 offset:35584
  ds_read_b128 v[248:251], v10 offset:34816
  s_add_u32 m0, s58, 0x18000
  s_nop 0
  buffer_load_dwordx4 v6, s[20:23], 0 offen offset:2048 lds
  v_mfma_f32_16x16x32_bf16 v[208:211], v[48:51], v[252:255], v[208:211]
  v_mul_f32 v86, 0x3e0293ee, v86
  v_mfma_f32_16x16x32_bf16 v[212:215], v[52:55], v[252:255], v[212:215]
  v_mul_f32 v87, 0x3e0293ee, v87
  s_setprio 1
  v_mfma_f32_16x16x32_bf16 v[216:219], v[56:59], v[252:255], v[216:219]
  v_cvt_pk_bf16_f32 v140, v84, v85
  v_cvt_pk_bf16_f32 v141, v86, v87
  s_add_u32 m0, s58, 0x18000
  s_nop 0
  buffer_load_dwordx4 v6, s[20:23], 0 offen offset:3072 lds
  s_add_u32 s20, s20, s50
  s_addc_u32 s21, s21, 0
  v_mfma_f32_16x16x32_bf16 v[220:223], v[60:63], v[252:255], v[220:223]
  v_mul_f32 v92, 0x3e0293ee, v92
  ds_read_b128 v[252:255], v10 offset:35840
  v_mfma_f32_16x16x32_bf16 v[224:227], v[48:51], v[20:23], v[224:227]
  v_mul_f32 v93, 0x3e0293ee, v93
  v_mfma_f32_16x16x32_bf16 v[228:231], v[52:55], v[20:23], v[228:231]
  v_mul_f32 v94, 0x3e0293ee, v94
  v_mul_f32 v95, 0x3e0293ee, v95
  v_mfma_f32_16x16x32_bf16 v[232:235], v[56:59], v[20:23], v[232:235]
  v_cvt_pk_bf16_f32 v142, v92, v93
  s_setprio 0
  v_mfma_f32_16x16x32_bf16 v[236:239], v[60:63], v[20:23], v[236:239]
  v_cvt_pk_bf16_f32 v143, v94, v95
  ds_read_b128 v[20:23], v10 offset:36864
  s_waitcnt lgkmcnt(10)
  v_mfma_f32_16x16x32_bf16 v[160:163], v[32:35], v[240:243], v[160:163]
  v_mul_f32 v96, 0x3e0293ee, v96
  v_mul_f32 v97, 0x3e0293ee, v97
  s_waitcnt lgkmcnt(8)
  v_mfma_f32_16x16x32_bf16 v[164:167], v[36:39], v[240:243], v[164:167]
  v_mul_f32 v98, 0x3e0293ee, v98
  s_waitcnt lgkmcnt(5)
  v_mfma_f32_16x16x32_bf16 v[168:171], v[40:43], v[240:243], v[168:171]
  v_mul_f32 v99, 0x3e0293ee, v99
  s_waitcnt lgkmcnt(3)
  v_mfma_f32_16x16x32_bf16 v[172:175], v[44:47], v[240:243], v[172:175]
  v_cvt_pk_bf16_f32 v144, v96, v97
  v_cvt_pk_bf16_f32 v145, v98, v99
  s_waitcnt lgkmcnt(0)
  s_waitcnt vmcnt(13)
  s_barrier
  s_setprio 3
  ds_read_b128 v[240:243], v11 offset:0
  v_mfma_f32_16x16x32_bf16 v[176:179], v[32:35], v[244:247], v[176:179]
  v_mul_f32 v104, 0x3e0293ee, v104
  ds_read_b64_tr_b16 v[48:49], v8 offset:0
  v_mfma_f32_16x16x32_bf16 v[180:183], v[36:39], v[244:247], v[180:183]
  v_mul_f32 v105, 0x3e0293ee, v105
  ds_read_b64_tr_b16 v[50:51], v8 offset:2048
  s_add_u32 m0, s58, 0x8000
  s_nop 0
  buffer_load_dwordx4 v6, s[20:23], 0 offen offset:0 lds
  v_mfma_f32_16x16x32_bf16 v[184:187], v[40:43], v[244:247], v[184:187]
  v_mul_f32 v106, 0x3e0293ee, v106
  v_mul_f32 v107, 0x3e0293ee, v107
  ds_read_b64_tr_b16 v[52:53], v8 offset:256
  v_mfma_f32_16x16x32_bf16 v[188:191], v[44:47], v[244:247], v[188:191]
  v_cvt_pk_bf16_f32 v146, v104, v105
  ds_read_b64_tr_b16 v[54:55], v8 offset:2304
  ds_read_b128 v[244:247], v11 offset:1024
  v_mfma_f32_16x16x32_bf16 v[192:195], v[32:35], v[248:251], v[192:195]
  v_cvt_pk_bf16_f32 v147, v106, v107
  s_setprio 2
  ds_read_b64_tr_b16 v[56:57], v8 offset:512
  s_add_u32 m0, s58, 0x8000
  s_nop 0
  buffer_load_dwordx4 v6, s[20:23], 0 offen offset:1024 lds
  v_mfma_f32_16x16x32_bf16 v[196:199], v[36:39], v[248:251], v[196:199]
  v_mul_f32 v100, 0x3e0293ee, v100
  v_mul_f32 v101, 0x3e0293ee, v101
  ds_read_b64_tr_b16 v[58:59], v8 offset:2560
  v_mfma_f32_16x16x32_bf16 v[200:203], v[40:43], v[248:251], v[200:203]
  v_mul_f32 v102, 0x3e0293ee, v102
  ds_read_b64_tr_b16 v[60:61], v8 offset:768
  v_mfma_f32_16x16x32_bf16 v[204:207], v[44:47], v[248:251], v[204:207]
  v_mul_f32 v103, 0x3e0293ee, v103
  ds_read_b64_tr_b16 v[62:63], v8 offset:2816
  ds_read_b128 v[248:251], v11 offset:2048
  s_add_u32 m0, s58, 0x8000
  s_nop 0
  buffer_load_dwordx4 v6, s[20:23], 0 offen offset:2048 lds
  v_mfma_f32_16x16x32_bf16 v[208:211], v[32:35], v[252:255], v[208:211]
  v_cvt_pk_bf16_f32 v148, v100, v101
  v_cvt_pk_bf16_f32 v149, v102, v103
  v_mfma_f32_16x16x32_bf16 v[212:215], v[36:39], v[252:255], v[212:215]
  v_mul_f32 v108, 0x3e0293ee, v108
  s_setprio 1
  v_mfma_f32_16x16x32_bf16 v[216:219], v[40:43], v[252:255], v[216:219]
  v_mul_f32 v109, 0x3e0293ee, v109
  s_add_u32 m0, s58, 0x8000
  s_nop 0
  buffer_load_dwordx4 v6, s[20:23], 0 offen offset:3072 lds
  s_add_u32 s20, s20, s50
  s_addc_u32 s21, s21, 0
  v_mfma_f32_16x16x32_bf16 v[220:223], v[44:47], v[252:255], v[220:223]
  v_mul_f32 v110, 0x3e0293ee, v110
  v_mul_f32 v111, 0x3e0293ee, v111
  ds_read_b128 v[252:255], v11 offset:3072
  v_mfma_f32_16x16x32_bf16 v[224:227], v[32:35], v[20:23], v[224:227]
  v_cvt_pk_bf16_f32 v150, v108, v109
  v_mfma_f32_16x16x32_bf16 v[228:231], v[36:39], v[20:23], v[228:231]
  v_cvt_pk_bf16_f32 v151, v110, v111
  v_mfma_f32_16x16x32_bf16 v[232:235], v[40:43], v[20:23], v[232:235]
  v_mul_f32 v112, 0x3e0293ee, v112
  v_mul_f32 v113, 0x3e0293ee, v113
  s_setprio 0
  v_mfma_f32_16x16x32_bf16 v[236:239], v[44:47], v[20:23], v[236:239]
  v_mul_f32 v114, 0x3e0293ee, v114
  ds_read_b128 v[20:23], v11 offset:4096
  s_waitcnt lgkmcnt(10)
  v_mfma_f32_16x16x32_bf16 v[160:163], v[48:51], v[240:243], v[160:163]
  v_mul_f32 v115, 0x3e0293ee, v115
  s_waitcnt lgkmcnt(8)
  v_mfma_f32_16x16x32_bf16 v[164:167], v[52:55], v[240:243], v[164:167]
  v_cvt_pk_bf16_f32 v152, v112, v113
  v_cvt_pk_bf16_f32 v153, v114, v115
  s_waitcnt lgkmcnt(5)
  v_mfma_f32_16x16x32_bf16 v[168:171], v[56:59], v[240:243], v[168:171]
  v_mul_f32 v120, 0x3e0293ee, v120
  s_waitcnt lgkmcnt(3)
  v_mfma_f32_16x16x32_bf16 v[172:175], v[60:63], v[240:243], v[172:175]
  v_mul_f32 v121, 0x3e0293ee, v121
  s_waitcnt lgkmcnt(0)
  s_waitcnt vmcnt(13)
  s_barrier
  s_setprio 3
  ds_read_b128 v[240:243], v24 offset:0
  v_mfma_f32_16x16x32_bf16 v[176:179], v[48:51], v[244:247], v[176:179]
  v_mul_f32 v122, 0x3e0293ee, v122
  v_mul_f32 v123, 0x3e0293ee, v123
  ds_read_b64_tr_b16 v[32:33], v9 offset:0
  v_mfma_f32_16x16x32_bf16 v[180:183], v[52:55], v[244:247], v[180:183]
  v_cvt_pk_bf16_f32 v154, v120, v121
  ds_read_b64_tr_b16 v[34:35], v9 offset:2048
  s_add_u32 m0, s58, 0x10000
  s_nop 0
  buffer_load_dwordx4 v6, s[20:23], 0 offen offset:0 lds
  v_mfma_f32_16x16x32_bf16 v[184:187], v[56:59], v[244:247], v[184:187]
  v_cvt_pk_bf16_f32 v155, v122, v123
  ds_read_b64_tr_b16 v[36:37], v9 offset:256
  v_mfma_f32_16x16x32_bf16 v[188:191], v[60:63], v[244:247], v[188:191]
  v_mul_f32 v116, 0x3e0293ee, v116
  v_mul_f32 v117, 0x3e0293ee, v117
  ds_read_b64_tr_b16 v[38:39], v9 offset:2304
  ds_read_b128 v[244:247], v24 offset:1024
  v_mfma_f32_16x16x32_bf16 v[192:195], v[48:51], v[248:251], v[192:195]
  v_mul_f32 v118, 0x3e0293ee, v118
  s_setprio 2
  ds_read_b64_tr_b16 v[40:41], v9 offset:512
  s_add_u32 m0, s58, 0x10000
  s_nop 0
  buffer_load_dwordx4 v6, s[20:23], 0 offen offset:1024 lds
  v_mfma_f32_16x16x32_bf16 v[196:199], v[52:55], v[248:251], v[196:199]
  v_mul_f32 v119, 0x3e0293ee, v119
  ds_read_b64_tr_b16 v[42:43], v9 offset:2560
  v_mfma_f32_16x16x32_bf16 v[200:203], v[56:59], v[248:251], v[200:203]
  v_cvt_pk_bf16_f32 v156, v116, v117
  v_cvt_pk_bf16_f32 v157, v118, v119
  ds_read_b64_tr_b16 v[44:45], v9 offset:768
  v_mfma_f32_16x16x32_bf16 v[204:207], v[60:63], v[248:251], v[204:207]
  v_mul_f32 v124, 0x3e0293ee, v124
  ds_read_b64_tr_b16 v[46:47], v9 offset:2816
  ds_read_b128 v[248:251], v24 offset:2048
  s_add_u32 m0, s58, 0x10000
  s_nop 0
  buffer_load_dwordx4 v6, s[20:23], 0 offen offset:2048 lds
  v_mfma_f32_16x16x32_bf16 v[208:211], v[48:51], v[252:255], v[208:211]
  v_mul_f32 v125, 0x3e0293ee, v125
  v_mfma_f32_16x16x32_bf16 v[212:215], v[52:55], v[252:255], v[212:215]
  v_mul_f32 v126, 0x3e0293ee, v126
  v_mul_f32 v127, 0x3e0293ee, v127
  s_setprio 1
  v_mfma_f32_16x16x32_bf16 v[216:219], v[56:59], v[252:255], v[216:219]
  v_cvt_pk_bf16_f32 v158, v124, v125
  s_add_u32 m0, s58, 0x10000
  s_nop 0
  buffer_load_dwordx4 v6, s[20:23], 0 offen offset:3072 lds
  s_add_u32 s20, s20, s50
  s_addc_u32 s21, s21, 0
  v_mfma_f32_16x16x32_bf16 v[220:223], v[60:63], v[252:255], v[220:223]
  v_cvt_pk_bf16_f32 v159, v126, v127
  ds_read_b128 v[252:255], v24 offset:3072
  v_mfma_f32_16x16x32_bf16 v[224:227], v[48:51], v[20:23], v[224:227]
  v_mfma_f32_16x16x32_bf16 v[228:231], v[52:55], v[20:23], v[228:231]
  v_mfma_f32_16x16x32_bf16 v[232:235], v[56:59], v[20:23], v[232:235]
  s_setprio 0
  v_mfma_f32_16x16x32_bf16 v[236:239], v[60:63], v[20:23], v[236:239]
  ds_read_b128 v[20:23], v24 offset:4096
  s_waitcnt lgkmcnt(10)
  v_mfma_f32_16x16x32_bf16 v[160:163], v[32:35], v[240:243], v[160:163]
  s_waitcnt lgkmcnt(8)
  v_mfma_f32_16x16x32_bf16 v[164:167], v[36:39], v[240:243], v[164:167]
  s_waitcnt lgkmcnt(5)
  v_mfma_f32_16x16x32_bf16 v[168:171], v[40:43], v[240:243], v[168:171]
  s_waitcnt lgkmcnt(3)
  v_mfma_f32_16x16x32_bf16 v[172:175], v[44:47], v[240:243], v[172:175]
  s_waitcnt lgkmcnt(0)
  s_waitcnt vmcnt(13)
  s_barrier
  s_setprio 3
  ds_read_b128 v[240:243], v10 offset:0
  v_mfma_f32_16x16x32_bf16 v[176:179], v[32:35], v[244:247], v[176:179]
  ds_read_b64_tr_b16 v[48:49], v7 offset:0
  v_mfma_f32_16x16x32_bf16 v[180:183], v[36:39], v[244:247], v[180:183]
  ds_read_b64_tr_b16 v[50:51], v7 offset:2048
  s_add_u32 m0, s58, 0x20000
  s_nop 0
  buffer_load_dwordx4 v6, s[20:23], 0 offen offset:0 lds
  v_mfma_f32_16x16x32_bf16 v[184:187], v[40:43], v[244:247], v[184:187]
  ds_read_b64_tr_b16 v[52:53], v7 offset:256
  v_mfma_f32_16x16x32_bf16 v[188:191], v[44:47], v[244:247], v[188:191]
  ds_read_b64_tr_b16 v[54:55], v7 offset:2304
  ds_read_b128 v[244:247], v10 offset:1024
  v_mfma_f32_16x16x32_bf16 v[192:195], v[32:35], v[248:251], v[192:195]
  s_setprio 2
  ds_read_b64_tr_b16 v[56:57], v7 offset:512
  s_add_u32 m0, s58, 0x20000
  s_nop 0
  buffer_load_dwordx4 v6, s[20:23], 0 offen offset:1024 lds
  v_mfma_f32_16x16x32_bf16 v[196:199], v[36:39], v[248:251], v[196:199]
  ds_read_b64_tr_b16 v[58:59], v7 offset:2560
  v_mfma_f32_16x16x32_bf16 v[200:203], v[40:43], v[248:251], v[200:203]
  ds_read_b64_tr_b16 v[60:61], v7 offset:768
  v_mfma_f32_16x16x32_bf16 v[204:207], v[44:47], v[248:251], v[204:207]
  ds_read_b64_tr_b16 v[62:63], v7 offset:2816
  ds_read_b128 v[248:251], v10 offset:2048
  s_add_u32 m0, s58, 0x20000
  s_nop 0
  buffer_load_dwordx4 v6, s[20:23], 0 offen offset:2048 lds
  v_mfma_f32_16x16x32_bf16 v[208:211], v[32:35], v[252:255], v[208:211]
  v_mfma_f32_16x16x32_bf16 v[212:215], v[36:39], v[252:255], v[212:215]
  s_setprio 1
  v_mfma_f32_16x16x32_bf16 v[216:219], v[40:43], v[252:255], v[216:219]
  s_add_u32 m0, s58, 0x20000
  s_nop 0
  buffer_load_dwordx4 v6, s[20:23], 0 offen offset:3072 lds
  s_add_u32 s20, s20, s50
  s_addc_u32 s21, s21, 0
  v_mfma_f32_16x16x32_bf16 v[220:223], v[44:47], v[252:255], v[220:223]
  ds_read_b128 v[252:255], v10 offset:3072
  v_mfma_f32_16x16x32_bf16 v[224:227], v[32:35], v[20:23], v[224:227]
  v_mfma_f32_16x16x32_bf16 v[228:231], v[36:39], v[20:23], v[228:231]
  v_mfma_f32_16x16x32_bf16 v[232:235], v[40:43], v[20:23], v[232:235]
  s_setprio 0
  v_mfma_f32_16x16x32_bf16 v[236:239], v[44:47], v[20:23], v[236:239]
  ds_read_b128 v[20:23], v10 offset:4096
  s_waitcnt lgkmcnt(10)
  v_mfma_f32_16x16x32_bf16 v[160:163], v[48:51], v[240:243], v[160:163]
  s_waitcnt lgkmcnt(8)
  v_mfma_f32_16x16x32_bf16 v[164:167], v[52:55], v[240:243], v[164:167]
  s_waitcnt lgkmcnt(5)
  v_mfma_f32_16x16x32_bf16 v[168:171], v[56:59], v[240:243], v[168:171]
  s_waitcnt lgkmcnt(3)
  v_mfma_f32_16x16x32_bf16 v[172:175], v[60:63], v[240:243], v[172:175]
  s_waitcnt lgkmcnt(0)
  s_waitcnt vmcnt(12)
  s_barrier
  s_setprio 3
  ds_read_b128 v[240:243], v11 offset:32768
  v_mfma_f32_16x16x32_bf16 v[176:179], v[48:51], v[244:247], v[176:179]
  ds_read_b64_tr_b16 v[32:33], v8 offset:32768
  v_mfma_f32_16x16x32_bf16 v[180:183], v[52:55], v[244:247], v[180:183]
  ds_read_b64_tr_b16 v[34:35], v8 offset:34816
  s_add_u32 m0, s58, 0x0
  s_nop 0
  buffer_load_dwordx4 v6, s[20:23], 0 offen offset:0 lds
  v_mfma_f32_16x16x32_bf16 v[184:187], v[56:59], v[244:247], v[184:187]
  ds_read_b64_tr_b16 v[36:37], v8 offset:33024
  v_mfma_f32_16x16x32_bf16 v[188:191], v[60:63], v[244:247], v[188:191]
  ds_read_b64_tr_b16 v[38:39], v8 offset:35072
  ds_read_b128 v[244:247], v11 offset:33792
  v_mfma_f32_16x16x32_bf16 v[192:195], v[48:51], v[248:251], v[192:195]
  s_setprio 2
  ds_read_b64_tr_b16 v[40:41], v8 offset:33280
  s_add_u32 m0, s58, 0x0
  s_nop 0
  buffer_load_dwordx4 v6, s[20:23], 0 offen offset:1024 lds
  v_mfma_f32_16x16x32_bf16 v[196:199], v[52:55], v[248:251], v[196:199]
  ds_read_b64_tr_b16 v[42:43], v8 offset:35328
  v_mfma_f32_16x16x32_bf16 v[200:203], v[56:59], v[248:251], v[200:203]
  ds_read_b64_tr_b16 v[44:45], v8 offset:33536
  v_mfma_f32_16x16x32_bf16 v[204:207], v[60:63], v[248:251], v[204:207]
  ds_read_b64_tr_b16 v[46:47], v8 offset:35584
  ds_read_b128 v[248:251], v11 offset:34816
  s_add_u32 m0, s58, 0x0
  s_nop 0
  buffer_load_dwordx4 v6, s[20:23], 0 offen offset:2048 lds
  v_mfma_f32_16x16x32_bf16 v[208:211], v[48:51], v[252:255], v[208:211]
  v_mfma_f32_16x16x32_bf16 v[212:215], v[52:55], v[252:255], v[212:215]
  s_setprio 1
  v_mfma_f32_16x16x32_bf16 v[216:219], v[56:59], v[252:255], v[216:219]
  s_add_u32 m0, s58, 0x0
  s_nop 0
  buffer_load_dwordx4 v6, s[20:23], 0 offen offset:3072 lds
  s_add_u32 s20, s20, s50
  s_addc_u32 s21, s21, 0
  v_mfma_f32_16x16x32_bf16 v[220:223], v[60:63], v[252:255], v[220:223]
  ds_read_b128 v[252:255], v11 offset:35840
  v_mfma_f32_16x16x32_bf16 v[224:227], v[48:51], v[20:23], v[224:227]
  v_mfma_f32_16x16x32_bf16 v[228:231], v[52:55], v[20:23], v[228:231]
  v_mfma_f32_16x16x32_bf16 v[232:235], v[56:59], v[20:23], v[232:235]
  s_setprio 0
  v_mfma_f32_16x16x32_bf16 v[236:239], v[60:63], v[20:23], v[236:239]
  ds_read_b128 v[20:23], v11 offset:36864
  s_waitcnt lgkmcnt(10)
  v_mfma_f32_16x16x32_bf16 v[160:163], v[32:35], v[240:243], v[160:163]
  s_waitcnt lgkmcnt(8)
  v_mfma_f32_16x16x32_bf16 v[164:167], v[36:39], v[240:243], v[164:167]
  s_waitcnt lgkmcnt(5)
  v_mfma_f32_16x16x32_bf16 v[168:171], v[40:43], v[240:243], v[168:171]
  s_waitcnt lgkmcnt(3)
  v_mfma_f32_16x16x32_bf16 v[172:175], v[44:47], v[240:243], v[172:175]
  s_waitcnt lgkmcnt(0)
  s_waitcnt vmcnt(12)
  s_barrier
  s_setprio 3
  ds_read_b128 v[240:243], v10 offset:32768
  v_mfma_f32_16x16x32_bf16 v[176:179], v[32:35], v[244:247], v[176:179]
  ds_read_b64_tr_b16 v[48:49], v7 offset:32768
  v_mfma_f32_16x16x32_bf16 v[180:183], v[36:39], v[244:247], v[180:183]
  ds_read_b64_tr_b16 v[50:51], v7 offset:34816
  s_add_u32 m0, s58, 0x18000
  s_nop 0
  buffer_load_dwordx4 v6, s[20:23], 0 offen offset:0 lds
  v_mfma_f32_16x16x32_bf16 v[184:187], v[40:43], v[244:247], v[184:187]
  ds_read_b64_tr_b16 v[52:53], v7 offset:33024
  v_mfma_f32_16x16x32_bf16 v[188:191], v[44:47], v[244:247], v[188:191]
  ds_read_b64_tr_b16 v[54:55], v7 offset:35072
  ds_read_b128 v[244:247], v10 offset:33792
  v_mfma_f32_16x16x32_bf16 v[192:195], v[32:35], v[248:251], v[192:195]
  s_setprio 2
  ds_read_b64_tr_b16 v[56:57], v7 offset:33280
  s_add_u32 m0, s58, 0x18000
  s_nop 0
  buffer_load_dwordx4 v6, s[20:23], 0 offen offset:1024 lds
  v_mfma_f32_16x16x32_bf16 v[196:199], v[36:39], v[248:251], v[196:199]
  ds_read_b64_tr_b16 v[58:59], v7 offset:35328
  v_mfma_f32_16x16x32_bf16 v[200:203], v[40:43], v[248:251], v[200:203]
  s_lshl_b32 s32, s37, 7
  s_add_u32 s32, s32, 0xc000
  v_lshrrev_b32 v31, 1, v1
  v_add_lshl_u32 v31, v31, s3, 20
  v_lshl_add_u32 v31, v1, 2, v31
  buffer_load_dword v15, v31, s[24:27], s32 offen sc1
  ds_read_b64_tr_b16 v[60:61], v7 offset:33536
  v_mfma_f32_16x16x32_bf16 v[204:207], v[44:47], v[248:251], v[204:207]
  ds_read_b64_tr_b16 v[62:63], v7 offset:35584
  ds_read_b128 v[248:251], v10 offset:34816
  s_add_u32 m0, s58, 0x18000
  s_nop 0
  buffer_load_dwordx4 v6, s[20:23], 0 offen offset:2048 lds
  v_mfma_f32_16x16x32_bf16 v[208:211], v[32:35], v[252:255], v[208:211]
  v_mfma_f32_16x16x32_bf16 v[212:215], v[36:39], v[252:255], v[212:215]
  s_setprio 1
  v_mfma_f32_16x16x32_bf16 v[216:219], v[40:43], v[252:255], v[216:219]
  s_add_u32 m0, s58, 0x18000
  s_nop 0
  buffer_load_dwordx4 v6, s[20:23], 0 offen offset:3072 lds
  s_add_u32 s20, s20, s50
  s_addc_u32 s21, s21, 0
  v_mfma_f32_16x16x32_bf16 v[220:223], v[44:47], v[252:255], v[220:223]
  ds_read_b128 v[252:255], v10 offset:35840
  v_mfma_f32_16x16x32_bf16 v[224:227], v[32:35], v[20:23], v[224:227]
  v_mfma_f32_16x16x32_bf16 v[228:231], v[36:39], v[20:23], v[228:231]
  v_mfma_f32_16x16x32_bf16 v[232:235], v[40:43], v[20:23], v[232:235]
  s_setprio 0
  v_mfma_f32_16x16x32_bf16 v[236:239], v[44:47], v[20:23], v[236:239]
  ds_read_b128 v[20:23], v10 offset:36864
  s_waitcnt lgkmcnt(10)
  v_mfma_f32_16x16x32_bf16 v[160:163], v[48:51], v[240:243], v[160:163]
  s_waitcnt lgkmcnt(8)
  v_mfma_f32_16x16x32_bf16 v[164:167], v[52:55], v[240:243], v[164:167]
  s_waitcnt lgkmcnt(5)
  v_mfma_f32_16x16x32_bf16 v[168:171], v[56:59], v[240:243], v[168:171]
  s_waitcnt lgkmcnt(3)
  v_mfma_f32_16x16x32_bf16 v[172:175], v[60:63], v[240:243], v[172:175]
  s_waitcnt lgkmcnt(0)
  s_waitcnt vmcnt(13)
  s_barrier
  s_setprio 3
  ds_read_b128 v[240:243], v11 offset:0
  v_mfma_f32_16x16x32_bf16 v[176:179], v[48:51], v[244:247], v[176:179]
  ds_read_b64_tr_b16 v[32:33], v8 offset:0
  v_mfma_f32_16x16x32_bf16 v[180:183], v[52:55], v[244:247], v[180:183]
  ds_read_b64_tr_b16 v[34:35], v8 offset:2048
  s_cmp_eq_u32 s36, 7
  s_cselect_b32 s22, 0, s22
  s_add_u32 m0, s58, 0x8000
  s_nop 0
  buffer_load_dwordx4 v6, s[20:23], 0 offen offset:0 lds
  v_mfma_f32_16x16x32_bf16 v[184:187], v[56:59], v[244:247], v[184:187]
  ds_read_b64_tr_b16 v[36:37], v8 offset:256
  v_mfma_f32_16x16x32_bf16 v[188:191], v[60:63], v[244:247], v[188:191]
  ds_read_b64_tr_b16 v[38:39], v8 offset:2304
  ds_read_b128 v[244:247], v11 offset:1024
  v_mfma_f32_16x16x32_bf16 v[192:195], v[48:51], v[248:251], v[192:195]
  s_setprio 2
  ds_read_b64_tr_b16 v[40:41], v8 offset:512
  s_add_u32 m0, s58, 0x8000
  s_nop 0
  buffer_load_dwordx4 v6, s[20:23], 0 offen offset:1024 lds
  v_mfma_f32_16x16x32_bf16 v[196:199], v[52:55], v[248:251], v[196:199]
  ds_read_b64_tr_b16 v[42:43], v8 offset:2560
  v_mfma_f32_16x16x32_bf16 v[200:203], v[56:59], v[248:251], v[200:203]
  ds_read_b64_tr_b16 v[44:45], v8 offset:768
  v_mfma_f32_16x16x32_bf16 v[204:207], v[60:63], v[248:251], v[204:207]
  ds_read_b64_tr_b16 v[46:47], v8 offset:2816
  ds_read_b128 v[248:251], v11 offset:2048
  s_add_u32 m0, s58, 0x8000
  s_nop 0
  buffer_load_dwordx4 v6, s[20:23], 0 offen offset:2048 lds
  v_mfma_f32_16x16x32_bf16 v[208:211], v[48:51], v[252:255], v[208:211]
  v_mfma_f32_16x16x32_bf16 v[212:215], v[52:55], v[252:255], v[212:215]
  s_setprio 1
  v_mfma_f32_16x16x32_bf16 v[216:219], v[56:59], v[252:255], v[216:219]
  s_add_u32 m0, s58, 0x8000
  s_nop 0
  buffer_load_dwordx4 v6, s[20:23], 0 offen offset:3072 lds
  s_add_u32 s20, s20, s50
  s_addc_u32 s21, s21, 0
  v_mfma_f32_16x16x32_bf16 v[220:223], v[60:63], v[252:255], v[220:223]
  ds_read_b128 v[252:255], v11 offset:3072
  v_mfma_f32_16x16x32_bf16 v[224:227], v[48:51], v[20:23], v[224:227]
  v_mfma_f32_16x16x32_bf16 v[228:231], v[52:55], v[20:23], v[228:231]
  v_mfma_f32_16x16x32_bf16 v[232:235], v[56:59], v[20:23], v[232:235]
  s_setprio 0
  v_mfma_f32_16x16x32_bf16 v[236:239], v[60:63], v[20:23], v[236:239]
  ds_read_b128 v[20:23], v11 offset:4096
  s_waitcnt lgkmcnt(10)
  v_mfma_f32_16x16x32_bf16 v[160:163], v[32:35], v[240:243], v[160:163]
  s_waitcnt lgkmcnt(8)
  v_mfma_f32_16x16x32_bf16 v[164:167], v[36:39], v[240:243], v[164:167]
  s_waitcnt lgkmcnt(5)
  v_mfma_f32_16x16x32_bf16 v[168:171], v[40:43], v[240:243], v[168:171]
  s_waitcnt lgkmcnt(3)
  v_mfma_f32_16x16x32_bf16 v[172:175], v[44:47], v[240:243], v[172:175]
  s_waitcnt lgkmcnt(0)
  s_waitcnt vmcnt(13)
  s_barrier
  s_setprio 3
  ds_read_b128 v[240:243], v24 offset:0
  v_mfma_f32_16x16x32_bf16 v[176:179], v[32:35], v[244:247], v[176:179]
  ds_read_b64_tr_b16 v[48:49], v9 offset:0
  v_mfma_f32_16x16x32_bf16 v[180:183], v[36:39], v[244:247], v[180:183]
  ds_read_b64_tr_b16 v[50:51], v9 offset:2048
  s_add_u32 m0, s58, 0x10000
  s_nop 0
  buffer_load_dwordx4 v6, s[20:23], 0 offen offset:0 lds
  v_mfma_f32_16x16x32_bf16 v[184:187], v[40:43], v[244:247], v[184:187]
  ds_read_b64_tr_b16 v[52:53], v9 offset:256
  v_mfma_f32_16x16x32_bf16 v[188:191], v[44:47], v[244:247], v[188:191]
  ds_read_b64_tr_b16 v[54:55], v9 offset:2304
  ds_read_b128 v[244:247], v24 offset:1024
  v_mfma_f32_16x16x32_bf16 v[192:195], v[32:35], v[248:251], v[192:195]
  s_setprio 2
  ds_read_b64_tr_b16 v[56:57], v9 offset:512
  s_add_u32 m0, s58, 0x10000
  s_nop 0
  buffer_load_dwordx4 v6, s[20:23], 0 offen offset:1024 lds
  v_mfma_f32_16x16x32_bf16 v[196:199], v[36:39], v[248:251], v[196:199]
  ds_read_b64_tr_b16 v[58:59], v9 offset:2560
  v_mfma_f32_16x16x32_bf16 v[200:203], v[40:43], v[248:251], v[200:203]
  ds_read_b64_tr_b16 v[60:61], v9 offset:768
  v_mfma_f32_16x16x32_bf16 v[204:207], v[44:47], v[248:251], v[204:207]
  ds_read_b64_tr_b16 v[62:63], v9 offset:2816
  ds_read_b128 v[248:251], v24 offset:2048
  s_add_u32 m0, s58, 0x10000
  s_nop 0
  buffer_load_dwordx4 v6, s[20:23], 0 offen offset:2048 lds
  v_mfma_f32_16x16x32_bf16 v[208:211], v[32:35], v[252:255], v[208:211]
  v_mfma_f32_16x16x32_bf16 v[212:215], v[36:39], v[252:255], v[212:215]
  s_setprio 1
  v_mfma_f32_16x16x32_bf16 v[216:219], v[40:43], v[252:255], v[216:219]
  s_add_u32 m0, s58, 0x10000
  s_nop 0
  buffer_load_dwordx4 v6, s[20:23], 0 offen offset:3072 lds
  s_add_u32 s20, s20, s50
  s_addc_u32 s21, s21, 0
  v_mfma_f32_16x16x32_bf16 v[220:223], v[44:47], v[252:255], v[220:223]
  ds_read_b128 v[252:255], v24 offset:3072
  v_mfma_f32_16x16x32_bf16 v[224:227], v[32:35], v[20:23], v[224:227]
  v_mfma_f32_16x16x32_bf16 v[228:231], v[36:39], v[20:23], v[228:231]
  v_mfma_f32_16x16x32_bf16 v[232:235], v[40:43], v[20:23], v[232:235]
  s_setprio 0
  v_mfma_f32_16x16x32_bf16 v[236:239], v[44:47], v[20:23], v[236:239]
  ds_read_b128 v[20:23], v24 offset:4096
  s_waitcnt lgkmcnt(10)
  v_mfma_f32_16x16x32_bf16 v[160:163], v[48:51], v[240:243], v[160:163]
  s_waitcnt lgkmcnt(8)
  v_mfma_f32_16x16x32_bf16 v[164:167], v[52:55], v[240:243], v[164:167]
  s_waitcnt lgkmcnt(5)
  v_mfma_f32_16x16x32_bf16 v[168:171], v[56:59], v[240:243], v[168:171]
  s_waitcnt lgkmcnt(3)
  v_mfma_f32_16x16x32_bf16 v[172:175], v[60:63], v[240:243], v[172:175]
  s_waitcnt lgkmcnt(0)
  s_waitcnt vmcnt(13)
  s_barrier
  s_setprio 3
  ds_read_b128 v[240:243], v10 offset:0
  v_mfma_f32_16x16x32_bf16 v[176:179], v[48:51], v[244:247], v[176:179]
  ds_read_b64_tr_b16 v[32:33], v7 offset:0
  v_mfma_f32_16x16x32_bf16 v[180:183], v[52:55], v[244:247], v[180:183]
  ds_read_b64_tr_b16 v[34:35], v7 offset:2048
  v_mfma_f32_16x16x32_bf16 v[184:187], v[56:59], v[244:247], v[184:187]
  ds_read_b64_tr_b16 v[36:37], v7 offset:256
  v_mfma_f32_16x16x32_bf16 v[188:191], v[60:63], v[244:247], v[188:191]
  ds_read_b64_tr_b16 v[38:39], v7 offset:2304
  ds_read_b128 v[244:247], v10 offset:1024
  v_mfma_f32_16x16x32_bf16 v[192:195], v[48:51], v[248:251], v[192:195]
  s_setprio 2
  ds_read_b64_tr_b16 v[40:41], v7 offset:512
  v_mfma_f32_16x16x32_bf16 v[196:199], v[52:55], v[248:251], v[196:199]
  ds_read_b64_tr_b16 v[42:43], v7 offset:2560
  v_mfma_f32_16x16x32_bf16 v[200:203], v[56:59], v[248:251], v[200:203]
  s_waitcnt vmcnt(10)
  ds_read_b64_tr_b16 v[44:45], v7 offset:768
  v_mfma_f32_16x16x32_bf16 v[204:207], v[60:63], v[248:251], v[204:207]
  ds_read_b64_tr_b16 v[46:47], v7 offset:2816
  ds_read_b128 v[248:251], v10 offset:2048
  v_mfma_f32_16x16x32_bf16 v[208:211], v[48:51], v[252:255], v[208:211]
  v_readlane_b32 s32, v15, 0
  v_readlane_b32 s33, v15, 1
  s_nop 0
  s_ff1_i32_b64 s32, s[32:33]
  s_lshr_b32 s32, s32, 3
  s_min_u32 s32, s32, 8
  s_lshl_b32 s61, s32, 17
  s_add_u32 s32, s61, s3
  s_cmp_eq_u32 s32, 0
  s_cbranch_scc1 fN_kv
fN_kv_ret:
  v_mfma_f32_16x16x32_bf16 v[212:215], v[52:55], v[252:255], v[212:215]
  s_setprio 1
  v_mfma_f32_16x16x32_bf16 v[216:219], v[56:59], v[252:255], v[216:219]
  v_mfma_f32_16x16x32_bf16 v[220:223], v[60:63], v[252:255], v[220:223]
  ds_read_b128 v[252:255], v10 offset:3072
  v_mfma_f32_16x16x32_bf16 v[224:227], v[48:51], v[20:23], v[224:227]
  v_mfma_f32_16x16x32_bf16 v[228:231], v[52:55], v[20:23], v[228:231]
  v_mfma_f32_16x16x32_bf16 v[232:235], v[56:59], v[20:23], v[232:235]
  s_setprio 0
  v_mfma_f32_16x16x32_bf16 v[236:239], v[60:63], v[20:23], v[236:239]
  ds_read_b128 v[20:23], v10 offset:4096
  s_waitcnt lgkmcnt(10)
  v_mfma_f32_16x16x32_bf16 v[160:163], v[32:35], v[240:243], v[160:163]
  s_waitcnt lgkmcnt(8)
  v_mfma_f32_16x16x32_bf16 v[164:167], v[36:39], v[240:243], v[164:167]
  s_waitcnt lgkmcnt(5)
  v_mfma_f32_16x16x32_bf16 v[168:171], v[40:43], v[240:243], v[168:171]
  s_waitcnt lgkmcnt(3)
  v_mfma_f32_16x16x32_bf16 v[172:175], v[44:47], v[240:243], v[172:175]
  s_waitcnt lgkmcnt(0)
  s_waitcnt vmcnt(8)
  s_barrier
  s_setprio 3
  ds_read_b128 v[240:243], v11 offset:32768
  v_mfma_f32_16x16x32_bf16 v[176:179], v[32:35], v[244:247], v[176:179]
  ds_read_b64_tr_b16 v[48:49], v8 offset:32768
  v_mfma_f32_16x16x32_bf16 v[180:183], v[36:39], v[244:247], v[180:183]
  ds_read_b64_tr_b16 v[50:51], v8 offset:34816
  s_add_u32 m0, s58, 0x0
  s_mov_b32 s33, 0x0
  buffer_load_dwordx4 v12, s[16:19], s33 offen offset:0 lds
  v_mfma_f32_16x16x32_bf16 v[184:187], v[40:43], v[244:247], v[184:187]
  ds_read_b64_tr_b16 v[52:53], v8 offset:33024
  v_mfma_f32_16x16x32_bf16 v[188:191], v[44:47], v[244:247], v[188:191]
  ds_read_b64_tr_b16 v[54:55], v8 offset:35072
  ds_read_b128 v[244:247], v11 offset:33792
  v_mfma_f32_16x16x32_bf16 v[192:195], v[32:35], v[248:251], v[192:195]
  s_setprio 2
  ds_read_b64_tr_b16 v[56:57], v8 offset:33280
  s_add_u32 m0, s58, 0x0
  s_mov_b32 s33, 0x0
  buffer_load_dwordx4 v12, s[16:19], s33 offen offset:1024 lds
  v_mfma_f32_16x16x32_bf16 v[196:199], v[36:39], v[248:251], v[196:199]
  ds_read_b64_tr_b16 v[58:59], v8 offset:35328
  v_mfma_f32_16x16x32_bf16 v[200:203], v[40:43], v[248:251], v[200:203]
  ds_read_b64_tr_b16 v[60:61], v8 offset:33536
  v_mfma_f32_16x16x32_bf16 v[204:207], v[44:47], v[248:251], v[204:207]
  ds_read_b64_tr_b16 v[62:63], v8 offset:35584
  ds_read_b128 v[248:251], v11 offset:34816
  s_add_u32 m0, s58, 0x0
  s_mov_b32 s33, 0x0
  buffer_load_dwordx4 v12, s[16:19], s33 offen offset:2048 lds
  v_mfma_f32_16x16x32_bf16 v[208:211], v[32:35], v[252:255], v[208:211]
  v_mfma_f32_16x16x32_bf16 v[212:215], v[36:39], v[252:255], v[212:215]
  s_setprio 1
  v_mfma_f32_16x16x32_bf16 v[216:219], v[40:43], v[252:255], v[216:219]
  s_add_u32 m0, s58, 0x0
  s_mov_b32 s33, 0x0
  buffer_load_dwordx4 v12, s[16:19], s33 offen offset:3072 lds
  v_mfma_f32_16x16x32_bf16 v[220:223], v[44:47], v[252:255], v[220:223]
  ds_read_b128 v[252:255], v11 offset:35840
  v_mfma_f32_16x16x32_bf16 v[224:227], v[32:35], v[20:23], v[224:227]
  v_mfma_f32_16x16x32_bf16 v[228:231], v[36:39], v[20:23], v[228:231]
  v_mfma_f32_16x16x32_bf16 v[232:235], v[40:43], v[20:23], v[232:235]
  s_setprio 0
  v_mfma_f32_16x16x32_bf16 v[236:239], v[44:47], v[20:23], v[236:239]
  ds_read_b128 v[20:23], v11 offset:36864
  s_waitcnt lgkmcnt(10)
  v_mfma_f32_16x16x32_bf16 v[160:163], v[48:51], v[240:243], v[160:163]
  s_waitcnt lgkmcnt(8)
  v_mfma_f32_16x16x32_bf16 v[164:167], v[52:55], v[240:243], v[164:167]
  s_waitcnt lgkmcnt(5)
  v_mfma_f32_16x16x32_bf16 v[168:171], v[56:59], v[240:243], v[168:171]
  s_waitcnt lgkmcnt(3)
  v_mfma_f32_16x16x32_bf16 v[172:175], v[60:63], v[240:243], v[172:175]
  s_waitcnt lgkmcnt(0)
  s_waitcnt vmcnt(8)
  s_barrier
  s_setprio 3
  ds_read_b128 v[240:243], v10 offset:32768
  v_mfma_f32_16x16x32_bf16 v[176:179], v[48:51], v[244:247], v[176:179]
  ds_read_b64_tr_b16 v[32:33], v7 offset:32768
  v_mfma_f32_16x16x32_bf16 v[180:183], v[52:55], v[244:247], v[180:183]
  ds_read_b64_tr_b16 v[34:35], v7 offset:34816
  v_mfma_f32_16x16x32_bf16 v[184:187], v[56:59], v[244:247], v[184:187]
  ds_read_b64_tr_b16 v[36:37], v7 offset:33024
  v_mfma_f32_16x16x32_bf16 v[188:191], v[60:63], v[244:247], v[188:191]
  ds_read_b64_tr_b16 v[38:39], v7 offset:35072
  ds_read_b128 v[244:247], v10 offset:33792
  v_mfma_f32_16x16x32_bf16 v[192:195], v[48:51], v[248:251], v[192:195]
  s_setprio 2
  ds_read_b64_tr_b16 v[40:41], v7 offset:33280
  v_mfma_f32_16x16x32_bf16 v[196:199], v[52:55], v[248:251], v[196:199]
  ds_read_b64_tr_b16 v[42:43], v7 offset:35328
  v_mfma_f32_16x16x32_bf16 v[200:203], v[56:59], v[248:251], v[200:203]
  ds_read_b64_tr_b16 v[44:45], v7 offset:33536
  v_mfma_f32_16x16x32_bf16 v[204:207], v[60:63], v[248:251], v[204:207]
  ds_read_b64_tr_b16 v[46:47], v7 offset:35584
  ds_read_b128 v[248:251], v10 offset:34816
  v_mfma_f32_16x16x32_bf16 v[208:211], v[48:51], v[252:255], v[208:211]
  v_mfma_f32_16x16x32_bf16 v[212:215], v[52:55], v[252:255], v[212:215]
  s_setprio 1
  v_mfma_f32_16x16x32_bf16 v[216:219], v[56:59], v[252:255], v[216:219]
  v_mfma_f32_16x16x32_bf16 v[220:223], v[60:63], v[252:255], v[220:223]
  ds_read_b128 v[252:255], v10 offset:35840
  v_mfma_f32_16x16x32_bf16 v[224:227], v[48:51], v[20:23], v[224:227]
  v_mfma_f32_16x16x32_bf16 v[228:231], v[52:55], v[20:23], v[228:231]
  v_mfma_f32_16x16x32_bf16 v[232:235], v[56:59], v[20:23], v[232:235]
  s_setprio 0
  v_mfma_f32_16x16x32_bf16 v[236:239], v[60:63], v[20:23], v[236:239]
  ds_read_b128 v[20:23], v10 offset:36864
  s_waitcnt lgkmcnt(10)
  v_mfma_f32_16x16x32_bf16 v[160:163], v[32:35], v[240:243], v[160:163]
  s_waitcnt lgkmcnt(8)
  v_mfma_f32_16x16x32_bf16 v[164:167], v[36:39], v[240:243], v[164:167]
  s_waitcnt lgkmcnt(5)
  v_mfma_f32_16x16x32_bf16 v[168:171], v[40:43], v[240:243], v[168:171]
  s_waitcnt lgkmcnt(3)
  v_mfma_f32_16x16x32_bf16 v[172:175], v[44:47], v[240:243], v[172:175]
  s_waitcnt lgkmcnt(0)
  s_waitcnt vmcnt(4)
  s_barrier
  s_setprio 3
  ds_read_b128 v[240:243], v11 offset:0
  v_mfma_f32_16x16x32_bf16 v[176:179], v[32:35], v[244:247], v[176:179]
  ds_read_b64_tr_b16 v[48:49], v8 offset:0
  v_mfma_f32_16x16x32_bf16 v[180:183], v[36:39], v[244:247], v[180:183]
  ds_read_b64_tr_b16 v[50:51], v8 offset:2048
  s_add_u32 m0, s58, 0x8000
  s_mov_b32 s33, 0x10000
  buffer_load_dwordx4 v12, s[16:19], s33 offen offset:0 lds
  v_mfma_f32_16x16x32_bf16 v[184:187], v[40:43], v[244:247], v[184:187]
  ds_read_b64_tr_b16 v[52:53], v8 offset:256
  v_mfma_f32_16x16x32_bf16 v[188:191], v[44:47], v[244:247], v[188:191]
  ds_read_b64_tr_b16 v[54:55], v8 offset:2304
  ds_read_b128 v[244:247], v11 offset:1024
  v_mfma_f32_16x16x32_bf16 v[192:195], v[32:35], v[248:251], v[192:195]
  s_setprio 2
  ds_read_b64_tr_b16 v[56:57], v8 offset:512
  s_add_u32 m0, s58, 0x8000
  s_mov_b32 s33, 0x10000
  buffer_load_dwordx4 v12, s[16:19], s33 offen offset:1024 lds
  v_mfma_f32_16x16x32_bf16 v[196:199], v[36:39], v[248:251], v[196:199]
  ds_read_b64_tr_b16 v[58:59], v8 offset:2560
  v_mfma_f32_16x16x32_bf16 v[200:203], v[40:43], v[248:251], v[200:203]
  ds_read_b64_tr_b16 v[60:61], v8 offset:768
  v_mfma_f32_16x16x32_bf16 v[204:207], v[44:47], v[248:251], v[204:207]
  ds_read_b64_tr_b16 v[62:63], v8 offset:2816
  ds_read_b128 v[248:251], v11 offset:2048
  s_add_u32 m0, s58, 0x8000
  s_mov_b32 s33, 0x10000
  buffer_load_dwordx4 v12, s[16:19], s33 offen offset:2048 lds
  v_mfma_f32_16x16x32_bf16 v[208:211], v[32:35], v[252:255], v[208:211]
  v_mfma_f32_16x16x32_bf16 v[212:215], v[36:39], v[252:255], v[212:215]
  s_setprio 1
  v_mfma_f32_16x16x32_bf16 v[216:219], v[40:43], v[252:255], v[216:219]
  s_add_u32 m0, s58, 0x8000
  s_mov_b32 s33, 0x10000
  buffer_load_dwordx4 v12, s[16:19], s33 offen offset:3072 lds
  v_mfma_f32_16x16x32_bf16 v[220:223], v[44:47], v[252:255], v[220:223]
  ds_read_b128 v[252:255], v11 offset:3072
  v_mfma_f32_16x16x32_bf16 v[224:227], v[32:35], v[20:23], v[224:227]
  v_mfma_f32_16x16x32_bf16 v[228:231], v[36:39], v[20:23], v[228:231]
  v_mfma_f32_16x16x32_bf16 v[232:235], v[40:43], v[20:23], v[232:235]
  s_setprio 0
  v_mfma_f32_16x16x32_bf16 v[236:239], v[44:47], v[20:23], v[236:239]
  ds_read_b128 v[20:23], v11 offset:4096
  s_waitcnt lgkmcnt(10)
  v_mfma_f32_16x16x32_bf16 v[160:163], v[48:51], v[240:243], v[160:163]
  s_waitcnt lgkmcnt(8)
  v_mfma_f32_16x16x32_bf16 v[164:167], v[52:55], v[240:243], v[164:167]
  s_waitcnt lgkmcnt(5)
  v_mfma_f32_16x16x32_bf16 v[168:171], v[56:59], v[240:243], v[168:171]
  s_waitcnt lgkmcnt(3)
  v_mfma_f32_16x16x32_bf16 v[172:175], v[60:63], v[240:243], v[172:175]
  s_waitcnt lgkmcnt(0)
  s_barrier
  s_setprio 3
  v_mfma_f32_16x16x32_bf16 v[176:179], v[48:51], v[244:247], v[176:179]
  v_mfma_f32_16x16x32_bf16 v[180:183], v[52:55], v[244:247], v[180:183]
  s_add_u32 m0, s58, 0x10000
  s_mov_b32 s33, 0x2000
  buffer_load_dwordx4 v12, s[16:19], s33 offen offset:0 lds
  v_mfma_f32_16x16x32_bf16 v[184:187], v[56:59], v[244:247], v[184:187]
  v_mfma_f32_16x16x32_bf16 v[188:191], v[60:63], v[244:247], v[188:191]
  v_cvt_pk_bf16_f32 v160, v160, v161
  v_cvt_pk_bf16_f32 v161, v162, v163
  v_cvt_pk_bf16_f32 v162, v164, v165
  v_mfma_f32_16x16x32_bf16 v[192:195], v[48:51], v[248:251], v[192:195]
  s_setprio 2
  s_add_u32 m0, s58, 0x10000
  s_mov_b32 s33, 0x2000
  buffer_load_dwordx4 v12, s[16:19], s33 offen offset:1024 lds
  v_cvt_pk_bf16_f32 v163, v166, v167
  s_add_u32 s33, s51, 0
  buffer_store_dwordx4 v[160:163], v2, s[28:31], s33 offen offset:0 sc1
  v_mfma_f32_16x16x32_bf16 v[196:199], v[52:55], v[248:251], v[196:199]
  v_cvt_pk_bf16_f32 v168, v168, v169
  v_cvt_pk_bf16_f32 v169, v170, v171
  v_cvt_pk_bf16_f32 v170, v172, v173
  v_mfma_f32_16x16x32_bf16 v[200:203], v[56:59], v[248:251], v[200:203]
  v_cvt_pk_bf16_f32 v171, v174, v175
  s_add_u32 s33, s51, 0
  buffer_store_dwordx4 v[168:171], v2, s[28:31], s33 offen offset:1024 sc1
  v_mfma_f32_16x16x32_bf16 v[204:207], v[60:63], v[248:251], v[204:207]
  s_add_u32 m0, s58, 0x10000
  s_mov_b32 s33, 0x2000
  buffer_load_dwordx4 v12, s[16:19], s33 offen offset:2048 lds
  v_cvt_pk_bf16_f32 v176, v176, v177
  v_cvt_pk_bf16_f32 v177, v178, v179
  v_cvt_pk_bf16_f32 v178, v180, v181
  v_mfma_f32_16x16x32_bf16 v[208:211], v[48:51], v[252:255], v[208:211]
  v_cvt_pk_bf16_f32 v179, v182, v183
  s_add_u32 s33, s51, 0
  buffer_store_dwordx4 v[176:179], v2, s[28:31], s33 offen offset:2048 sc1
  v_mfma_f32_16x16x32_bf16 v[212:215], v[52:55], v[252:255], v[212:215]
  s_setprio 1
  v_cvt_pk_bf16_f32 v184, v184, v185
  v_cvt_pk_bf16_f32 v185, v186, v187
  v_cvt_pk_bf16_f32 v186, v188, v189
  v_mfma_f32_16x16x32_bf16 v[216:219], v[56:59], v[252:255], v[216:219]
  s_add_u32 m0, s58, 0x10000
  s_mov_b32 s33, 0x2000
  buffer_load_dwordx4 v12, s[16:19], s33 offen offset:3072 lds
  v_cvt_pk_bf16_f32 v187, v190, v191
  s_add_u32 s33, s51, 0
  buffer_store_dwordx4 v[184:187], v2, s[28:31], s33 offen offset:3072 sc1
  v_mfma_f32_16x16x32_bf16 v[220:223], v[60:63], v[252:255], v[220:223]
  v_cvt_pk_bf16_f32 v192, v192, v193
  v_cvt_pk_bf16_f32 v193, v194, v195
  v_cvt_pk_bf16_f32 v194, v196, v197
  v_mfma_f32_16x16x32_bf16 v[224:227], v[48:51], v[20:23], v[224:227]
  v_cvt_pk_bf16_f32 v195, v198, v199
  s_add_u32 s33, s51, 4096
  buffer_store_dwordx4 v[192:195], v2, s[28:31], s33 offen offset:0 sc1
  v_mfma_f32_16x16x32_bf16 v[228:231], v[52:55], v[20:23], v[228:231]
  v_cvt_pk_bf16_f32 v200, v200, v201
  v_cvt_pk_bf16_f32 v201, v202, v203
  v_cvt_pk_bf16_f32 v202, v204, v205
  v_mfma_f32_16x16x32_bf16 v[232:235], v[56:59], v[20:23], v[232:235]
  s_setprio 0
  v_cvt_pk_bf16_f32 v203, v206, v207
  s_add_u32 s33, s51, 4096
  buffer_store_dwordx4 v[200:203], v2, s[28:31], s33 offen offset:1024 sc1
  v_mfma_f32_16x16x32_bf16 v[236:239], v[60:63], v[20:23], v[236:239]
  v_cvt_pk_bf16_f32 v208, v208, v209
  v_cvt_pk_bf16_f32 v209, v210, v211
  v_cvt_pk_bf16_f32 v210, v212, v213
  v_cvt_pk_bf16_f32 v211, v214, v215
  s_add_u32 s33, s51, 4096
  buffer_store_dwordx4 v[208:211], v2, s[28:31], s33 offen offset:2048 sc1
  v_cvt_pk_bf16_f32 v216, v216, v217
  v_cvt_pk_bf16_f32 v217, v218, v219
  v_cvt_pk_bf16_f32 v218, v220, v221
  v_cvt_pk_bf16_f32 v219, v222, v223
  s_add_u32 s33, s51, 4096
  buffer_store_dwordx4 v[216:219], v2, s[28:31], s33 offen offset:3072 sc1
  v_cvt_pk_bf16_f32 v224, v224, v225
  v_cvt_pk_bf16_f32 v225, v226, v227
  v_cvt_pk_bf16_f32 v226, v228, v229
  v_cvt_pk_bf16_f32 v227, v230, v231
  s_add_u32 s33, s51, 8192
  buffer_store_dwordx4 v[224:227], v2, s[28:31], s33 offen offset:0 sc1
  v_cvt_pk_bf16_f32 v232, v232, v233
  v_cvt_pk_bf16_f32 v233, v234, v235
  v_cvt_pk_bf16_f32 v234, v236, v237
  v_cvt_pk_bf16_f32 v235, v238, v239
  s_add_u32 s33, s51, 8192
  buffer_store_dwordx4 v[232:235], v2, s[28:31], s33 offen offset:1024 sc1
  s_lshl_b32 s32, s37, 7
  s_add_u32 s32, s32, 0xc000
  v_lshrrev_b32 v31, 1, v1
  v_add_lshl_u32 v31, v31, s3, 20
  v_lshl_add_u32 v31, v1, 2, v31
  buffer_load_dword v30, v31, s[24:27], s32 offen sc1
  s_waitcnt vmcnt(19)
  s_branch f_join
f_U:
  s_lshr_b32 s32, s2, 3
  s_cmp_ge_u32 s32, 10
  s_cselect_b32 s33, 1, 0
  s_lshl_b32 s48, s34, 1
  s_add_u32 s48, s48, s33
  s_mul_i32 s33, s33, 10
  s_sub_u32 s49, s32, s33
  s_lshr_b32 s33, s33, 1
  s_add_u32 s33, s33, s49
  s_add_u32 s33, s33, s34
  s_sub_u32 s32, s33, 10
  s_cselect_b32 s33, s33, s32
  s_sub_u32 s32, s33, 10
  s_cselect_b32 s33, s33, s32
  s_lshl_b32 s38, s33, 7
  s_lshl_b32 s32, s48, 7
  s_lshr_b32 s33, s3, 1
  s_lshl_b32 s33, s33, 6
  s_add_u32 s46, s32, s33
  s_lshl_b32 s33, s49, 6
  s_cmp_lt_u32 s3, 4
  s_cselect_b32 s46, s46, s33
  s_and_b32 s33, s3, 1
  s_lshl_b32 s33, s33, 3
  s_add_u32 s46, s46, s33
  v_lshrrev_b32 v41, 5, v1
  v_bfe_u32 v42, v1, 3, 2
  v_lshl_add_u32 v41, v41, 4, v42
  v_add_u32 v41, s46, v41
  v_mul_u32_u24 v41, 1280, v41
  v_lshl_add_u32 v6, v35, 4, v41
  v_lshl_add_u32 v7, v36, 4, v41
  v_add_u32 v7, 0xa000, v7
  s_waitcnt lgkmcnt(0)
  s_cmp_lt_u32 s3, 6
  s_cselect_b32 s32, s70, s72
  s_cselect_b32 s33, s71, s73
  s_cmp_lt_u32 s3, 4
  s_cselect_b32 s20, s64, s32
  s_cselect_b32 s33, s65, s33
  s_mov_b32 s32, 0xc8000
  s_cselect_b32 s22, 0x280000, s32
  s_and_b32 s21, s33, 0xffff
  s_mov_b32 s23, 0x00020000
  s_add_u32 m0, s58, 0x20000
  s_add_u32 s33, s38, 0
  buffer_load_dwordx4 v6, s[20:23], s33 offen lds
  s_add_u32 m0, s58, 0x20400
  s_add_u32 s33, s38, 0
  buffer_load_dwordx4 v7, s[20:23], s33 offen lds
  s_add_u32 m0, s58, 0x20800
  s_add_u32 s33, s38, 5120
  buffer_load_dwordx4 v6, s[20:23], s33 offen lds
  s_add_u32 m0, s58, 0x20c00
  s_add_u32 s33, s38, 5120
  buffer_load_dwordx4 v7, s[20:23], s33 offen lds
  s_add_u32 s38, s38, 128
  s_cmp_eq_u32 s38, 1280
  s_cselect_b32 s38, 0, s38
  s_add_u32 m0, s58, 0x0
  s_add_u32 s33, s38, 0
  buffer_load_dwordx4 v6, s[20:23], s33 offen lds
  s_add_u32 m0, s58, 0x400
  s_add_u32 s33, s38, 0
  buffer_load_dwordx4 v7, s[20:23], s33 offen lds
  s_add_u32 m0, s58, 0x800
  s_add_u32 s33, s38, 5120
  buffer_load_dwordx4 v6, s[20:23], s33 offen lds
  s_add_u32 m0, s58, 0xc00
  s_add_u32 s33, s38, 5120
  buffer_load_dwordx4 v7, s[20:23], s33 offen lds
  s_add_u32 s38, s38, 128
  s_cmp_eq_u32 s38, 1280
  s_cselect_b32 s38, 0, s38
  s_add_u32 m0, s58, 0x18000
  s_add_u32 s33, s38, 0
  buffer_load_dwordx4 v6, s[20:23], s33 offen lds
  s_add_u32 m0, s58, 0x18400
  s_add_u32 s33, s38, 0
  buffer_load_dwordx4 v7, s[20:23], s33 offen lds
  s_add_u32 m0, s58, 0x18800
  s_add_u32 s33, s38, 5120
  buffer_load_dwordx4 v6, s[20:23], s33 offen lds
  s_add_u32 m0, s58, 0x18c00
  s_add_u32 s33, s38, 5120
  buffer_load_dwordx4 v7, s[20:23], s33 offen lds
  s_add_u32 s38, s38, 128
  s_cmp_eq_u32 s38, 1280
  s_cselect_b32 s38, 0, s38
  s_add_u32 m0, s58, 0x8000
  s_add_u32 s33, s38, 0
  buffer_load_dwordx4 v6, s[20:23], s33 offen lds
  s_add_u32 m0, s58, 0x8400
  s_add_u32 s33, s38, 0
  buffer_load_dwordx4 v7, s[20:23], s33 offen lds
  s_add_u32 m0, s58, 0x8800
  s_add_u32 s33, s38, 5120
  buffer_load_dwordx4 v6, s[20:23], s33 offen lds
  s_add_u32 m0, s58, 0x8c00
  s_add_u32 s33, s38, 5120
  buffer_load_dwordx4 v7, s[20:23], s33 offen lds
  s_add_u32 s38, s38, 128
  s_cmp_eq_u32 s38, 1280
  s_cselect_b32 s38, 0, s38
  s_add_u32 m0, s58, 0x10000
  s_add_u32 s33, s38, 0
  buffer_load_dwordx4 v6, s[20:23], s33 offen lds
  s_add_u32 m0, s58, 0x10400
  s_add_u32 s33, s38, 0
  buffer_load_dwordx4 v7, s[20:23], s33 offen lds
  s_add_u32 m0, s58, 0x10800
  s_add_u32 s33, s38, 5120
  buffer_load_dwordx4 v6, s[20:23], s33 offen lds
  s_add_u32 m0, s58, 0x10c00
  s_add_u32 s33, s38, 5120
  buffer_load_dwordx4 v7, s[20:23], s33 offen lds
  s_add_u32 s38, s38, 128
  s_cmp_eq_u32 s38, 1280
  s_cselect_b32 s38, 0, s38
  s_lshr_b32 s46, s3, 2
  s_lshl_b32 s46, s46, 13
  s_and_b32 s47, s3, 3
  s_lshl_b32 s47, s47, 11
  s_add_u32 s47, s47, 0x4000
  s_mov_b32 s4, s84
  s_and_b32 s5, s85, 0xffff
  s_mov_b32 s6, 0x200000
  s_mov_b32 s7, 0x00020000
  s_cmp_lt_u32 s3, 4
  s_cselect_b32 s8, s88, s90
  s_cselect_b32 s9, s89, s91
  s_and_b32 s9, s9, 0xffff
  s_mov_b32 s10, 0x400000
  s_mov_b32 s11, 0x00020000
  s_sub_u32 s32, s3, 5
  s_cmp_gt_u32 s32, 1
  s_cbranch_scc1 fU_nt
  s_lshr_b32 s33, s2, 3
  v_and_b32 v42, 1, v1
  v_lshl_add_u32 v42, s33, 1, v42
  s_min_u32 s33, s33, 4
  s_cmp_eq_u32 s32, 0
  s_cselect_b32 s100, s98, s94
  s_cselect_b32 s101, s99, s95
  s_cbranch_scc1 fU_nt1
  v_mov_b32 v42, s33
fU_nt1:
  v_lshlrev_b32 v42, 21, v42
  global_load_dword v15, v42, s[100:101]
fU_nt:
  v_lshlrev_b32 v2, 4, v1
  v_bfe_u32 v32, v1, 2, 2
  v_lshl_add_u32 v33, v34, 3, v32
  v_and_b32 v35, 3, v1
  v_lshlrev_b32 v35, 3, v35
  v_add_u32 v35, 0x18000, v35
  v_lshl_add_u32 v36, v33, 8, v35
  v_and_b32 v37, 1, v34
  v_lshl_add_u32 v38, v37, 2, v32
  v_xor_b32 v39, 0, v38
  v_lshl_add_u32 v16, v39, 5, v36
  v_xor_b32 v39, 1, v38
  v_lshl_add_u32 v17, v39, 5, v36
  v_xor_b32 v39, 2, v38
  v_lshl_add_u32 v18, v39, 5, v36
  v_xor_b32 v39, 3, v38
  v_lshl_add_u32 v19, v39, 5, v36
  s_lshr_b32 s40, s3, 2
  s_lshl_b32 s40, s40, 7
  v_xor_b32 v16, s40, v16
  v_xor_b32 v17, s40, v17
  v_xor_b32 v18, s40, v18
  v_xor_b32 v19, s40, v19
  v_and_b32 v39, 15, v1
  v_lshrrev_b32 v40, 1, v39
  v_xor_b32 v40, v40, v34
  v_lshlrev_b32 v39, 7, v39
  v_lshl_add_u32 v3, v40, 4, v39
  v_xor_b32 v4, 64, v3
  s_and_b32 s32, s3, 3
  s_lshl_b32 s32, s32, 13
  s_add_u32 s33, s32, 0x10000
  v_add_u32 v27, s32, v3
  v_add_u32 v28, s32, v4
  v_add_u32 v29, s33, v3
  v_add_u32 v30, s33, v4
  s_lshl_b32 s32, s37, 3
  s_add_u32 s32, s32, s41
  s_lshl_b32 s32, s32, 2
  s_and_b32 s33, s3, 3
  s_add_u32 s32, s32, s33
  s_lshl_b32 s32, s32, 15
  s_add_u32 s12, s98, s32
  s_addc_u32 s13, s99, 0
  s_and_b32 s13, s13, 0xffff
  s_mov_b32 s14, 0x8000
  s_mov_b32 s15, 0x00020000
  s_lshl_b32 s44, s40, 4
  s_lshl_b32 s45, s40, 5
  s_add_u32 s45, s45, 0x2000
  s_add_u32 s24, s98, 0x6000000
  s_addc_u32 s25, s99, 0
  s_and_b32 s25, s25, 0xffff
  s_mov_b32 s26, 0x38000
  s_mov_b32 s27, 0x00020000
  s_lshl_b32 s33, s49, 2
  s_and_b32 s50, s3, 3
  s_add_u32 s50, s50, s33
  s_lshl_b32 s33, s50, 12
  s_add_u32 s33, s33, 0x6010000
  s_add_u32 s28, s98, s33
  s_addc_u32 s29, s99, 0
  s_and_b32 s29, s29, 0xffff
  s_movk_i32 s30, 0x1000
  s_mov_b32 s31, 0x00020000
  s_lshl_b32 s32, s48, 1
  s_lshr_b32 s33, s3, 2
  s_add_u32 s32, s32, s33
  s_sub_u32 s32, 31, s32
  s_lshl_b32 s51, s32, 7
  s_waitcnt vmcnt(16)
  s_barrier
  s_add_u32 s33, s46, 0x20000
  v_add_u32 v8, s33, v3
  v_add_u32 v9, s33, v4
  s_add_u32 s33, s47, 0x20000
  v_add_u32 v10, s33, v3
  v_add_u32 v11, s33, v4
  ds_read_b128 v[32:35], v8 offset:0
  ds_read_b128 v[36:39], v8 offset:2048
  ds_read_b128 v[40:43], v8 offset:4096
  ds_read_b128 v[44:47], v8 offset:6144
  ds_read_b128 v[128:131], v10 offset:0
  ds_read_b128 v[132:135], v10 offset:8192
  ds_read_b128 v[136:139], v9 offset:0
  ds_read_b128 v[140:143], v9 offset:2048
  ds_read_b128 v[144:147], v9 offset:4096
  ds_read_b128 v[148:151], v9 offset:6144
  ds_read_b128 v[152:155], v11 offset:0
  ds_read_b128 v[156:159], v11 offset:8192
  s_waitcnt lgkmcnt(0)
  s_waitcnt vmcnt(12)
  s_barrier
  s_setprio 3
  v_mfma_f32_16x16x32_bf16 v[224:227], v[32:35], v[128:131], 0
  s_add_u32 s33, s46, 0x0
  v_add_u32 v8, s33, v3
  v_add_u32 v9, s33, v4
  s_add_u32 s33, s47, 0x0
  v_add_u32 v10, s33, v3
  v_add_u32 v11, s33, v4
  v_mfma_f32_16x16x32_bf16 v[228:231], v[36:39], v[128:131], 0
  ds_read_b128 v[48:51], v8 offset:0
  s_add_u32 m0, s58, 0x20000
  s_add_u32 s33, s38, 0
  buffer_load_dwordx4 v6, s[20:23], s33 offen lds
  v_mfma_f32_16x16x32_bf16 v[232:235], v[40:43], v[128:131], 0
  ds_read_b128 v[52:55], v8 offset:2048
  v_and_b32 v218, 3, v1
  v_bfe_u32 v31, v1, 2, 2
  v_mfma_f32_16x16x32_bf16 v[236:239], v[44:47], v[128:131], 0
  ds_read_b128 v[56:59], v8 offset:4096
  v_mfma_f32_16x16x32_bf16 v[240:243], v[32:35], v[132:135], 0
  s_setprio 2
  ds_read_b128 v[60:63], v8 offset:6144
  s_add_u32 m0, s58, 0x20400
  s_add_u32 s33, s38, 0
  buffer_load_dwordx4 v7, s[20:23], s33 offen lds
  v_lshl_add_u32 v31, v31, 4, v218
  v_mfma_f32_16x16x32_bf16 v[244:247], v[36:39], v[132:135], 0
  ds_read_b128 v[160:163], v10 offset:0
  v_mfma_f32_16x16x32_bf16 v[248:251], v[40:43], v[132:135], 0
  ds_read_b128 v[164:167], v10 offset:8192
  ds_read_b128 v[168:171], v9 offset:0
  s_lshl_b32 s32, s49, 6
  s_and_b32 s33, s3, 3
  s_lshl_b32 s33, s33, 2
  s_add_u32 s32, s32, s33
  v_add_lshl_u32 v31, v31, s32, 1
  v_mfma_f32_16x16x32_bf16 v[252:255], v[44:47], v[132:135], 0
  ds_read_b128 v[172:175], v9 offset:2048
  s_add_u32 m0, s58, 0x20800
  s_add_u32 s33, s38, 5120
  buffer_load_dwordx4 v6, s[20:23], s33 offen lds
  v_mfma_f32_16x16x32_bf16 v[224:227], v[136:139], v[152:155], v[224:227]
  s_setprio 1
  ds_read_b128 v[176:179], v9 offset:4096
  global_load_ushort v218, v31, s[66:67]
  v_mfma_f32_16x16x32_bf16 v[228:231], v[140:143], v[152:155], v[228:231]
  ds_read_b128 v[180:183], v9 offset:6144
  v_mfma_f32_16x16x32_bf16 v[232:235], v[144:147], v[152:155], v[232:235]
  ds_read_b128 v[184:187], v11 offset:0
  s_add_u32 m0, s58, 0x20c00
  s_add_u32 s33, s38, 5120
  buffer_load_dwordx4 v7, s[20:23], s33 offen lds
  s_add_u32 s38, s38, 128
  s_cmp_eq_u32 s38, 1280
  s_cselect_b32 s38, 0, s38
  global_load_ushort v219, v31, s[68:69]
  v_mfma_f32_16x16x32_bf16 v[236:239], v[148:151], v[152:155], v[236:239]
  ds_read_b128 v[188:191], v11 offset:8192
  v_mfma_f32_16x16x32_bf16 v[240:243], v[136:139], v[156:159], v[240:243]
  s_setprio 0
  global_load_ushort v220, v31, s[78:79]
  v_mfma_f32_16x16x32_bf16 v[244:247], v[140:143], v[156:159], v[244:247]
  v_mfma_f32_16x16x32_bf16 v[248:251], v[144:147], v[156:159], v[248:251]
  v_mfma_f32_16x16x32_bf16 v[252:255], v[148:151], v[156:159], v[252:255]
  s_waitcnt lgkmcnt(0)
  s_waitcnt vmcnt(15)
  s_barrier
  s_setprio 3
  v_mfma_f32_16x16x32_bf16 v[224:227], v[48:51], v[160:163], v[224:227]
  s_add_u32 s33, s46, 0x18000
  v_add_u32 v8, s33, v3
  v_add_u32 v9, s33, v4
  s_add_u32 s33, s47, 0x18000
  v_add_u32 v10, s33, v3
  v_add_u32 v11, s33, v4
  v_mfma_f32_16x16x32_bf16 v[228:231], v[52:55], v[160:163], v[228:231]
  ds_read_b128 v[32:35], v8 offset:0
  s_add_u32 m0, s58, 0x0
  s_add_u32 s33, s38, 0
  buffer_load_dwordx4 v6, s[20:23], s33 offen lds
  v_mfma_f32_16x16x32_bf16 v[232:235], v[56:59], v[160:163], v[232:235]
  ds_read_b128 v[36:39], v8 offset:2048
  v_mfma_f32_16x16x32_bf16 v[236:239], v[60:63], v[160:163], v[236:239]
  ds_read_b128 v[40:43], v8 offset:4096
  v_mfma_f32_16x16x32_bf16 v[240:243], v[48:51], v[164:167], v[240:243]
  s_setprio 2
  ds_read_b128 v[44:47], v8 offset:6144
  s_add_u32 m0, s58, 0x400
  s_add_u32 s33, s38, 0
  buffer_load_dwordx4 v7, s[20:23], s33 offen lds
  v_mfma_f32_16x16x32_bf16 v[244:247], v[52:55], v[164:167], v[244:247]
  ds_read_b128 v[128:131], v10 offset:0
  v_mfma_f32_16x16x32_bf16 v[248:251], v[56:59], v[164:167], v[248:251]
  ds_read_b128 v[132:135], v10 offset:8192
  ds_read_b128 v[136:139], v9 offset:0
  v_mfma_f32_16x16x32_bf16 v[252:255], v[60:63], v[164:167], v[252:255]
  ds_read_b128 v[140:143], v9 offset:2048
  s_add_u32 m0, s58, 0x800
  s_add_u32 s33, s38, 5120
  buffer_load_dwordx4 v6, s[20:23], s33 offen lds
  v_mfma_f32_16x16x32_bf16 v[224:227], v[168:171], v[184:187], v[224:227]
  s_setprio 1
  ds_read_b128 v[144:147], v9 offset:4096
  v_mfma_f32_16x16x32_bf16 v[228:231], v[172:175], v[184:187], v[228:231]
  ds_read_b128 v[148:151], v9 offset:6144
  v_mfma_f32_16x16x32_bf16 v[232:235], v[176:179], v[184:187], v[232:235]
  ds_read_b128 v[152:155], v11 offset:0
  s_add_u32 m0, s58, 0xc00
  s_add_u32 s33, s38, 5120
  buffer_load_dwordx4 v7, s[20:23], s33 offen lds
  s_add_u32 s38, s38, 128
  s_cmp_eq_u32 s38, 1280
  s_cselect_b32 s38, 0, s38
  v_mfma_f32_16x16x32_bf16 v[236:239], v[180:183], v[184:187], v[236:239]
  ds_read_b128 v[156:159], v11 offset:8192
  v_mfma_f32_16x16x32_bf16 v[240:243], v[168:171], v[188:191], v[240:243]
  s_setprio 0
  v_mfma_f32_16x16x32_bf16 v[244:247], v[172:175], v[188:191], v[244:247]
  v_mfma_f32_16x16x32_bf16 v[248:251], v[176:179], v[188:191], v[248:251]
  v_mfma_f32_16x16x32_bf16 v[252:255], v[180:183], v[188:191], v[252:255]
  s_waitcnt lgkmcnt(0)
  s_waitcnt vmcnt(15)
  s_barrier
  s_setprio 3
  v_mfma_f32_16x16x32_bf16 v[224:227], v[32:35], v[128:131], v[224:227]
  s_add_u32 s33, s46, 0x8000
  v_add_u32 v8, s33, v3
  v_add_u32 v9, s33, v4
  s_add_u32 s33, s47, 0x8000
  v_add_u32 v10, s33, v3
  v_add_u32 v11, s33, v4
  v_mfma_f32_16x16x32_bf16 v[228:231], v[36:39], v[128:131], v[228:231]
  ds_read_b128 v[48:51], v8 offset:0
  s_add_u32 m0, s58, 0x18000
  s_add_u32 s33, s38, 0
  buffer_load_dwordx4 v6, s[20:23], s33 offen lds
  v_mfma_f32_16x16x32_bf16 v[232:235], v[40:43], v[128:131], v[232:235]
  ds_read_b128 v[52:55], v8 offset:2048
  v_mfma_f32_16x16x32_bf16 v[236:239], v[44:47], v[128:131], v[236:239]
  ds_read_b128 v[56:59], v8 offset:4096
  v_mfma_f32_16x16x32_bf16 v[240:243], v[32:35], v[132:135], v[240:243]
  s_setprio 2
  ds_read_b128 v[60:63], v8 offset:6144
  s_add_u32 m0, s58, 0x18400
  s_add_u32 s33, s38, 0
  buffer_load_dwordx4 v7, s[20:23], s33 offen lds
  v_mfma_f32_16x16x32_bf16 v[244:247], v[36:39], v[132:135], v[244:247]
  ds_read_b128 v[160:163], v10 offset:0
  v_mfma_f32_16x16x32_bf16 v[248:251], v[40:43], v[132:135], v[248:251]
  ds_read_b128 v[164:167], v10 offset:8192
  ds_read_b128 v[168:171], v9 offset:0
  v_mfma_f32_16x16x32_bf16 v[252:255], v[44:47], v[132:135], v[252:255]
  ds_read_b128 v[172:175], v9 offset:2048
  s_add_u32 m0, s58, 0x18800
  s_add_u32 s33, s38, 5120
  buffer_load_dwordx4 v6, s[20:23], s33 offen lds
  v_mfma_f32_16x16x32_bf16 v[224:227], v[136:139], v[152:155], v[224:227]
  s_setprio 1
  ds_read_b128 v[176:179], v9 offset:4096
  v_mfma_f32_16x16x32_bf16 v[228:231], v[140:143], v[152:155], v[228:231]
  ds_read_b128 v[180:183], v9 offset:6144
  v_mfma_f32_16x16x32_bf16 v[232:235], v[144:147], v[152:155], v[232:235]
  ds_read_b128 v[184:187], v11 offset:0
  s_add_u32 m0, s58, 0x18c00
  s_add_u32 s33, s38, 5120
  buffer_load_dwordx4 v7, s[20:23], s33 offen lds
  s_add_u32 s38, s38, 128
  s_cmp_eq_u32 s38, 1280
  s_cselect_b32 s38, 0, s38
  v_mfma_f32_16x16x32_bf16 v[236:239], v[148:151], v[152:155], v[236:239]
  ds_read_b128 v[188:191], v11 offset:8192
  v_mfma_f32_16x16x32_bf16 v[240:243], v[136:139], v[156:159], v[240:243]
  s_setprio 0
  v_mfma_f32_16x16x32_bf16 v[244:247], v[140:143], v[156:159], v[244:247]
  v_mfma_f32_16x16x32_bf16 v[248:251], v[144:147], v[156:159], v[248:251]
  v_mfma_f32_16x16x32_bf16 v[252:255], v[148:151], v[156:159], v[252:255]
  s_lshl_b32 s32, s35, 3
  s_add_u32 s32, s32, s3
  s_lshl_b32 s32, s32, 13
  s_lshl_b32 s33, s41, 18
  s_add_u32 s32, s32, s33
  v_lshlrev_b32 v15, 7, v1
  buffer_load_dword v15, v15, s[4:7], s32 offen
  s_waitcnt lgkmcnt(0)
  s_waitcnt vmcnt(16)
  s_barrier
  s_setprio 3
  v_mfma_f32_16x16x32_bf16 v[224:227], v[48:51], v[160:163], v[224:227]
  s_add_u32 s33, s46, 0x10000
  v_add_u32 v8, s33, v3
  v_add_u32 v9, s33, v4
  s_add_u32 s33, s47, 0x10000
  v_add_u32 v10, s33, v3
  v_add_u32 v11, s33, v4
  v_mfma_f32_16x16x32_bf16 v[228:231], v[52:55], v[160:163], v[228:231]
  ds_read_b128 v[32:35], v8 offset:0
  s_add_u32 m0, s58, 0x8000
  s_add_u32 s33, s38, 0
  buffer_load_dwordx4 v6, s[20:23], s33 offen lds
  v_mfma_f32_16x16x32_bf16 v[232:235], v[56:59], v[160:163], v[232:235]
  s_mov_b32 s76, s96
  s_and_b32 s77, s97, 0xffff
  s_mov_b32 s78, 0x100
  s_mov_b32 s79, 0x00020000
  ds_read_b128 v[36:39], v8 offset:2048
  v_mfma_f32_16x16x32_bf16 v[236:239], v[60:63], v[160:163], v[236:239]
  ds_read_b128 v[40:43], v8 offset:4096
  v_mfma_f32_16x16x32_bf16 v[240:243], v[48:51], v[164:167], v[240:243]
  s_setprio 2
  ds_read_b128 v[44:47], v8 offset:6144
  s_add_u32 m0, s58, 0x8400
  s_add_u32 s33, s38, 0
  buffer_load_dwordx4 v7, s[20:23], s33 offen lds
  v_mfma_f32_16x16x32_bf16 v[244:247], v[52:55], v[164:167], v[244:247]
  ds_read_b128 v[128:131], v10 offset:0
  v_mfma_f32_16x16x32_bf16 v[248:251], v[56:59], v[164:167], v[248:251]
  ds_read_b128 v[132:135], v10 offset:8192
  ds_read_b128 v[136:139], v9 offset:0
  s_mov_b32 s16, s82
  s_mov_b32 s17, s83
  s_and_b32 s17, s17, 0xffff
  s_mov_b32 s19, 0x00020000
  v_mfma_f32_16x16x32_bf16 v[252:255], v[60:63], v[164:167], v[252:255]
  ds_read_b128 v[140:143], v9 offset:2048
  s_add_u32 m0, s58, 0x8800
  s_add_u32 s33, s38, 5120
  buffer_load_dwordx4 v6, s[20:23], s33 offen lds
  v_mfma_f32_16x16x32_bf16 v[224:227], v[168:171], v[184:187], v[224:227]
  s_setprio 1
  ds_read_b128 v[144:147], v9 offset:4096
  s_mov_b32 s33, 0x280000
  s_cmp_eq_u32 s3, 1
  s_cselect_b32 s18, s33, 0
  v_mfma_f32_16x16x32_bf16 v[228:231], v[172:175], v[184:187], v[228:231]
  ds_read_b128 v[148:151], v9 offset:6144
  v_mfma_f32_16x16x32_bf16 v[232:235], v[176:179], v[184:187], v[232:235]
  ds_read_b128 v[152:155], v11 offset:0
  s_add_u32 m0, s58, 0x8c00
  s_add_u32 s33, s38, 5120
  buffer_load_dwordx4 v7, s[20:23], s33 offen lds
  s_add_u32 s38, s38, 128
  s_cmp_eq_u32 s38, 1280
  s_cselect_b32 s38, 0, s38
  v_mfma_f32_16x16x32_bf16 v[236:239], v[180:183], v[184:187], v[236:239]
  ds_read_b128 v[156:159], v11 offset:8192
  v_lshlrev_b32 v12, 7, v1
  v_mfma_f32_16x16x32_bf16 v[240:243], v[168:171], v[188:191], v[240:243]
  s_setprio 0
  v_mfma_f32_16x16x32_bf16 v[244:247], v[172:175], v[188:191], v[244:247]
  v_mfma_f32_16x16x32_bf16 v[248:251], v[176:179], v[188:191], v[248:251]
  v_mfma_f32_16x16x32_bf16 v[252:255], v[180:183], v[188:191], v[252:255]
  s_lshl_b32 s32, s2, 13
  v_add_u32 v12, s32, v12
  buffer_load_dword v15, v12, s[16:19], 0 offen
  s_waitcnt lgkmcnt(0)
  s_waitcnt vmcnt(16)
  s_barrier
  s_setprio 3
  v_mfma_f32_16x16x32_bf16 v[224:227], v[32:35], v[128:131], v[224:227]
  s_add_u32 s33, s46, 0x20000
  v_add_u32 v8, s33, v3
  v_add_u32 v9, s33, v4
  s_add_u32 s33, s47, 0x20000
  v_add_u32 v10, s33, v3
  v_add_u32 v11, s33, v4
  v_mfma_f32_16x16x32_bf16 v[228:231], v[36:39], v[128:131], v[228:231]
  ds_read_b128 v[48:51], v8 offset:0
  s_add_u32 m0, s58, 0x10000
  s_add_u32 s33, s38, 0
  buffer_load_dwordx4 v6, s[20:23], s33 offen lds
  v_mfma_f32_16x16x32_bf16 v[232:235], v[40:43], v[128:131], v[232:235]
  ds_read_b128 v[52:55], v8 offset:2048
  v_mfma_f32_16x16x32_bf16 v[236:239], v[44:47], v[128:131], v[236:239]
  ds_read_b128 v[56:59], v8 offset:4096
  v_mfma_f32_16x16x32_bf16 v[240:243], v[32:35], v[132:135], v[240:243]
  s_setprio 2
  ds_read_b128 v[60:63], v8 offset:6144
  s_add_u32 m0, s58, 0x10400
  s_add_u32 s33, s38, 0
  buffer_load_dwordx4 v7, s[20:23], s33 offen lds
  v_mfma_f32_16x16x32_bf16 v[244:247], v[36:39], v[132:135], v[244:247]
  ds_read_b128 v[160:163], v10 offset:0
  v_mfma_f32_16x16x32_bf16 v[248:251], v[40:43], v[132:135], v[248:251]
  ds_read_b128 v[164:167], v10 offset:8192
  ds_read_b128 v[168:171], v9 offset:0
  s_mov_b32 s16, s86
  s_mov_b32 s17, s87
  s_and_b32 s17, s17, 0xffff
  s_mov_b32 s19, 0x00020000
  v_mfma_f32_16x16x32_bf16 v[252:255], v[44:47], v[132:135], v[252:255]
  ds_read_b128 v[172:175], v9 offset:2048
  s_add_u32 m0, s58, 0x10800
  s_add_u32 s33, s38, 5120
  buffer_load_dwordx4 v6, s[20:23], s33 offen lds
  v_mfma_f32_16x16x32_bf16 v[224:227], v[136:139], v[152:155], v[224:227]
  s_setprio 1
  ds_read_b128 v[176:179], v9 offset:4096
  s_mov_b32 s33, 0x500000
  s_cmp_eq_u32 s3, 3
  s_cselect_b32 s18, s33, 0
  v_mfma_f32_16x16x32_bf16 v[228:231], v[140:143], v[152:155], v[228:231]
  ds_read_b128 v[180:183], v9 offset:6144
  v_mfma_f32_16x16x32_bf16 v[232:235], v[144:147], v[152:155], v[232:235]
  ds_read_b128 v[184:187], v11 offset:0
  s_add_u32 m0, s58, 0x10c00
  s_add_u32 s33, s38, 5120
  buffer_load_dwordx4 v7, s[20:23], s33 offen lds
  s_add_u32 s38, s38, 128
  s_cmp_eq_u32 s38, 1280
  s_cselect_b32 s38, 0, s38
  v_lshrrev_b32 v12, 3, v1
  v_lshlrev_b32 v12, 13, v12
  v_mfma_f32_16x16x32_bf16 v[236:239], v[148:151], v[152:155], v[236:239]
  ds_read_b128 v[188:191], v11 offset:8192
  v_mfma_f32_16x16x32_bf16 v[240:243], v[136:139], v[156:159], v[240:243]
  s_setprio 0
  v_and_b32 v5, 7, v1
  v_lshl_add_u32 v12, v5, 7, v12
  v_mfma_f32_16x16x32_bf16 v[244:247], v[140:143], v[156:159], v[244:247]
  v_mfma_f32_16x16x32_bf16 v[248:251], v[144:147], v[156:159], v[248:251]
  v_mfma_f32_16x16x32_bf16 v[252:255], v[148:151], v[156:159], v[252:255]
  s_lshr_b32 s32, s2, 3
  s_add_u32 s32, s32, 0
  s_lshl_b32 s32, s32, 16
  s_lshl_b32 s33, s34, 10
  s_add_u32 s32, s32, s33
  v_add_u32 v12, s32, v12
  buffer_load_dword v15, v12, s[16:19], 0 offen
  s_waitcnt lgkmcnt(0)
  s_waitcnt vmcnt(15)
  s_barrier
  s_setprio 3
  v_mfma_f32_16x16x32_bf16 v[224:227], v[48:51], v[160:163], v[224:227]
  s_add_u32 s33, s46, 0x0
  v_add_u32 v8, s33, v3
  v_add_u32 v9, s33, v4
  s_add_u32 s33, s47, 0x0
  v_add_u32 v10, s33, v3
  v_add_u32 v11, s33, v4
  v_mfma_f32_16x16x32_bf16 v[228:231], v[52:55], v[160:163], v[228:231]
  ds_read_b128 v[32:35], v8 offset:0
  s_add_u32 m0, s59, 0x20000
  s_mov_b32 s32, 0x0
  buffer_load_dwordx4 v24, s[8:11], s32 offen lds
  v_mfma_f32_16x16x32_bf16 v[232:235], v[56:59], v[160:163], v[232:235]
  ds_read_b128 v[36:39], v8 offset:2048
  v_mfma_f32_16x16x32_bf16 v[236:239], v[60:63], v[160:163], v[236:239]
  ds_read_b128 v[40:43], v8 offset:4096
  v_lshlrev_b32 v218, 16, v218
  v_mfma_f32_16x16x32_bf16 v[240:243], v[48:51], v[164:167], v[240:243]
  s_setprio 2
  ds_read_b128 v[44:47], v8 offset:6144
  s_add_u32 m0, s59, 0x20400
  s_mov_b32 s32, 0x8000
  buffer_load_dwordx4 v24, s[8:11], s32 offen lds
  v_lshlrev_b32 v219, 16, v219
  v_mfma_f32_16x16x32_bf16 v[244:247], v[52:55], v[164:167], v[244:247]
  ds_read_b128 v[128:131], v10 offset:0
  v_mfma_f32_16x16x32_bf16 v[248:251], v[56:59], v[164:167], v[248:251]
  ds_read_b128 v[132:135], v10 offset:8192
  ds_read_b128 v[136:139], v9 offset:0
  s_mov_b32 s16, s86
  s_mov_b32 s17, s87
  s_and_b32 s17, s17, 0xffff
  s_mov_b32 s19, 0x00020000
  v_lshlrev_b32 v220, 16, v220
  v_mfma_f32_16x16x32_bf16 v[252:255], v[60:63], v[164:167], v[252:255]
  ds_read_b128 v[140:143], v9 offset:2048
  s_add_u32 m0, s59, 0x24000
  s_mov_b32 s32, 0x40000
  buffer_load_dwordx4 v24, s[8:11], s32 offen lds
  v_mul_f32 v220, 0x3fb8aa3b, v220
  v_mfma_f32_16x16x32_bf16 v[224:227], v[168:171], v[184:187], v[224:227]
  s_setprio 1
  ds_read_b128 v[144:147], v9 offset:4096
  s_mov_b32 s33, 0x500000
  s_cmp_eq_u32 s3, 4
  s_cselect_b32 s18, s33, 0
  v_exp_f32 v220, v220
  v_mfma_f32_16x16x32_bf16 v[228:231], v[172:175], v[184:187], v[228:231]
  ds_read_b128 v[148:151], v9 offset:6144
  v_mfma_f32_16x16x32_bf16 v[232:235], v[176:179], v[184:187], v[232:235]
  ds_read_b128 v[152:155], v11 offset:0
  s_add_u32 m0, s59, 0x24400
  s_mov_b32 s32, 0x48000
  buffer_load_dwordx4 v24, s[8:11], s32 offen lds
  v_lshrrev_b32 v12, 3, v1
  v_lshlrev_b32 v12, 13, v12
  v_cvt_pk_bf16_f32 v220, v220, v220
  v_mfma_f32_16x16x32_bf16 v[236:239], v[180:183], v[184:187], v[236:239]
  ds_read_b128 v[156:159], v11 offset:8192
  v_lshlrev_b32 v220, 16, v220
  v_mfma_f32_16x16x32_bf16 v[240:243], v[168:171], v[188:191], v[240:243]
  s_setprio 0
  v_and_b32 v5, 7, v1
  v_lshl_add_u32 v12, v5, 7, v12
  v_mfma_f32_16x16x32_bf16 v[244:247], v[172:175], v[188:191], v[244:247]
  v_mul_f32 v216, v220, v218
  v_mfma_f32_16x16x32_bf16 v[248:251], v[176:179], v[188:191], v[248:251]
  v_mul_f32 v217, v220, v219
  v_mfma_f32_16x16x32_bf16 v[252:255], v[180:183], v[188:191], v[252:255]
  s_lshr_b32 s32, s2, 3
  s_add_u32 s32, s32, 20
  s_lshl_b32 s32, s32, 16
  s_lshl_b32 s33, s34, 10
  s_add_u32 s32, s32, s33
  v_add_u32 v12, s32, v12
  buffer_load_dword v15, v12, s[16:19], 0 offen
  v_mul_f32 v216, 0x3fb8aa3b, v216
  s_waitcnt lgkmcnt(0)
  s_waitcnt vmcnt(16)
  s_barrier
  s_setprio 3
  v_mfma_f32_16x16x32_bf16 v[224:227], v[32:35], v[128:131], v[224:227]
  s_add_u32 s33, s46, 0x18000
  v_add_u32 v8, s33, v3
  v_add_u32 v9, s33, v4
  s_add_u32 s33, s47, 0x18000
  v_add_u32 v10, s33, v3
  v_add_u32 v11, s33, v4
  v_mfma_f32_16x16x32_bf16 v[228:231], v[36:39], v[128:131], v[228:231]
  v_min_u32 v22, 13, v1
  ds_read_b128 v[48:51], v8 offset:0
  s_add_u32 m0, s58, 0x0
  s_movk_i32 s33, 0x0
  buffer_load_dwordx4 v25, s[4:7], s33 offen lds
  v_mul_f32 v217, 0x3e22f983, v217
  v_mfma_f32_16x16x32_bf16 v[232:235], v[40:43], v[128:131], v[232:235]
  v_lshlrev_b32 v22, 4, v22
  ds_read_b128 v[52:55], v8 offset:2048
  v_fract_f32 v209, v217
  v_mfma_f32_16x16x32_bf16 v[236:239], v[44:47], v[128:131], v[236:239]
  s_lshl_b32 s32, s3, 20
  v_add_u32 v22, s32, v22
  ds_read_b128 v[56:59], v8 offset:4096
  v_mfma_f32_16x16x32_bf16 v[240:243], v[32:35], v[132:135], v[240:243]
  buffer_load_dword v23, v22, s[76:79], 0 offen sc1
  s_setprio 2
  ds_read_b128 v[60:63], v8 offset:6144
  s_add_u32 m0, s58, 0x400
  s_movk_i32 s33, 0x0
  buffer_load_dwordx4 v26, s[4:7], s33 offen lds
  v_exp_f32 v31, v216
  v_mfma_f32_16x16x32_bf16 v[244:247], v[36:39], v[132:135], v[244:247]
  ds_read_b128 v[160:163], v10 offset:0
  v_cos_f32 v208, v209
  v_mfma_f32_16x16x32_bf16 v[248:251], v[40:43], v[132:135], v[248:251]
  ds_read_b128 v[164:167], v10 offset:8192
  ds_read_b128 v[168:171], v9 offset:0
  s_mov_b32 s16, s86
  s_mov_b32 s17, s87
  s_and_b32 s17, s17, 0xffff
  s_mov_b32 s19, 0x00020000
  v_sin_f32 v209, v209
  v_mfma_f32_16x16x32_bf16 v[252:255], v[44:47], v[132:135], v[252:255]
  ds_read_b128 v[172:175], v9 offset:2048
  s_add_u32 m0, s58, 0x800
  s_movk_i32 s33, 0x4000
  buffer_load_dwordx4 v25, s[4:7], s33 offen lds
  v_mfma_f32_16x16x32_bf16 v[224:227], v[136:139], v[152:155], v[224:227]
  s_setprio 1
  ds_read_b128 v[176:179], v9 offset:4096
  s_mov_b32 s33, 0x500000
  s_cmp_eq_u32 s3, 5
  s_cselect_b32 s18, s33, 0
  v_mul_f32 v208, v208, v31
  v_mfma_f32_16x16x32_bf16 v[228:231], v[140:143], v[152:155], v[228:231]
  ds_read_b128 v[180:183], v9 offset:6144
  v_mul_f32 v209, v209, v31
  v_mfma_f32_16x16x32_bf16 v[232:235], v[144:147], v[152:155], v[232:235]
  ds_read_b128 v[184:187], v11 offset:0
  s_add_u32 m0, s58, 0xc00
  s_movk_i32 s33, 0x4000
  buffer_load_dwordx4 v26, s[4:7], s33 offen lds
  v_lshrrev_b32 v12, 3, v1
  v_lshlrev_b32 v12, 13, v12
  v_mfma_f32_16x16x32_bf16 v[236:239], v[148:151], v[152:155], v[236:239]
  ds_read_b128 v[188:191], v11 offset:8192
  v_mul_f32 v211, 0x41800000, v217
  v_mfma_f32_16x16x32_bf16 v[240:243], v[136:139], v[156:159], v[240:243]
  s_setprio 0
  v_and_b32 v5, 7, v1
  v_lshl_add_u32 v12, v5, 7, v12
  v_mul_f32 v31, 0x41800000, v216
  v_mfma_f32_16x16x32_bf16 v[244:247], v[140:143], v[156:159], v[244:247]
  v_fract_f32 v211, v211
  v_mfma_f32_16x16x32_bf16 v[248:251], v[144:147], v[156:159], v[248:251]
  v_mfma_f32_16x16x32_bf16 v[252:255], v[148:151], v[156:159], v[252:255]
  s_lshr_b32 s32, s2, 3
  s_add_u32 s32, s32, 40
  s_lshl_b32 s32, s32, 16
  s_lshl_b32 s33, s34, 10
  s_add_u32 s32, s32, s33
  v_add_u32 v12, s32, v12
  buffer_load_dword v15, v12, s[16:19], 0 offen
  v_exp_f32 v31, v31
  s_waitcnt lgkmcnt(0)
  s_waitcnt vmcnt(17)
  s_barrier
  s_setprio 3
  v_mfma_f32_16x16x32_bf16 v[224:227], v[48:51], v[160:163], v[224:227]
  s_add_u32 s33, s46, 0x8000
  v_add_u32 v8, s33, v3
  v_add_u32 v9, s33, v4
  s_add_u32 s33, s47, 0x8000
  v_add_u32 v10, s33, v3
  v_add_u32 v11, s33, v4
  v_cos_f32 v210, v211
  v_mfma_f32_16x16x32_bf16 v[228:231], v[52:55], v[160:163], v[228:231]
  ds_read_b128 v[32:35], v8 offset:0
  s_add_u32 m0, s59, 0x18000
  s_mov_b32 s32, 0x80000
  buffer_load_dwordx4 v24, s[8:11], s32 offen lds
  v_mfma_f32_16x16x32_bf16 v[232:235], v[56:59], v[160:163], v[232:235]
  ds_read_b128 v[36:39], v8 offset:2048
  v_sin_f32 v211, v211
  v_mfma_f32_16x16x32_bf16 v[236:239], v[60:63], v[160:163], v[236:239]
  ds_read_b128 v[40:43], v8 offset:4096
  v_mul_f32 v210, v210, v31
  v_mfma_f32_16x16x32_bf16 v[240:243], v[48:51], v[164:167], v[240:243]
  s_setprio 2
  ds_read_b128 v[44:47], v8 offset:6144
  s_add_u32 m0, s59, 0x18400
  s_mov_b32 s32, 0x88000
  buffer_load_dwordx4 v24, s[8:11], s32 offen lds
  v_mul_f32 v211, v211, v31
  v_mfma_f32_16x16x32_bf16 v[244:247], v[52:55], v[164:167], v[244:247]
  ds_read_b128 v[128:131], v10 offset:0
  v_mfma_f32_16x16x32_bf16 v[248:251], v[56:59], v[164:167], v[248:251]
  ds_read_b128 v[132:135], v10 offset:8192
  ds_read_b128 v[136:139], v9 offset:0
  s_mov_b32 s16, s86
  s_mov_b32 s17, s87
  s_and_b32 s17, s17, 0xffff
  s_mov_b32 s19, 0x00020000
  v_mul_f32 v213, 0x42000000, v217
  v_mfma_f32_16x16x32_bf16 v[252:255], v[60:63], v[164:167], v[252:255]
  ds_read_b128 v[140:143], v9 offset:2048
  s_add_u32 m0, s59, 0x1c000
  s_mov_b32 s32, 0xc0000
  buffer_load_dwordx4 v24, s[8:11], s32 offen lds
  v_mul_f32 v31, 0x42000000, v216
  v_mfma_f32_16x16x32_bf16 v[224:227], v[168:171], v[184:187], v[224:227]
  s_setprio 1
  ds_read_b128 v[144:147], v9 offset:4096
  s_mov_b32 s33, 0x500000
  s_cmp_eq_u32 s3, 6
  s_cselect_b32 s18, s33, 0
  v_mfma_f32_16x16x32_bf16 v[228:231], v[172:175], v[184:187], v[228:231]
  ds_read_b128 v[148:151], v9 offset:6144
  v_fract_f32 v213, v213
  v_mfma_f32_16x16x32_bf16 v[232:235], v[176:179], v[184:187], v[232:235]
  ds_read_b128 v[152:155], v11 offset:0
  s_add_u32 m0, s59, 0x1c400
  s_mov_b32 s32, 0xc8000
  buffer_load_dwordx4 v24, s[8:11], s32 offen lds
  v_lshrrev_b32 v12, 3, v1
  v_lshlrev_b32 v12, 13, v12
  v_exp_f32 v31, v31
  v_mfma_f32_16x16x32_bf16 v[236:239], v[180:183], v[184:187], v[236:239]
  ds_read_b128 v[156:159], v11 offset:8192
  v_cos_f32 v212, v213
  v_mfma_f32_16x16x32_bf16 v[240:243], v[168:171], v[188:191], v[240:243]
  s_setprio 0
  v_and_b32 v5, 7, v1
  v_lshl_add_u32 v12, v5, 7, v12
  v_mfma_f32_16x16x32_bf16 v[244:247], v[172:175], v[188:191], v[244:247]
  v_sin_f32 v213, v213
  v_mfma_f32_16x16x32_bf16 v[248:251], v[176:179], v[188:191], v[248:251]
  v_mul_f32 v212, v212, v31
  v_mfma_f32_16x16x32_bf16 v[252:255], v[180:183], v[188:191], v[252:255]
  s_lshr_b32 s32, s2, 3
  s_add_u32 s32, s32, 60
  s_lshl_b32 s32, s32, 16
  s_lshl_b32 s33, s34, 10
  s_add_u32 s32, s32, s33
  v_add_u32 v12, s32, v12
  buffer_load_dword v15, v12, s[16:19], 0 offen
  s_waitcnt lgkmcnt(0)
  s_waitcnt vmcnt(17)
  s_barrier
  s_setprio 3
  v_mfma_f32_16x16x32_bf16 v[224:227], v[32:35], v[128:131], v[224:227]
  s_add_u32 s33, s46, 0x10000
  v_add_u32 v8, s33, v3
  v_add_u32 v9, s33, v4
  s_add_u32 s33, s47, 0x10000
  v_add_u32 v10, s33, v3
  v_add_u32 v11, s33, v4
  v_mul_f32 v213, v213, v31
  v_mfma_f32_16x16x32_bf16 v[228:231], v[36:39], v[128:131], v[228:231]
  ds_read_b128 v[48:51], v8 offset:0
  s_add_u32 m0, s58, 0x8000
  s_movk_i32 s33, 0x80
  buffer_load_dwordx4 v25, s[4:7], s33 offen lds
  v_mul_f32 v7, 0x43800000, v217
  v_mfma_f32_16x16x32_bf16 v[232:235], v[40:43], v[128:131], v[232:235]
  ds_read_b128 v[52:55], v8 offset:2048
  v_mul_f32 v31, 0x43800000, v216
  v_mfma_f32_16x16x32_bf16 v[236:239], v[44:47], v[128:131], v[236:239]
  ds_read_b128 v[56:59], v8 offset:4096
  v_mfma_f32_16x16x32_bf16 v[240:243], v[32:35], v[132:135], v[240:243]
  s_setprio 2
  ds_read_b128 v[60:63], v8 offset:6144
  s_add_u32 m0, s58, 0x8400
  s_movk_i32 s33, 0x80
  buffer_load_dwordx4 v26, s[4:7], s33 offen lds
  v_fract_f32 v7, v7
  v_mfma_f32_16x16x32_bf16 v[244:247], v[36:39], v[132:135], v[244:247]
  ds_read_b128 v[160:163], v10 offset:0
  v_exp_f32 v31, v31
  v_mfma_f32_16x16x32_bf16 v[248:251], v[40:43], v[132:135], v[248:251]
  ds_read_b128 v[164:167], v10 offset:8192
  ds_read_b128 v[168:171], v9 offset:0
  s_mov_b32 s16, s82
  s_mov_b32 s17, s83
  s_and_b32 s17, s17, 0xffff
  s_mov_b32 s19, 0x00020000
  v_mfma_f32_16x16x32_bf16 v[252:255], v[44:47], v[132:135], v[252:255]
  ds_read_b128 v[172:175], v9 offset:2048
  s_add_u32 m0, s58, 0x8800
  s_movk_i32 s33, 0x4080
  buffer_load_dwordx4 v25, s[4:7], s33 offen lds
  v_cos_f32 v6, v7
  v_mfma_f32_16x16x32_bf16 v[224:227], v[136:139], v[152:155], v[224:227]
  s_setprio 1
  ds_read_b128 v[176:179], v9 offset:4096
  s_mov_b32 s33, 0x280000
  s_cmp_eq_u32 s3, 7
  s_cselect_b32 s18, s33, 0
  v_sin_f32 v7, v7
  v_mfma_f32_16x16x32_bf16 v[228:231], v[140:143], v[152:155], v[228:231]
  ds_read_b128 v[180:183], v9 offset:6144
  v_mul_f32 v6, v6, v31
  v_mfma_f32_16x16x32_bf16 v[232:235], v[144:147], v[152:155], v[232:235]
  ds_read_b128 v[184:187], v11 offset:0
  s_add_u32 m0, s58, 0x8c00
  s_movk_i32 s33, 0x4080
  buffer_load_dwordx4 v26, s[4:7], s33 offen lds
  v_mfma_f32_16x16x32_bf16 v[236:239], v[148:151], v[152:155], v[236:239]
  ds_read_b128 v[188:191], v11 offset:8192
  v_lshlrev_b32 v12, 7, v1
  v_mul_f32 v7, v7, v31
  v_mfma_f32_16x16x32_bf16 v[240:243], v[136:139], v[156:159], v[240:243]
  s_waitcnt vmcnt(13)
  s_setprio 0
  v_lshrrev_b32 v31, 4, v1
  v_mfma_f32_16x16x32_bf16 v[244:247], v[140:143], v[156:159], v[244:247]
  v_cmp_ne_u32 vcc, 1, v23
  s_cmp_lg_u32 s3, 0
  s_cbranch_scc1 fU_in_ret
  s_nop 2
  s_cbranch_vccnz fU_in
fU_in_ret:
  v_mfma_f32_16x16x32_bf16 v[248:251], v[144:147], v[156:159], v[248:251]
  v_lshlrev_b32 v31, 6, v31
  v_mfma_f32_16x16x32_bf16 v[252:255], v[148:151], v[156:159], v[252:255]
  s_lshl_b32 s32, s2, 13
  s_add_u32 s32, s32, 0x140000
  v_add_u32 v12, s32, v12
  buffer_load_dword v15, v12, s[16:19], 0 offen
  v_cvt_f32_u32 v31, v31
  s_waitcnt lgkmcnt(0)
  s_waitcnt vmcnt(11)
  s_barrier
  s_setprio 3
  v_mfma_f32_16x16x32_bf16 v[224:227], v[48:51], v[160:163], v[224:227]
  ds_read_b128 v[192:195], v27 offset:0
  v_mul_f32 v21, v31, v217
  v_mfma_f32_16x16x32_bf16 v[228:231], v[52:55], v[160:163], v[228:231]
  ds_read_b64_tr_b16 v[32:33], v16 offset:32768
  s_add_u32 m0, s58, 0x10000
  s_movk_i32 s33, 0x100
  buffer_load_dwordx4 v25, s[4:7], s33 offen lds
  v_mfma_f32_16x16x32_bf16 v[232:235], v[56:59], v[160:163], v[232:235]
  ds_read_b64_tr_b16 v[34:35], v16 offset:33792
  v_mul_f32 v31, v31, v216
  v_mfma_f32_16x16x32_bf16 v[236:239], v[60:63], v[160:163], v[236:239]
  ds_read_b64_tr_b16 v[36:37], v17 offset:32768
  v_fract_f32 v21, v21
  v_mfma_f32_16x16x32_bf16 v[240:243], v[48:51], v[164:167], v[240:243]
  s_setprio 2
  ds_read_b64_tr_b16 v[38:39], v17 offset:33792
  s_add_u32 m0, s58, 0x10400
  s_movk_i32 s33, 0x100
  buffer_load_dwordx4 v26, s[4:7], s33 offen lds
  v_mfma_f32_16x16x32_bf16 v[244:247], v[52:55], v[164:167], v[244:247]
  ds_read_b64_tr_b16 v[40:41], v18 offset:32768
  v_exp_f32 v31, v31
  v_mfma_f32_16x16x32_bf16 v[248:251], v[56:59], v[164:167], v[248:251]
  ds_read_b64_tr_b16 v[42:43], v18 offset:33792
  v_cos_f32 v20, v21
  v_mfma_f32_16x16x32_bf16 v[252:255], v[60:63], v[164:167], v[252:255]
  ds_read_b64_tr_b16 v[44:45], v19 offset:32768
  s_add_u32 m0, s58, 0x10800
  s_movk_i32 s33, 0x4100
  buffer_load_dwordx4 v25, s[4:7], s33 offen lds
  v_sin_f32 v21, v21
  v_mfma_f32_16x16x32_bf16 v[224:227], v[168:171], v[184:187], v[224:227]
  s_setprio 1
  ds_read_b64_tr_b16 v[46:47], v19 offset:33792
  v_mfma_f32_16x16x32_bf16 v[228:231], v[172:175], v[184:187], v[228:231]
  ds_read_b128 v[196:199], v27 offset:2048
  v_mul_f32 v20, v20, v31
  v_mfma_f32_16x16x32_bf16 v[232:235], v[176:179], v[184:187], v[232:235]
  ds_read_b128 v[200:203], v27 offset:4096
  s_add_u32 m0, s58, 0x10c00
  s_movk_i32 s33, 0x4100
  buffer_load_dwordx4 v26, s[4:7], s33 offen lds
  v_mul_f32 v21, v21, v31
  v_mfma_f32_16x16x32_bf16 v[236:239], v[180:183], v[184:187], v[236:239]
  ds_read_b128 v[204:207], v27 offset:6144
  v_mfma_f32_16x16x32_bf16 v[240:243], v[168:171], v[188:191], v[240:243]
  s_setprio 0
  v_mfma_f32_16x16x32_bf16 v[244:247], v[172:175], v[188:191], v[244:247]
  v_mfma_f32_16x16x32_bf16 v[248:251], v[176:179], v[188:191], v[248:251]
  v_mfma_f32_16x16x32_bf16 v[252:255], v[180:183], v[188:191], v[252:255]
  s_waitcnt lgkmcnt(9)
  v_mfma_f32_16x16x32_bf16 v[64:67], v[32:35], v[192:195], 0
  ds_read_b64_tr_b16 v[48:49], v16 offset:40960
  s_waitcnt lgkmcnt(8)
  v_mfma_f32_16x16x32_bf16 v[68:71], v[36:39], v[192:195], 0
  ds_read_b64_tr_b16 v[50:51], v16 offset:41984
  s_waitcnt lgkmcnt(7)
  v_mfma_f32_16x16x32_bf16 v[96:99], v[40:43], v[192:195], 0
  ds_read_b64_tr_b16 v[52:53], v17 offset:40960
  s_waitcnt lgkmcnt(6)
  v_mfma_f32_16x16x32_bf16 v[100:103], v[44:47], v[192:195], 0
  ds_read_b64_tr_b16 v[54:55], v17 offset:41984
  s_waitcnt lgkmcnt(6)
  v_mfma_f32_16x16x32_bf16 v[72:75], v[32:35], v[196:199], 0
  ds_read_b64_tr_b16 v[56:57], v18 offset:40960
  v_fma_f32 v214, v208, v224, v225
  v_fma_f32 v215, v208, v240, v241
  v_mfma_f32_16x16x32_bf16 v[76:79], v[36:39], v[196:199], 0
  ds_read_b64_tr_b16 v[58:59], v18 offset:41984
  v_fma_f32 v214, -v209, v240, v214
  v_fmac_f32 v215, v209, v224
  v_mfma_f32_16x16x32_bf16 v[104:107], v[40:43], v[196:199], 0
  ds_read_b64_tr_b16 v[60:61], v19 offset:40960
  v_fma_f32 v216, v208, v214, v226
  v_fma_f32 v217, v208, v215, v242
  v_mfma_f32_16x16x32_bf16 v[108:111], v[44:47], v[196:199], 0
  ds_read_b64_tr_b16 v[62:63], v19 offset:41984
  v_fma_f32 v216, -v209, v215, v216
  v_fmac_f32 v217, v209, v214
  s_waitcnt lgkmcnt(9)
  v_mfma_f32_16x16x32_bf16 v[80:83], v[32:35], v[200:203], 0
  v_fma_f32 v214, v208, v216, v227
  v_fma_f32 v215, v208, v217, v243
  v_mfma_f32_16x16x32_bf16 v[84:87], v[36:39], v[200:203], 0
  v_fma_f32 v214, -v209, v217, v214
  v_fmac_f32 v215, v209, v216
  v_mfma_f32_16x16x32_bf16 v[112:115], v[40:43], v[200:203], 0
  v_fma_f32 v216, v208, v214, v228
  v_mfma_f32_16x16x32_bf16 v[116:119], v[44:47], v[200:203], 0
  v_fma_f32 v217, v208, v215, v244
  v_fma_f32 v216, -v209, v215, v216
  s_waitcnt lgkmcnt(8)
  v_mfma_f32_16x16x32_bf16 v[88:91], v[32:35], v[204:207], 0
  s_waitcnt lgkmcnt(0)
  s_barrier
  s_setprio 3
  v_fmac_f32 v217, v209, v214
  v_fma_f32 v214, v208, v216, v229
  v_mfma_f32_16x16x32_bf16 v[92:95], v[36:39], v[204:207], 0
  ds_read_b64_tr_b16 v[32:33], v16 offset:49152
  v_fma_f32 v215, v208, v217, v245
  v_fma_f32 v214, -v209, v217, v214
  v_mfma_f32_16x16x32_bf16 v[120:123], v[40:43], v[204:207], 0
  ds_read_b64_tr_b16 v[34:35], v16 offset:50176
  s_add_u32 m0, s59, 0x20000
  s_mov_b32 s32, 0x100000
  buffer_load_dwordx4 v24, s[8:11], s32 offen lds
  v_fmac_f32 v215, v209, v216
  v_fma_f32 v216, v208, v214, v230
  v_mfma_f32_16x16x32_bf16 v[124:127], v[44:47], v[204:207], 0
  ds_read_b64_tr_b16 v[36:37], v17 offset:49152
  v_fma_f32 v217, v208, v215, v246
  v_fma_f32 v216, -v209, v215, v216
  v_mfma_f32_16x16x32_bf16 v[128:131], v[192:195], v[48:51], 0
  ds_read_b64_tr_b16 v[38:39], v17 offset:50176
  v_fmac_f32 v217, v209, v214
  v_mfma_f32_16x16x32_bf16 v[144:147], v[192:195], v[52:55], 0
  ds_read_b64_tr_b16 v[40:41], v18 offset:49152
  v_fma_f32 v214, v208, v216, v231
  v_fma_f32 v215, v208, v217, v247
  v_mfma_f32_16x16x32_bf16 v[160:163], v[192:195], v[56:59], 0
  ds_read_b64_tr_b16 v[42:43], v18 offset:50176
  v_fma_f32 v214, -v209, v217, v214
  v_fmac_f32 v215, v209, v216
  v_mfma_f32_16x16x32_bf16 v[176:179], v[192:195], v[60:63], 0
  ds_read_b128 v[192:195], v28 offset:0
  s_add_u32 m0, s59, 0x20400
  s_mov_b32 s32, 0x108000
  buffer_load_dwordx4 v24, s[8:11], s32 offen lds
  v_fma_f32 v216, v208, v214, v232
  v_fma_f32 v217, v208, v215, v248
  v_mfma_f32_16x16x32_bf16 v[132:135], v[196:199], v[48:51], 0
  s_setprio 2
  ds_read_b64_tr_b16 v[44:45], v19 offset:49152
  v_fma_f32 v216, -v209, v215, v216
  v_fmac_f32 v217, v209, v214
  v_mfma_f32_16x16x32_bf16 v[148:151], v[196:199], v[52:55], 0
  ds_read_b64_tr_b16 v[46:47], v19 offset:50176
  v_fma_f32 v214, v208, v216, v233
  v_fma_f32 v215, v208, v217, v249
  v_mfma_f32_16x16x32_bf16 v[164:167], v[196:199], v[56:59], 0
  v_fma_f32 v214, -v209, v217, v214
  v_mfma_f32_16x16x32_bf16 v[180:183], v[196:199], v[60:63], 0
  ds_read_b128 v[196:199], v28 offset:2048
  v_fmac_f32 v215, v209, v216
  v_fma_f32 v216, v208, v214, v234
  v_mfma_f32_16x16x32_bf16 v[136:139], v[200:203], v[48:51], 0
  v_fma_f32 v217, v208, v215, v250
  v_fma_f32 v216, -v209, v215, v216
  v_mfma_f32_16x16x32_bf16 v[152:155], v[200:203], v[52:55], 0
  v_fmac_f32 v217, v209, v214
  v_fma_f32 v214, v208, v216, v235
  v_mfma_f32_16x16x32_bf16 v[168:171], v[200:203], v[56:59], 0
  v_fma_f32 v215, v208, v217, v251
  v_fma_f32 v214, -v209, v217, v214
  v_mfma_f32_16x16x32_bf16 v[184:187], v[200:203], v[60:63], 0
  ds_read_b128 v[200:203], v28 offset:4096
  v_fmac_f32 v215, v209, v216
  v_fma_f32 v216, v208, v214, v236
  v_mfma_f32_16x16x32_bf16 v[140:143], v[204:207], v[48:51], 0
  s_setprio 1
  v_fma_f32 v217, v208, v215, v252
  v_fma_f32 v216, -v209, v215, v216
  v_mfma_f32_16x16x32_bf16 v[156:159], v[204:207], v[52:55], 0
  v_fmac_f32 v217, v209, v214
  v_mfma_f32_16x16x32_bf16 v[172:175], v[204:207], v[56:59], 0
  v_fma_f32 v214, v208, v216, v237
  v_fma_f32 v215, v208, v217, v253
  v_mfma_f32_16x16x32_bf16 v[188:191], v[204:207], v[60:63], 0
  ds_read_b128 v[204:207], v28 offset:6144
  v_fma_f32 v214, -v209, v217, v214
  v_fmac_f32 v215, v209, v216
  s_waitcnt lgkmcnt(10)
  s_waitcnt lgkmcnt(5)
  v_mfma_f32_16x16x32_bf16 v[64:67], v[32:35], v[192:195], v[64:67]
  ds_read_b64_tr_b16 v[48:49], v16 offset:57344
  v_fma_f32 v216, v208, v214, v238
  v_fma_f32 v217, v208, v215, v254
  v_mfma_f32_16x16x32_bf16 v[68:71], v[36:39], v[192:195], v[68:71]
  ds_read_b64_tr_b16 v[50:51], v16 offset:58368
  v_fma_f32 v216, -v209, v215, v216
  v_fmac_f32 v217, v209, v214
  v_mfma_f32_16x16x32_bf16 v[96:99], v[40:43], v[192:195], v[96:99]
  ds_read_b64_tr_b16 v[52:53], v17 offset:57344
  v_fma_f32 v214, v208, v216, v239
  v_fma_f32 v215, v208, v217, v255
  s_waitcnt lgkmcnt(6)
  v_mfma_f32_16x16x32_bf16 v[100:103], v[44:47], v[192:195], v[100:103]
  ds_read_b64_tr_b16 v[54:55], v17 offset:58368
  v_fma_f32 v214, -v209, v217, v214
  s_waitcnt lgkmcnt(6)
  v_mfma_f32_16x16x32_bf16 v[72:75], v[32:35], v[196:199], v[72:75]
  s_setprio 0
  ds_read_b64_tr_b16 v[56:57], v18 offset:57344
  v_fmac_f32 v215, v209, v216
  v_mov_b32 v8, v214
  v_mfma_f32_16x16x32_bf16 v[76:79], v[36:39], v[196:199], v[76:79]
  ds_read_b64_tr_b16 v[58:59], v18 offset:58368
  v_mov_b32 v9, v215
  v_permlane16_swap_b32 v8, v214
  v_mfma_f32_16x16x32_bf16 v[104:107], v[40:43], v[196:199], v[104:107]
  ds_read_b64_tr_b16 v[60:61], v19 offset:57344
  v_permlane16_swap_b32 v9, v215
  v_fma_f32 v214, v210, v8, v214
  v_mfma_f32_16x16x32_bf16 v[108:111], v[44:47], v[196:199], v[108:111]
  ds_read_b64_tr_b16 v[62:63], v19 offset:58368
  v_fma_f32 v215, v210, v9, v215
  v_fma_f32 v214, -v211, v9, v214
  s_waitcnt lgkmcnt(9)
  v_mfma_f32_16x16x32_bf16 v[80:83], v[32:35], v[200:203], v[80:83]
  v_fmac_f32 v215, v211, v8
  v_mov_b32 v10, v214
  v_mfma_f32_16x16x32_bf16 v[84:87], v[36:39], v[200:203], v[84:87]
  v_mov_b32 v11, v215
  v_mfma_f32_16x16x32_bf16 v[112:115], v[40:43], v[200:203], v[112:115]
  v_permlane32_swap_b32 v10, v214
  v_permlane32_swap_b32 v11, v215
  v_mfma_f32_16x16x32_bf16 v[116:119], v[44:47], v[200:203], v[116:119]
  v_fma_f32 v214, v212, v10, v214
  v_fma_f32 v215, v212, v11, v215
  s_waitcnt lgkmcnt(8)
  v_mfma_f32_16x16x32_bf16 v[88:91], v[32:35], v[204:207], v[88:91]
  s_waitcnt lgkmcnt(0)
  s_waitcnt vmcnt(7)
  s_barrier
  s_setprio 3
  v_fma_f32 v214, -v213, v11, v214
  v_fmac_f32 v215, v213, v10
  v_mfma_f32_16x16x32_bf16 v[92:95], v[36:39], v[204:207], v[92:95]
  ds_read_b64_tr_b16 v[32:33], v16 offset:0
  v_min_u32 v214, -2, v214
  v_min_u32 v215, -2, v215
  v_mfma_f32_16x16x32_bf16 v[120:123], v[40:43], v[204:207], v[120:123]
  ds_read_b64_tr_b16 v[34:35], v16 offset:1024
  s_add_u32 m0, s59, 0x24000
  s_mov_b32 s32, 0x140000
  buffer_load_dwordx4 v24, s[8:11], s32 offen lds
  v_lshrrev_b32 v31, 4, v1
  v_lshlrev_b32 v216, 3, v1
  v_lshl_add_u32 v216, v31, 12, v216
  v_mfma_f32_16x16x32_bf16 v[124:127], v[44:47], v[204:207], v[124:127]
  ds_read_b64_tr_b16 v[36:37], v17 offset:0
  buffer_store_dwordx2 v[214:215], v216, s[28:31], s51 offen sc1
  v_mfma_f32_16x16x32_bf16 v[128:131], v[192:195], v[48:51], v[128:131]
  ds_read_b64_tr_b16 v[38:39], v17 offset:1024
  v_mfma_f32_16x16x32_bf16 v[144:147], v[192:195], v[52:55], v[144:147]
  ds_read_b64_tr_b16 v[40:41], v18 offset:0
  v_mfma_f32_16x16x32_bf16 v[160:163], v[192:195], v[56:59], v[160:163]
  ds_read_b64_tr_b16 v[42:43], v18 offset:1024
  v_mfma_f32_16x16x32_bf16 v[176:179], v[192:195], v[60:63], v[176:179]
  ds_read_b128 v[192:195], v27 offset:32768
  s_add_u32 m0, s59, 0x24400
  s_mov_b32 s32, 0x148000
  buffer_load_dwordx4 v24, s[8:11], s32 offen lds
  v_mfma_f32_16x16x32_bf16 v[132:135], v[196:199], v[48:51], v[132:135]
  s_setprio 2
  ds_read_b64_tr_b16 v[44:45], v19 offset:0
  v_mfma_f32_16x16x32_bf16 v[148:151], v[196:199], v[52:55], v[148:151]
  ds_read_b64_tr_b16 v[46:47], v19 offset:1024
  v_mfma_f32_16x16x32_bf16 v[164:167], v[196:199], v[56:59], v[164:167]
  v_mfma_f32_16x16x32_bf16 v[180:183], v[196:199], v[60:63], v[180:183]
  ds_read_b128 v[196:199], v27 offset:34816
  v_mfma_f32_16x16x32_bf16 v[136:139], v[200:203], v[48:51], v[136:139]
  s_add_u32 m0, s58, 0x0
  s_movk_i32 s33, 0x180
  buffer_load_dwordx4 v25, s[4:7], s33 offen lds
  v_mfma_f32_16x16x32_bf16 v[152:155], v[200:203], v[52:55], v[152:155]
  v_mfma_f32_16x16x32_bf16 v[168:171], v[200:203], v[56:59], v[168:171]
  v_mfma_f32_16x16x32_bf16 v[184:187], v[200:203], v[60:63], v[184:187]
  ds_read_b128 v[200:203], v27 offset:36864
  v_mfma_f32_16x16x32_bf16 v[140:143], v[204:207], v[48:51], v[140:143]
  s_setprio 1
  v_mfma_f32_16x16x32_bf16 v[156:159], v[204:207], v[52:55], v[156:159]
  s_add_u32 m0, s58, 0x400
  s_movk_i32 s33, 0x180
  buffer_load_dwordx4 v26, s[4:7], s33 offen lds
  v_mfma_f32_16x16x32_bf16 v[172:175], v[204:207], v[56:59], v[172:175]
  v_mfma_f32_16x16x32_bf16 v[188:191], v[204:207], v[60:63], v[188:191]
  ds_read_b128 v[204:207], v27 offset:38912
  s_waitcnt lgkmcnt(10)
  s_waitcnt lgkmcnt(5)
  v_mfma_f32_16x16x32_bf16 v[64:67], v[32:35], v[192:195], v[64:67]
  ds_read_b64_tr_b16 v[48:49], v16 offset:8192
  v_mfma_f32_16x16x32_bf16 v[68:71], v[36:39], v[192:195], v[68:71]
  ds_read_b64_tr_b16 v[50:51], v16 offset:9216
  v_mfma_f32_16x16x32_bf16 v[96:99], v[40:43], v[192:195], v[96:99]
  ds_read_b64_tr_b16 v[52:53], v17 offset:8192
  s_waitcnt lgkmcnt(6)
  v_mfma_f32_16x16x32_bf16 v[100:103], v[44:47], v[192:195], v[100:103]
  ds_read_b64_tr_b16 v[54:55], v17 offset:9216
  s_waitcnt lgkmcnt(6)
  v_mfma_f32_16x16x32_bf16 v[72:75], v[32:35], v[196:199], v[72:75]
  s_setprio 0
  ds_read_b64_tr_b16 v[56:57], v18 offset:8192
  v_mfma_f32_16x16x32_bf16 v[76:79], v[36:39], v[196:199], v[76:79]
  ds_read_b64_tr_b16 v[58:59], v18 offset:9216
  v_mfma_f32_16x16x32_bf16 v[104:107], v[40:43], v[196:199], v[104:107]
  ds_read_b64_tr_b16 v[60:61], v19 offset:8192
  v_mfma_f32_16x16x32_bf16 v[108:111], v[44:47], v[196:199], v[108:111]
  ds_read_b64_tr_b16 v[62:63], v19 offset:9216
  s_waitcnt lgkmcnt(9)
  v_mfma_f32_16x16x32_bf16 v[80:83], v[32:35], v[200:203], v[80:83]
  v_mfma_f32_16x16x32_bf16 v[84:87], v[36:39], v[200:203], v[84:87]
  v_mfma_f32_16x16x32_bf16 v[112:115], v[40:43], v[200:203], v[112:115]
  v_mfma_f32_16x16x32_bf16 v[116:119], v[44:47], v[200:203], v[116:119]
  s_waitcnt lgkmcnt(8)
  v_mfma_f32_16x16x32_bf16 v[88:91], v[32:35], v[204:207], v[88:91]
  s_waitcnt lgkmcnt(0)
  s_barrier
  s_setprio 3
  v_mfma_f32_16x16x32_bf16 v[92:95], v[36:39], v[204:207], v[92:95]
  ds_read_b64_tr_b16 v[32:33], v16 offset:16384
  v_mfma_f32_16x16x32_bf16 v[120:123], v[40:43], v[204:207], v[120:123]
  ds_read_b64_tr_b16 v[34:35], v16 offset:17408
  s_add_u32 m0, s59, 0x18000
  s_mov_b32 s32, 0x180000
  buffer_load_dwordx4 v24, s[8:11], s32 offen lds
  v_mfma_f32_16x16x32_bf16 v[124:127], v[44:47], v[204:207], v[124:127]
  ds_read_b64_tr_b16 v[36:37], v17 offset:16384
  v_mfma_f32_16x16x32_bf16 v[128:131], v[192:195], v[48:51], v[128:131]
  ds_read_b64_tr_b16 v[38:39], v17 offset:17408
  v_mfma_f32_16x16x32_bf16 v[144:147], v[192:195], v[52:55], v[144:147]
  ds_read_b64_tr_b16 v[40:41], v18 offset:16384
  v_mfma_f32_16x16x32_bf16 v[160:163], v[192:195], v[56:59], v[160:163]
  ds_read_b64_tr_b16 v[42:43], v18 offset:17408
  v_mfma_f32_16x16x32_bf16 v[176:179], v[192:195], v[60:63], v[176:179]
  ds_read_b128 v[192:195], v28 offset:32768
  s_add_u32 m0, s59, 0x18400
  s_mov_b32 s32, 0x188000
  buffer_load_dwordx4 v24, s[8:11], s32 offen lds
  v_mfma_f32_16x16x32_bf16 v[132:135], v[196:199], v[48:51], v[132:135]
  s_setprio 2
  ds_read_b64_tr_b16 v[44:45], v19 offset:16384
  s_mov_b32 s16, s92
  s_mov_b32 s17, s93
  s_and_b32 s17, s17, 0xffff
  s_mov_b32 s19, 0x00020000
  v_mfma_f32_16x16x32_bf16 v[148:151], v[196:199], v[52:55], v[148:151]
  ds_read_b64_tr_b16 v[46:47], v19 offset:17408
  v_mfma_f32_16x16x32_bf16 v[164:167], v[196:199], v[56:59], v[164:167]
  v_mfma_f32_16x16x32_bf16 v[180:183], v[196:199], v[60:63], v[180:183]
  ds_read_b128 v[196:199], v28 offset:34816
  s_add_u32 s33, s34, 1
  s_mul_i32 s33, s33, 655360
  s_cmp_eq_u32 s3, 2
  s_cselect_b32 s18, s33, 0
  v_mfma_f32_16x16x32_bf16 v[136:139], v[200:203], v[48:51], v[136:139]
  s_add_u32 m0, s58, 0x800
  s_movk_i32 s33, 0x4180
  buffer_load_dwordx4 v25, s[4:7], s33 offen lds
  v_mfma_f32_16x16x32_bf16 v[152:155], v[200:203], v[52:55], v[152:155]
  v_mfma_f32_16x16x32_bf16 v[168:171], v[200:203], v[56:59], v[168:171]
  v_lshlrev_b32 v12, 7, v1
  v_mfma_f32_16x16x32_bf16 v[184:187], v[200:203], v[60:63], v[184:187]
  ds_read_b128 v[200:203], v28 offset:36864
  v_mfma_f32_16x16x32_bf16 v[140:143], v[204:207], v[48:51], v[140:143]
  s_setprio 1
  v_mfma_f32_16x16x32_bf16 v[156:159], v[204:207], v[52:55], v[156:159]
  s_add_u32 m0, s58, 0xc00
  s_movk_i32 s33, 0x4180
  buffer_load_dwordx4 v26, s[4:7], s33 offen lds
  v_mfma_f32_16x16x32_bf16 v[172:175], v[204:207], v[56:59], v[172:175]
  v_mfma_f32_16x16x32_bf16 v[188:191], v[204:207], v[60:63], v[188:191]
  ds_read_b128 v[204:207], v28 offset:38912
  s_lshr_b32 s32, s2, 3
  s_add_u32 s32, s32, 0
  s_lshl_b32 s32, s32, 13
  s_mul_i32 s33, s34, 655360
  s_add_u32 s32, s32, s33
  v_add_u32 v12, s32, v12
  buffer_load_dword v15, v12, s[16:19], 0 offen
  s_waitcnt lgkmcnt(10)
  s_waitcnt lgkmcnt(5)
  v_mfma_f32_16x16x32_bf16 v[64:67], v[32:35], v[192:195], v[64:67]
  ds_read_b64_tr_b16 v[48:49], v16 offset:24576
  v_mfma_f32_16x16x32_bf16 v[68:71], v[36:39], v[192:195], v[68:71]
  ds_read_b64_tr_b16 v[50:51], v16 offset:25600
  v_mfma_f32_16x16x32_bf16 v[96:99], v[40:43], v[192:195], v[96:99]
  ds_read_b64_tr_b16 v[52:53], v17 offset:24576
  s_waitcnt lgkmcnt(6)
  v_mfma_f32_16x16x32_bf16 v[100:103], v[44:47], v[192:195], v[100:103]
  ds_read_b64_tr_b16 v[54:55], v17 offset:25600
  s_waitcnt lgkmcnt(6)
  v_mfma_f32_16x16x32_bf16 v[72:75], v[32:35], v[196:199], v[72:75]
  s_setprio 0
  ds_read_b64_tr_b16 v[56:57], v18 offset:24576
  v_mfma_f32_16x16x32_bf16 v[76:79], v[36:39], v[196:199], v[76:79]
  ds_read_b64_tr_b16 v[58:59], v18 offset:25600
  v_mfma_f32_16x16x32_bf16 v[104:107], v[40:43], v[196:199], v[104:107]
  ds_read_b64_tr_b16 v[60:61], v19 offset:24576
  v_mfma_f32_16x16x32_bf16 v[108:111], v[44:47], v[196:199], v[108:111]
  ds_read_b64_tr_b16 v[62:63], v19 offset:25600
  s_waitcnt lgkmcnt(9)
  v_mfma_f32_16x16x32_bf16 v[80:83], v[32:35], v[200:203], v[80:83]
  v_mfma_f32_16x16x32_bf16 v[84:87], v[36:39], v[200:203], v[84:87]
  v_mfma_f32_16x16x32_bf16 v[112:115], v[40:43], v[200:203], v[112:115]
  v_mfma_f32_16x16x32_bf16 v[116:119], v[44:47], v[200:203], v[116:119]
  s_waitcnt lgkmcnt(8)
  v_mfma_f32_16x16x32_bf16 v[88:91], v[32:35], v[204:207], v[88:91]
  s_waitcnt lgkmcnt(0)
  s_waitcnt vmcnt(10)
  s_barrier
  s_setprio 3
  v_mfma_f32_16x16x32_bf16 v[92:95], v[36:39], v[204:207], v[92:95]
  ds_read_b64_tr_b16 v[32:33], v16 offset:32768
  v_mfma_f32_16x16x32_bf16 v[120:123], v[40:43], v[204:207], v[120:123]
  ds_read_b64_tr_b16 v[34:35], v16 offset:33792
  s_add_u32 m0, s59, 0x1c000
  s_mov_b32 s32, 0x1c0000
  buffer_load_dwordx4 v24, s[8:11], s32 offen lds
  v_lshl_add_u32 v22, v1, 3, s51
  v_mfma_f32_16x16x32_bf16 v[124:127], v[44:47], v[204:207], v[124:127]
  ds_read_b64_tr_b16 v[36:37], v17 offset:32768
  v_mfma_f32_16x16x32_bf16 v[128:131], v[192:195], v[48:51], v[128:131]
  ds_read_b64_tr_b16 v[38:39], v17 offset:33792
  buffer_load_dwordx2 v[216:217], v22, s[28:31], 0 offen offset:2176 sc1
  v_mfma_f32_16x16x32_bf16 v[144:147], v[192:195], v[52:55], v[144:147]
  ds_read_b64_tr_b16 v[40:41], v18 offset:32768
  v_mfma_f32_16x16x32_bf16 v[160:163], v[192:195], v[56:59], v[160:163]
  ds_read_b64_tr_b16 v[42:43], v18 offset:33792
  buffer_load_dwordx2 v[218:219], v22, s[28:31], 0 offen offset:2688 sc1
  v_mfma_f32_16x16x32_bf16 v[176:179], v[192:195], v[60:63], v[176:179]
  ds_read_b128 v[192:195], v29 offset:0
  s_add_u32 m0, s59, 0x1c400
  s_mov_b32 s32, 0x1c8000
  buffer_load_dwordx4 v24, s[8:11], s32 offen lds
  v_mfma_f32_16x16x32_bf16 v[132:135], v[196:199], v[48:51], v[132:135]
  s_setprio 2
  ds_read_b64_tr_b16 v[44:45], v19 offset:32768
  s_mov_b32 s16, s92
  s_mov_b32 s17, s93
  s_and_b32 s17, s17, 0xffff
  s_mov_b32 s19, 0x00020000
  buffer_load_dwordx2 v[220:221], v22, s[28:31], 0 offen offset:3200 sc1
  v_mfma_f32_16x16x32_bf16 v[148:151], v[196:199], v[52:55], v[148:151]
  ds_read_b64_tr_b16 v[46:47], v19 offset:33792
  v_mfma_f32_16x16x32_bf16 v[164:167], v[196:199], v[56:59], v[164:167]
  buffer_load_dwordx2 v[222:223], v22, s[28:31], 0 offen offset:3712 sc1
  v_mfma_f32_16x16x32_bf16 v[180:183], v[196:199], v[60:63], v[180:183]
  ds_read_b128 v[196:199], v29 offset:2048
  s_add_u32 s33, s34, 1
  s_mul_i32 s33, s33, 655360
  s_cmp_eq_u32 s3, 3
  s_cselect_b32 s18, s33, 0
  v_mfma_f32_16x16x32_bf16 v[136:139], v[200:203], v[48:51], v[136:139]
  s_add_u32 m0, s58, 0x8000
  s_movk_i32 s33, 0x200
  buffer_load_dwordx4 v25, s[4:7], s33 offen lds
  v_mfma_f32_16x16x32_bf16 v[152:155], v[200:203], v[52:55], v[152:155]
  v_mfma_f32_16x16x32_bf16 v[168:171], v[200:203], v[56:59], v[168:171]
  v_lshlrev_b32 v12, 7, v1
  v_mfma_f32_16x16x32_bf16 v[184:187], v[200:203], v[60:63], v[184:187]
  ds_read_b128 v[200:203], v29 offset:4096
  v_mfma_f32_16x16x32_bf16 v[140:143], v[204:207], v[48:51], v[140:143]
  s_setprio 1
  v_mfma_f32_16x16x32_bf16 v[156:159], v[204:207], v[52:55], v[156:159]
  s_add_u32 m0, s58, 0x8400
  s_movk_i32 s33, 0x200
  buffer_load_dwordx4 v26, s[4:7], s33 offen lds
  v_mfma_f32_16x16x32_bf16 v[172:175], v[204:207], v[56:59], v[172:175]
  v_mfma_f32_16x16x32_bf16 v[188:191], v[204:207], v[60:63], v[188:191]
  ds_read_b128 v[204:207], v29 offset:6144
  s_lshr_b32 s32, s2, 3
  s_add_u32 s32, s32, 20
  s_lshl_b32 s32, s32, 13
  s_mul_i32 s33, s34, 655360
  s_add_u32 s32, s32, s33
  v_add_u32 v12, s32, v12
  buffer_load_dword v15, v12, s[16:19], 0 offen
  s_waitcnt lgkmcnt(10)
  s_waitcnt lgkmcnt(5)
  v_mfma_f32_16x16x32_bf16 v[64:67], v[32:35], v[192:195], v[64:67]
  ds_read_b64_tr_b16 v[48:49], v16 offset:40960
  v_mfma_f32_16x16x32_bf16 v[68:71], v[36:39], v[192:195], v[68:71]
  ds_read_b64_tr_b16 v[50:51], v16 offset:41984
  v_mfma_f32_16x16x32_bf16 v[96:99], v[40:43], v[192:195], v[96:99]
  ds_read_b64_tr_b16 v[52:53], v17 offset:40960
  s_waitcnt lgkmcnt(6)
  v_mfma_f32_16x16x32_bf16 v[100:103], v[44:47], v[192:195], v[100:103]
  ds_read_b64_tr_b16 v[54:55], v17 offset:41984
  s_waitcnt lgkmcnt(6)
  v_mfma_f32_16x16x32_bf16 v[72:75], v[32:35], v[196:199], v[72:75]
  s_setprio 0
  ds_read_b64_tr_b16 v[56:57], v18 offset:40960
  v_mfma_f32_16x16x32_bf16 v[76:79], v[36:39], v[196:199], v[76:79]
  ds_read_b64_tr_b16 v[58:59], v18 offset:41984
  v_mfma_f32_16x16x32_bf16 v[104:107], v[40:43], v[196:199], v[104:107]
  ds_read_b64_tr_b16 v[60:61], v19 offset:40960
  v_mfma_f32_16x16x32_bf16 v[108:111], v[44:47], v[196:199], v[108:111]
  ds_read_b64_tr_b16 v[62:63], v19 offset:41984
  s_waitcnt lgkmcnt(9)
  v_mfma_f32_16x16x32_bf16 v[80:83], v[32:35], v[200:203], v[80:83]
  v_mfma_f32_16x16x32_bf16 v[84:87], v[36:39], v[200:203], v[84:87]
  v_mfma_f32_16x16x32_bf16 v[112:115], v[40:43], v[200:203], v[112:115]
  v_mfma_f32_16x16x32_bf16 v[116:119], v[44:47], v[200:203], v[116:119]
  s_waitcnt lgkmcnt(8)
  v_mfma_f32_16x16x32_bf16 v[88:91], v[32:35], v[204:207], v[88:91]
  s_waitcnt lgkmcnt(0)
  s_waitcnt vmcnt(16)
  s_barrier
  s_setprio 3
  v_mfma_f32_16x16x32_bf16 v[92:95], v[36:39], v[204:207], v[92:95]
  ds_read_b64_tr_b16 v[32:33], v16 offset:49152
  v_mfma_f32_16x16x32_bf16 v[120:123], v[40:43], v[204:207], v[120:123]
  ds_read_b64_tr_b16 v[34:35], v16 offset:50176
  s_add_u32 m0, s59, 0x20000
  s_mov_b32 s32, 0x200000
  buffer_load_dwordx4 v24, s[8:11], s32 offen lds
  v_mfma_f32_16x16x32_bf16 v[124:127], v[44:47], v[204:207], v[124:127]
  ds_read_b64_tr_b16 v[36:37], v17 offset:49152
  v_mfma_f32_16x16x32_bf16 v[128:131], v[192:195], v[48:51], v[128:131]
  ds_read_b64_tr_b16 v[38:39], v17 offset:50176
  v_mfma_f32_16x16x32_bf16 v[144:147], v[192:195], v[52:55], v[144:147]
  ds_read_b64_tr_b16 v[40:41], v18 offset:49152
  v_mfma_f32_16x16x32_bf16 v[160:163], v[192:195], v[56:59], v[160:163]
  ds_read_b64_tr_b16 v[42:43], v18 offset:50176
  v_mfma_f32_16x16x32_bf16 v[176:179], v[192:195], v[60:63], v[176:179]
  ds_read_b128 v[192:195], v30 offset:0
  s_add_u32 m0, s59, 0x20400
  s_mov_b32 s32, 0x208000
  buffer_load_dwordx4 v24, s[8:11], s32 offen lds
  v_mfma_f32_16x16x32_bf16 v[132:135], v[196:199], v[48:51], v[132:135]
  s_setprio 2
  ds_read_b64_tr_b16 v[44:45], v19 offset:49152
  s_mov_b32 s16, s92
  s_mov_b32 s17, s93
  s_and_b32 s17, s17, 0xffff
  s_mov_b32 s19, 0x00020000
  v_mfma_f32_16x16x32_bf16 v[148:151], v[196:199], v[52:55], v[148:151]
  ds_read_b64_tr_b16 v[46:47], v19 offset:50176
  v_mfma_f32_16x16x32_bf16 v[164:167], v[196:199], v[56:59], v[164:167]
  s_waitcnt vmcnt(5)
  v_max3_u32 v31, v216, v217, v218
  v_mfma_f32_16x16x32_bf16 v[180:183], v[196:199], v[60:63], v[180:183]
  ds_read_b128 v[196:199], v30 offset:2048
  s_add_u32 s33, s34, 1
  s_mul_i32 s33, s33, 655360
  s_cmp_eq_u32 s3, 4
  s_cselect_b32 s18, s33, 0
  v_max3_u32 v31, v31, v219, v220
  v_mfma_f32_16x16x32_bf16 v[136:139], v[200:203], v[48:51], v[136:139]
  s_add_u32 m0, s58, 0x8800
  s_movk_i32 s33, 0x4200
  buffer_load_dwordx4 v25, s[4:7], s33 offen lds
  v_max3_u32 v31, v31, v221, v222
  v_max_u32 v31, v31, v223
  v_mfma_f32_16x16x32_bf16 v[152:155], v[200:203], v[52:55], v[152:155]
  v_cmp_eq_u32 vcc, -1, v31
  s_nop 0
  s_nop 3
  s_cbranch_vccnz fU_es0
fU_es0_ret:
  v_mfma_f32_16x16x32_bf16 v[168:171], v[200:203], v[56:59], v[168:171]
  v_lshlrev_b32 v12, 7, v1
  v_fma_f32 v220, v6, v222, v220
  v_mfma_f32_16x16x32_bf16 v[184:187], v[200:203], v[60:63], v[184:187]
  ds_read_b128 v[200:203], v30 offset:4096
  v_fma_f32 v221, v6, v223, v221
  v_fma_f32 v220, -v7, v223, v220
  v_mfma_f32_16x16x32_bf16 v[140:143], v[204:207], v[48:51], v[140:143]
  s_setprio 1
  v_fmac_f32 v221, v7, v222
  v_mfma_f32_16x16x32_bf16 v[156:159], v[204:207], v[52:55], v[156:159]
  s_add_u32 m0, s58, 0x8c00
  s_movk_i32 s33, 0x4200
  buffer_load_dwordx4 v26, s[4:7], s33 offen lds
  v_fma_f32 v218, v6, v220, v218
  v_mfma_f32_16x16x32_bf16 v[172:175], v[204:207], v[56:59], v[172:175]
  v_fma_f32 v219, v6, v221, v219
  v_fma_f32 v218, -v7, v221, v218
  v_mfma_f32_16x16x32_bf16 v[188:191], v[204:207], v[60:63], v[188:191]
  ds_read_b128 v[204:207], v30 offset:6144
  s_lshr_b32 s32, s2, 3
  s_add_u32 s32, s32, 40
  s_lshl_b32 s32, s32, 13
  s_mul_i32 s33, s34, 655360
  s_add_u32 s32, s32, s33
  v_add_u32 v12, s32, v12
  buffer_load_dword v15, v12, s[16:19], 0 offen
  v_fmac_f32 v219, v7, v220
  s_waitcnt lgkmcnt(10)
  s_waitcnt lgkmcnt(5)
  v_mfma_f32_16x16x32_bf16 v[64:67], v[32:35], v[192:195], v[64:67]
  ds_read_b64_tr_b16 v[48:49], v16 offset:57344
  v_fma_f32 v214, v6, v218, v216
  v_fma_f32 v215, v6, v219, v217
  v_mfma_f32_16x16x32_bf16 v[68:71], v[36:39], v[192:195], v[68:71]
  ds_read_b64_tr_b16 v[50:51], v16 offset:58368
  v_fma_f32 v214, -v7, v219, v214
  v_mfma_f32_16x16x32_bf16 v[96:99], v[40:43], v[192:195], v[96:99]
  ds_read_b64_tr_b16 v[52:53], v17 offset:57344
  v_fmac_f32 v215, v7, v218
  s_waitcnt lgkmcnt(6)
  v_mfma_f32_16x16x32_bf16 v[100:103], v[44:47], v[192:195], v[100:103]
  ds_read_b64_tr_b16 v[54:55], v17 offset:58368
  buffer_load_dwordx2 v[216:217], v22, s[28:31], 0 offen offset:128 sc1
  buffer_load_dwordx2 v[218:219], v22, s[28:31], 0 offen offset:640 sc1
  s_waitcnt lgkmcnt(6)
  v_mfma_f32_16x16x32_bf16 v[72:75], v[32:35], v[196:199], v[72:75]
  s_setprio 0
  ds_read_b64_tr_b16 v[56:57], v18 offset:57344
  buffer_load_dwordx2 v[220:221], v22, s[28:31], 0 offen offset:1152 sc1
  v_mfma_f32_16x16x32_bf16 v[76:79], v[36:39], v[196:199], v[76:79]
  ds_read_b64_tr_b16 v[58:59], v18 offset:58368
  buffer_load_dwordx2 v[222:223], v22, s[28:31], 0 offen offset:1664 sc1
  v_mfma_f32_16x16x32_bf16 v[104:107], v[40:43], v[196:199], v[104:107]
  ds_read_b64_tr_b16 v[60:61], v19 offset:57344
  v_mfma_f32_16x16x32_bf16 v[108:111], v[44:47], v[196:199], v[108:111]
  ds_read_b64_tr_b16 v[62:63], v19 offset:58368
  s_waitcnt lgkmcnt(9)
  v_mfma_f32_16x16x32_bf16 v[80:83], v[32:35], v[200:203], v[80:83]
  v_mfma_f32_16x16x32_bf16 v[84:87], v[36:39], v[200:203], v[84:87]
  v_mfma_f32_16x16x32_bf16 v[112:115], v[40:43], v[200:203], v[112:115]
  v_mfma_f32_16x16x32_bf16 v[116:119], v[44:47], v[200:203], v[116:119]
  s_waitcnt lgkmcnt(8)
  v_mfma_f32_16x16x32_bf16 v[88:91], v[32:35], v[204:207], v[88:91]
  s_waitcnt lgkmcnt(0)
  s_barrier
  s_setprio 3
  v_mfma_f32_16x16x32_bf16 v[92:95], v[36:39], v[204:207], v[92:95]
  ds_read_b64_tr_b16 v[32:33], v16 offset:0
  v_mfma_f32_16x16x32_bf16 v[120:123], v[40:43], v[204:207], v[120:123]
  ds_read_b64_tr_b16 v[34:35], v16 offset:1024
  s_add_u32 m0, s59, 0x24000
  s_mov_b32 s32, 0x240000
  buffer_load_dwordx4 v24, s[8:11], s32 offen lds
  v_mfma_f32_16x16x32_bf16 v[124:127], v[44:47], v[204:207], v[124:127]
  ds_read_b64_tr_b16 v[36:37], v17 offset:0
  v_mfma_f32_16x16x32_bf16 v[128:131], v[192:195], v[48:51], v[128:131]
  ds_read_b64_tr_b16 v[38:39], v17 offset:1024
  v_mfma_f32_16x16x32_bf16 v[144:147], v[192:195], v[52:55], v[144:147]
  ds_read_b64_tr_b16 v[40:41], v18 offset:0
  v_mfma_f32_16x16x32_bf16 v[160:163], v[192:195], v[56:59], v[160:163]
  ds_read_b64_tr_b16 v[42:43], v18 offset:1024
  v_mfma_f32_16x16x32_bf16 v[176:179], v[192:195], v[60:63], v[176:179]
  ds_read_b128 v[192:195], v27 offset:0
  s_add_u32 m0, s59, 0x24400
  s_mov_b32 s32, 0x248000
  buffer_load_dwordx4 v24, s[8:11], s32 offen lds
  v_mfma_f32_16x16x32_bf16 v[132:135], v[196:199], v[48:51], v[132:135]
  s_setprio 2
  ds_read_b64_tr_b16 v[44:45], v19 offset:0
  s_mov_b32 s16, s92
  s_mov_b32 s17, s93
  s_and_b32 s17, s17, 0xffff
  s_mov_b32 s19, 0x00020000
  v_mfma_f32_16x16x32_bf16 v[148:151], v[196:199], v[52:55], v[148:151]
  ds_read_b64_tr_b16 v[46:47], v19 offset:1024
  v_mfma_f32_16x16x32_bf16 v[164:167], v[196:199], v[56:59], v[164:167]
  v_mfma_f32_16x16x32_bf16 v[180:183], v[196:199], v[60:63], v[180:183]
  ds_read_b128 v[196:199], v27 offset:2048
  s_add_u32 s33, s34, 1
  s_mul_i32 s33, s33, 655360
  s_cmp_eq_u32 s3, 5
  s_cselect_b32 s18, s33, 0
  v_mfma_f32_16x16x32_bf16 v[136:139], v[200:203], v[48:51], v[136:139]
  s_add_u32 m0, s58, 0x10000
  s_movk_i32 s33, 0x280
  buffer_load_dwordx4 v25, s[4:7], s33 offen lds
  v_mfma_f32_16x16x32_bf16 v[152:155], v[200:203], v[52:55], v[152:155]
  v_mfma_f32_16x16x32_bf16 v[168:171], v[200:203], v[56:59], v[168:171]
  v_lshlrev_b32 v12, 7, v1
  v_mfma_f32_16x16x32_bf16 v[184:187], v[200:203], v[60:63], v[184:187]
  ds_read_b128 v[200:203], v27 offset:4096
  v_mfma_f32_16x16x32_bf16 v[140:143], v[204:207], v[48:51], v[140:143]
  s_setprio 1
  v_mfma_f32_16x16x32_bf16 v[156:159], v[204:207], v[52:55], v[156:159]
  s_add_u32 m0, s58, 0x10400
  s_movk_i32 s33, 0x280
  buffer_load_dwordx4 v26, s[4:7], s33 offen lds
  v_mfma_f32_16x16x32_bf16 v[172:175], v[204:207], v[56:59], v[172:175]
  v_mfma_f32_16x16x32_bf16 v[188:191], v[204:207], v[60:63], v[188:191]
  ds_read_b128 v[204:207], v27 offset:6144
  s_lshr_b32 s32, s2, 3
  s_add_u32 s32, s32, 60
  s_lshl_b32 s32, s32, 13
  s_mul_i32 s33, s34, 655360
  s_add_u32 s32, s32, s33
  v_add_u32 v12, s32, v12
  buffer_load_dword v15, v12, s[16:19], 0 offen
  s_waitcnt lgkmcnt(10)
  s_waitcnt lgkmcnt(5)
  v_mfma_f32_16x16x32_bf16 v[64:67], v[32:35], v[192:195], v[64:67]
  ds_read_b64_tr_b16 v[48:49], v16 offset:8192
  v_mfma_f32_16x16x32_bf16 v[68:71], v[36:39], v[192:195], v[68:71]
  ds_read_b64_tr_b16 v[50:51], v16 offset:9216
  v_mfma_f32_16x16x32_bf16 v[96:99], v[40:43], v[192:195], v[96:99]
  ds_read_b64_tr_b16 v[52:53], v17 offset:8192
  s_waitcnt lgkmcnt(6)
  v_mfma_f32_16x16x32_bf16 v[100:103], v[44:47], v[192:195], v[100:103]
  ds_read_b64_tr_b16 v[54:55], v17 offset:9216
  s_waitcnt lgkmcnt(6)
  v_mfma_f32_16x16x32_bf16 v[72:75], v[32:35], v[196:199], v[72:75]
  s_setprio 0
  ds_read_b64_tr_b16 v[56:57], v18 offset:8192
  v_mfma_f32_16x16x32_bf16 v[76:79], v[36:39], v[196:199], v[76:79]
  ds_read_b64_tr_b16 v[58:59], v18 offset:9216
  v_mfma_f32_16x16x32_bf16 v[104:107], v[40:43], v[196:199], v[104:107]
  ds_read_b64_tr_b16 v[60:61], v19 offset:8192
  v_mfma_f32_16x16x32_bf16 v[108:111], v[44:47], v[196:199], v[108:111]
  ds_read_b64_tr_b16 v[62:63], v19 offset:9216
  s_waitcnt lgkmcnt(9)
  v_mfma_f32_16x16x32_bf16 v[80:83], v[32:35], v[200:203], v[80:83]
  s_waitcnt vmcnt(5)
  v_max3_u32 v31, v216, v217, v218
  v_mfma_f32_16x16x32_bf16 v[84:87], v[36:39], v[200:203], v[84:87]
  v_max3_u32 v31, v31, v219, v220
  v_max3_u32 v31, v31, v221, v222
  v_mfma_f32_16x16x32_bf16 v[112:115], v[40:43], v[200:203], v[112:115]
  v_max_u32 v31, v31, v223
  v_cmp_eq_u32 vcc, -1, v31
  s_nop 0
  s_nop 3
  s_cbranch_vccnz fU_es1
fU_es1_ret:
  v_mfma_f32_16x16x32_bf16 v[116:119], v[44:47], v[200:203], v[116:119]
  v_fma_f32 v222, v6, v214, v222
  v_fma_f32 v223, v6, v215, v223
  s_waitcnt lgkmcnt(8)
  v_mfma_f32_16x16x32_bf16 v[88:91], v[32:35], v[204:207], v[88:91]
  s_waitcnt lgkmcnt(0)
  s_barrier
  s_setprio 3
  v_fma_f32 v222, -v7, v215, v222
  v_fmac_f32 v223, v7, v214
  v_mfma_f32_16x16x32_bf16 v[92:95], v[36:39], v[204:207], v[92:95]
  ds_read_b64_tr_b16 v[32:33], v16 offset:16384
  v_fma_f32 v220, v6, v222, v220
  v_fma_f32 v221, v6, v223, v221
  v_mfma_f32_16x16x32_bf16 v[120:123], v[40:43], v[204:207], v[120:123]
  ds_read_b64_tr_b16 v[34:35], v16 offset:17408
  s_add_u32 m0, s59, 0x18000
  s_mov_b32 s32, 0x280000
  buffer_load_dwordx4 v24, s[8:11], s32 offen lds
  v_fma_f32 v220, -v7, v223, v220
  v_fmac_f32 v221, v7, v222
  v_mfma_f32_16x16x32_bf16 v[124:127], v[44:47], v[204:207], v[124:127]
  ds_read_b64_tr_b16 v[36:37], v17 offset:16384
  v_fma_f32 v218, v6, v220, v218
  v_fma_f32 v219, v6, v221, v219
  v_mfma_f32_16x16x32_bf16 v[128:131], v[192:195], v[48:51], v[128:131]
  ds_read_b64_tr_b16 v[38:39], v17 offset:17408
  v_fma_f32 v218, -v7, v221, v218
  v_mfma_f32_16x16x32_bf16 v[144:147], v[192:195], v[52:55], v[144:147]
  ds_read_b64_tr_b16 v[40:41], v18 offset:16384
  v_fmac_f32 v219, v7, v220
  v_fma_f32 v216, v6, v218, v216
  v_mfma_f32_16x16x32_bf16 v[160:163], v[192:195], v[56:59], v[160:163]
  ds_read_b64_tr_b16 v[42:43], v18 offset:17408
  v_fma_f32 v217, v6, v219, v217
  v_fma_f32 v216, -v7, v219, v216
  v_mfma_f32_16x16x32_bf16 v[176:179], v[192:195], v[60:63], v[176:179]
  ds_read_b128 v[192:195], v28 offset:0
  s_add_u32 m0, s59, 0x18400
  s_mov_b32 s32, 0x288000
  buffer_load_dwordx4 v24, s[8:11], s32 offen lds
  v_fmac_f32 v217, v7, v218
  v_mul_f32 v218, v20, v216
  v_mfma_f32_16x16x32_bf16 v[132:135], v[196:199], v[48:51], v[132:135]
  s_setprio 2
  ds_read_b64_tr_b16 v[44:45], v19 offset:16384
  v_mul_f32 v219, v20, v217
  v_fma_f32 v218, -v21, v217, v218
  v_mfma_f32_16x16x32_bf16 v[148:151], v[196:199], v[52:55], v[148:151]
  ds_read_b64_tr_b16 v[46:47], v19 offset:17408
  v_fmac_f32 v219, v21, v216
  v_mov_b32 v22, v218
  v_mfma_f32_16x16x32_bf16 v[164:167], v[196:199], v[56:59], v[164:167]
  v_mov_b32 v23, v219
  v_permlane16_swap_b32 v218, v22
  v_mfma_f32_16x16x32_bf16 v[180:183], v[196:199], v[60:63], v[180:183]
  ds_read_b128 v[196:199], v28 offset:2048
  v_permlane16_swap_b32 v219, v23
  v_add_f32 v218, v218, v22
  v_mfma_f32_16x16x32_bf16 v[136:139], v[200:203], v[48:51], v[136:139]
  s_add_u32 m0, s58, 0x10800
  s_movk_i32 s33, 0x4280
  buffer_load_dwordx4 v25, s[4:7], s33 offen lds
  v_add_f32 v219, v219, v23
  v_mov_b32 v22, v218
  v_mfma_f32_16x16x32_bf16 v[152:155], v[200:203], v[52:55], v[152:155]
  v_mov_b32 v23, v219
  v_mfma_f32_16x16x32_bf16 v[168:171], v[200:203], v[56:59], v[168:171]
  v_permlane32_swap_b32 v218, v22
  v_permlane32_swap_b32 v219, v23
  v_mfma_f32_16x16x32_bf16 v[184:187], v[200:203], v[60:63], v[184:187]
  ds_read_b128 v[200:203], v28 offset:4096
  v_add_f32 v218, v218, v22
  v_add_f32 v219, v219, v23
  v_mfma_f32_16x16x32_bf16 v[140:143], v[204:207], v[48:51], v[140:143]
  s_setprio 1
  v_fma_f32 v10, v212, v218, v10
  v_fma_f32 v11, v212, v219, v11
  v_mfma_f32_16x16x32_bf16 v[156:159], v[204:207], v[52:55], v[156:159]
  s_add_u32 m0, s58, 0x10c00
  s_movk_i32 s33, 0x4280
  buffer_load_dwordx4 v26, s[4:7], s33 offen lds
  v_fma_f32 v10, -v213, v219, v10
  v_fmac_f32 v11, v213, v218
  v_mfma_f32_16x16x32_bf16 v[172:175], v[204:207], v[56:59], v[172:175]
  v_cmp_lt_u32 vcc, 31, v1
  s_nop 1
  v_cndmask_b32 v218, v218, v10, vcc
  v_cndmask_b32 v219, v219, v11, vcc
  v_fma_f32 v8, v210, v218, v8
  v_mfma_f32_16x16x32_bf16 v[188:191], v[204:207], v[60:63], v[188:191]
  ds_read_b128 v[204:207], v28 offset:6144
  v_fma_f32 v9, v210, v219, v9
  v_fma_f32 v8, -v211, v219, v8
  s_waitcnt lgkmcnt(10)
  s_waitcnt lgkmcnt(5)
  v_mfma_f32_16x16x32_bf16 v[64:67], v[32:35], v[192:195], v[64:67]
  ds_read_b64_tr_b16 v[48:49], v16 offset:24576
  v_fmac_f32 v9, v211, v218
  v_and_b32 v31, 16, v1
  v_mfma_f32_16x16x32_bf16 v[68:71], v[36:39], v[192:195], v[68:71]
  ds_read_b64_tr_b16 v[50:51], v16 offset:25600
  v_cmp_ne_u32 vcc, 0, v31
  s_nop 1
  v_cndmask_b32 v218, v218, v8, vcc
  v_cndmask_b32 v219, v219, v9, vcc
  s_add_u32 s20, s98, 0x2800000
  s_addc_u32 s21, s99, 0
  s_and_b32 s21, s21, 0xffff
  s_mov_b32 s22, 0x500000
  s_mov_b32 s23, 0x00020000
  v_mfma_f32_16x16x32_bf16 v[96:99], v[40:43], v[192:195], v[96:99]
  ds_read_b64_tr_b16 v[52:53], v17 offset:24576
  s_mul_i32 s32, s34, 40
  s_add_u32 s32, s32, s50
  s_lshl_b32 s32, s32, 1
  s_and_b32 s33, s48, 1
  s_add_u32 s32, s32, s33
  s_lshl_b32 s32, s32, 1
  s_lshr_b32 s33, s3, 2
  s_add_u32 s32, s32, s33
  s_lshl_b32 s50, s32, 12
  s_waitcnt lgkmcnt(6)
  v_mfma_f32_16x16x32_bf16 v[100:103], v[44:47], v[192:195], v[100:103]
  ds_read_b64_tr_b16 v[54:55], v17 offset:25600
  v_xor_b32 v22, 0x80, v2
  v_fmac_f32 v224, v208, v218
  s_waitcnt lgkmcnt(6)
  v_mfma_f32_16x16x32_bf16 v[72:75], v[32:35], v[196:199], v[72:75]
  s_setprio 0
  ds_read_b64_tr_b16 v[56:57], v18 offset:24576
  v_fmac_f32 v240, v208, v219
  v_fma_f32 v224, -v209, v219, v224
  v_mfma_f32_16x16x32_bf16 v[76:79], v[36:39], v[196:199], v[76:79]
  ds_read_b64_tr_b16 v[58:59], v18 offset:25600
  v_fmac_f32 v240, v209, v218
  v_fmac_f32 v225, v208, v224
  v_mfma_f32_16x16x32_bf16 v[104:107], v[40:43], v[196:199], v[104:107]
  ds_read_b64_tr_b16 v[60:61], v19 offset:24576
  v_fmac_f32 v241, v208, v240
  v_fma_f32 v225, -v209, v240, v225
  v_mfma_f32_16x16x32_bf16 v[108:111], v[44:47], v[196:199], v[108:111]
  ds_read_b64_tr_b16 v[62:63], v19 offset:25600
  v_fmac_f32 v241, v209, v224
  v_fmac_f32 v226, v208, v225
  s_waitcnt lgkmcnt(9)
  v_mfma_f32_16x16x32_bf16 v[80:83], v[32:35], v[200:203], v[80:83]
  v_fmac_f32 v242, v208, v241
  v_fma_f32 v226, -v209, v241, v226
  v_mfma_f32_16x16x32_bf16 v[84:87], v[36:39], v[200:203], v[84:87]
  v_fmac_f32 v242, v209, v225
  v_fmac_f32 v227, v208, v226
  v_mfma_f32_16x16x32_bf16 v[112:115], v[40:43], v[200:203], v[112:115]
  v_fmac_f32 v243, v208, v242
  v_fma_f32 v227, -v209, v242, v227
  v_mfma_f32_16x16x32_bf16 v[116:119], v[44:47], v[200:203], v[116:119]
  v_fmac_f32 v243, v209, v226
  s_waitcnt lgkmcnt(8)
  v_mfma_f32_16x16x32_bf16 v[88:91], v[32:35], v[204:207], v[88:91]
  s_waitcnt lgkmcnt(0)
  s_barrier
  s_setprio 3
  v_fmac_f32 v228, v208, v227
  v_fmac_f32 v244, v208, v243
  v_mfma_f32_16x16x32_bf16 v[92:95], v[36:39], v[204:207], v[92:95]
  ds_read_b64_tr_b16 v[32:33], v16 offset:32768
  v_fma_f32 v228, -v209, v243, v228
  v_fmac_f32 v244, v209, v227
  v_mfma_f32_16x16x32_bf16 v[120:123], v[40:43], v[204:207], v[120:123]
  ds_read_b64_tr_b16 v[34:35], v16 offset:33792
  s_add_u32 m0, s59, 0x1c000
  s_mov_b32 s32, 0x2c0000
  buffer_load_dwordx4 v24, s[8:11], s32 offen lds
  v_fmac_f32 v229, v208, v228
  v_fmac_f32 v245, v208, v244
  v_mfma_f32_16x16x32_bf16 v[124:127], v[44:47], v[204:207], v[124:127]
  ds_read_b64_tr_b16 v[36:37], v17 offset:32768
  v_fma_f32 v229, -v209, v244, v229
  v_fmac_f32 v245, v209, v228
  v_mfma_f32_16x16x32_bf16 v[128:131], v[192:195], v[48:51], v[128:131]
  ds_read_b64_tr_b16 v[38:39], v17 offset:33792
  v_fmac_f32 v230, v208, v229
  v_fmac_f32 v246, v208, v245
  v_mfma_f32_16x16x32_bf16 v[144:147], v[192:195], v[52:55], v[144:147]
  ds_read_b64_tr_b16 v[40:41], v18 offset:32768
  v_fma_f32 v230, -v209, v245, v230
  v_fmac_f32 v246, v209, v229
  v_mfma_f32_16x16x32_bf16 v[160:163], v[192:195], v[56:59], v[160:163]
  ds_read_b64_tr_b16 v[42:43], v18 offset:33792
  v_fmac_f32 v231, v208, v230
  v_fmac_f32 v247, v208, v246
  v_mfma_f32_16x16x32_bf16 v[176:179], v[192:195], v[60:63], v[176:179]
  ds_read_b128 v[192:195], v27 offset:32768
  s_add_u32 m0, s59, 0x1c400
  s_mov_b32 s32, 0x2c8000
  buffer_load_dwordx4 v24, s[8:11], s32 offen lds
  v_fma_f32 v231, -v209, v246, v231
  v_fmac_f32 v247, v209, v230
  v_mfma_f32_16x16x32_bf16 v[132:135], v[196:199], v[48:51], v[132:135]
  s_setprio 2
  ds_read_b64_tr_b16 v[44:45], v19 offset:32768
  v_fmac_f32 v232, v208, v231
  v_mfma_f32_16x16x32_bf16 v[148:151], v[196:199], v[52:55], v[148:151]
  ds_read_b64_tr_b16 v[46:47], v19 offset:33792
  v_fmac_f32 v248, v208, v247
  v_fma_f32 v232, -v209, v247, v232
  v_mfma_f32_16x16x32_bf16 v[164:167], v[196:199], v[56:59], v[164:167]
  v_fmac_f32 v248, v209, v231
  v_cvt_pk_bf16_f32 v224, v224, v225
  v_mfma_f32_16x16x32_bf16 v[180:183], v[196:199], v[60:63], v[180:183]
  ds_read_b128 v[196:199], v27 offset:34816
  v_cvt_pk_bf16_f32 v225, v226, v227
  v_cvt_pk_bf16_f32 v226, v228, v229
  v_mfma_f32_16x16x32_bf16 v[136:139], v[200:203], v[48:51], v[136:139]
  s_add_u32 m0, s58, 0x0
  s_movk_i32 s33, 0x300
  buffer_load_dwordx4 v25, s[4:7], s33 offen lds
  v_cvt_pk_bf16_f32 v227, v230, v231
  buffer_store_dwordx4 v[224:227], v2, s[20:23], s50 offen offset:0 sc1
  v_mfma_f32_16x16x32_bf16 v[152:155], v[200:203], v[52:55], v[152:155]
  v_cvt_pk_bf16_f32 v240, v240, v241
  v_cvt_pk_bf16_f32 v241, v242, v243
  v_mfma_f32_16x16x32_bf16 v[168:171], v[200:203], v[56:59], v[168:171]
  v_cvt_pk_bf16_f32 v242, v244, v245
  v_cvt_pk_bf16_f32 v243, v246, v247
  v_mfma_f32_16x16x32_bf16 v[184:187], v[200:203], v[60:63], v[184:187]
  ds_read_b128 v[200:203], v27 offset:36864
  buffer_store_dwordx4 v[240:243], v2, s[20:23], s50 offen offset:2048 sc1
  v_fmac_f32 v233, v208, v232
  v_mfma_f32_16x16x32_bf16 v[140:143], v[204:207], v[48:51], v[140:143]
  s_setprio 1
  v_fmac_f32 v249, v208, v248
  v_fma_f32 v233, -v209, v248, v233
  v_mfma_f32_16x16x32_bf16 v[156:159], v[204:207], v[52:55], v[156:159]
  s_add_u32 m0, s58, 0x400
  s_movk_i32 s33, 0x300
  buffer_load_dwordx4 v26, s[4:7], s33 offen lds
  v_fmac_f32 v249, v209, v232
  v_mfma_f32_16x16x32_bf16 v[172:175], v[204:207], v[56:59], v[172:175]
  v_fmac_f32 v234, v208, v233
  v_fmac_f32 v250, v208, v249
  v_mfma_f32_16x16x32_bf16 v[188:191], v[204:207], v[60:63], v[188:191]
  ds_read_b128 v[204:207], v27 offset:38912
  v_fma_f32 v234, -v209, v249, v234
  v_fmac_f32 v250, v209, v233
  s_waitcnt lgkmcnt(10)
  s_waitcnt lgkmcnt(5)
  v_mfma_f32_16x16x32_bf16 v[64:67], v[32:35], v[192:195], v[64:67]
  ds_read_b64_tr_b16 v[48:49], v16 offset:40960
  v_fmac_f32 v235, v208, v234
  v_fmac_f32 v251, v208, v250
  v_mfma_f32_16x16x32_bf16 v[68:71], v[36:39], v[192:195], v[68:71]
  ds_read_b64_tr_b16 v[50:51], v16 offset:41984
  v_fma_f32 v235, -v209, v250, v235
  v_fmac_f32 v251, v209, v234
  v_mfma_f32_16x16x32_bf16 v[96:99], v[40:43], v[192:195], v[96:99]
  ds_read_b64_tr_b16 v[52:53], v17 offset:40960
  v_fmac_f32 v236, v208, v235
  v_fmac_f32 v252, v208, v251
  s_waitcnt lgkmcnt(6)
  v_mfma_f32_16x16x32_bf16 v[100:103], v[44:47], v[192:195], v[100:103]
  ds_read_b64_tr_b16 v[54:55], v17 offset:41984
  v_fma_f32 v236, -v209, v251, v236
  v_fmac_f32 v252, v209, v235
  s_waitcnt lgkmcnt(6)
  v_mfma_f32_16x16x32_bf16 v[72:75], v[32:35], v[196:199], v[72:75]
  s_setprio 0
  ds_read_b64_tr_b16 v[56:57], v18 offset:40960
  v_fmac_f32 v237, v208, v236
  v_fmac_f32 v253, v208, v252
  v_mfma_f32_16x16x32_bf16 v[76:79], v[36:39], v[196:199], v[76:79]
  ds_read_b64_tr_b16 v[58:59], v18 offset:41984
  v_fma_f32 v237, -v209, v252, v237
  v_fmac_f32 v253, v209, v236
  v_mfma_f32_16x16x32_bf16 v[104:107], v[40:43], v[196:199], v[104:107]
  ds_read_b64_tr_b16 v[60:61], v19 offset:40960
  v_fmac_f32 v238, v208, v237
  v_mfma_f32_16x16x32_bf16 v[108:111], v[44:47], v[196:199], v[108:111]
  ds_read_b64_tr_b16 v[62:63], v19 offset:41984
  v_fmac_f32 v254, v208, v253
  v_fma_f32 v238, -v209, v253, v238
  s_waitcnt lgkmcnt(9)
  v_mfma_f32_16x16x32_bf16 v[80:83], v[32:35], v[200:203], v[80:83]
  v_fmac_f32 v254, v209, v237
  v_fmac_f32 v239, v208, v238
  v_mfma_f32_16x16x32_bf16 v[84:87], v[36:39], v[200:203], v[84:87]
  v_fmac_f32 v255, v208, v254
  v_fma_f32 v239, -v209, v254, v239
  v_mfma_f32_16x16x32_bf16 v[112:115], v[40:43], v[200:203], v[112:115]
  v_fmac_f32 v255, v209, v238
  v_cvt_pk_bf16_f32 v232, v232, v233
  v_mfma_f32_16x16x32_bf16 v[116:119], v[44:47], v[200:203], v[116:119]
  v_cvt_pk_bf16_f32 v233, v234, v235
  v_cvt_pk_bf16_f32 v234, v236, v237
  s_waitcnt lgkmcnt(8)
  v_mfma_f32_16x16x32_bf16 v[88:91], v[32:35], v[204:207], v[88:91]
  s_waitcnt lgkmcnt(0)
  s_waitcnt vmcnt(13)
  s_barrier
  s_setprio 3
  v_cvt_pk_bf16_f32 v235, v238, v239
  buffer_store_dwordx4 v[232:235], v22, s[20:23], s50 offen offset:1024 sc1
  v_mfma_f32_16x16x32_bf16 v[92:95], v[36:39], v[204:207], v[92:95]
  ds_read_b64_tr_b16 v[32:33], v16 offset:49152
  v_cvt_pk_bf16_f32 v248, v248, v249
  v_cvt_pk_bf16_f32 v249, v250, v251
  v_mfma_f32_16x16x32_bf16 v[120:123], v[40:43], v[204:207], v[120:123]
  ds_read_b64_tr_b16 v[34:35], v16 offset:50176
  s_add_u32 m0, s59, 0x20000
  s_mov_b32 s32, 0x300000
  buffer_load_dwordx4 v24, s[8:11], s32 offen lds
  v_cvt_pk_bf16_f32 v250, v252, v253
  v_cvt_pk_bf16_f32 v251, v254, v255
  v_mfma_f32_16x16x32_bf16 v[124:127], v[44:47], v[204:207], v[124:127]
  ds_read_b64_tr_b16 v[36:37], v17 offset:49152
  buffer_store_dwordx4 v[248:251], v22, s[20:23], s50 offen offset:3072 sc1
  v_mfma_f32_16x16x32_bf16 v[128:131], v[192:195], v[48:51], v[128:131]
  ds_read_b64_tr_b16 v[38:39], v17 offset:50176
  v_mfma_f32_16x16x32_bf16 v[144:147], v[192:195], v[52:55], v[144:147]
  ds_read_b64_tr_b16 v[40:41], v18 offset:49152
  v_mfma_f32_16x16x32_bf16 v[160:163], v[192:195], v[56:59], v[160:163]
  ds_read_b64_tr_b16 v[42:43], v18 offset:50176
  v_mfma_f32_16x16x32_bf16 v[176:179], v[192:195], v[60:63], v[176:179]
  ds_read_b128 v[192:195], v28 offset:32768
  s_add_u32 m0, s59, 0x20400
  s_mov_b32 s32, 0x308000
  buffer_load_dwordx4 v24, s[8:11], s32 offen lds
  v_mfma_f32_16x16x32_bf16 v[132:135], v[196:199], v[48:51], v[132:135]
  s_setprio 2
  ds_read_b64_tr_b16 v[44:45], v19 offset:49152
  v_mfma_f32_16x16x32_bf16 v[148:151], v[196:199], v[52:55], v[148:151]
  ds_read_b64_tr_b16 v[46:47], v19 offset:50176
  v_mfma_f32_16x16x32_bf16 v[164:167], v[196:199], v[56:59], v[164:167]
  v_mfma_f32_16x16x32_bf16 v[180:183], v[196:199], v[60:63], v[180:183]
  ds_read_b128 v[196:199], v28 offset:34816
  v_mfma_f32_16x16x32_bf16 v[136:139], v[200:203], v[48:51], v[136:139]
  s_add_u32 m0, s58, 0x800
  s_movk_i32 s33, 0x4300
  buffer_load_dwordx4 v25, s[4:7], s33 offen lds
  v_mfma_f32_16x16x32_bf16 v[152:155], v[200:203], v[52:55], v[152:155]
  v_mfma_f32_16x16x32_bf16 v[168:171], v[200:203], v[56:59], v[168:171]
  v_mfma_f32_16x16x32_bf16 v[184:187], v[200:203], v[60:63], v[184:187]
  ds_read_b128 v[200:203], v28 offset:36864
  v_mfma_f32_16x16x32_bf16 v[140:143], v[204:207], v[48:51], v[140:143]
  s_setprio 1
  v_mfma_f32_16x16x32_bf16 v[156:159], v[204:207], v[52:55], v[156:159]
  s_add_u32 m0, s58, 0xc00
  s_movk_i32 s33, 0x4300
  buffer_load_dwordx4 v26, s[4:7], s33 offen lds
  v_mfma_f32_16x16x32_bf16 v[172:175], v[204:207], v[56:59], v[172:175]
  v_mfma_f32_16x16x32_bf16 v[188:191], v[204:207], v[60:63], v[188:191]
  ds_read_b128 v[204:207], v28 offset:38912
  s_waitcnt lgkmcnt(10)
  s_waitcnt lgkmcnt(5)
  v_mfma_f32_16x16x32_bf16 v[64:67], v[32:35], v[192:195], v[64:67]
  ds_read_b64_tr_b16 v[48:49], v16 offset:57344
  v_mfma_f32_16x16x32_bf16 v[68:71], v[36:39], v[192:195], v[68:71]
  ds_read_b64_tr_b16 v[50:51], v16 offset:58368
  v_mfma_f32_16x16x32_bf16 v[96:99], v[40:43], v[192:195], v[96:99]
  ds_read_b64_tr_b16 v[52:53], v17 offset:57344
  s_waitcnt lgkmcnt(6)
  v_mfma_f32_16x16x32_bf16 v[100:103], v[44:47], v[192:195], v[100:103]
  ds_read_b64_tr_b16 v[54:55], v17 offset:58368
  s_waitcnt lgkmcnt(6)
  v_mfma_f32_16x16x32_bf16 v[72:75], v[32:35], v[196:199], v[72:75]
  s_setprio 0
  ds_read_b64_tr_b16 v[56:57], v18 offset:57344
  v_mfma_f32_16x16x32_bf16 v[76:79], v[36:39], v[196:199], v[76:79]
  ds_read_b64_tr_b16 v[58:59], v18 offset:58368
  v_mfma_f32_16x16x32_bf16 v[104:107], v[40:43], v[196:199], v[104:107]
  ds_read_b64_tr_b16 v[60:61], v19 offset:57344
  v_mfma_f32_16x16x32_bf16 v[108:111], v[44:47], v[196:199], v[108:111]
  ds_read_b64_tr_b16 v[62:63], v19 offset:58368
  s_waitcnt lgkmcnt(9)
  v_mfma_f32_16x16x32_bf16 v[80:83], v[32:35], v[200:203], v[80:83]
  v_mfma_f32_16x16x32_bf16 v[84:87], v[36:39], v[200:203], v[84:87]
  v_mfma_f32_16x16x32_bf16 v[112:115], v[40:43], v[200:203], v[112:115]
  v_mfma_f32_16x16x32_bf16 v[116:119], v[44:47], v[200:203], v[116:119]
  s_waitcnt lgkmcnt(8)
  v_mfma_f32_16x16x32_bf16 v[88:91], v[32:35], v[204:207], v[88:91]
  s_waitcnt lgkmcnt(0)
  s_waitcnt vmcnt(12)
  s_barrier
  s_setprio 3
  v_mfma_f32_16x16x32_bf16 v[92:95], v[36:39], v[204:207], v[92:95]
  ds_read_b64_tr_b16 v[32:33], v16 offset:0
  v_mfma_f32_16x16x32_bf16 v[120:123], v[40:43], v[204:207], v[120:123]
  ds_read_b64_tr_b16 v[34:35], v16 offset:1024
  s_add_u32 m0, s59, 0x24000
  s_mov_b32 s32, 0x340000
  buffer_load_dwordx4 v24, s[8:11], s32 offen lds
  v_mfma_f32_16x16x32_bf16 v[124:127], v[44:47], v[204:207], v[124:127]
  ds_read_b64_tr_b16 v[36:37], v17 offset:0
  v_mfma_f32_16x16x32_bf16 v[128:131], v[192:195], v[48:51], v[128:131]
  ds_read_b64_tr_b16 v[38:39], v17 offset:1024
  v_mfma_f32_16x16x32_bf16 v[144:147], v[192:195], v[52:55], v[144:147]
  ds_read_b64_tr_b16 v[40:41], v18 offset:0
  v_mfma_f32_16x16x32_bf16 v[160:163], v[192:195], v[56:59], v[160:163]
  ds_read_b64_tr_b16 v[42:43], v18 offset:1024
  v_mfma_f32_16x16x32_bf16 v[176:179], v[192:195], v[60:63], v[176:179]
  ds_read_b128 v[192:195], v29 offset:0
  s_add_u32 m0, s59, 0x24400
  s_mov_b32 s32, 0x348000
  buffer_load_dwordx4 v24, s[8:11], s32 offen lds
  v_mfma_f32_16x16x32_bf16 v[132:135], v[196:199], v[48:51], v[132:135]
  s_setprio 2
  ds_read_b64_tr_b16 v[44:45], v19 offset:0
  v_mfma_f32_16x16x32_bf16 v[148:151], v[196:199], v[52:55], v[148:151]
  ds_read_b64_tr_b16 v[46:47], v19 offset:1024
  v_mfma_f32_16x16x32_bf16 v[164:167], v[196:199], v[56:59], v[164:167]
  v_mfma_f32_16x16x32_bf16 v[180:183], v[196:199], v[60:63], v[180:183]
  ds_read_b128 v[196:199], v29 offset:2048
  v_mfma_f32_16x16x32_bf16 v[136:139], v[200:203], v[48:51], v[136:139]
  s_add_u32 m0, s58, 0x8000
  s_movk_i32 s33, 0x380
  buffer_load_dwordx4 v25, s[4:7], s33 offen lds
  v_mfma_f32_16x16x32_bf16 v[152:155], v[200:203], v[52:55], v[152:155]
  v_mfma_f32_16x16x32_bf16 v[168:171], v[200:203], v[56:59], v[168:171]
  v_mfma_f32_16x16x32_bf16 v[184:187], v[200:203], v[60:63], v[184:187]
  ds_read_b128 v[200:203], v29 offset:4096
  v_mfma_f32_16x16x32_bf16 v[140:143], v[204:207], v[48:51], v[140:143]
  s_setprio 1
  v_mfma_f32_16x16x32_bf16 v[156:159], v[204:207], v[52:55], v[156:159]
  s_add_u32 m0, s58, 0x8400
  s_movk_i32 s33, 0x380
  buffer_load_dwordx4 v26, s[4:7], s33 offen lds
  v_mfma_f32_16x16x32_bf16 v[172:175], v[204:207], v[56:59], v[172:175]
  v_mfma_f32_16x16x32_bf16 v[188:191], v[204:207], v[60:63], v[188:191]
  ds_read_b128 v[204:207], v29 offset:6144
  s_waitcnt lgkmcnt(10)
  s_waitcnt lgkmcnt(5)
  v_mfma_f32_16x16x32_bf16 v[64:67], v[32:35], v[192:195], v[64:67]
  ds_read_b64_tr_b16 v[48:49], v16 offset:8192
  v_mfma_f32_16x16x32_bf16 v[68:71], v[36:39], v[192:195], v[68:71]
  ds_read_b64_tr_b16 v[50:51], v16 offset:9216
  v_mfma_f32_16x16x32_bf16 v[96:99], v[40:43], v[192:195], v[96:99]
  ds_read_b64_tr_b16 v[52:53], v17 offset:8192
  s_waitcnt lgkmcnt(6)
  v_mfma_f32_16x16x32_bf16 v[100:103], v[44:47], v[192:195], v[100:103]
  ds_read_b64_tr_b16 v[54:55], v17 offset:9216
  s_waitcnt lgkmcnt(6)
  v_mfma_f32_16x16x32_bf16 v[72:75], v[32:35], v[196:199], v[72:75]
  s_setprio 0
  ds_read_b64_tr_b16 v[56:57], v18 offset:8192
  v_mfma_f32_16x16x32_bf16 v[76:79], v[36:39], v[196:199], v[76:79]
  ds_read_b64_tr_b16 v[58:59], v18 offset:9216
  v_mfma_f32_16x16x32_bf16 v[104:107], v[40:43], v[196:199], v[104:107]
  ds_read_b64_tr_b16 v[60:61], v19 offset:8192
  v_mfma_f32_16x16x32_bf16 v[108:111], v[44:47], v[196:199], v[108:111]
  ds_read_b64_tr_b16 v[62:63], v19 offset:9216
  s_waitcnt lgkmcnt(9)
  v_mfma_f32_16x16x32_bf16 v[80:83], v[32:35], v[200:203], v[80:83]
  v_mfma_f32_16x16x32_bf16 v[84:87], v[36:39], v[200:203], v[84:87]
  v_mfma_f32_16x16x32_bf16 v[112:115], v[40:43], v[200:203], v[112:115]
  v_mfma_f32_16x16x32_bf16 v[116:119], v[44:47], v[200:203], v[116:119]
  s_waitcnt lgkmcnt(8)
  v_mfma_f32_16x16x32_bf16 v[88:91], v[32:35], v[204:207], v[88:91]
  s_waitcnt lgkmcnt(0)
  s_waitcnt vmcnt(14)
  s_barrier
  s_setprio 3
  v_mfma_f32_16x16x32_bf16 v[92:95], v[36:39], v[204:207], v[92:95]
  ds_read_b64_tr_b16 v[32:33], v16 offset:16384
  v_mfma_f32_16x16x32_bf16 v[120:123], v[40:43], v[204:207], v[120:123]
  ds_read_b64_tr_b16 v[34:35], v16 offset:17408
  s_add_u32 m0, s59, 0x18000
  s_mov_b32 s32, 0x380000
  buffer_load_dwordx4 v24, s[8:11], s32 offen lds
  v_mfma_f32_16x16x32_bf16 v[124:127], v[44:47], v[204:207], v[124:127]
  ds_read_b64_tr_b16 v[36:37], v17 offset:16384
  v_mfma_f32_16x16x32_bf16 v[128:131], v[192:195], v[48:51], v[128:131]
  ds_read_b64_tr_b16 v[38:39], v17 offset:17408
  v_mfma_f32_16x16x32_bf16 v[144:147], v[192:195], v[52:55], v[144:147]
  ds_read_b64_tr_b16 v[40:41], v18 offset:16384
  v_mfma_f32_16x16x32_bf16 v[160:163], v[192:195], v[56:59], v[160:163]
  ds_read_b64_tr_b16 v[42:43], v18 offset:17408
  v_mfma_f32_16x16x32_bf16 v[176:179], v[192:195], v[60:63], v[176:179]
  ds_read_b128 v[192:195], v30 offset:0
  s_add_u32 m0, s59, 0x18400
  s_mov_b32 s32, 0x388000
  buffer_load_dwordx4 v24, s[8:11], s32 offen lds
  v_mfma_f32_16x16x32_bf16 v[132:135], v[196:199], v[48:51], v[132:135]
  s_setprio 2
  ds_read_b64_tr_b16 v[44:45], v19 offset:16384
  v_mfma_f32_16x16x32_bf16 v[148:151], v[196:199], v[52:55], v[148:151]
  ds_read_b64_tr_b16 v[46:47], v19 offset:17408
  v_mfma_f32_16x16x32_bf16 v[164:167], v[196:199], v[56:59], v[164:167]
  v_mfma_f32_16x16x32_bf16 v[180:183], v[196:199], v[60:63], v[180:183]
  ds_read_b128 v[196:199], v30 offset:2048
  v_mfma_f32_16x16x32_bf16 v[136:139], v[200:203], v[48:51], v[136:139]
  s_add_u32 m0, s58, 0x8800
  s_movk_i32 s33, 0x4380
  buffer_load_dwordx4 v25, s[4:7], s33 offen lds
  v_mfma_f32_16x16x32_bf16 v[152:155], v[200:203], v[52:55], v[152:155]
  v_mfma_f32_16x16x32_bf16 v[168:171], v[200:203], v[56:59], v[168:171]
  v_mfma_f32_16x16x32_bf16 v[184:187], v[200:203], v[60:63], v[184:187]
  ds_read_b128 v[200:203], v30 offset:4096
  v_mfma_f32_16x16x32_bf16 v[140:143], v[204:207], v[48:51], v[140:143]
  s_setprio 1
  v_mfma_f32_16x16x32_bf16 v[156:159], v[204:207], v[52:55], v[156:159]
  s_add_u32 m0, s58, 0x8c00
  s_movk_i32 s33, 0x4380
  buffer_load_dwordx4 v26, s[4:7], s33 offen lds
  v_mfma_f32_16x16x32_bf16 v[172:175], v[204:207], v[56:59], v[172:175]
  s_movk_i32 s42, 10240
  v_mfma_f32_16x16x32_bf16 v[188:191], v[204:207], v[60:63], v[188:191]
  ds_read_b128 v[204:207], v30 offset:6144
  s_sub_u32 s32, 15, s36
  s_and_b32 s33, s3, 3
  s_lshl_b32 s43, s32, 2
  s_add_u32 s43, s43, s33
  s_waitcnt lgkmcnt(10)
  s_waitcnt lgkmcnt(5)
  v_mfma_f32_16x16x32_bf16 v[64:67], v[32:35], v[192:195], v[64:67]
  ds_read_b64_tr_b16 v[48:49], v16 offset:24576
  s_lshl_b32 s41, s36, 2
  s_and_b32 s33, s3, 3
  s_add_u32 s41, s41, s33
  v_mfma_f32_16x16x32_bf16 v[68:71], v[36:39], v[192:195], v[68:71]
  ds_read_b64_tr_b16 v[50:51], v16 offset:25600
  s_lshl_b32 s56, s41, 18
  s_lshl_b32 s57, s43, 18
  v_mfma_f32_16x16x32_bf16 v[96:99], v[40:43], v[192:195], v[96:99]
  ds_read_b64_tr_b16 v[52:53], v17 offset:24576
  s_cmp_ge_u32 s3, 4
  s_cselect_b32 s39, s41, s43
  s_waitcnt lgkmcnt(6)
  v_mfma_f32_16x16x32_bf16 v[100:103], v[44:47], v[192:195], v[100:103]
  ds_read_b64_tr_b16 v[54:55], v17 offset:25600
  s_lshl_b32 s32, s39, 5
  v_lshrrev_b32 v14, 3, v1
  v_add_u32 v14, s32, v14
  s_waitcnt lgkmcnt(6)
  v_mfma_f32_16x16x32_bf16 v[72:75], v[32:35], v[196:199], v[72:75]
  s_setprio 0
  ds_read_b64_tr_b16 v[56:57], v18 offset:24576
  v_mul_u32_u24 v14, 1280, v14
  v_mfma_f32_16x16x32_bf16 v[76:79], v[36:39], v[196:199], v[76:79]
  ds_read_b64_tr_b16 v[58:59], v18 offset:25600
  v_mfma_f32_16x16x32_bf16 v[104:107], v[40:43], v[196:199], v[104:107]
  ds_read_b64_tr_b16 v[60:61], v19 offset:24576
  v_and_b32 v25, 0x70, v25
  v_mfma_f32_16x16x32_bf16 v[108:111], v[44:47], v[196:199], v[108:111]
  ds_read_b64_tr_b16 v[62:63], v19 offset:25600
  v_and_b32 v26, 0x70, v26
  s_waitcnt lgkmcnt(9)
  v_mfma_f32_16x16x32_bf16 v[80:83], v[32:35], v[200:203], v[80:83]
  v_add_u32 v25, v25, v14
  v_mfma_f32_16x16x32_bf16 v[84:87], v[36:39], v[200:203], v[84:87]
  v_add3_u32 v26, v26, v14, s42
  v_mfma_f32_16x16x32_bf16 v[112:115], v[40:43], v[200:203], v[112:115]
  s_mov_b32 s4, s82
  s_and_b32 s5, s83, 0xffff
  s_mov_b32 s6, 0x280000
  s_mov_b32 s7, 0x00020000
  v_mfma_f32_16x16x32_bf16 v[116:119], v[44:47], v[200:203], v[116:119]
  s_waitcnt lgkmcnt(8)
  v_mfma_f32_16x16x32_bf16 v[88:91], v[32:35], v[204:207], v[88:91]
  s_waitcnt lgkmcnt(0)
  s_waitcnt vmcnt(8)
  s_barrier
  s_setprio 3
  s_lshr_b32 s33, s2, 3
  s_lshl_b32 s32, s34, 5
  s_add_u32 s33, s33, s32
  s_lshl_b32 s33, s33, 2
  s_add_u32 s33, s33, 0xd000
  v_mov_b32 v14, 1
  buffer_store_dword v14, v13, s[24:27], s33 offen sc1
  v_mfma_f32_16x16x32_bf16 v[92:95], v[36:39], v[204:207], v[92:95]
  ds_read_b64_tr_b16 v[32:33], v16 offset:32768
  v_mfma_f32_16x16x32_bf16 v[120:123], v[40:43], v[204:207], v[120:123]
  ds_read_b64_tr_b16 v[34:35], v16 offset:33792
  s_add_u32 m0, s59, 0x1c000
  s_mov_b32 s32, 0x3c0000
  buffer_load_dwordx4 v24, s[8:11], s32 offen lds
  v_mfma_f32_16x16x32_bf16 v[124:127], v[44:47], v[204:207], v[124:127]
  ds_read_b64_tr_b16 v[36:37], v17 offset:32768
  v_mfma_f32_16x16x32_bf16 v[128:131], v[192:195], v[48:51], v[128:131]
  ds_read_b64_tr_b16 v[38:39], v17 offset:33792
  v_mfma_f32_16x16x32_bf16 v[144:147], v[192:195], v[52:55], v[144:147]
  ds_read_b64_tr_b16 v[40:41], v18 offset:32768
  v_mfma_f32_16x16x32_bf16 v[160:163], v[192:195], v[56:59], v[160:163]
  ds_read_b64_tr_b16 v[42:43], v18 offset:33792
  v_mfma_f32_16x16x32_bf16 v[176:179], v[192:195], v[60:63], v[176:179]
  ds_read_b128 v[192:195], v27 offset:0
  s_add_u32 m0, s59, 0x1c400
  s_mov_b32 s32, 0x3c8000
  buffer_load_dwordx4 v24, s[8:11], s32 offen lds
  v_mfma_f32_16x16x32_bf16 v[132:135], v[196:199], v[48:51], v[132:135]
  s_setprio 2
  ds_read_b64_tr_b16 v[44:45], v19 offset:32768
  v_mfma_f32_16x16x32_bf16 v[148:151], v[196:199], v[52:55], v[148:151]
  ds_read_b64_tr_b16 v[46:47], v19 offset:33792
  v_mfma_f32_16x16x32_bf16 v[164:167], v[196:199], v[56:59], v[164:167]
  v_mfma_f32_16x16x32_bf16 v[180:183], v[196:199], v[60:63], v[180:183]
  ds_read_b128 v[196:199], v27 offset:2048
  v_mfma_f32_16x16x32_bf16 v[136:139], v[200:203], v[48:51], v[136:139]
  s_add_u32 m0, s58, 0x10000
  s_movk_i32 s33, 0x0
  buffer_load_dwordx4 v25, s[4:7], s33 offen lds
  v_mfma_f32_16x16x32_bf16 v[152:155], v[200:203], v[52:55], v[152:155]
  v_mfma_f32_16x16x32_bf16 v[168:171], v[200:203], v[56:59], v[168:171]
  v_mfma_f32_16x16x32_bf16 v[184:187], v[200:203], v[60:63], v[184:187]
  ds_read_b128 v[200:203], v27 offset:4096
  v_mfma_f32_16x16x32_bf16 v[140:143], v[204:207], v[48:51], v[140:143]
  s_setprio 1
  v_mfma_f32_16x16x32_bf16 v[156:159], v[204:207], v[52:55], v[156:159]
  s_add_u32 m0, s58, 0x10400
  s_movk_i32 s33, 0x0
  buffer_load_dwordx4 v26, s[4:7], s33 offen lds
  v_mfma_f32_16x16x32_bf16 v[172:175], v[204:207], v[56:59], v[172:175]
  v_mfma_f32_16x16x32_bf16 v[188:191], v[204:207], v[60:63], v[188:191]
  ds_read_b128 v[204:207], v27 offset:6144
  s_waitcnt lgkmcnt(10)
  s_waitcnt lgkmcnt(5)
  v_mfma_f32_16x16x32_bf16 v[64:67], v[32:35], v[192:195], v[64:67]
  ds_read_b64_tr_b16 v[48:49], v16 offset:40960
  v_mfma_f32_16x16x32_bf16 v[68:71], v[36:39], v[192:195], v[68:71]
  ds_read_b64_tr_b16 v[50:51], v16 offset:41984
  v_mfma_f32_16x16x32_bf16 v[96:99], v[40:43], v[192:195], v[96:99]
  ds_read_b64_tr_b16 v[52:53], v17 offset:40960
  s_lshr_b32 s32, s3, 2
  s_lshl_b32 s32, s32, 18
  v_add_u32 v24, s32, v24
  s_waitcnt lgkmcnt(6)
  v_mfma_f32_16x16x32_bf16 v[100:103], v[44:47], v[192:195], v[100:103]
  ds_read_b64_tr_b16 v[54:55], v17 offset:41984
  s_waitcnt lgkmcnt(6)
  v_mfma_f32_16x16x32_bf16 v[72:75], v[32:35], v[196:199], v[72:75]
  s_setprio 0
  ds_read_b64_tr_b16 v[56:57], v18 offset:40960
  v_mfma_f32_16x16x32_bf16 v[76:79], v[36:39], v[196:199], v[76:79]
  ds_read_b64_tr_b16 v[58:59], v18 offset:41984
  s_mov_b32 s8, s86
  s_and_b32 s9, s87, 0xffff
  s_mov_b32 s10, 0x500000
  s_mov_b32 s11, 0x00020000
  v_mfma_f32_16x16x32_bf16 v[104:107], v[40:43], v[196:199], v[104:107]
  ds_read_b64_tr_b16 v[60:61], v19 offset:40960
  v_mfma_f32_16x16x32_bf16 v[108:111], v[44:47], v[196:199], v[108:111]
  ds_read_b64_tr_b16 v[62:63], v19 offset:41984
  s_waitcnt lgkmcnt(9)
  v_mfma_f32_16x16x32_bf16 v[80:83], v[32:35], v[200:203], v[80:83]
  v_mfma_f32_16x16x32_bf16 v[84:87], v[36:39], v[200:203], v[84:87]
  v_mfma_f32_16x16x32_bf16 v[112:115], v[40:43], v[200:203], v[112:115]
  v_mfma_f32_16x16x32_bf16 v[116:119], v[44:47], v[200:203], v[116:119]
  s_waitcnt lgkmcnt(8)
  v_mfma_f32_16x16x32_bf16 v[88:91], v[32:35], v[204:207], v[88:91]
  s_waitcnt lgkmcnt(0)
  s_waitcnt vmcnt(11)
  s_barrier
  s_setprio 3
  v_mfma_f32_16x16x32_bf16 v[92:95], v[36:39], v[204:207], v[92:95]
  ds_read_b64_tr_b16 v[32:33], v16 offset:49152
  v_mfma_f32_16x16x32_bf16 v[120:123], v[40:43], v[204:207], v[120:123]
  ds_read_b64_tr_b16 v[34:35], v16 offset:50176
  s_add_u32 m0, s59, 0x20000
  s_mov_b32 s32, 0x0
  buffer_load_dwordx4 v24, s[8:11], s32 offen lds
  v_mfma_f32_16x16x32_bf16 v[124:127], v[44:47], v[204:207], v[124:127]
  ds_read_b64_tr_b16 v[36:37], v17 offset:49152
  v_mfma_f32_16x16x32_bf16 v[128:131], v[192:195], v[48:51], v[128:131]
  ds_read_b64_tr_b16 v[38:39], v17 offset:50176
  v_mfma_f32_16x16x32_bf16 v[144:147], v[192:195], v[52:55], v[144:147]
  ds_read_b64_tr_b16 v[40:41], v18 offset:49152
  v_mfma_f32_16x16x32_bf16 v[160:163], v[192:195], v[56:59], v[160:163]
  ds_read_b64_tr_b16 v[42:43], v18 offset:50176
  v_mfma_f32_16x16x32_bf16 v[176:179], v[192:195], v[60:63], v[176:179]
  ds_read_b128 v[192:195], v28 offset:0
  s_add_u32 m0, s59, 0x20400
  s_mov_b32 s32, 0x8000
  buffer_load_dwordx4 v24, s[8:11], s32 offen lds
  v_mfma_f32_16x16x32_bf16 v[132:135], v[196:199], v[48:51], v[132:135]
  s_setprio 2
  ds_read_b64_tr_b16 v[44:45], v19 offset:49152
  v_mfma_f32_16x16x32_bf16 v[148:151], v[196:199], v[52:55], v[148:151]
  ds_read_b64_tr_b16 v[46:47], v19 offset:50176
  v_mfma_f32_16x16x32_bf16 v[164:167], v[196:199], v[56:59], v[164:167]
  v_mfma_f32_16x16x32_bf16 v[180:183], v[196:199], v[60:63], v[180:183]
  ds_read_b128 v[196:199], v28 offset:2048
  v_mfma_f32_16x16x32_bf16 v[136:139], v[200:203], v[48:51], v[136:139]
  s_add_u32 m0, s58, 0x10800
  s_movk_i32 s33, 0x5000
  buffer_load_dwordx4 v25, s[4:7], s33 offen lds
  v_mfma_f32_16x16x32_bf16 v[152:155], v[200:203], v[52:55], v[152:155]
  v_mfma_f32_16x16x32_bf16 v[168:171], v[200:203], v[56:59], v[168:171]
  v_mfma_f32_16x16x32_bf16 v[184:187], v[200:203], v[60:63], v[184:187]
  ds_read_b128 v[200:203], v28 offset:4096
  v_mfma_f32_16x16x32_bf16 v[140:143], v[204:207], v[48:51], v[140:143]
  s_setprio 1
  v_mfma_f32_16x16x32_bf16 v[156:159], v[204:207], v[52:55], v[156:159]
  s_add_u32 m0, s58, 0x10c00
  s_movk_i32 s33, 0x5000
  buffer_load_dwordx4 v26, s[4:7], s33 offen lds
  v_mfma_f32_16x16x32_bf16 v[172:175], v[204:207], v[56:59], v[172:175]
  v_mfma_f32_16x16x32_bf16 v[188:191], v[204:207], v[60:63], v[188:191]
  ds_read_b128 v[204:207], v28 offset:6144
  s_waitcnt lgkmcnt(10)
  s_waitcnt lgkmcnt(5)
  v_mfma_f32_16x16x32_bf16 v[64:67], v[32:35], v[192:195], v[64:67]
  ds_read_b64_tr_b16 v[48:49], v16 offset:57344
  v_mfma_f32_16x16x32_bf16 v[68:71], v[36:39], v[192:195], v[68:71]
  ds_read_b64_tr_b16 v[50:51], v16 offset:58368
  v_mfma_f32_16x16x32_bf16 v[96:99], v[40:43], v[192:195], v[96:99]
  ds_read_b64_tr_b16 v[52:53], v17 offset:57344
  s_waitcnt lgkmcnt(6)
  v_mfma_f32_16x16x32_bf16 v[100:103], v[44:47], v[192:195], v[100:103]
  ds_read_b64_tr_b16 v[54:55], v17 offset:58368
  s_waitcnt lgkmcnt(6)
  v_mfma_f32_16x16x32_bf16 v[72:75], v[32:35], v[196:199], v[72:75]
  s_setprio 0
  ds_read_b64_tr_b16 v[56:57], v18 offset:57344
  v_mfma_f32_16x16x32_bf16 v[76:79], v[36:39], v[196:199], v[76:79]
  ds_read_b64_tr_b16 v[58:59], v18 offset:58368
  v_mfma_f32_16x16x32_bf16 v[104:107], v[40:43], v[196:199], v[104:107]
  ds_read_b64_tr_b16 v[60:61], v19 offset:57344
  v_mfma_f32_16x16x32_bf16 v[108:111], v[44:47], v[196:199], v[108:111]
  ds_read_b64_tr_b16 v[62:63], v19 offset:58368
  s_waitcnt lgkmcnt(9)
  v_mfma_f32_16x16x32_bf16 v[80:83], v[32:35], v[200:203], v[80:83]
  v_mfma_f32_16x16x32_bf16 v[84:87], v[36:39], v[200:203], v[84:87]
  v_mfma_f32_16x16x32_bf16 v[112:115], v[40:43], v[200:203], v[112:115]
  v_mfma_f32_16x16x32_bf16 v[116:119], v[44:47], v[200:203], v[116:119]
  s_waitcnt lgkmcnt(8)
  v_mfma_f32_16x16x32_bf16 v[88:91], v[32:35], v[204:207], v[88:91]
  s_waitcnt lgkmcnt(0)
  s_waitcnt vmcnt(9)
  s_barrier
  s_setprio 3
  v_mfma_f32_16x16x32_bf16 v[92:95], v[36:39], v[204:207], v[92:95]
  ds_read_b64_tr_b16 v[32:33], v16 offset:0
  v_mfma_f32_16x16x32_bf16 v[120:123], v[40:43], v[204:207], v[120:123]
  ds_read_b64_tr_b16 v[34:35], v16 offset:1024
  s_add_u32 m0, s59, 0x24000
  s_mov_b32 s32, 0x80000
  buffer_load_dwordx4 v24, s[8:11], s32 offen lds
  v_mfma_f32_16x16x32_bf16 v[124:127], v[44:47], v[204:207], v[124:127]
  ds_read_b64_tr_b16 v[36:37], v17 offset:0
  v_mfma_f32_16x16x32_bf16 v[128:131], v[192:195], v[48:51], v[128:131]
  ds_read_b64_tr_b16 v[38:39], v17 offset:1024
  v_mfma_f32_16x16x32_bf16 v[144:147], v[192:195], v[52:55], v[144:147]
  ds_read_b64_tr_b16 v[40:41], v18 offset:0
  v_mfma_f32_16x16x32_bf16 v[160:163], v[192:195], v[56:59], v[160:163]
  ds_read_b64_tr_b16 v[42:43], v18 offset:1024
  v_mfma_f32_16x16x32_bf16 v[176:179], v[192:195], v[60:63], v[176:179]
  ds_read_b128 v[192:195], v27 offset:32768
  s_add_u32 m0, s59, 0x24400
  s_mov_b32 s32, 0x88000
  buffer_load_dwordx4 v24, s[8:11], s32 offen lds
  v_mfma_f32_16x16x32_bf16 v[132:135], v[196:199], v[48:51], v[132:135]
  s_setprio 2
  ds_read_b64_tr_b16 v[44:45], v19 offset:0
  v_mfma_f32_16x16x32_bf16 v[148:151], v[196:199], v[52:55], v[148:151]
  ds_read_b64_tr_b16 v[46:47], v19 offset:1024
  v_mfma_f32_16x16x32_bf16 v[164:167], v[196:199], v[56:59], v[164:167]
  v_mfma_f32_16x16x32_bf16 v[180:183], v[196:199], v[60:63], v[180:183]
  ds_read_b128 v[196:199], v27 offset:34816
  v_mfma_f32_16x16x32_bf16 v[136:139], v[200:203], v[48:51], v[136:139]
  s_add_u32 m0, s58, 0x0
  s_movk_i32 s33, 0x80
  buffer_load_dwordx4 v25, s[4:7], s33 offen lds
  v_mfma_f32_16x16x32_bf16 v[152:155], v[200:203], v[52:55], v[152:155]
  v_mfma_f32_16x16x32_bf16 v[168:171], v[200:203], v[56:59], v[168:171]
  v_mfma_f32_16x16x32_bf16 v[184:187], v[200:203], v[60:63], v[184:187]
  ds_read_b128 v[200:203], v27 offset:36864
  v_mfma_f32_16x16x32_bf16 v[140:143], v[204:207], v[48:51], v[140:143]
  s_setprio 1
  v_mfma_f32_16x16x32_bf16 v[156:159], v[204:207], v[52:55], v[156:159]
  s_add_u32 m0, s58, 0x400
  s_movk_i32 s33, 0x80
  buffer_load_dwordx4 v26, s[4:7], s33 offen lds
  v_mfma_f32_16x16x32_bf16 v[172:175], v[204:207], v[56:59], v[172:175]
  v_mfma_f32_16x16x32_bf16 v[188:191], v[204:207], v[60:63], v[188:191]
  ds_read_b128 v[204:207], v27 offset:38912
  s_waitcnt lgkmcnt(10)
  s_waitcnt lgkmcnt(5)
  v_mfma_f32_16x16x32_bf16 v[64:67], v[32:35], v[192:195], v[64:67]
  ds_read_b64_tr_b16 v[48:49], v16 offset:8192
  v_mfma_f32_16x16x32_bf16 v[68:71], v[36:39], v[192:195], v[68:71]
  ds_read_b64_tr_b16 v[50:51], v16 offset:9216
  v_mfma_f32_16x16x32_bf16 v[96:99], v[40:43], v[192:195], v[96:99]
  ds_read_b64_tr_b16 v[52:53], v17 offset:8192
  s_waitcnt lgkmcnt(6)
  v_mfma_f32_16x16x32_bf16 v[100:103], v[44:47], v[192:195], v[100:103]
  ds_read_b64_tr_b16 v[54:55], v17 offset:9216
  s_waitcnt lgkmcnt(6)
  v_mfma_f32_16x16x32_bf16 v[72:75], v[32:35], v[196:199], v[72:75]
  s_setprio 0
  ds_read_b64_tr_b16 v[56:57], v18 offset:8192
  v_mfma_f32_16x16x32_bf16 v[76:79], v[36:39], v[196:199], v[76:79]
  ds_read_b64_tr_b16 v[58:59], v18 offset:9216
  v_mfma_f32_16x16x32_bf16 v[104:107], v[40:43], v[196:199], v[104:107]
  ds_read_b64_tr_b16 v[60:61], v19 offset:8192
  v_mfma_f32_16x16x32_bf16 v[108:111], v[44:47], v[196:199], v[108:111]
  ds_read_b64_tr_b16 v[62:63], v19 offset:9216
  s_waitcnt lgkmcnt(9)
  v_mfma_f32_16x16x32_bf16 v[80:83], v[32:35], v[200:203], v[80:83]
  v_mfma_f32_16x16x32_bf16 v[84:87], v[36:39], v[200:203], v[84:87]
  v_mfma_f32_16x16x32_bf16 v[112:115], v[40:43], v[200:203], v[112:115]
  v_mfma_f32_16x16x32_bf16 v[116:119], v[44:47], v[200:203], v[116:119]
  s_waitcnt lgkmcnt(8)
  v_mfma_f32_16x16x32_bf16 v[88:91], v[32:35], v[204:207], v[88:91]
  s_waitcnt lgkmcnt(0)
  s_waitcnt vmcnt(10)
  s_barrier
  s_setprio 3
  v_mfma_f32_16x16x32_bf16 v[92:95], v[36:39], v[204:207], v[92:95]
  ds_read_b64_tr_b16 v[32:33], v16 offset:16384
  v_mfma_f32_16x16x32_bf16 v[120:123], v[40:43], v[204:207], v[120:123]
  ds_read_b64_tr_b16 v[34:35], v16 offset:17408
  s_add_u32 m0, s59, 0x18000
  s_mov_b32 s32, 0x100000
  buffer_load_dwordx4 v24, s[8:11], s32 offen lds
  v_mfma_f32_16x16x32_bf16 v[124:127], v[44:47], v[204:207], v[124:127]
  ds_read_b64_tr_b16 v[36:37], v17 offset:16384
  v_mfma_f32_16x16x32_bf16 v[128:131], v[192:195], v[48:51], v[128:131]
  ds_read_b64_tr_b16 v[38:39], v17 offset:17408
  v_mfma_f32_16x16x32_bf16 v[144:147], v[192:195], v[52:55], v[144:147]
  ds_read_b64_tr_b16 v[40:41], v18 offset:16384
  v_mfma_f32_16x16x32_bf16 v[160:163], v[192:195], v[56:59], v[160:163]
  ds_read_b64_tr_b16 v[42:43], v18 offset:17408
  v_mfma_f32_16x16x32_bf16 v[176:179], v[192:195], v[60:63], v[176:179]
  ds_read_b128 v[192:195], v28 offset:32768
  s_add_u32 m0, s59, 0x18400
  s_mov_b32 s32, 0x108000
  buffer_load_dwordx4 v24, s[8:11], s32 offen lds
  v_mfma_f32_16x16x32_bf16 v[132:135], v[196:199], v[48:51], v[132:135]
  s_setprio 2
  ds_read_b64_tr_b16 v[44:45], v19 offset:16384
  v_mfma_f32_16x16x32_bf16 v[148:151], v[196:199], v[52:55], v[148:151]
  ds_read_b64_tr_b16 v[46:47], v19 offset:17408
  v_mfma_f32_16x16x32_bf16 v[164:167], v[196:199], v[56:59], v[164:167]
  v_mfma_f32_16x16x32_bf16 v[180:183], v[196:199], v[60:63], v[180:183]
  ds_read_b128 v[196:199], v28 offset:34816
  v_mfma_f32_16x16x32_bf16 v[136:139], v[200:203], v[48:51], v[136:139]
  s_add_u32 m0, s58, 0x800
  s_movk_i32 s33, 0x5080
  buffer_load_dwordx4 v25, s[4:7], s33 offen lds
  v_mfma_f32_16x16x32_bf16 v[152:155], v[200:203], v[52:55], v[152:155]
  v_mfma_f32_16x16x32_bf16 v[168:171], v[200:203], v[56:59], v[168:171]
  v_mfma_f32_16x16x32_bf16 v[184:187], v[200:203], v[60:63], v[184:187]
  ds_read_b128 v[200:203], v28 offset:36864
  v_mfma_f32_16x16x32_bf16 v[140:143], v[204:207], v[48:51], v[140:143]
  s_setprio 1
  v_mfma_f32_16x16x32_bf16 v[156:159], v[204:207], v[52:55], v[156:159]
  s_add_u32 m0, s58, 0xc00
  s_movk_i32 s33, 0x5080
  buffer_load_dwordx4 v26, s[4:7], s33 offen lds
  v_mfma_f32_16x16x32_bf16 v[172:175], v[204:207], v[56:59], v[172:175]
  v_mfma_f32_16x16x32_bf16 v[188:191], v[204:207], v[60:63], v[188:191]
  ds_read_b128 v[204:207], v28 offset:38912
  s_waitcnt lgkmcnt(10)
  s_waitcnt lgkmcnt(5)
  v_mfma_f32_16x16x32_bf16 v[64:67], v[32:35], v[192:195], v[64:67]
  ds_read_b64_tr_b16 v[48:49], v16 offset:24576
  v_mfma_f32_16x16x32_bf16 v[68:71], v[36:39], v[192:195], v[68:71]
  ds_read_b64_tr_b16 v[50:51], v16 offset:25600
  s_add_u32 s33, s58, 0x10000
  v_add_u32 v29, s33, v3
  v_add_u32 v30, s33, v4
  v_mfma_f32_16x16x32_bf16 v[96:99], v[40:43], v[192:195], v[96:99]
  ds_read_b64_tr_b16 v[52:53], v17 offset:24576
  v_add_u32 v27, s58, v3
  s_waitcnt lgkmcnt(6)
  v_mfma_f32_16x16x32_bf16 v[100:103], v[44:47], v[192:195], v[100:103]
  ds_read_b64_tr_b16 v[54:55], v17 offset:25600
  s_waitcnt lgkmcnt(6)
  v_mfma_f32_16x16x32_bf16 v[72:75], v[32:35], v[196:199], v[72:75]
  s_setprio 0
  ds_read_b64_tr_b16 v[56:57], v18 offset:24576
  v_add_u32 v28, s58, v4
  v_mfma_f32_16x16x32_bf16 v[76:79], v[36:39], v[196:199], v[76:79]
  ds_read_b64_tr_b16 v[58:59], v18 offset:25600
  v_mfma_f32_16x16x32_bf16 v[104:107], v[40:43], v[196:199], v[104:107]
  ds_read_b64_tr_b16 v[60:61], v19 offset:24576
  v_mfma_f32_16x16x32_bf16 v[108:111], v[44:47], v[196:199], v[108:111]
  ds_read_b64_tr_b16 v[62:63], v19 offset:25600
  v_cvt_pk_bf16_f32 v224, v64, v65
  v_cvt_pk_bf16_f32 v225, v66, v67
  s_waitcnt lgkmcnt(9)
  v_mfma_f32_16x16x32_bf16 v[80:83], v[32:35], v[200:203], v[80:83]
  v_xor_b32 v16, s40, v16
  v_cvt_pk_bf16_f32 v226, v68, v69
  v_cvt_pk_bf16_f32 v227, v70, v71
  v_mfma_f32_16x16x32_bf16 v[84:87], v[36:39], v[200:203], v[84:87]
  v_xor_b32 v17, s40, v17
  v_cvt_pk_bf16_f32 v240, v96, v97
  v_mfma_f32_16x16x32_bf16 v[112:115], v[40:43], v[200:203], v[112:115]
  v_xor_b32 v18, s40, v18
  v_cvt_pk_bf16_f32 v241, v98, v99
  v_cvt_pk_bf16_f32 v242, v100, v101
  v_mfma_f32_16x16x32_bf16 v[116:119], v[44:47], v[200:203], v[116:119]
  v_xor_b32 v19, s40, v19
  v_cvt_pk_bf16_f32 v243, v102, v103
  s_waitcnt lgkmcnt(8)
  v_mfma_f32_16x16x32_bf16 v[88:91], v[32:35], v[204:207], v[88:91]
  s_waitcnt lgkmcnt(0)
  s_waitcnt vmcnt(8)
  s_barrier
  s_setprio 3
  s_mov_b32 s40, s39
  v_cvt_pk_bf16_f32 v228, v72, v73
  v_cvt_pk_bf16_f32 v229, v74, v75
  v_mfma_f32_16x16x32_bf16 v[92:95], v[36:39], v[204:207], v[92:95]
  v_xor_b32 v20, 0x80, v16
  v_cvt_pk_bf16_f32 v230, v76, v77
  v_cvt_pk_bf16_f32 v231, v78, v79
  v_mfma_f32_16x16x32_bf16 v[120:123], v[40:43], v[204:207], v[120:123]
  s_add_u32 m0, s59, 0x1c000
  s_mov_b32 s32, 0x180000
  buffer_load_dwordx4 v24, s[8:11], s32 offen lds
  v_xor_b32 v21, 0x80, v17
  v_cvt_pk_bf16_f32 v244, v104, v105
  v_mfma_f32_16x16x32_bf16 v[124:127], v[44:47], v[204:207], v[124:127]
  v_xor_b32 v22, 0x80, v18
  v_cvt_pk_bf16_f32 v245, v106, v107
  v_cvt_pk_bf16_f32 v246, v108, v109
  v_mfma_f32_16x16x32_bf16 v[128:131], v[192:195], v[48:51], v[128:131]
  v_xor_b32 v23, 0x80, v19
  v_cvt_pk_bf16_f32 v247, v110, v111
  ds_read_b64_tr_b16 v[32:33], v16 offset:32768
  v_mfma_f32_16x16x32_bf16 v[144:147], v[192:195], v[52:55], v[144:147]
  v_cvt_pk_bf16_f32 v232, v80, v81
  v_cvt_pk_bf16_f32 v233, v82, v83
  ds_read_b64_tr_b16 v[34:35], v16 offset:33792
  v_mfma_f32_16x16x32_bf16 v[160:163], v[192:195], v[56:59], v[160:163]
  v_cvt_pk_bf16_f32 v234, v84, v85
  v_cvt_pk_bf16_f32 v235, v86, v87
  ds_read_b128 v[208:211], v29 offset:0
  v_mfma_f32_16x16x32_bf16 v[176:179], v[192:195], v[60:63], v[176:179]
  s_add_u32 m0, s59, 0x1c400
  s_mov_b32 s32, 0x188000
  buffer_load_dwordx4 v24, s[8:11], s32 offen lds
  v_cvt_pk_bf16_f32 v248, v112, v113
  ds_read_b128 v[212:215], v29 offset:2048
  v_mfma_f32_16x16x32_bf16 v[132:135], v[196:199], v[48:51], v[132:135]
  s_setprio 2
  v_cvt_pk_bf16_f32 v249, v114, v115
  v_cvt_pk_bf16_f32 v250, v116, v117
  v_mfma_f32_16x16x32_bf16 v[148:151], v[196:199], v[52:55], v[148:151]
  v_cvt_pk_bf16_f32 v251, v118, v119
  ds_read_b64_tr_b16 v[36:37], v16 offset:40960
  v_mfma_f32_16x16x32_bf16 v[164:167], v[196:199], v[56:59], v[164:167]
  v_cvt_pk_bf16_f32 v236, v88, v89
  v_cvt_pk_bf16_f32 v237, v90, v91
  ds_read_b64_tr_b16 v[38:39], v16 offset:41984
  v_mfma_f32_16x16x32_bf16 v[180:183], v[196:199], v[60:63], v[180:183]
  v_cvt_pk_bf16_f32 v238, v92, v93
  v_cvt_pk_bf16_f32 v239, v94, v95
  ds_read_b128 v[216:219], v30 offset:0
  v_mfma_f32_16x16x32_bf16 v[136:139], v[200:203], v[48:51], v[136:139]
  s_add_u32 m0, s58, 0x8000
  s_movk_i32 s33, 0x100
  buffer_load_dwordx4 v25, s[4:7], s33 offen lds
  v_cvt_pk_bf16_f32 v252, v120, v121
  ds_read_b128 v[220:223], v30 offset:2048
  v_mfma_f32_16x16x32_bf16 v[152:155], v[200:203], v[52:55], v[152:155]
  v_cvt_pk_bf16_f32 v253, v122, v123
  v_cvt_pk_bf16_f32 v254, v124, v125
  v_mfma_f32_16x16x32_bf16 v[168:171], v[200:203], v[56:59], v[168:171]
  v_cvt_pk_bf16_f32 v255, v126, v127
  ds_read_b64_tr_b16 v[40:41], v17 offset:32768
  v_mfma_f32_16x16x32_bf16 v[184:187], v[200:203], v[60:63], v[184:187]
  v_cvt_pk_bf16_f32 v128, v128, v129
  v_cvt_pk_bf16_f32 v129, v130, v131
  ds_read_b64_tr_b16 v[42:43], v17 offset:33792
  v_mfma_f32_16x16x32_bf16 v[140:143], v[204:207], v[48:51], v[140:143]
  s_setprio 1
  v_cvt_pk_bf16_f32 v130, v132, v133
  v_cvt_pk_bf16_f32 v131, v134, v135
  ds_read_b64_tr_b16 v[44:45], v17 offset:40960
  v_mfma_f32_16x16x32_bf16 v[156:159], v[204:207], v[52:55], v[156:159]
  s_add_u32 m0, s58, 0x8400
  s_movk_i32 s33, 0x100
  buffer_load_dwordx4 v26, s[4:7], s33 offen lds
  v_cvt_pk_bf16_f32 v144, v144, v145
  ds_read_b64_tr_b16 v[46:47], v17 offset:41984
  v_mfma_f32_16x16x32_bf16 v[172:175], v[204:207], v[56:59], v[172:175]
  v_cvt_pk_bf16_f32 v145, v146, v147
  v_cvt_pk_bf16_f32 v146, v148, v149
  v_mfma_f32_16x16x32_bf16 v[188:191], v[204:207], v[60:63], v[188:191]
  v_cvt_pk_bf16_f32 v147, v150, v151
  s_waitcnt lgkmcnt(10)
  s_waitcnt lgkmcnt(9)
  v_mfma_f32_16x16x32_bf16 v[64:67], v[32:35], v[208:211], 0
  v_cvt_pk_bf16_f32 v160, v160, v161
  v_cvt_pk_bf16_f32 v161, v162, v163
  ds_read_b64_tr_b16 v[48:49], v18 offset:32768
  ds_read_b64_tr_b16 v[50:51], v18 offset:33792
  s_waitcnt lgkmcnt(10)
  v_mfma_f32_16x16x32_bf16 v[68:71], v[32:35], v[212:215], 0
  v_cvt_pk_bf16_f32 v162, v164, v165
  v_cvt_pk_bf16_f32 v163, v166, v167
  s_add_u32 m0, s58, 0x8800
  s_movk_i32 s33, 0x5100
  buffer_load_dwordx4 v25, s[4:7], s33 offen lds
  ds_read_b64_tr_b16 v[52:53], v18 offset:40960
  s_waitcnt lgkmcnt(9)
  s_waitcnt lgkmcnt(8)
  v_mfma_f32_16x16x32_bf16 v[64:67], v[36:39], v[216:219], v[64:67]
  v_cvt_pk_bf16_f32 v176, v176, v177
  ds_read_b64_tr_b16 v[54:55], v18 offset:41984
  s_waitcnt lgkmcnt(8)
  v_mfma_f32_16x16x32_bf16 v[68:71], v[36:39], v[220:223], v[68:71]
  v_cvt_pk_bf16_f32 v177, v178, v179
  v_cvt_pk_bf16_f32 v178, v180, v181
  ds_read_b64_tr_b16 v[56:57], v19 offset:32768
  ds_read_b64_tr_b16 v[58:59], v19 offset:33792
  s_waitcnt lgkmcnt(8)
  v_mfma_f32_16x16x32_bf16 v[72:75], v[40:43], v[208:211], 0
  s_setprio 0
  v_cvt_pk_bf16_f32 v179, v182, v183
  s_add_u32 m0, s58, 0x8c00
  s_movk_i32 s33, 0x5100
  buffer_load_dwordx4 v26, s[4:7], s33 offen lds
  ds_read_b64_tr_b16 v[60:61], v19 offset:40960
  v_mfma_f32_16x16x32_bf16 v[76:79], v[40:43], v[212:215], 0
  v_cvt_pk_bf16_f32 v136, v136, v137
  v_cvt_pk_bf16_f32 v137, v138, v139
  ds_read_b64_tr_b16 v[62:63], v19 offset:41984
  s_waitcnt lgkmcnt(8)
  v_mfma_f32_16x16x32_bf16 v[72:75], v[44:47], v[216:219], v[72:75]
  v_cvt_pk_bf16_f32 v138, v140, v141
  v_cvt_pk_bf16_f32 v139, v142, v143
  v_mfma_f32_16x16x32_bf16 v[76:79], v[44:47], v[220:223], v[76:79]
  v_cvt_pk_bf16_f32 v152, v152, v153
  s_add_u32 s33, s44, 0x0
  buffer_store_dwordx4 v[224:227], v2, s[12:15], s33 offen offset:0 sc1
  s_waitcnt lgkmcnt(6)
  v_mfma_f32_16x16x32_bf16 v[80:83], v[48:51], v[208:211], 0
  v_cvt_pk_bf16_f32 v153, v154, v155
  v_cvt_pk_bf16_f32 v154, v156, v157
  ds_read_b64_tr_b16 v[32:33], v20 offset:32768
  ds_read_b64_tr_b16 v[34:35], v20 offset:33792
  s_add_u32 m0, s58, 0x10000
  s_movk_i32 s33, 0x180
  buffer_load_dwordx4 v25, s[4:7], s33 offen lds
  v_mfma_f32_16x16x32_bf16 v[84:87], v[48:51], v[212:215], 0
  v_cvt_pk_bf16_f32 v155, v158, v159
  ds_read_b64_tr_b16 v[36:37], v20 offset:40960
  s_waitcnt lgkmcnt(7)
  v_mfma_f32_16x16x32_bf16 v[80:83], v[52:55], v[216:219], v[80:83]
  v_cvt_pk_bf16_f32 v168, v168, v169
  v_cvt_pk_bf16_f32 v169, v170, v171
  ds_read_b64_tr_b16 v[38:39], v20 offset:41984
  v_mfma_f32_16x16x32_bf16 v[84:87], v[52:55], v[220:223], v[84:87]
  v_cvt_pk_bf16_f32 v170, v172, v173
  v_cvt_pk_bf16_f32 v171, v174, v175
  ds_read_b64_tr_b16 v[40:41], v21 offset:32768
  ds_read_b64_tr_b16 v[42:43], v21 offset:33792
  s_waitcnt lgkmcnt(8)
  v_mfma_f32_16x16x32_bf16 v[88:91], v[56:59], v[208:211], 0
  v_cvt_pk_bf16_f32 v184, v184, v185
  ds_read_b64_tr_b16 v[44:45], v21 offset:40960
  s_add_u32 m0, s58, 0x10400
  s_movk_i32 s33, 0x180
  buffer_load_dwordx4 v26, s[4:7], s33 offen lds
  v_mfma_f32_16x16x32_bf16 v[92:95], v[56:59], v[212:215], 0
  v_cvt_pk_bf16_f32 v185, v186, v187
  v_cvt_pk_bf16_f32 v186, v188, v189
  ds_read_b64_tr_b16 v[46:47], v21 offset:41984
  s_waitcnt lgkmcnt(8)
  v_mfma_f32_16x16x32_bf16 v[88:91], v[60:63], v[216:219], v[88:91]
  v_cvt_pk_bf16_f32 v187, v190, v191
  v_mfma_f32_16x16x32_bf16 v[92:95], v[60:63], v[220:223], v[92:95]
  s_waitcnt lgkmcnt(6)
  v_mfma_f32_16x16x32_bf16 v[96:99], v[32:35], v[208:211], 0
  ds_read_b64_tr_b16 v[48:49], v22 offset:32768
  ds_read_b64_tr_b16 v[50:51], v22 offset:33792
  s_add_u32 m0, s58, 0x10800
  s_movk_i32 s33, 0x5180
  buffer_load_dwordx4 v25, s[4:7], s33 offen lds
  v_mfma_f32_16x16x32_bf16 v[100:103], v[32:35], v[212:215], 0
  ds_read_b64_tr_b16 v[52:53], v22 offset:40960
  s_waitcnt lgkmcnt(7)
  v_mfma_f32_16x16x32_bf16 v[96:99], v[36:39], v[216:219], v[96:99]
  ds_read_b64_tr_b16 v[54:55], v22 offset:41984
  v_mfma_f32_16x16x32_bf16 v[100:103], v[36:39], v[220:223], v[100:103]
  ds_read_b64_tr_b16 v[56:57], v23 offset:32768
  ds_read_b64_tr_b16 v[58:59], v23 offset:33792
  s_waitcnt lgkmcnt(8)
  v_mfma_f32_16x16x32_bf16 v[104:107], v[40:43], v[208:211], 0
  ds_read_b64_tr_b16 v[60:61], v23 offset:40960
  s_add_u32 m0, s58, 0x10c00
  s_movk_i32 s33, 0x5180
  buffer_load_dwordx4 v26, s[4:7], s33 offen lds
  v_mfma_f32_16x16x32_bf16 v[108:111], v[40:43], v[212:215], 0
  ds_read_b64_tr_b16 v[62:63], v23 offset:41984
  s_waitcnt lgkmcnt(8)
  v_mfma_f32_16x16x32_bf16 v[104:107], v[44:47], v[216:219], v[104:107]
  v_mfma_f32_16x16x32_bf16 v[108:111], v[44:47], v[220:223], v[108:111]
  s_waitcnt lgkmcnt(6)
  v_mfma_f32_16x16x32_bf16 v[112:115], v[48:51], v[208:211], 0
  v_mfma_f32_16x16x32_bf16 v[116:119], v[48:51], v[212:215], 0
  s_add_u32 s33, s44, 0x1000
  buffer_store_dwordx4 v[228:231], v2, s[12:15], s33 offen offset:0 sc1
  s_waitcnt lgkmcnt(0)
  s_waitcnt vmcnt(12)
  s_barrier
  s_setprio 3
  ds_read_b64_tr_b16 v[32:33], v16 offset:49152
  ds_read_b64_tr_b16 v[34:35], v16 offset:50176
  v_mfma_f32_16x16x32_bf16 v[112:115], v[52:55], v[216:219], v[112:115]
  ds_read_b128 v[192:195], v27 offset:0
  ds_read_b128 v[196:199], v27 offset:2048
  v_mfma_f32_16x16x32_bf16 v[116:119], v[52:55], v[220:223], v[116:119]
  ds_read_b64_tr_b16 v[36:37], v16 offset:57344
  ds_read_b64_tr_b16 v[38:39], v16 offset:58368
  v_mfma_f32_16x16x32_bf16 v[120:123], v[56:59], v[208:211], 0
  ds_read_b128 v[200:203], v28 offset:0
  ds_read_b128 v[204:207], v28 offset:2048
  s_add_u32 m0, s59, 0x20000
  s_mov_b32 s32, 0x200000
  buffer_load_dwordx4 v24, s[8:11], s32 offen lds
  v_mfma_f32_16x16x32_bf16 v[124:127], v[56:59], v[212:215], 0
  ds_read_b64_tr_b16 v[40:41], v17 offset:49152
  ds_read_b64_tr_b16 v[42:43], v17 offset:50176
  v_mfma_f32_16x16x32_bf16 v[120:123], v[60:63], v[216:219], v[120:123]
  ds_read_b64_tr_b16 v[44:45], v17 offset:57344
  ds_read_b64_tr_b16 v[46:47], v17 offset:58368
  v_mfma_f32_16x16x32_bf16 v[124:127], v[60:63], v[220:223], v[124:127]
  s_waitcnt lgkmcnt(10)
  s_waitcnt lgkmcnt(9)
  v_mfma_f32_16x16x32_bf16 v[64:67], v[32:35], v[192:195], v[64:67]
  s_add_u32 m0, s59, 0x20400
  s_mov_b32 s32, 0x208000
  buffer_load_dwordx4 v24, s[8:11], s32 offen lds
  ds_read_b64_tr_b16 v[48:49], v18 offset:49152
  ds_read_b64_tr_b16 v[50:51], v18 offset:50176
  s_waitcnt lgkmcnt(10)
  v_mfma_f32_16x16x32_bf16 v[68:71], v[32:35], v[196:199], v[68:71]
  s_setprio 2
  ds_read_b64_tr_b16 v[52:53], v18 offset:57344
  s_waitcnt lgkmcnt(9)
  s_waitcnt lgkmcnt(8)
  v_mfma_f32_16x16x32_bf16 v[64:67], v[36:39], v[200:203], v[64:67]
  ds_read_b64_tr_b16 v[54:55], v18 offset:58368
  s_waitcnt lgkmcnt(8)
  v_mfma_f32_16x16x32_bf16 v[68:71], v[36:39], v[204:207], v[68:71]
  ds_read_b64_tr_b16 v[56:57], v19 offset:49152
  ds_read_b64_tr_b16 v[58:59], v19 offset:50176
  s_waitcnt lgkmcnt(8)
  v_mfma_f32_16x16x32_bf16 v[72:75], v[40:43], v[192:195], v[72:75]
  ds_read_b64_tr_b16 v[60:61], v19 offset:57344
  v_mfma_f32_16x16x32_bf16 v[76:79], v[40:43], v[196:199], v[76:79]
  ds_read_b64_tr_b16 v[62:63], v19 offset:58368
  s_waitcnt lgkmcnt(8)
  v_mfma_f32_16x16x32_bf16 v[72:75], v[44:47], v[200:203], v[72:75]
  v_mfma_f32_16x16x32_bf16 v[76:79], v[44:47], v[204:207], v[76:79]
  s_waitcnt lgkmcnt(6)
  v_mfma_f32_16x16x32_bf16 v[80:83], v[48:51], v[192:195], v[80:83]
  ds_read_b64_tr_b16 v[32:33], v20 offset:49152
  ds_read_b64_tr_b16 v[34:35], v20 offset:50176
  s_add_u32 m0, s58, 0x0
  s_movk_i32 s33, 0x200
  buffer_load_dwordx4 v25, s[4:7], s33 offen lds
  v_mfma_f32_16x16x32_bf16 v[84:87], v[48:51], v[196:199], v[84:87]
  s_setprio 1
  ds_read_b64_tr_b16 v[36:37], v20 offset:57344
  s_waitcnt lgkmcnt(7)
  v_mfma_f32_16x16x32_bf16 v[80:83], v[52:55], v[200:203], v[80:83]
  ds_read_b64_tr_b16 v[38:39], v20 offset:58368
  v_mfma_f32_16x16x32_bf16 v[84:87], v[52:55], v[204:207], v[84:87]
  s_add_u32 s33, s45, 0x0
  buffer_store_dwordx4 v[128:131], v2, s[12:15], s33 offen offset:0 sc1
  ds_read_b64_tr_b16 v[40:41], v21 offset:49152
  ds_read_b64_tr_b16 v[42:43], v21 offset:50176
  s_waitcnt lgkmcnt(8)
  v_mfma_f32_16x16x32_bf16 v[88:91], v[56:59], v[192:195], v[88:91]
  ds_read_b64_tr_b16 v[44:45], v21 offset:57344
  s_add_u32 m0, s58, 0x400
  s_movk_i32 s33, 0x200
  buffer_load_dwordx4 v26, s[4:7], s33 offen lds
  v_mfma_f32_16x16x32_bf16 v[92:95], v[56:59], v[196:199], v[92:95]
  ds_read_b64_tr_b16 v[46:47], v21 offset:58368
  s_waitcnt lgkmcnt(8)
  v_mfma_f32_16x16x32_bf16 v[88:91], v[60:63], v[200:203], v[88:91]
  v_mfma_f32_16x16x32_bf16 v[92:95], v[60:63], v[204:207], v[92:95]
  s_waitcnt lgkmcnt(6)
  v_mfma_f32_16x16x32_bf16 v[96:99], v[32:35], v[192:195], v[96:99]
  ds_read_b64_tr_b16 v[48:49], v22 offset:49152
  ds_read_b64_tr_b16 v[50:51], v22 offset:50176
  s_add_u32 m0, s58, 0x800
  s_movk_i32 s33, 0x5200
  buffer_load_dwordx4 v25, s[4:7], s33 offen lds
  v_mfma_f32_16x16x32_bf16 v[100:103], v[32:35], v[196:199], v[100:103]
  s_setprio 0
  ds_read_b64_tr_b16 v[52:53], v22 offset:57344
  s_waitcnt lgkmcnt(7)
  v_mfma_f32_16x16x32_bf16 v[96:99], v[36:39], v[200:203], v[96:99]
  ds_read_b64_tr_b16 v[54:55], v22 offset:58368
  v_mfma_f32_16x16x32_bf16 v[100:103], v[36:39], v[204:207], v[100:103]
  ds_read_b64_tr_b16 v[56:57], v23 offset:49152
  ds_read_b64_tr_b16 v[58:59], v23 offset:50176
  s_waitcnt lgkmcnt(8)
  v_mfma_f32_16x16x32_bf16 v[104:107], v[40:43], v[192:195], v[104:107]
  ds_read_b64_tr_b16 v[60:61], v23 offset:57344
  s_add_u32 m0, s58, 0xc00
  s_movk_i32 s33, 0x5200
  buffer_load_dwordx4 v26, s[4:7], s33 offen lds
  v_mfma_f32_16x16x32_bf16 v[108:111], v[40:43], v[196:199], v[108:111]
  ds_read_b64_tr_b16 v[62:63], v23 offset:58368
  s_waitcnt lgkmcnt(8)
  v_mfma_f32_16x16x32_bf16 v[104:107], v[44:47], v[200:203], v[104:107]
  v_mfma_f32_16x16x32_bf16 v[108:111], v[44:47], v[204:207], v[108:111]
  s_waitcnt lgkmcnt(6)
  v_mfma_f32_16x16x32_bf16 v[112:115], v[48:51], v[192:195], v[112:115]
  v_mfma_f32_16x16x32_bf16 v[116:119], v[48:51], v[196:199], v[116:119]
  s_waitcnt lgkmcnt(0)
  s_waitcnt vmcnt(13)
  s_barrier
  s_setprio 3
  ds_read_b64_tr_b16 v[32:33], v16 offset:0
  ds_read_b64_tr_b16 v[34:35], v16 offset:1024
  v_mfma_f32_16x16x32_bf16 v[112:115], v[52:55], v[200:203], v[112:115]
  ds_read_b128 v[208:211], v27 offset:32768
  ds_read_b128 v[212:215], v27 offset:34816
  v_mfma_f32_16x16x32_bf16 v[116:119], v[52:55], v[204:207], v[116:119]
  ds_read_b64_tr_b16 v[36:37], v16 offset:8192
  ds_read_b64_tr_b16 v[38:39], v16 offset:9216
  v_mfma_f32_16x16x32_bf16 v[120:123], v[56:59], v[192:195], v[120:123]
  ds_read_b128 v[216:219], v28 offset:32768
  ds_read_b128 v[220:223], v28 offset:34816
  s_add_u32 m0, s59, 0x24000
  s_mov_b32 s32, 0x280000
  buffer_load_dwordx4 v24, s[8:11], s32 offen lds
  v_mfma_f32_16x16x32_bf16 v[124:127], v[56:59], v[196:199], v[124:127]
  s_add_u32 s33, s45, 0x4000
  buffer_store_dwordx4 v[136:139], v2, s[12:15], s33 offen offset:0 sc1
  ds_read_b64_tr_b16 v[40:41], v17 offset:0
  ds_read_b64_tr_b16 v[42:43], v17 offset:1024
  v_mfma_f32_16x16x32_bf16 v[120:123], v[60:63], v[200:203], v[120:123]
  ds_read_b64_tr_b16 v[44:45], v17 offset:8192
  ds_read_b64_tr_b16 v[46:47], v17 offset:9216
  v_mfma_f32_16x16x32_bf16 v[124:127], v[60:63], v[204:207], v[124:127]
  s_waitcnt lgkmcnt(10)
  s_waitcnt lgkmcnt(9)
  v_mfma_f32_16x16x32_bf16 v[64:67], v[32:35], v[208:211], v[64:67]
  s_add_u32 m0, s59, 0x24400
  s_mov_b32 s32, 0x288000
  buffer_load_dwordx4 v24, s[8:11], s32 offen lds
  ds_read_b64_tr_b16 v[48:49], v18 offset:0
  ds_read_b64_tr_b16 v[50:51], v18 offset:1024
  s_waitcnt lgkmcnt(10)
  v_mfma_f32_16x16x32_bf16 v[68:71], v[32:35], v[212:215], v[68:71]
  s_setprio 2
  ds_read_b64_tr_b16 v[52:53], v18 offset:8192
  s_waitcnt lgkmcnt(9)
  s_waitcnt lgkmcnt(8)
  v_mfma_f32_16x16x32_bf16 v[64:67], v[36:39], v[216:219], v[64:67]
  ds_read_b64_tr_b16 v[54:55], v18 offset:9216
  s_waitcnt lgkmcnt(8)
  v_mfma_f32_16x16x32_bf16 v[68:71], v[36:39], v[220:223], v[68:71]
  ds_read_b64_tr_b16 v[56:57], v19 offset:0
  ds_read_b64_tr_b16 v[58:59], v19 offset:1024
  s_waitcnt lgkmcnt(8)
  v_mfma_f32_16x16x32_bf16 v[72:75], v[40:43], v[208:211], v[72:75]
  ds_read_b64_tr_b16 v[60:61], v19 offset:8192
  v_mfma_f32_16x16x32_bf16 v[76:79], v[40:43], v[212:215], v[76:79]
  ds_read_b64_tr_b16 v[62:63], v19 offset:9216
  s_waitcnt lgkmcnt(8)
  v_mfma_f32_16x16x32_bf16 v[72:75], v[44:47], v[216:219], v[72:75]
  v_mfma_f32_16x16x32_bf16 v[76:79], v[44:47], v[220:223], v[76:79]
  s_waitcnt lgkmcnt(6)
  v_mfma_f32_16x16x32_bf16 v[80:83], v[48:51], v[208:211], v[80:83]
  ds_read_b64_tr_b16 v[32:33], v20 offset:0
  ds_read_b64_tr_b16 v[34:35], v20 offset:1024
  s_add_u32 m0, s58, 0x8000
  s_movk_i32 s33, 0x280
  buffer_load_dwordx4 v25, s[4:7], s33 offen lds
  v_mfma_f32_16x16x32_bf16 v[84:87], v[48:51], v[212:215], v[84:87]
  s_setprio 1
  ds_read_b64_tr_b16 v[36:37], v20 offset:8192
  s_waitcnt lgkmcnt(7)
  v_mfma_f32_16x16x32_bf16 v[80:83], v[52:55], v[216:219], v[80:83]
  ds_read_b64_tr_b16 v[38:39], v20 offset:9216
  v_mfma_f32_16x16x32_bf16 v[84:87], v[52:55], v[220:223], v[84:87]
  ds_read_b64_tr_b16 v[40:41], v21 offset:0
  ds_read_b64_tr_b16 v[42:43], v21 offset:1024
  s_waitcnt lgkmcnt(8)
  v_mfma_f32_16x16x32_bf16 v[88:91], v[56:59], v[208:211], v[88:91]
  ds_read_b64_tr_b16 v[44:45], v21 offset:8192
  s_add_u32 m0, s58, 0x8400
  s_movk_i32 s33, 0x280
  buffer_load_dwordx4 v26, s[4:7], s33 offen lds
  v_mfma_f32_16x16x32_bf16 v[92:95], v[56:59], v[212:215], v[92:95]
  ds_read_b64_tr_b16 v[46:47], v21 offset:9216
  s_waitcnt lgkmcnt(8)
  v_mfma_f32_16x16x32_bf16 v[88:91], v[60:63], v[216:219], v[88:91]
  v_mfma_f32_16x16x32_bf16 v[92:95], v[60:63], v[220:223], v[92:95]
  s_waitcnt lgkmcnt(6)
  v_mfma_f32_16x16x32_bf16 v[96:99], v[32:35], v[208:211], v[96:99]
  s_add_u32 s33, s45, 0x0
  buffer_store_dwordx4 v[144:147], v2, s[12:15], s33 offen offset:1024 sc1
  ds_read_b64_tr_b16 v[48:49], v22 offset:0
  ds_read_b64_tr_b16 v[50:51], v22 offset:1024
  s_add_u32 m0, s58, 0x8800
  s_movk_i32 s33, 0x5280
  buffer_load_dwordx4 v25, s[4:7], s33 offen lds
  v_mfma_f32_16x16x32_bf16 v[100:103], v[32:35], v[212:215], v[100:103]
  s_setprio 0
  ds_read_b64_tr_b16 v[52:53], v22 offset:8192
  s_waitcnt lgkmcnt(7)
  v_mfma_f32_16x16x32_bf16 v[96:99], v[36:39], v[216:219], v[96:99]
  ds_read_b64_tr_b16 v[54:55], v22 offset:9216
  v_mfma_f32_16x16x32_bf16 v[100:103], v[36:39], v[220:223], v[100:103]
  ds_read_b64_tr_b16 v[56:57], v23 offset:0
  ds_read_b64_tr_b16 v[58:59], v23 offset:1024
  s_waitcnt lgkmcnt(8)
  v_mfma_f32_16x16x32_bf16 v[104:107], v[40:43], v[208:211], v[104:107]
  ds_read_b64_tr_b16 v[60:61], v23 offset:8192
  s_add_u32 m0, s58, 0x8c00
  s_movk_i32 s33, 0x5280
  buffer_load_dwordx4 v26, s[4:7], s33 offen lds
  v_mfma_f32_16x16x32_bf16 v[108:111], v[40:43], v[212:215], v[108:111]
  ds_read_b64_tr_b16 v[62:63], v23 offset:9216
  s_waitcnt lgkmcnt(8)
  v_mfma_f32_16x16x32_bf16 v[104:107], v[44:47], v[216:219], v[104:107]
  v_mfma_f32_16x16x32_bf16 v[108:111], v[44:47], v[220:223], v[108:111]
  s_waitcnt lgkmcnt(6)
  v_mfma_f32_16x16x32_bf16 v[112:115], v[48:51], v[208:211], v[112:115]
  v_mfma_f32_16x16x32_bf16 v[116:119], v[48:51], v[212:215], v[116:119]
  s_waitcnt lgkmcnt(0)
  s_waitcnt vmcnt(16)
  s_barrier
  s_setprio 3
  ds_read_b64_tr_b16 v[32:33], v16 offset:16384
  ds_read_b64_tr_b16 v[34:35], v16 offset:17408
  v_mfma_f32_16x16x32_bf16 v[112:115], v[52:55], v[216:219], v[112:115]
  ds_read_b128 v[192:195], v29 offset:0
  ds_read_b128 v[196:199], v29 offset:2048
  v_mfma_f32_16x16x32_bf16 v[116:119], v[52:55], v[220:223], v[116:119]
  ds_read_b64_tr_b16 v[36:37], v16 offset:24576
  ds_read_b64_tr_b16 v[38:39], v16 offset:25600
  v_mfma_f32_16x16x32_bf16 v[120:123], v[56:59], v[208:211], v[120:123]
  ds_read_b128 v[200:203], v30 offset:0
  ds_read_b128 v[204:207], v30 offset:2048
  s_add_u32 m0, s59, 0x18000
  s_mov_b32 s32, 0x300000
  buffer_load_dwordx4 v24, s[8:11], s32 offen lds
  v_mfma_f32_16x16x32_bf16 v[124:127], v[56:59], v[212:215], v[124:127]
  ds_read_b64_tr_b16 v[40:41], v17 offset:16384
  ds_read_b64_tr_b16 v[42:43], v17 offset:17408
  v_mfma_f32_16x16x32_bf16 v[120:123], v[60:63], v[216:219], v[120:123]
  ds_read_b64_tr_b16 v[44:45], v17 offset:24576
  ds_read_b64_tr_b16 v[46:47], v17 offset:25600
  v_mfma_f32_16x16x32_bf16 v[124:127], v[60:63], v[220:223], v[124:127]
  s_waitcnt lgkmcnt(10)
  s_waitcnt lgkmcnt(9)
  v_mfma_f32_16x16x32_bf16 v[64:67], v[32:35], v[192:195], v[64:67]
  s_add_u32 m0, s59, 0x18400
  s_mov_b32 s32, 0x308000
  buffer_load_dwordx4 v24, s[8:11], s32 offen lds
  ds_read_b64_tr_b16 v[48:49], v18 offset:16384
  ds_read_b64_tr_b16 v[50:51], v18 offset:17408
  s_waitcnt lgkmcnt(10)
  v_mfma_f32_16x16x32_bf16 v[68:71], v[32:35], v[196:199], v[68:71]
  s_setprio 2
  ds_read_b64_tr_b16 v[52:53], v18 offset:24576
  s_waitcnt lgkmcnt(9)
  s_waitcnt lgkmcnt(8)
  v_mfma_f32_16x16x32_bf16 v[64:67], v[36:39], v[200:203], v[64:67]
  s_add_u32 s33, s45, 0x4000
  buffer_store_dwordx4 v[152:155], v2, s[12:15], s33 offen offset:1024 sc1
  ds_read_b64_tr_b16 v[54:55], v18 offset:25600
  s_waitcnt lgkmcnt(8)
  v_mfma_f32_16x16x32_bf16 v[68:71], v[36:39], v[204:207], v[68:71]
  ds_read_b64_tr_b16 v[56:57], v19 offset:16384
  ds_read_b64_tr_b16 v[58:59], v19 offset:17408
  s_waitcnt lgkmcnt(8)
  v_mfma_f32_16x16x32_bf16 v[72:75], v[40:43], v[192:195], v[72:75]
  ds_read_b64_tr_b16 v[60:61], v19 offset:24576
  s_lshl_b32 s32, s37, 20
  s_add_u32 s16, s98, s32
  s_addc_u32 s17, s99, 0
  s_and_b32 s17, s17, 0xffff
  v_mfma_f32_16x16x32_bf16 v[76:79], v[40:43], v[196:199], v[76:79]
  ds_read_b64_tr_b16 v[62:63], v19 offset:25600
  s_waitcnt lgkmcnt(8)
  v_mfma_f32_16x16x32_bf16 v[72:75], v[44:47], v[200:203], v[72:75]
  v_mfma_f32_16x16x32_bf16 v[76:79], v[44:47], v[204:207], v[76:79]
  s_sub_u32 s32, 16, s36
  s_lshl_b32 s18, s32, 16
  s_mov_b32 s19, 0x00020000
  s_mov_b32 s63, s18
  s_waitcnt lgkmcnt(6)
  v_mfma_f32_16x16x32_bf16 v[80:83], v[48:51], v[192:195], v[80:83]
  ds_read_b64_tr_b16 v[32:33], v20 offset:16384
  ds_read_b64_tr_b16 v[34:35], v20 offset:17408
  s_add_u32 m0, s58, 0x10000
  s_movk_i32 s33, 0x300
  buffer_load_dwordx4 v25, s[4:7], s33 offen lds
  v_mfma_f32_16x16x32_bf16 v[84:87], v[48:51], v[196:199], v[84:87]
  s_setprio 1
  ds_read_b64_tr_b16 v[36:37], v20 offset:24576
  s_waitcnt lgkmcnt(7)
  v_mfma_f32_16x16x32_bf16 v[80:83], v[52:55], v[200:203], v[80:83]
  ds_read_b64_tr_b16 v[38:39], v20 offset:25600
  s_lshl_b32 s32, s37, 13
  s_add_u32 s56, s56, s32
  s_add_u32 s57, s57, s32
  v_mfma_f32_16x16x32_bf16 v[84:87], v[52:55], v[204:207], v[84:87]
  ds_read_b64_tr_b16 v[40:41], v21 offset:16384
  ds_read_b64_tr_b16 v[42:43], v21 offset:17408
  s_waitcnt lgkmcnt(8)
  v_mfma_f32_16x16x32_bf16 v[88:91], v[56:59], v[192:195], v[88:91]
  ds_read_b64_tr_b16 v[44:45], v21 offset:24576
  s_add_u32 m0, s58, 0x10400
  s_movk_i32 s33, 0x300
  buffer_load_dwordx4 v26, s[4:7], s33 offen lds
  v_mfma_f32_16x16x32_bf16 v[92:95], v[56:59], v[196:199], v[92:95]
  ds_read_b64_tr_b16 v[46:47], v21 offset:25600
  s_lshr_b32 s32, s3, 1
  s_lshl_b32 s32, s32, 14
  s_and_b32 s33, s3, 1
  s_lshl_b32 s33, s33, 12
  s_add_u32 s32, s32, s33
  v_add_u32 v12, s32, v2
  s_waitcnt lgkmcnt(8)
  v_mfma_f32_16x16x32_bf16 v[88:91], v[60:63], v[200:203], v[88:91]
  v_mfma_f32_16x16x32_bf16 v[92:95], v[60:63], v[204:207], v[92:95]
  s_waitcnt lgkmcnt(6)
  v_mfma_f32_16x16x32_bf16 v[96:99], v[32:35], v[192:195], v[96:99]
  ds_read_b64_tr_b16 v[48:49], v22 offset:16384
  ds_read_b64_tr_b16 v[50:51], v22 offset:17408
  s_add_u32 m0, s58, 0x10800
  s_movk_i32 s33, 0x5300
  buffer_load_dwordx4 v25, s[4:7], s33 offen lds
  s_lshr_b32 s32, s3, 2
  s_lshl_b32 s32, s32, 14
  s_and_b32 s33, s3, 3
  s_lshl_b32 s33, s33, 11
  s_add_u32 s32, s32, s33
  v_add_u32 v5, s32, v2
  v_mfma_f32_16x16x32_bf16 v[100:103], v[32:35], v[196:199], v[100:103]
  s_setprio 0
  ds_read_b64_tr_b16 v[52:53], v22 offset:24576
  s_waitcnt lgkmcnt(7)
  v_mfma_f32_16x16x32_bf16 v[96:99], v[36:39], v[200:203], v[96:99]
  ds_read_b64_tr_b16 v[54:55], v22 offset:25600
  v_mfma_f32_16x16x32_bf16 v[100:103], v[36:39], v[204:207], v[100:103]
  ds_read_b64_tr_b16 v[56:57], v23 offset:16384
  ds_read_b64_tr_b16 v[58:59], v23 offset:17408
  s_mov_b32 s52, s59
  s_add_u32 s54, s59, 0x8000
  s_waitcnt lgkmcnt(8)
  v_mfma_f32_16x16x32_bf16 v[104:107], v[40:43], v[192:195], v[104:107]
  s_add_u32 s33, s45, 0x0
  buffer_store_dwordx4 v[160:163], v2, s[12:15], s33 offen offset:2048 sc1
  ds_read_b64_tr_b16 v[60:61], v23 offset:24576
  s_add_u32 m0, s58, 0x10c00
  s_movk_i32 s33, 0x5300
  buffer_load_dwordx4 v26, s[4:7], s33 offen lds
  v_mfma_f32_16x16x32_bf16 v[108:111], v[40:43], v[196:199], v[108:111]
  ds_read_b64_tr_b16 v[62:63], v23 offset:25600
  s_waitcnt lgkmcnt(8)
  v_mfma_f32_16x16x32_bf16 v[104:107], v[44:47], v[200:203], v[104:107]
  s_mov_b32 s53, 0x20000
  s_mov_b32 s55, 0x12000
  v_mfma_f32_16x16x32_bf16 v[108:111], v[44:47], v[204:207], v[108:111]
  s_waitcnt lgkmcnt(6)
  v_mfma_f32_16x16x32_bf16 v[112:115], v[48:51], v[192:195], v[112:115]
  v_mfma_f32_16x16x32_bf16 v[116:119], v[48:51], v[196:199], v[116:119]
  s_waitcnt lgkmcnt(0)
  s_waitcnt vmcnt(16)
  s_barrier
  s_setprio 3
  ds_read_b64_tr_b16 v[32:33], v16 offset:32768
  ds_read_b64_tr_b16 v[34:35], v16 offset:33792
  s_lshl_b32 s32, s36, 1
  s_add_u32 s39, s32, 2
  v_mfma_f32_16x16x32_bf16 v[112:115], v[52:55], v[200:203], v[112:115]
  ds_read_b128 v[208:211], v27 offset:0
  ds_read_b128 v[212:215], v27 offset:2048
  v_mfma_f32_16x16x32_bf16 v[116:119], v[52:55], v[204:207], v[116:119]
  ds_read_b64_tr_b16 v[36:37], v16 offset:40960
  ds_read_b64_tr_b16 v[38:39], v16 offset:41984
  v_mfma_f32_16x16x32_bf16 v[120:123], v[56:59], v[192:195], v[120:123]
  ds_read_b128 v[216:219], v28 offset:0
  ds_read_b128 v[220:223], v28 offset:2048
  s_add_u32 m0, s59, 0x1c000
  s_mov_b32 s32, 0x380000
  buffer_load_dwordx4 v24, s[8:11], s32 offen lds
  s_mov_b32 s38, 0
  s_mov_b32 s41, 0
  v_mfma_f32_16x16x32_bf16 v[124:127], v[56:59], v[196:199], v[124:127]
  ds_read_b64_tr_b16 v[40:41], v17 offset:32768
  ds_read_b64_tr_b16 v[42:43], v17 offset:33792
  v_mfma_f32_16x16x32_bf16 v[120:123], v[60:63], v[200:203], v[120:123]
  ds_read_b64_tr_b16 v[44:45], v17 offset:40960
  ds_read_b64_tr_b16 v[46:47], v17 offset:41984
  v_mfma_f32_16x16x32_bf16 v[124:127], v[60:63], v[204:207], v[124:127]
  s_mov_b32 s42, 0x4e800000
  s_waitcnt lgkmcnt(10)
  s_waitcnt lgkmcnt(9)
  v_mfma_f32_16x16x32_bf16 v[64:67], v[32:35], v[208:211], v[64:67]
  s_add_u32 m0, s59, 0x1c400
  s_mov_b32 s32, 0x388000
  buffer_load_dwordx4 v24, s[8:11], s32 offen lds
  ds_read_b64_tr_b16 v[48:49], v18 offset:32768
  ds_read_b64_tr_b16 v[50:51], v18 offset:33792
  s_waitcnt lgkmcnt(10)
  v_mfma_f32_16x16x32_bf16 v[68:71], v[32:35], v[212:215], v[68:71]
  s_setprio 2
  ds_read_b64_tr_b16 v[52:53], v18 offset:40960
  s_waitcnt lgkmcnt(9)
  s_waitcnt lgkmcnt(8)
  v_mfma_f32_16x16x32_bf16 v[64:67], v[36:39], v[216:219], v[64:67]
  ds_read_b64_tr_b16 v[54:55], v18 offset:41984
  s_cmp_eq_u32 s3, 0
  s_cselect_b32 s60, 0x6003, 0
  s_waitcnt lgkmcnt(8)
  v_mfma_f32_16x16x32_bf16 v[68:71], v[36:39], v[220:223], v[68:71]
  ds_read_b64_tr_b16 v[56:57], v19 offset:32768
  ds_read_b64_tr_b16 v[58:59], v19 offset:33792
  s_waitcnt lgkmcnt(8)
  v_mfma_f32_16x16x32_bf16 v[72:75], v[40:43], v[208:211], v[72:75]
  ds_read_b64_tr_b16 v[60:61], v19 offset:40960
  v_mfma_f32_16x16x32_bf16 v[76:79], v[40:43], v[212:215], v[76:79]
  ds_read_b64_tr_b16 v[62:63], v19 offset:41984
  s_waitcnt lgkmcnt(8)
  v_mfma_f32_16x16x32_bf16 v[72:75], v[44:47], v[216:219], v[72:75]
  v_mfma_f32_16x16x32_bf16 v[76:79], v[44:47], v[220:223], v[76:79]
  s_add_u32 s33, s45, 0x4000
  buffer_store_dwordx4 v[168:171], v2, s[12:15], s33 offen offset:2048 sc1
  s_waitcnt lgkmcnt(6)
  v_mfma_f32_16x16x32_bf16 v[80:83], v[48:51], v[208:211], v[80:83]
  ds_read_b64_tr_b16 v[32:33], v20 offset:32768
  ds_read_b64_tr_b16 v[34:35], v20 offset:33792
  s_add_u32 m0, s58, 0x0
  s_movk_i32 s33, 0x380
  buffer_load_dwordx4 v25, s[4:7], s33 offen lds
  v_mfma_f32_16x16x32_bf16 v[84:87], v[48:51], v[212:215], v[84:87]
  s_setprio 1
  ds_read_b64_tr_b16 v[36:37], v20 offset:40960
  s_waitcnt lgkmcnt(7)
  v_mfma_f32_16x16x32_bf16 v[80:83], v[52:55], v[216:219], v[80:83]
  ds_read_b64_tr_b16 v[38:39], v20 offset:41984
  v_mfma_f32_16x16x32_bf16 v[84:87], v[52:55], v[220:223], v[84:87]
  ds_read_b64_tr_b16 v[40:41], v21 offset:32768
  ds_read_b64_tr_b16 v[42:43], v21 offset:33792
  s_waitcnt lgkmcnt(8)
  v_mfma_f32_16x16x32_bf16 v[88:91], v[56:59], v[208:211], v[88:91]
  ds_read_b64_tr_b16 v[44:45], v21 offset:40960
  s_add_u32 m0, s58, 0x400
  s_movk_i32 s33, 0x380
  buffer_load_dwordx4 v26, s[4:7], s33 offen lds
  v_mfma_f32_16x16x32_bf16 v[92:95], v[56:59], v[212:215], v[92:95]
  ds_read_b64_tr_b16 v[46:47], v21 offset:41984
  s_waitcnt lgkmcnt(8)
  v_mfma_f32_16x16x32_bf16 v[88:91], v[60:63], v[216:219], v[88:91]
  v_mfma_f32_16x16x32_bf16 v[92:95], v[60:63], v[220:223], v[92:95]
  s_waitcnt lgkmcnt(6)
  v_mfma_f32_16x16x32_bf16 v[96:99], v[32:35], v[208:211], v[96:99]
  ds_read_b64_tr_b16 v[48:49], v22 offset:32768
  ds_read_b64_tr_b16 v[50:51], v22 offset:33792
  s_add_u32 m0, s58, 0x800
  s_movk_i32 s33, 0x5380
  buffer_load_dwordx4 v25, s[4:7], s33 offen lds
  v_mfma_f32_16x16x32_bf16 v[100:103], v[32:35], v[212:215], v[100:103]
  s_setprio 0
  ds_read_b64_tr_b16 v[52:53], v22 offset:40960
  s_waitcnt lgkmcnt(7)
  v_mfma_f32_16x16x32_bf16 v[96:99], v[36:39], v[216:219], v[96:99]
  ds_read_b64_tr_b16 v[54:55], v22 offset:41984
  v_mfma_f32_16x16x32_bf16 v[100:103], v[36:39], v[220:223], v[100:103]
  ds_read_b64_tr_b16 v[56:57], v23 offset:32768
  ds_read_b64_tr_b16 v[58:59], v23 offset:33792
  s_waitcnt lgkmcnt(8)
  v_mfma_f32_16x16x32_bf16 v[104:107], v[40:43], v[208:211], v[104:107]
  ds_read_b64_tr_b16 v[60:61], v23 offset:40960
  s_add_u32 m0, s58, 0xc00
  s_movk_i32 s33, 0x5380
  buffer_load_dwordx4 v26, s[4:7], s33 offen lds
  v_mfma_f32_16x16x32_bf16 v[108:111], v[40:43], v[212:215], v[108:111]
  ds_read_b64_tr_b16 v[62:63], v23 offset:41984
  s_waitcnt lgkmcnt(8)
  v_mfma_f32_16x16x32_bf16 v[104:107], v[44:47], v[216:219], v[104:107]
  v_mfma_f32_16x16x32_bf16 v[108:111], v[44:47], v[220:223], v[108:111]
  s_waitcnt lgkmcnt(6)
  v_mfma_f32_16x16x32_bf16 v[112:115], v[48:51], v[208:211], v[112:115]
  v_mfma_f32_16x16x32_bf16 v[116:119], v[48:51], v[212:215], v[116:119]
  s_add_u32 s33, s45, 0x0
  buffer_store_dwordx4 v[176:179], v2, s[12:15], s33 offen offset:3072 sc1
  s_waitcnt lgkmcnt(0)
  s_waitcnt vmcnt(16)
  s_barrier
  s_setprio 3
  ds_read_b64_tr_b16 v[32:33], v16 offset:49152
  ds_read_b64_tr_b16 v[34:35], v16 offset:50176
  v_mfma_f32_16x16x32_bf16 v[112:115], v[52:55], v[216:219], v[112:115]
  ds_read_b128 v[192:195], v27 offset:32768
  ds_read_b128 v[196:199], v27 offset:34816
  v_mfma_f32_16x16x32_bf16 v[116:119], v[52:55], v[220:223], v[116:119]
  ds_read_b64_tr_b16 v[36:37], v16 offset:57344
  ds_read_b64_tr_b16 v[38:39], v16 offset:58368
  v_mfma_f32_16x16x32_bf16 v[120:123], v[56:59], v[208:211], v[120:123]
  ds_read_b128 v[200:203], v28 offset:32768
  ds_read_b128 v[204:207], v28 offset:34816
  s_add_u32 m0, s59, 0x20000
  s_mov_b32 s32, 0x400000
  buffer_load_dwordx4 v24, s[8:11], s32 offen lds
  v_mfma_f32_16x16x32_bf16 v[124:127], v[56:59], v[212:215], v[124:127]
  ds_read_b64_tr_b16 v[40:41], v17 offset:49152
  ds_read_b64_tr_b16 v[42:43], v17 offset:50176
  v_mfma_f32_16x16x32_bf16 v[120:123], v[60:63], v[216:219], v[120:123]
  ds_read_b64_tr_b16 v[44:45], v17 offset:57344
  ds_read_b64_tr_b16 v[46:47], v17 offset:58368
  v_mfma_f32_16x16x32_bf16 v[124:127], v[60:63], v[220:223], v[124:127]
  s_waitcnt lgkmcnt(10)
  s_waitcnt lgkmcnt(9)
  v_mfma_f32_16x16x32_bf16 v[64:67], v[32:35], v[192:195], v[64:67]
  s_add_u32 m0, s59, 0x20400
  s_mov_b32 s32, 0x408000
  buffer_load_dwordx4 v24, s[8:11], s32 offen lds
  ds_read_b64_tr_b16 v[48:49], v18 offset:49152
  ds_read_b64_tr_b16 v[50:51], v18 offset:50176
  s_waitcnt lgkmcnt(10)
  v_mfma_f32_16x16x32_bf16 v[68:71], v[32:35], v[196:199], v[68:71]
  s_setprio 2
  ds_read_b64_tr_b16 v[52:53], v18 offset:57344
  s_waitcnt lgkmcnt(9)
  s_waitcnt lgkmcnt(8)
  v_mfma_f32_16x16x32_bf16 v[64:67], v[36:39], v[200:203], v[64:67]
  ds_read_b64_tr_b16 v[54:55], v18 offset:58368
  s_waitcnt lgkmcnt(8)
  v_mfma_f32_16x16x32_bf16 v[68:71], v[36:39], v[204:207], v[68:71]
  ds_read_b64_tr_b16 v[56:57], v19 offset:49152
  ds_read_b64_tr_b16 v[58:59], v19 offset:50176
  s_waitcnt lgkmcnt(8)
  v_mfma_f32_16x16x32_bf16 v[72:75], v[40:43], v[192:195], v[72:75]
  ds_read_b64_tr_b16 v[60:61], v19 offset:57344
  v_mfma_f32_16x16x32_bf16 v[76:79], v[40:43], v[196:199], v[76:79]
  ds_read_b64_tr_b16 v[62:63], v19 offset:58368
  s_waitcnt lgkmcnt(8)
  v_mfma_f32_16x16x32_bf16 v[72:75], v[44:47], v[200:203], v[72:75]
  v_mfma_f32_16x16x32_bf16 v[76:79], v[44:47], v[204:207], v[76:79]
  s_waitcnt lgkmcnt(6)
  v_mfma_f32_16x16x32_bf16 v[80:83], v[48:51], v[192:195], v[80:83]
  ds_read_b64_tr_b16 v[32:33], v20 offset:49152
  ds_read_b64_tr_b16 v[34:35], v20 offset:50176
  s_add_u32 m0, s58, 0x8000
  s_movk_i32 s33, 0x400
  buffer_load_dwordx4 v25, s[4:7], s33 offen lds
  v_mfma_f32_16x16x32_bf16 v[84:87], v[48:51], v[196:199], v[84:87]
  s_setprio 1
  ds_read_b64_tr_b16 v[36:37], v20 offset:57344
  s_waitcnt lgkmcnt(7)
  v_mfma_f32_16x16x32_bf16 v[80:83], v[52:55], v[200:203], v[80:83]
  ds_read_b64_tr_b16 v[38:39], v20 offset:58368
  v_mfma_f32_16x16x32_bf16 v[84:87], v[52:55], v[204:207], v[84:87]
  s_add_u32 s33, s45, 0x4000
  buffer_store_dwordx4 v[184:187], v2, s[12:15], s33 offen offset:3072 sc1
  ds_read_b64_tr_b16 v[40:41], v21 offset:49152
  ds_read_b64_tr_b16 v[42:43], v21 offset:50176
  s_waitcnt lgkmcnt(8)
  v_mfma_f32_16x16x32_bf16 v[88:91], v[56:59], v[192:195], v[88:91]
  ds_read_b64_tr_b16 v[44:45], v21 offset:57344
  s_add_u32 m0, s58, 0x8400
  s_movk_i32 s33, 0x400
  buffer_load_dwordx4 v26, s[4:7], s33 offen lds
  v_mfma_f32_16x16x32_bf16 v[92:95], v[56:59], v[196:199], v[92:95]
  ds_read_b64_tr_b16 v[46:47], v21 offset:58368
  s_waitcnt lgkmcnt(8)
  v_mfma_f32_16x16x32_bf16 v[88:91], v[60:63], v[200:203], v[88:91]
  v_mfma_f32_16x16x32_bf16 v[92:95], v[60:63], v[204:207], v[92:95]
  s_waitcnt lgkmcnt(6)
  v_mfma_f32_16x16x32_bf16 v[96:99], v[32:35], v[192:195], v[96:99]
  ds_read_b64_tr_b16 v[48:49], v22 offset:49152
  ds_read_b64_tr_b16 v[50:51], v22 offset:50176
  s_add_u32 m0, s58, 0x8800
  s_movk_i32 s33, 0x5400
  buffer_load_dwordx4 v25, s[4:7], s33 offen lds
  v_mfma_f32_16x16x32_bf16 v[100:103], v[32:35], v[196:199], v[100:103]
  s_setprio 0
  ds_read_b64_tr_b16 v[52:53], v22 offset:57344
  s_waitcnt lgkmcnt(7)
  v_mfma_f32_16x16x32_bf16 v[96:99], v[36:39], v[200:203], v[96:99]
  ds_read_b64_tr_b16 v[54:55], v22 offset:58368
  v_mfma_f32_16x16x32_bf16 v[100:103], v[36:39], v[204:207], v[100:103]
  ds_read_b64_tr_b16 v[56:57], v23 offset:49152
  ds_read_b64_tr_b16 v[58:59], v23 offset:50176
  s_waitcnt lgkmcnt(8)
  v_mfma_f32_16x16x32_bf16 v[104:107], v[40:43], v[192:195], v[104:107]
  ds_read_b64_tr_b16 v[60:61], v23 offset:57344
  s_add_u32 m0, s58, 0x8c00
  s_movk_i32 s33, 0x5400
  buffer_load_dwordx4 v26, s[4:7], s33 offen lds
  v_mfma_f32_16x16x32_bf16 v[108:111], v[40:43], v[196:199], v[108:111]
  ds_read_b64_tr_b16 v[62:63], v23 offset:58368
  s_waitcnt lgkmcnt(8)
  v_mfma_f32_16x16x32_bf16 v[104:107], v[44:47], v[200:203], v[104:107]
  v_mfma_f32_16x16x32_bf16 v[108:111], v[44:47], v[204:207], v[108:111]
  s_waitcnt lgkmcnt(6)
  v_mfma_f32_16x16x32_bf16 v[112:115], v[48:51], v[192:195], v[112:115]
  s_lshl_b32 s32, s37, 7
  s_add_u32 s32, s32, 0xc000
  v_lshrrev_b32 v31, 1, v1
  v_add_lshl_u32 v31, v31, s3, 20
  v_lshl_add_u32 v31, v1, 2, v31
  buffer_load_dword v15, v31, s[24:27], s32 offen sc1
  v_mfma_f32_16x16x32_bf16 v[116:119], v[48:51], v[196:199], v[116:119]
  s_waitcnt lgkmcnt(0)
  s_waitcnt vmcnt(16)
  s_barrier
  s_setprio 3
  ds_read_b64_tr_b16 v[32:33], v16 offset:0
  ds_read_b64_tr_b16 v[34:35], v16 offset:1024
  v_mfma_f32_16x16x32_bf16 v[112:115], v[52:55], v[200:203], v[112:115]
  ds_read_b128 v[208:211], v29 offset:0
  ds_read_b128 v[212:215], v29 offset:2048
  v_mfma_f32_16x16x32_bf16 v[116:119], v[52:55], v[204:207], v[116:119]
  ds_read_b64_tr_b16 v[36:37], v16 offset:8192
  ds_read_b64_tr_b16 v[38:39], v16 offset:9216
  v_mfma_f32_16x16x32_bf16 v[120:123], v[56:59], v[192:195], v[120:123]
  ds_read_b128 v[216:219], v30 offset:0
  ds_read_b128 v[220:223], v30 offset:2048
  s_add_u32 m0, s59, 0x24000
  s_mov_b32 s32, 0x480000
  buffer_load_dwordx4 v24, s[8:11], s32 offen lds
  v_mfma_f32_16x16x32_bf16 v[124:127], v[56:59], v[196:199], v[124:127]
  ds_read_b64_tr_b16 v[40:41], v17 offset:0
  ds_read_b64_tr_b16 v[42:43], v17 offset:1024
  v_mfma_f32_16x16x32_bf16 v[120:123], v[60:63], v[200:203], v[120:123]
  s_add_u32 s33, s44, 0x4000
  buffer_store_dwordx4 v[232:235], v2, s[12:15], s33 offen offset:0 sc1
  ds_read_b64_tr_b16 v[44:45], v17 offset:8192
  ds_read_b64_tr_b16 v[46:47], v17 offset:9216
  v_mfma_f32_16x16x32_bf16 v[124:127], v[60:63], v[204:207], v[124:127]
  s_waitcnt lgkmcnt(10)
  s_waitcnt lgkmcnt(9)
  v_mfma_f32_16x16x32_bf16 v[64:67], v[32:35], v[208:211], v[64:67]
  s_add_u32 m0, s59, 0x24400
  s_mov_b32 s32, 0x488000
  buffer_load_dwordx4 v24, s[8:11], s32 offen lds
  ds_read_b64_tr_b16 v[48:49], v18 offset:0
  ds_read_b64_tr_b16 v[50:51], v18 offset:1024
  s_waitcnt lgkmcnt(10)
  v_mfma_f32_16x16x32_bf16 v[68:71], v[32:35], v[212:215], v[68:71]
  s_setprio 2
  ds_read_b64_tr_b16 v[52:53], v18 offset:8192
  s_waitcnt lgkmcnt(9)
  s_waitcnt lgkmcnt(8)
  v_mfma_f32_16x16x32_bf16 v[64:67], v[36:39], v[216:219], v[64:67]
  ds_read_b64_tr_b16 v[54:55], v18 offset:9216
  s_waitcnt lgkmcnt(8)
  v_mfma_f32_16x16x32_bf16 v[68:71], v[36:39], v[220:223], v[68:71]
  ds_read_b64_tr_b16 v[56:57], v19 offset:0
  ds_read_b64_tr_b16 v[58:59], v19 offset:1024
  s_waitcnt lgkmcnt(8)
  v_mfma_f32_16x16x32_bf16 v[72:75], v[40:43], v[208:211], v[72:75]
  ds_read_b64_tr_b16 v[60:61], v19 offset:8192
  v_mfma_f32_16x16x32_bf16 v[76:79], v[40:43], v[212:215], v[76:79]
  ds_read_b64_tr_b16 v[62:63], v19 offset:9216
  s_waitcnt lgkmcnt(8)
  v_mfma_f32_16x16x32_bf16 v[72:75], v[44:47], v[216:219], v[72:75]
  v_mfma_f32_16x16x32_bf16 v[76:79], v[44:47], v[220:223], v[76:79]
  s_waitcnt lgkmcnt(6)
  v_mfma_f32_16x16x32_bf16 v[80:83], v[48:51], v[208:211], v[80:83]
  ds_read_b64_tr_b16 v[32:33], v20 offset:0
  ds_read_b64_tr_b16 v[34:35], v20 offset:1024
  s_add_u32 m0, s58, 0x10000
  s_movk_i32 s33, 0x480
  buffer_load_dwordx4 v25, s[4:7], s33 offen lds
  v_mfma_f32_16x16x32_bf16 v[84:87], v[48:51], v[212:215], v[84:87]
  s_setprio 1
  ds_read_b64_tr_b16 v[36:37], v20 offset:8192
  s_waitcnt lgkmcnt(7)
  v_mfma_f32_16x16x32_bf16 v[80:83], v[52:55], v[216:219], v[80:83]
  ds_read_b64_tr_b16 v[38:39], v20 offset:9216
  v_mfma_f32_16x16x32_bf16 v[84:87], v[52:55], v[220:223], v[84:87]
  ds_read_b64_tr_b16 v[40:41], v21 offset:0
  ds_read_b64_tr_b16 v[42:43], v21 offset:1024
  s_waitcnt lgkmcnt(8)
  v_mfma_f32_16x16x32_bf16 v[88:91], v[56:59], v[208:211], v[88:91]
  ds_read_b64_tr_b16 v[44:45], v21 offset:8192
  s_add_u32 m0, s58, 0x10400
  s_movk_i32 s33, 0x480
  buffer_load_dwordx4 v26, s[4:7], s33 offen lds
  v_mfma_f32_16x16x32_bf16 v[92:95], v[56:59], v[212:215], v[92:95]
  ds_read_b64_tr_b16 v[46:47], v21 offset:9216
  s_waitcnt lgkmcnt(8)
  v_mfma_f32_16x16x32_bf16 v[88:91], v[60:63], v[216:219], v[88:91]
  v_mfma_f32_16x16x32_bf16 v[92:95], v[60:63], v[220:223], v[92:95]
  s_waitcnt lgkmcnt(6)
  v_mfma_f32_16x16x32_bf16 v[96:99], v[32:35], v[208:211], v[96:99]
  s_add_u32 s33, s44, 0x5000
  buffer_store_dwordx4 v[236:239], v2, s[12:15], s33 offen offset:0 sc1
  ds_read_b64_tr_b16 v[48:49], v22 offset:0
  ds_read_b64_tr_b16 v[50:51], v22 offset:1024
  s_add_u32 m0, s58, 0x10800
  s_movk_i32 s33, 0x5480
  buffer_load_dwordx4 v25, s[4:7], s33 offen lds
  v_mfma_f32_16x16x32_bf16 v[100:103], v[32:35], v[212:215], v[100:103]
  s_setprio 0
  ds_read_b64_tr_b16 v[52:53], v22 offset:8192
  s_waitcnt lgkmcnt(7)
  v_mfma_f32_16x16x32_bf16 v[96:99], v[36:39], v[216:219], v[96:99]
  ds_read_b64_tr_b16 v[54:55], v22 offset:9216
  v_mfma_f32_16x16x32_bf16 v[100:103], v[36:39], v[220:223], v[100:103]
  ds_read_b64_tr_b16 v[56:57], v23 offset:0
  ds_read_b64_tr_b16 v[58:59], v23 offset:1024
  s_waitcnt lgkmcnt(8)
  v_mfma_f32_16x16x32_bf16 v[104:107], v[40:43], v[208:211], v[104:107]
  ds_read_b64_tr_b16 v[60:61], v23 offset:8192
  s_add_u32 m0, s58, 0x10c00
  s_movk_i32 s33, 0x5480
  buffer_load_dwordx4 v26, s[4:7], s33 offen lds
  s_waitcnt vmcnt(8)
  v_mfma_f32_16x16x32_bf16 v[108:111], v[40:43], v[212:215], v[108:111]
  ds_read_b64_tr_b16 v[62:63], v23 offset:9216
  s_waitcnt lgkmcnt(8)
  v_mfma_f32_16x16x32_bf16 v[104:107], v[44:47], v[216:219], v[104:107]
  v_readlane_b32 s32, v15, 0
  v_readlane_b32 s33, v15, 1
  s_nop 0
  s_ff1_i32_b64 s32, s[32:33]
  s_lshr_b32 s32, s32, 3
  s_min_u32 s32, s32, 8
  s_lshl_b32 s61, s32, 17
  s_add_u32 s32, s61, s3
  s_cmp_eq_u32 s32, 0
  s_cbranch_scc1 fU_kv
fU_kv_ret:
  v_mfma_f32_16x16x32_bf16 v[108:111], v[44:47], v[220:223], v[108:111]
  s_waitcnt lgkmcnt(6)
  v_mfma_f32_16x16x32_bf16 v[112:115], v[48:51], v[208:211], v[112:115]
  v_mfma_f32_16x16x32_bf16 v[116:119], v[48:51], v[212:215], v[116:119]
  s_waitcnt lgkmcnt(0)
  s_barrier
  s_setprio 3
  ds_read_b64_tr_b16 v[32:33], v16 offset:16384
  ds_read_b64_tr_b16 v[34:35], v16 offset:17408
  v_mfma_f32_16x16x32_bf16 v[112:115], v[52:55], v[216:219], v[112:115]
  ds_read_b128 v[192:195], v27 offset:0
  ds_read_b128 v[196:199], v27 offset:2048
  v_mfma_f32_16x16x32_bf16 v[116:119], v[52:55], v[220:223], v[116:119]
  ds_read_b64_tr_b16 v[36:37], v16 offset:24576
  ds_read_b64_tr_b16 v[38:39], v16 offset:25600
  v_mfma_f32_16x16x32_bf16 v[120:123], v[56:59], v[208:211], v[120:123]
  ds_read_b128 v[200:203], v28 offset:0
  ds_read_b128 v[204:207], v28 offset:2048
  v_mfma_f32_16x16x32_bf16 v[124:127], v[56:59], v[212:215], v[124:127]
  ds_read_b64_tr_b16 v[40:41], v17 offset:16384
  ds_read_b64_tr_b16 v[42:43], v17 offset:17408
  v_mfma_f32_16x16x32_bf16 v[120:123], v[60:63], v[216:219], v[120:123]
  ds_read_b64_tr_b16 v[44:45], v17 offset:24576
  ds_read_b64_tr_b16 v[46:47], v17 offset:25600
  v_mfma_f32_16x16x32_bf16 v[124:127], v[60:63], v[220:223], v[124:127]
  s_waitcnt lgkmcnt(10)
  s_waitcnt lgkmcnt(9)
  v_mfma_f32_16x16x32_bf16 v[64:67], v[32:35], v[192:195], v[64:67]
  ds_read_b64_tr_b16 v[48:49], v18 offset:16384
  ds_read_b64_tr_b16 v[50:51], v18 offset:17408
  s_waitcnt lgkmcnt(10)
  v_mfma_f32_16x16x32_bf16 v[68:71], v[32:35], v[196:199], v[68:71]
  s_setprio 2
  ds_read_b64_tr_b16 v[52:53], v18 offset:24576
  s_waitcnt lgkmcnt(9)
  s_waitcnt lgkmcnt(8)
  v_mfma_f32_16x16x32_bf16 v[64:67], v[36:39], v[200:203], v[64:67]
  s_add_u32 s33, s44, 0x0
  buffer_store_dwordx4 v[240:243], v2, s[12:15], s33 offen offset:1024 sc1
  ds_read_b64_tr_b16 v[54:55], v18 offset:25600
  s_waitcnt lgkmcnt(8)
  v_mfma_f32_16x16x32_bf16 v[68:71], v[36:39], v[204:207], v[68:71]
  ds_read_b64_tr_b16 v[56:57], v19 offset:16384
  ds_read_b64_tr_b16 v[58:59], v19 offset:17408
  s_waitcnt lgkmcnt(8)
  v_mfma_f32_16x16x32_bf16 v[72:75], v[40:43], v[192:195], v[72:75]
  ds_read_b64_tr_b16 v[60:61], v19 offset:24576
  v_mfma_f32_16x16x32_bf16 v[76:79], v[40:43], v[196:199], v[76:79]
  ds_read_b64_tr_b16 v[62:63], v19 offset:25600
  s_waitcnt lgkmcnt(8)
  v_mfma_f32_16x16x32_bf16 v[72:75], v[44:47], v[200:203], v[72:75]
  v_mfma_f32_16x16x32_bf16 v[76:79], v[44:47], v[204:207], v[76:79]
  s_waitcnt lgkmcnt(6)
  v_mfma_f32_16x16x32_bf16 v[80:83], v[48:51], v[192:195], v[80:83]
  ds_read_b64_tr_b16 v[32:33], v20 offset:16384
  ds_read_b64_tr_b16 v[34:35], v20 offset:17408
  s_add_u32 m0, s58, 0x0
  s_mov_b32 s33, 0x0
  buffer_load_dwordx4 v12, s[16:19], s33 offen offset:0 lds
  v_mfma_f32_16x16x32_bf16 v[84:87], v[48:51], v[196:199], v[84:87]
  s_setprio 1
  ds_read_b64_tr_b16 v[36:37], v20 offset:24576
  s_waitcnt lgkmcnt(7)
  v_mfma_f32_16x16x32_bf16 v[80:83], v[52:55], v[200:203], v[80:83]
  ds_read_b64_tr_b16 v[38:39], v20 offset:25600
  v_mfma_f32_16x16x32_bf16 v[84:87], v[52:55], v[204:207], v[84:87]
  ds_read_b64_tr_b16 v[40:41], v21 offset:16384
  ds_read_b64_tr_b16 v[42:43], v21 offset:17408
  s_waitcnt lgkmcnt(8)
  v_mfma_f32_16x16x32_bf16 v[88:91], v[56:59], v[192:195], v[88:91]
  ds_read_b64_tr_b16 v[44:45], v21 offset:24576
  s_add_u32 m0, s58, 0x0
  s_mov_b32 s33, 0x0
  buffer_load_dwordx4 v12, s[16:19], s33 offen offset:1024 lds
  v_mfma_f32_16x16x32_bf16 v[92:95], v[56:59], v[196:199], v[92:95]
  ds_read_b64_tr_b16 v[46:47], v21 offset:25600
  s_waitcnt lgkmcnt(8)
  v_mfma_f32_16x16x32_bf16 v[88:91], v[60:63], v[200:203], v[88:91]
  v_mfma_f32_16x16x32_bf16 v[92:95], v[60:63], v[204:207], v[92:95]
  s_waitcnt lgkmcnt(6)
  v_mfma_f32_16x16x32_bf16 v[96:99], v[32:35], v[192:195], v[96:99]
  ds_read_b64_tr_b16 v[48:49], v22 offset:16384
  ds_read_b64_tr_b16 v[50:51], v22 offset:17408
  s_add_u32 m0, s58, 0x0
  s_mov_b32 s33, 0x0
  buffer_load_dwordx4 v12, s[16:19], s33 offen offset:2048 lds
  v_mfma_f32_16x16x32_bf16 v[100:103], v[32:35], v[196:199], v[100:103]
  s_setprio 0
  ds_read_b64_tr_b16 v[52:53], v22 offset:24576
  s_waitcnt lgkmcnt(7)
  v_mfma_f32_16x16x32_bf16 v[96:99], v[36:39], v[200:203], v[96:99]
  ds_read_b64_tr_b16 v[54:55], v22 offset:25600
  v_mfma_f32_16x16x32_bf16 v[100:103], v[36:39], v[204:207], v[100:103]
  ds_read_b64_tr_b16 v[56:57], v23 offset:16384
  ds_read_b64_tr_b16 v[58:59], v23 offset:17408
  s_waitcnt lgkmcnt(8)
  v_mfma_f32_16x16x32_bf16 v[104:107], v[40:43], v[192:195], v[104:107]
  ds_read_b64_tr_b16 v[60:61], v23 offset:24576
  s_add_u32 m0, s58, 0x0
  s_mov_b32 s33, 0x0
  buffer_load_dwordx4 v12, s[16:19], s33 offen offset:3072 lds
  v_mfma_f32_16x16x32_bf16 v[108:111], v[40:43], v[196:199], v[108:111]
  s_add_u32 s33, s44, 0x1000
  buffer_store_dwordx4 v[244:247], v2, s[12:15], s33 offen offset:1024 sc1
  ds_read_b64_tr_b16 v[62:63], v23 offset:25600
  s_waitcnt lgkmcnt(8)
  v_mfma_f32_16x16x32_bf16 v[104:107], v[44:47], v[200:203], v[104:107]
  v_mfma_f32_16x16x32_bf16 v[108:111], v[44:47], v[204:207], v[108:111]
  s_waitcnt lgkmcnt(6)
  v_mfma_f32_16x16x32_bf16 v[112:115], v[48:51], v[192:195], v[112:115]
  v_mfma_f32_16x16x32_bf16 v[116:119], v[48:51], v[196:199], v[116:119]
  s_waitcnt lgkmcnt(0)
  s_barrier
  s_setprio 3
  ds_read_b64_tr_b16 v[32:33], v16 offset:32768
  ds_read_b64_tr_b16 v[34:35], v16 offset:33792
  v_mfma_f32_16x16x32_bf16 v[112:115], v[52:55], v[200:203], v[112:115]
  ds_read_b128 v[208:211], v27 offset:32768
  ds_read_b128 v[212:215], v27 offset:34816
  v_mfma_f32_16x16x32_bf16 v[116:119], v[52:55], v[204:207], v[116:119]
  ds_read_b64_tr_b16 v[36:37], v16 offset:40960
  ds_read_b64_tr_b16 v[38:39], v16 offset:41984
  v_mfma_f32_16x16x32_bf16 v[120:123], v[56:59], v[192:195], v[120:123]
  ds_read_b128 v[216:219], v28 offset:32768
  ds_read_b128 v[220:223], v28 offset:34816
  v_mfma_f32_16x16x32_bf16 v[124:127], v[56:59], v[196:199], v[124:127]
  ds_read_b64_tr_b16 v[40:41], v17 offset:32768
  ds_read_b64_tr_b16 v[42:43], v17 offset:33792
  v_mfma_f32_16x16x32_bf16 v[120:123], v[60:63], v[200:203], v[120:123]
  ds_read_b64_tr_b16 v[44:45], v17 offset:40960
  ds_read_b64_tr_b16 v[46:47], v17 offset:41984
  v_mfma_f32_16x16x32_bf16 v[124:127], v[60:63], v[204:207], v[124:127]
  s_waitcnt lgkmcnt(10)
  s_waitcnt lgkmcnt(9)
  v_mfma_f32_16x16x32_bf16 v[64:67], v[32:35], v[208:211], v[64:67]
  ds_read_b64_tr_b16 v[48:49], v18 offset:32768
  ds_read_b64_tr_b16 v[50:51], v18 offset:33792
  s_waitcnt lgkmcnt(10)
  v_mfma_f32_16x16x32_bf16 v[68:71], v[32:35], v[212:215], v[68:71]
  s_setprio 2
  ds_read_b64_tr_b16 v[52:53], v18 offset:40960
  s_waitcnt lgkmcnt(9)
  s_waitcnt lgkmcnt(8)
  v_mfma_f32_16x16x32_bf16 v[64:67], v[36:39], v[216:219], v[64:67]
  ds_read_b64_tr_b16 v[54:55], v18 offset:41984
  s_waitcnt lgkmcnt(8)
  v_mfma_f32_16x16x32_bf16 v[68:71], v[36:39], v[220:223], v[68:71]
  ds_read_b64_tr_b16 v[56:57], v19 offset:32768
  ds_read_b64_tr_b16 v[58:59], v19 offset:33792
  s_waitcnt lgkmcnt(8)
  v_mfma_f32_16x16x32_bf16 v[72:75], v[40:43], v[208:211], v[72:75]
  ds_read_b64_tr_b16 v[60:61], v19 offset:40960
  v_mfma_f32_16x16x32_bf16 v[76:79], v[40:43], v[212:215], v[76:79]
  ds_read_b64_tr_b16 v[62:63], v19 offset:41984
  s_waitcnt lgkmcnt(8)
  v_mfma_f32_16x16x32_bf16 v[72:75], v[44:47], v[216:219], v[72:75]
  v_mfma_f32_16x16x32_bf16 v[76:79], v[44:47], v[220:223], v[76:79]
  s_add_u32 s33, s44, 0x4000
  buffer_store_dwordx4 v[248:251], v2, s[12:15], s33 offen offset:1024 sc1
  s_waitcnt lgkmcnt(6)
  v_mfma_f32_16x16x32_bf16 v[80:83], v[48:51], v[208:211], v[80:83]
  ds_read_b64_tr_b16 v[32:33], v20 offset:32768
  ds_read_b64_tr_b16 v[34:35], v20 offset:33792
  s_add_u32 m0, s58, 0x8000
  s_mov_b32 s33, 0x10000
  buffer_load_dwordx4 v12, s[16:19], s33 offen offset:0 lds
  v_mfma_f32_16x16x32_bf16 v[84:87], v[48:51], v[212:215], v[84:87]
  s_setprio 1
  ds_read_b64_tr_b16 v[36:37], v20 offset:40960
  s_waitcnt lgkmcnt(7)
  v_mfma_f32_16x16x32_bf16 v[80:83], v[52:55], v[216:219], v[80:83]
  ds_read_b64_tr_b16 v[38:39], v20 offset:41984
  v_mfma_f32_16x16x32_bf16 v[84:87], v[52:55], v[220:223], v[84:87]
  ds_read_b64_tr_b16 v[40:41], v21 offset:32768
  ds_read_b64_tr_b16 v[42:43], v21 offset:33792
  s_waitcnt lgkmcnt(8)
  v_mfma_f32_16x16x32_bf16 v[88:91], v[56:59], v[208:211], v[88:91]
  ds_read_b64_tr_b16 v[44:45], v21 offset:40960
  s_add_u32 m0, s58, 0x8000
  s_mov_b32 s33, 0x10000
  buffer_load_dwordx4 v12, s[16:19], s33 offen offset:1024 lds
  v_mfma_f32_16x16x32_bf16 v[92:95], v[56:59], v[212:215], v[92:95]
  ds_read_b64_tr_b16 v[46:47], v21 offset:41984
  s_waitcnt lgkmcnt(8)
  v_mfma_f32_16x16x32_bf16 v[88:91], v[60:63], v[216:219], v[88:91]
  v_mfma_f32_16x16x32_bf16 v[92:95], v[60:63], v[220:223], v[92:95]
  s_waitcnt lgkmcnt(6)
  v_mfma_f32_16x16x32_bf16 v[96:99], v[32:35], v[208:211], v[96:99]
  ds_read_b64_tr_b16 v[48:49], v22 offset:32768
  ds_read_b64_tr_b16 v[50:51], v22 offset:33792
  s_add_u32 m0, s58, 0x8000
  s_mov_b32 s33, 0x10000
  buffer_load_dwordx4 v12, s[16:19], s33 offen offset:2048 lds
  v_mfma_f32_16x16x32_bf16 v[100:103], v[32:35], v[212:215], v[100:103]
  s_setprio 0
  ds_read_b64_tr_b16 v[52:53], v22 offset:40960
  s_waitcnt lgkmcnt(7)
  v_mfma_f32_16x16x32_bf16 v[96:99], v[36:39], v[216:219], v[96:99]
  ds_read_b64_tr_b16 v[54:55], v22 offset:41984
  v_mfma_f32_16x16x32_bf16 v[100:103], v[36:39], v[220:223], v[100:103]
  ds_read_b64_tr_b16 v[56:57], v23 offset:32768
  ds_read_b64_tr_b16 v[58:59], v23 offset:33792
  s_waitcnt lgkmcnt(8)
  v_mfma_f32_16x16x32_bf16 v[104:107], v[40:43], v[208:211], v[104:107]
  ds_read_b64_tr_b16 v[60:61], v23 offset:40960
  s_add_u32 m0, s58, 0x8000
  s_mov_b32 s33, 0x10000
  buffer_load_dwordx4 v12, s[16:19], s33 offen offset:3072 lds
  v_mfma_f32_16x16x32_bf16 v[108:111], v[40:43], v[212:215], v[108:111]
  ds_read_b64_tr_b16 v[62:63], v23 offset:41984
  s_waitcnt lgkmcnt(8)
  v_mfma_f32_16x16x32_bf16 v[104:107], v[44:47], v[216:219], v[104:107]
  v_mfma_f32_16x16x32_bf16 v[108:111], v[44:47], v[220:223], v[108:111]
  s_waitcnt lgkmcnt(6)
  v_mfma_f32_16x16x32_bf16 v[112:115], v[48:51], v[208:211], v[112:115]
  v_mfma_f32_16x16x32_bf16 v[116:119], v[48:51], v[212:215], v[116:119]
  s_add_u32 s33, s44, 0x5000
  buffer_store_dwordx4 v[252:255], v2, s[12:15], s33 offen offset:1024 sc1
  s_waitcnt lgkmcnt(0)
  s_waitcnt vmcnt(12)
  s_barrier
  s_setprio 3
  ds_read_b64_tr_b16 v[32:33], v16 offset:49152
  ds_read_b64_tr_b16 v[34:35], v16 offset:50176
  v_mfma_f32_16x16x32_bf16 v[112:115], v[52:55], v[216:219], v[112:115]
  ds_read_b128 v[192:195], v29 offset:0
  ds_read_b128 v[196:199], v29 offset:2048
  v_mfma_f32_16x16x32_bf16 v[116:119], v[52:55], v[220:223], v[116:119]
  ds_read_b64_tr_b16 v[36:37], v16 offset:57344
  ds_read_b64_tr_b16 v[38:39], v16 offset:58368
  v_mfma_f32_16x16x32_bf16 v[120:123], v[56:59], v[208:211], v[120:123]
  ds_read_b128 v[200:203], v30 offset:0
  ds_read_b128 v[204:207], v30 offset:2048
  v_mfma_f32_16x16x32_bf16 v[124:127], v[56:59], v[212:215], v[124:127]
  ds_read_b64_tr_b16 v[40:41], v17 offset:49152
  ds_read_b64_tr_b16 v[42:43], v17 offset:50176
  v_mfma_f32_16x16x32_bf16 v[120:123], v[60:63], v[216:219], v[120:123]
  ds_read_b64_tr_b16 v[44:45], v17 offset:57344
  ds_read_b64_tr_b16 v[46:47], v17 offset:58368
  v_mfma_f32_16x16x32_bf16 v[124:127], v[60:63], v[220:223], v[124:127]
  s_waitcnt lgkmcnt(10)
  s_waitcnt lgkmcnt(9)
  v_mfma_f32_16x16x32_bf16 v[64:67], v[32:35], v[192:195], v[64:67]
  ds_read_b64_tr_b16 v[48:49], v18 offset:49152
  ds_read_b64_tr_b16 v[50:51], v18 offset:50176
  s_waitcnt lgkmcnt(10)
  v_mfma_f32_16x16x32_bf16 v[68:71], v[32:35], v[196:199], v[68:71]
  s_setprio 2
  ds_read_b64_tr_b16 v[52:53], v18 offset:57344
  s_waitcnt lgkmcnt(9)
  s_waitcnt lgkmcnt(8)
  v_mfma_f32_16x16x32_bf16 v[64:67], v[36:39], v[200:203], v[64:67]
  ds_read_b64_tr_b16 v[54:55], v18 offset:58368
  s_waitcnt lgkmcnt(8)
  v_mfma_f32_16x16x32_bf16 v[68:71], v[36:39], v[204:207], v[68:71]
  ds_read_b64_tr_b16 v[56:57], v19 offset:49152
  ds_read_b64_tr_b16 v[58:59], v19 offset:50176
  s_waitcnt lgkmcnt(8)
  v_mfma_f32_16x16x32_bf16 v[72:75], v[40:43], v[192:195], v[72:75]
  ds_read_b64_tr_b16 v[60:61], v19 offset:57344
  v_mfma_f32_16x16x32_bf16 v[76:79], v[40:43], v[196:199], v[76:79]
  ds_read_b64_tr_b16 v[62:63], v19 offset:58368
  s_waitcnt lgkmcnt(8)
  v_mfma_f32_16x16x32_bf16 v[72:75], v[44:47], v[200:203], v[72:75]
  v_mfma_f32_16x16x32_bf16 v[76:79], v[44:47], v[204:207], v[76:79]
  s_waitcnt lgkmcnt(6)
  v_mfma_f32_16x16x32_bf16 v[80:83], v[48:51], v[192:195], v[80:83]
  ds_read_b64_tr_b16 v[32:33], v20 offset:49152
  ds_read_b64_tr_b16 v[34:35], v20 offset:50176
  s_add_u32 m0, s58, 0x10000
  s_mov_b32 s33, 0x2000
  buffer_load_dwordx4 v12, s[16:19], s33 offen offset:0 lds
  v_mfma_f32_16x16x32_bf16 v[84:87], v[48:51], v[196:199], v[84:87]
  s_setprio 1
  ds_read_b64_tr_b16 v[36:37], v20 offset:57344
  s_waitcnt lgkmcnt(7)
  v_mfma_f32_16x16x32_bf16 v[80:83], v[52:55], v[200:203], v[80:83]
  ds_read_b64_tr_b16 v[38:39], v20 offset:58368
  v_mfma_f32_16x16x32_bf16 v[84:87], v[52:55], v[204:207], v[84:87]
  ds_read_b64_tr_b16 v[40:41], v21 offset:49152
  ds_read_b64_tr_b16 v[42:43], v21 offset:50176
  v_mul_f32 v64, 0x3e0293ee, v64
  v_mul_f32 v65, 0x3e0293ee, v65
  v_mul_f32 v66, 0x3e0293ee, v66
  s_waitcnt lgkmcnt(8)
  v_mfma_f32_16x16x32_bf16 v[88:91], v[56:59], v[192:195], v[88:91]
  ds_read_b64_tr_b16 v[44:45], v21 offset:57344
  s_add_u32 m0, s58, 0x10000
  s_mov_b32 s33, 0x2000
  buffer_load_dwordx4 v12, s[16:19], s33 offen offset:1024 lds
  v_mul_f32 v67, 0x3e0293ee, v67
  v_cvt_pk_bf16_f32 v128, v64, v65
  v_cvt_pk_bf16_f32 v129, v66, v67
  v_mfma_f32_16x16x32_bf16 v[92:95], v[56:59], v[196:199], v[92:95]
  ds_read_b64_tr_b16 v[46:47], v21 offset:58368
  v_mul_f32 v72, 0x3e0293ee, v72
  v_mul_f32 v73, 0x3e0293ee, v73
  v_mul_f32 v74, 0x3e0293ee, v74
  s_waitcnt lgkmcnt(8)
  v_mfma_f32_16x16x32_bf16 v[88:91], v[60:63], v[200:203], v[88:91]
  v_mul_f32 v75, 0x3e0293ee, v75
  v_cvt_pk_bf16_f32 v130, v72, v73
  v_cvt_pk_bf16_f32 v131, v74, v75
  v_mfma_f32_16x16x32_bf16 v[92:95], v[60:63], v[204:207], v[92:95]
  v_mul_f32 v68, 0x3e0293ee, v68
  v_mul_f32 v69, 0x3e0293ee, v69
  v_mul_f32 v70, 0x3e0293ee, v70
  s_waitcnt lgkmcnt(6)
  v_mfma_f32_16x16x32_bf16 v[96:99], v[32:35], v[192:195], v[96:99]
  ds_read_b64_tr_b16 v[48:49], v22 offset:49152
  ds_read_b64_tr_b16 v[50:51], v22 offset:50176
  s_add_u32 m0, s58, 0x10000
  s_mov_b32 s33, 0x2000
  buffer_load_dwordx4 v12, s[16:19], s33 offen offset:2048 lds
  v_mul_f32 v71, 0x3e0293ee, v71
  v_cvt_pk_bf16_f32 v132, v68, v69
  v_cvt_pk_bf16_f32 v133, v70, v71
  v_mfma_f32_16x16x32_bf16 v[100:103], v[32:35], v[196:199], v[100:103]
  s_setprio 0
  ds_read_b64_tr_b16 v[52:53], v22 offset:57344
  v_mul_f32 v76, 0x3e0293ee, v76
  v_mul_f32 v77, 0x3e0293ee, v77
  v_mul_f32 v78, 0x3e0293ee, v78
  s_waitcnt lgkmcnt(7)
  v_mfma_f32_16x16x32_bf16 v[96:99], v[36:39], v[200:203], v[96:99]
  ds_read_b64_tr_b16 v[54:55], v22 offset:58368
  v_mul_f32 v79, 0x3e0293ee, v79
  v_cvt_pk_bf16_f32 v134, v76, v77
  v_cvt_pk_bf16_f32 v135, v78, v79
  v_mfma_f32_16x16x32_bf16 v[100:103], v[36:39], v[204:207], v[100:103]
  ds_read_b64_tr_b16 v[56:57], v23 offset:49152
  ds_read_b64_tr_b16 v[58:59], v23 offset:50176
  v_mul_f32 v80, 0x3e0293ee, v80
  v_mul_f32 v81, 0x3e0293ee, v81
  v_mul_f32 v82, 0x3e0293ee, v82
  s_waitcnt lgkmcnt(8)
  v_mfma_f32_16x16x32_bf16 v[104:107], v[40:43], v[192:195], v[104:107]
  ds_read_b64_tr_b16 v[60:61], v23 offset:57344
  s_add_u32 m0, s58, 0x10000
  s_mov_b32 s33, 0x2000
  buffer_load_dwordx4 v12, s[16:19], s33 offen offset:3072 lds
  v_mul_f32 v83, 0x3e0293ee, v83
  v_cvt_pk_bf16_f32 v136, v80, v81
  v_cvt_pk_bf16_f32 v137, v82, v83
  v_mfma_f32_16x16x32_bf16 v[108:111], v[40:43], v[196:199], v[108:111]
  ds_read_b64_tr_b16 v[62:63], v23 offset:58368
  v_mul_f32 v88, 0x3e0293ee, v88
  v_mul_f32 v89, 0x3e0293ee, v89
  v_mul_f32 v90, 0x3e0293ee, v90
  s_waitcnt lgkmcnt(8)
  v_mfma_f32_16x16x32_bf16 v[104:107], v[44:47], v[200:203], v[104:107]
  v_mul_f32 v91, 0x3e0293ee, v91
  v_cvt_pk_bf16_f32 v138, v88, v89
  v_cvt_pk_bf16_f32 v139, v90, v91
  v_mfma_f32_16x16x32_bf16 v[108:111], v[44:47], v[204:207], v[108:111]
  v_mul_f32 v84, 0x3e0293ee, v84
  v_mul_f32 v85, 0x3e0293ee, v85
  v_mul_f32 v86, 0x3e0293ee, v86
  s_waitcnt lgkmcnt(6)
  v_mfma_f32_16x16x32_bf16 v[112:115], v[48:51], v[192:195], v[112:115]
  v_mul_f32 v87, 0x3e0293ee, v87
  v_cvt_pk_bf16_f32 v140, v84, v85
  v_cvt_pk_bf16_f32 v141, v86, v87
  v_mfma_f32_16x16x32_bf16 v[116:119], v[48:51], v[196:199], v[116:119]
  v_mul_f32 v92, 0x3e0293ee, v92
  v_mul_f32 v93, 0x3e0293ee, v93
  v_mul_f32 v94, 0x3e0293ee, v94
  s_waitcnt lgkmcnt(4)
  v_mfma_f32_16x16x32_bf16 v[112:115], v[52:55], v[200:203], v[112:115]
  v_mul_f32 v95, 0x3e0293ee, v95
  v_cvt_pk_bf16_f32 v142, v92, v93
  v_cvt_pk_bf16_f32 v143, v94, v95
  v_mfma_f32_16x16x32_bf16 v[116:119], v[52:55], v[204:207], v[116:119]
  v_mul_f32 v96, 0x3e0293ee, v96
  v_mul_f32 v97, 0x3e0293ee, v97
  v_mul_f32 v98, 0x3e0293ee, v98
  s_waitcnt lgkmcnt(2)
  v_mfma_f32_16x16x32_bf16 v[120:123], v[56:59], v[192:195], v[120:123]
  v_mul_f32 v99, 0x3e0293ee, v99
  v_cvt_pk_bf16_f32 v144, v96, v97
  v_mfma_f32_16x16x32_bf16 v[124:127], v[56:59], v[196:199], v[124:127]
  v_cvt_pk_bf16_f32 v145, v98, v99
  v_mul_f32 v104, 0x3e0293ee, v104
  v_mul_f32 v105, 0x3e0293ee, v105
  s_waitcnt lgkmcnt(0)
  v_mfma_f32_16x16x32_bf16 v[120:123], v[60:63], v[200:203], v[120:123]
  v_mul_f32 v106, 0x3e0293ee, v106
  v_mul_f32 v107, 0x3e0293ee, v107
  v_mfma_f32_16x16x32_bf16 v[124:127], v[60:63], v[204:207], v[124:127]
  v_cvt_pk_bf16_f32 v146, v104, v105
  v_cvt_pk_bf16_f32 v147, v106, v107
  v_mul_f32 v100, 0x3e0293ee, v100
  v_mul_f32 v101, 0x3e0293ee, v101
  v_mul_f32 v102, 0x3e0293ee, v102
  v_mul_f32 v103, 0x3e0293ee, v103
  v_cvt_pk_bf16_f32 v148, v100, v101
  v_cvt_pk_bf16_f32 v149, v102, v103
  v_mul_f32 v108, 0x3e0293ee, v108
  v_mul_f32 v109, 0x3e0293ee, v109
  v_mul_f32 v110, 0x3e0293ee, v110
  v_mul_f32 v111, 0x3e0293ee, v111
  v_cvt_pk_bf16_f32 v150, v108, v109
  v_cvt_pk_bf16_f32 v151, v110, v111
  v_mul_f32 v112, 0x3e0293ee, v112
  v_mul_f32 v113, 0x3e0293ee, v113
  v_mul_f32 v114, 0x3e0293ee, v114
  v_mul_f32 v115, 0x3e0293ee, v115
  v_cvt_pk_bf16_f32 v152, v112, v113
  v_cvt_pk_bf16_f32 v153, v114, v115
  v_mul_f32 v120, 0x3e0293ee, v120
  v_mul_f32 v121, 0x3e0293ee, v121
  v_mul_f32 v122, 0x3e0293ee, v122
  v_mul_f32 v123, 0x3e0293ee, v123
  v_cvt_pk_bf16_f32 v154, v120, v121
  v_cvt_pk_bf16_f32 v155, v122, v123
  v_mul_f32 v116, 0x3e0293ee, v116
  v_mul_f32 v117, 0x3e0293ee, v117
  v_mul_f32 v118, 0x3e0293ee, v118
  v_mul_f32 v119, 0x3e0293ee, v119
  v_cvt_pk_bf16_f32 v156, v116, v117
  v_cvt_pk_bf16_f32 v157, v118, v119
  v_mul_f32 v124, 0x3e0293ee, v124
  v_mul_f32 v125, 0x3e0293ee, v125
  v_mul_f32 v126, 0x3e0293ee, v126
  v_mul_f32 v127, 0x3e0293ee, v127
  v_cvt_pk_bf16_f32 v158, v124, v125
  v_cvt_pk_bf16_f32 v159, v126, v127
  s_lshl_b32 s32, s37, 7
  s_add_u32 s32, s32, 0xc000
  v_lshrrev_b32 v31, 1, v1
  v_add_lshl_u32 v31, v31, s3, 20
  v_lshl_add_u32 v31, v1, 2, v31
  buffer_load_dword v30, v31, s[24:27], s32 offen sc1
  s_waitcnt vmcnt(12)
f_join:
  s_and_b32 s32, s3, 3
  s_lshl_b32 s32, s32, 13
  s_add_u32 s32, s32, 0x18000
  v_add_u32 v27, s32, v2
  s_cmp_ge_u32 s3, 4
  s_cbranch_scc1 k2_nopub
  ds_write_b128 v27, v[128:131] offset:0
  ds_write_b128 v27, v[132:135] offset:1024
  ds_write_b128 v27, v[136:139] offset:2048
  ds_write_b128 v27, v[140:143] offset:3072
  ds_write_b128 v27, v[144:147] offset:4096
  ds_write_b128 v27, v[148:151] offset:5120
  ds_write_b128 v27, v[152:155] offset:6144
  ds_write_b128 v27, v[156:159] offset:7168
k2_nopub:
  v_mov_b32 v3, v2
  s_waitcnt lgkmcnt(0)
  s_barrier
  ds_read_b128 v[32:35], v3 offset:0
  ds_read_b128 v[36:39], v3 offset:1024
  ds_read_b128 v[40:43], v3 offset:2048
  ds_read_b128 v[44:47], v3 offset:3072
  ds_read_b128 v[48:51], v3 offset:4096
  ds_read_b128 v[52:55], v3 offset:5120
  ds_read_b128 v[56:59], v3 offset:6144
  ds_read_b128 v[60:63], v3 offset:7168
  v_mov_b32 v208, 0
  v_mov_b32 v209, 0
  v_mov_b32 v210, 0
  v_mov_b32 v211, 0
  v_mov_b32 v212, 0
  v_mov_b32 v213, 0
  v_mov_b32 v214, 0
  v_mov_b32 v215, 0
  v_mov_b32 v216, 0
  v_mov_b32 v217, 0
  v_mov_b32 v218, 0
  v_mov_b32 v219, 0
  v_mov_b32 v220, 0
  v_mov_b32 v221, 0
  v_mov_b32 v222, 0
  v_mov_b32 v223, 0
  v_mov_b32 v8, 0
  v_mov_b32 v9, 0
  v_and_b32 v24, 15, v1
  v_lshrrev_b32 v25, 4, v1
  v_lshlrev_b32 v25, 2, v25
  v_add_u32 v26, 0, v25
  v_cmp_gt_u32 s[44:45], v26, v24
  v_add_u32 v26, 1, v25
  v_cmp_gt_u32 s[46:47], v26, v24
  v_add_u32 v26, 2, v25
  v_cmp_gt_u32 s[48:49], v26, v24
  v_add_u32 v26, 3, v25
  v_cmp_gt_u32 s[50:51], v26, v24
  s_and_b32 s32, s3, 3
  s_lshl_b32 s32, s32, 9
  s_add_u32 s32, s32, 0x20000
  v_lshl_add_u32 v31, v1, 3, s32
  s_add_u32 s4, s98, 0x3000000
  s_addc_u32 s5, s99, 0
  s_and_b32 s5, s5, 0xffff
  s_mov_b32 s6, 0x1000000
  s_mov_b32 s7, 0x00020000
  s_cmp_ge_u32 s41, s40
  s_cbranch_scc1 k2_p0
k2_p0_ret:
  s_add_u32 s20, s98, 0x4000000
  s_addc_u32 s21, s99, 0
  s_and_b32 s21, s21, 0xffff
  s_mov_b32 s22, 0x2400000
  s_mov_b32 s23, 0x00020000
  s_mul_i32 s32, s34, 655360
  s_add_u32 s28, s92, s32
  s_addc_u32 s29, s93, 0
  s_and_b32 s29, s29, 0xffff
  s_mov_b32 s30, 0xa0000
  s_mov_b32 s31, 0x00020000
  s_and_b32 s76, s3, 3
  s_sub_u32 s90, 7, s36
  s_sub_u32 s32, 15, s36
  s_cmp_lt_u32 s3, 4
  s_cselect_b32 s32, s90, s32
  s_cselect_b32 s33, s90, s36
  s_mov_b32 s89, 1
  s_cselect_b32 s82, 0x0, 0xc00000
  s_lshl_b32 s32, s32, 2
  s_add_u32 s32, s32, s76
  s_lshl_b32 s32, s32, 3
  s_add_u32 s32, s32, s34
  s_lshl_b32 s83, s32, 15
  s_lshl_b32 s32, s34, 3
  s_add_u32 s32, s32, s33
  s_lshl_b32 s32, s32, 2
  s_add_u32 s32, s32, s76
  s_lshl_b32 s32, s32, 7
  s_add_u32 s79, s32, 0x2000000
  s_lshr_b32 s77, s2, 3
  s_lshl_b32 s77, s77, 2
  s_add_u32 s77, s77, s76
  s_lshl_b32 s32, s77, 5
  s_add_u32 s32, s32, s34
  s_lshl_b32 s32, s32, 2
  s_add_u32 s32, s32, 0x2008000
  s_lshl_b32 s33, s35, 2
  s_add_u32 s33, s33, s79
  s_cmp_lt_u32 s3, 4
  s_cselect_b32 s78, s32, s33
  s_mov_b32 s88, 15
  s_lshl_b32 s33, s35, 9
  s_sub_u32 s32, s32, s33
  s_cmp_lt_u32 s3, 4
  s_cselect_b32 s79, s79, s32
  s_lshl_b32 s32, s77, 4
  s_add_u32 s32, s32, s34
  s_mul_i32 s32, s32, 5120
  s_add_u32 s82, s82, s32
  s_lshr_b32 s33, s3, 2
  s_mul_i32 s33, s33, 40960
  s_add_u32 s32, s32, s33
  s_add_u32 s87, s32, 0xc00000
  s_bitcmp1_b32 s36, 0
  s_cselect_b32 s69, 0x20000, 0
  s_waitcnt lgkmcnt(0)
  v_mfma_f32_16x16x32_bf16 v[160:163], v[32:35], v[128:131], v[208:211]
  v_mov_b32 v64, 0
  v_mov_b32 v65, 0
  v_mov_b32 v66, 0
  v_mov_b32 v67, 0
  s_cselect_b32 s86, 0, 0x8000
  s_mov_b32 s68, s69
  v_mfma_f32_16x16x32_bf16 v[164:167], v[32:35], v[132:135], v[212:215]
  v_mov_b32 v68, 0
  v_mov_b32 v69, 0
  v_mov_b32 v70, 0
  v_mov_b32 v71, 0
  s_cmp_lt_u32 s3, 3
  s_cselect_b32 s32, 12, 16
  ds_read_b128 v[32:35], v3 offset:8192
  v_mfma_f32_16x16x32_bf16 v[160:163], v[36:39], v[136:139], v[160:163]
  v_mov_b32 v72, 0
  v_mov_b32 v73, 0
  v_mov_b32 v74, 0
  v_mov_b32 v75, 0
  s_mov_b32 s75, 0x100fe
  s_bitset1_b32 s75, s32
  v_mfma_f32_16x16x32_bf16 v[164:167], v[36:39], v[140:143], v[164:167]
  v_mov_b32 v76, 0
  v_mov_b32 v77, 0
  v_mov_b32 v78, 0
  v_mov_b32 v79, 0
  s_add_u32 s32, s39, 1
  s_cmp_lt_u32 s3, 4
  ds_read_b128 v[36:39], v3 offset:9216
  v_mfma_f32_16x16x32_bf16 v[160:163], v[40:43], v[144:147], v[160:163]
  v_mov_b32 v80, 0
  v_mov_b32 v81, 0
  v_mov_b32 v82, 0
  v_mov_b32 v83, 0
  s_cselect_b32 s66, 9, s32
  s_cselect_b32 s32, 15, s32
  v_mfma_f32_16x16x32_bf16 v[164:167], v[40:43], v[148:151], v[164:167]
  v_mov_b32 v84, 0
  v_mov_b32 v85, 0
  v_mov_b32 v86, 0
  v_mov_b32 v87, 0
  s_bitset1_b32 s75, s32
  s_bitset1_b32 s75, s66
  ds_read_b128 v[40:43], v3 offset:10240
  v_mfma_f32_16x16x32_bf16 v[160:163], v[44:47], v[152:155], v[160:163]
  v_mov_b32 v88, 0
  v_mov_b32 v89, 0
  v_mov_b32 v90, 0
  v_mov_b32 v91, 0
  s_lshr_b32 s32, s2, 1
  s_lshl_b32 s32, s32, 7
  v_mfma_f32_16x16x32_bf16 v[164:167], v[44:47], v[156:159], v[164:167]
  v_mov_b32 v92, 0
  v_mov_b32 v93, 0
  v_mov_b32 v94, 0
  v_mov_b32 v95, 0
  s_add_u32 s84, s32, 0x2008000
  s_mov_b32 s85, 0
  ds_read_b128 v[44:47], v3 offset:11264
  v_mfma_f32_16x16x32_bf16 v[168:171], v[48:51], v[128:131], v[216:219]
  v_mov_b32 v96, 0
  v_mov_b32 v97, 0
  v_mov_b32 v98, 0
  v_mov_b32 v99, 0
  s_mov_b64 s[8:9], s[28:29]
  s_mov_b64 s[10:11], s[30:31]
  v_mfma_f32_16x16x32_bf16 v[172:175], v[48:51], v[132:135], v[220:223]
  v_mov_b32 v100, 0
  v_mov_b32 v101, 0
  v_mov_b32 v102, 0
  v_mov_b32 v103, 0
  s_mov_b64 s[12:13], s[28:29]
  s_mov_b64 s[14:15], s[30:31]
  ds_read_b128 v[48:51], v3 offset:12288
  v_mfma_f32_16x16x32_bf16 v[168:171], v[52:55], v[136:139], v[168:171]
  v_mov_b32 v104, 0
  v_mov_b32 v105, 0
  v_mov_b32 v106, 0
  v_mov_b32 v107, 0
  s_lshl_b32 s32, s35, 2
  s_add_u32 s32, s32, s3
  v_mfma_f32_16x16x32_bf16 v[172:175], v[52:55], v[140:143], v[172:175]
  v_mov_b32 v108, 0
  v_mov_b32 v109, 0
  v_mov_b32 v110, 0
  v_mov_b32 v111, 0
  s_and_b32 s33, s32, 15
  s_mul_i32 s70, s33, 40960
  ds_read_b128 v[52:55], v3 offset:13312
  v_mfma_f32_16x16x32_bf16 v[168:171], v[56:59], v[144:147], v[168:171]
  v_mov_b32 v112, 0
  v_mov_b32 v113, 0
  v_mov_b32 v114, 0
  v_mov_b32 v115, 0
  s_xor_b32 s33, s33, 8
  s_mul_i32 s71, s33, 40960
  v_mfma_f32_16x16x32_bf16 v[172:175], v[56:59], v[148:151], v[172:175]
  v_mov_b32 v116, 0
  v_mov_b32 v117, 0
  v_mov_b32 v118, 0
  v_mov_b32 v119, 0
  s_mul_i32 s32, s35, 320
  s_add_u32 s70, s70, s32
  ds_read_b128 v[56:59], v3 offset:14336
  v_mfma_f32_16x16x32_bf16 v[168:171], v[60:63], v[152:155], v[168:171]
  v_mov_b32 v120, 0
  v_mov_b32 v121, 0
  v_mov_b32 v122, 0
  v_mov_b32 v123, 0
  s_add_u32 s71, s71, s32
  s_movk_i32 s72, 64
  v_mfma_f32_16x16x32_bf16 v[172:175], v[60:63], v[156:159], v[172:175]
  v_mov_b32 v124, 0
  v_mov_b32 v125, 0
  v_mov_b32 v126, 0
  v_mov_b32 v127, 0
  s_movk_i32 s73, 64
  s_movk_i32 s74, 19456
  ds_read_b128 v[60:63], v3 offset:15360
  s_cmp_lt_u32 s3, 4
  s_cbranch_scc1 k2_noqb
  ds_read_b128 v[224:227], v27 offset:0
  ds_read_b128 v[228:231], v27 offset:1024
  ds_read_b128 v[232:235], v27 offset:2048
  ds_read_b128 v[236:239], v27 offset:3072
  ds_read_b128 v[240:243], v27 offset:4096
  ds_read_b128 v[244:247], v27 offset:5120
  ds_read_b128 v[248:251], v27 offset:6144
  ds_read_b128 v[252:255], v27 offset:7168
k2_noqb:
  v_max3_f32 v10, v160, v161, v162
  v_max3_f32 v24, v163, v168, v169
  v_max3_f32 v10, v10, v170, v171
  v_max_f32 v10, v10, v24
  v_mov_b32 v24, v10
  s_nop 1
  v_permlane16_swap_b32 v10, v24
  v_max_f32 v10, v10, v24
  v_mov_b32 v24, v10
  s_nop 1
  v_permlane32_swap_b32 v10, v24
  v_max_f32 v10, v10, v24
  v_xor_b32 v10, 0x80000000, v10
  v_max3_f32 v11, v164, v165, v166
  v_max3_f32 v25, v167, v172, v173
  v_max3_f32 v11, v11, v174, v175
  v_max_f32 v11, v11, v25
  v_mov_b32 v25, v11
  s_nop 1
  v_permlane16_swap_b32 v11, v25
  v_max_f32 v11, v11, v25
  v_mov_b32 v25, v11
  s_nop 1
  v_permlane32_swap_b32 v11, v25
  v_max_f32 v11, v11, v25
  v_xor_b32 v11, 0x80000000, v11
  s_cmp_ge_u32 s3, 4
  s_cbranch_scc1 k2_nopub2
  ds_write_b64 v31, v[10:11]
k2_nopub2:
  v_add_f32 v160, v160, v10
  v_add_f32 v161, v161, v10
  v_add_f32 v162, v162, v10
  v_add_f32 v163, v163, v10
  v_add_f32 v168, v168, v10
  v_add_f32 v169, v169, v10
  v_add_f32 v170, v170, v10
  v_add_f32 v171, v171, v10
  v_add_f32 v164, v164, v11
  v_add_f32 v165, v165, v11
  v_add_f32 v166, v166, v11
  v_add_f32 v167, v167, v11
  v_add_f32 v172, v172, v11
  v_add_f32 v173, v173, v11
  v_add_f32 v174, v174, v11
  v_add_f32 v175, v175, v11
  v_exp_f32 v16, v160
  v_exp_f32 v17, v161
  s_nop 0
  v_cvt_pk_bf16_f32 v192, v16, v17
  v_add_f32 v12, v16, v17
  v_exp_f32 v18, v162
  v_exp_f32 v19, v163
  s_nop 0
  v_cvt_pk_bf16_f32 v193, v18, v19
  v_add_f32 v18, v18, v19
  v_exp_f32 v20, v164
  v_add_f32 v12, v12, v18
  v_exp_f32 v21, v165
  s_nop 0
  v_cvt_pk_bf16_f32 v196, v20, v21
  v_add_f32 v13, v20, v21
  v_exp_f32 v22, v166
  v_exp_f32 v23, v167
  s_nop 0
  v_cvt_pk_bf16_f32 v197, v22, v23
  v_add_f32 v22, v22, v23
  v_exp_f32 v16, v168
  v_add_f32 v13, v13, v22
  v_exp_f32 v17, v169
  s_nop 0
  v_cvt_pk_bf16_f32 v194, v16, v17
  v_add_f32 v16, v16, v17
  v_exp_f32 v18, v170
  v_add_f32 v12, v12, v16
  v_add_f32 v208, v208, v10
  v_add_f32 v209, v209, v10
  v_add_f32 v210, v210, v10
  v_add_f32 v211, v211, v10
  v_add_f32 v216, v216, v10
  v_add_f32 v217, v217, v10
  v_add_f32 v218, v218, v10
  v_add_f32 v219, v219, v10
  v_add_f32 v212, v212, v11
  v_add_f32 v213, v213, v11
  v_add_f32 v214, v214, v11
  v_add_f32 v215, v215, v11
  v_add_f32 v220, v220, v11
  v_add_f32 v221, v221, v11
  v_add_f32 v222, v222, v11
  v_add_f32 v223, v223, v11
  s_mov_b32 s33, 1
  s_cmp_ge_u32 s33, s40
  s_cbranch_scc1 k2_p1
k2_p1_ret:
  s_waitcnt lgkmcnt(0)
  s_branch k2_h3_1
k2_loop1:
  s_waitcnt lgkmcnt(4)
  v_mfma_f32_16x16x32_bf16 v[64:67], v[32:35], v[192:195], v[64:67]
  v_exp_f32 v19, v179
  s_and_b32 s32, s41, 7
  s_lshl_b32 s32, s32, 13
  v_add_u32 v3, s32, v2
  v_mfma_f32_16x16x32_bf16 v[68:71], v[32:35], v[196:199], v[68:71]
  ds_read_b128 v[32:35], v3 offset:0
  v_cvt_pk_bf16_f32 v201, v18, v19
  v_mfma_f32_16x16x32_bf16 v[72:75], v[36:39], v[192:195], v[72:75]
  v_add_f32 v18, v18, v19
  v_exp_f32 v20, v180
  s_and_b32 m0, s54, 0xffff
  s_bitset1_b32 m0, 16
  s_add_u32 s54, s54, 0x4000
  buffer_load_dwordx4 v5, s[16:19], s55 offen offset:0 lds
  v_mfma_f32_16x16x32_bf16 v[76:79], v[36:39], v[196:199], v[76:79]
  ds_read_b128 v[36:39], v3 offset:1024
  v_add_f32 v14, v14, v18
  v_mfma_f32_16x16x32_bf16 v[80:83], v[40:43], v[192:195], v[80:83]
  v_exp_f32 v21, v181
  v_add_f32 v8, v8, v12
  v_add_f32 v9, v9, v13
  v_mfma_f32_16x16x32_bf16 v[84:87], v[40:43], v[196:199], v[84:87]
  ds_read_b128 v[40:43], v3 offset:2048
  v_cvt_pk_bf16_f32 v204, v20, v21
  v_mfma_f32_16x16x32_bf16 v[88:91], v[44:47], v[192:195], v[88:91]
  v_add_f32 v15, v20, v21
  v_exp_f32 v22, v182
  v_mfma_f32_16x16x32_bf16 v[92:95], v[44:47], v[196:199], v[92:95]
  ds_read_b128 v[44:47], v3 offset:3072
  s_waitcnt lgkmcnt(4)
  v_mfma_f32_16x16x32_bf16 v[96:99], v[48:51], v[192:195], v[96:99]
  v_exp_f32 v23, v183
  s_cmp_ge_u32 s41, s40
  s_cbranch_scc1 k2_pa1
k2_pa1_ret:
  v_mfma_f32_16x16x32_bf16 v[100:103], v[48:51], v[196:199], v[100:103]
  ds_read_b128 v[48:51], v3 offset:4096
  v_cvt_pk_bf16_f32 v205, v22, v23
  v_mfma_f32_16x16x32_bf16 v[104:107], v[52:55], v[192:195], v[104:107]
  v_add_f32 v22, v22, v23
  v_exp_f32 v16, v184
  buffer_load_dwordx4 v5, s[16:19], s55 offen offset:1024 lds
  s_add_u32 s55, s55, 0x8000
  v_mfma_f32_16x16x32_bf16 v[108:111], v[52:55], v[196:199], v[108:111]
  ds_read_b128 v[52:55], v3 offset:5120
  v_add_f32 v15, v15, v22
  v_mfma_f32_16x16x32_bf16 v[112:115], v[56:59], v[192:195], v[112:115]
  v_exp_f32 v17, v185
  v_mfma_f32_16x16x32_bf16 v[116:119], v[56:59], v[196:199], v[116:119]
  s_setprio 2
  ds_read_b128 v[56:59], v3 offset:6144
  v_cvt_pk_bf16_f32 v202, v16, v17
  v_mfma_f32_16x16x32_bf16 v[120:123], v[60:63], v[192:195], v[120:123]
  v_add_f32 v16, v16, v17
  v_exp_f32 v18, v186
  v_mfma_f32_16x16x32_bf16 v[124:127], v[60:63], v[196:199], v[124:127]
  ds_read_b128 v[60:63], v3 offset:7168
  v_add_f32 v14, v14, v16
  s_waitcnt lgkmcnt(4)
  v_mfma_f32_16x16x32_bf16 v[160:163], v[32:35], v[128:131], v[208:211]
  v_exp_f32 v19, v187
  v_mfma_f32_16x16x32_bf16 v[164:167], v[32:35], v[132:135], v[212:215]
  ds_read_b128 v[32:35], v4 offset:8192
  v_cvt_pk_bf16_f32 v203, v18, v19
  v_mfma_f32_16x16x32_bf16 v[160:163], v[36:39], v[136:139], v[160:163]
  v_add_f32 v18, v18, v19
  v_exp_f32 v20, v188
  s_cmp_ge_u32 s53, s63
  s_cbranch_scc1 f_g1
  s_and_b32 m0, s52, 0xffff
  s_add_u32 s52, s52, 0x4000
  buffer_load_dwordx4 v5, s[16:19], s53 offen offset:0 lds
f_g1:
  v_mfma_f32_16x16x32_bf16 v[164:167], v[36:39], v[140:143], v[164:167]
  ds_read_b128 v[36:39], v4 offset:9216
  v_add_f32 v14, v14, v18
  v_mfma_f32_16x16x32_bf16 v[160:163], v[40:43], v[144:147], v[160:163]
  v_exp_f32 v21, v189
  v_mfma_f32_16x16x32_bf16 v[164:167], v[40:43], v[148:151], v[164:167]
  ds_read_b128 v[40:43], v4 offset:10240
  v_cvt_pk_bf16_f32 v206, v20, v21
  v_mfma_f32_16x16x32_bf16 v[160:163], v[44:47], v[152:155], v[160:163]
  v_add_f32 v20, v20, v21
  v_exp_f32 v22, v190
  v_mfma_f32_16x16x32_bf16 v[164:167], v[44:47], v[156:159], v[164:167]
  ds_read_b128 v[44:47], v4 offset:11264
  v_add_f32 v15, v15, v20
  s_waitcnt lgkmcnt(4)
  v_mfma_f32_16x16x32_bf16 v[168:171], v[48:51], v[128:131], v[216:219]
  v_exp_f32 v23, v191
  v_mfma_f32_16x16x32_bf16 v[172:175], v[48:51], v[132:135], v[220:223]
  ds_read_b128 v[48:51], v4 offset:12288
  v_cvt_pk_bf16_f32 v207, v22, v23
  v_mfma_f32_16x16x32_bf16 v[168:171], v[52:55], v[136:139], v[168:171]
  v_exp_f32 v16, v160
  v_add_f32 v22, v22, v23
  s_cmp_ge_u32 s53, s63
  s_cbranch_scc1 f_g2
  buffer_load_dwordx4 v5, s[16:19], s53 offen offset:1024 lds
  s_add_u32 s53, s53, 0x8000
f_g2:
  v_mfma_f32_16x16x32_bf16 v[172:175], v[52:55], v[140:143], v[172:175]
  ds_read_b128 v[52:55], v4 offset:13312
  v_add_f32 v15, v15, v22
  v_mfma_f32_16x16x32_bf16 v[168:171], v[56:59], v[144:147], v[168:171]
  v_exp_f32 v17, v161
  v_add_f32 v7, v14, v15
  v_mfma_f32_16x16x32_bf16 v[172:175], v[56:59], v[148:151], v[172:175]
  ds_read_b128 v[56:59], v4 offset:14336
  v_cvt_pk_bf16_f32 v192, v16, v17
  v_cmp_nge_f32 vcc, s42, v7
  v_mfma_f32_16x16x32_bf16 v[168:171], v[60:63], v[152:155], v[168:171]
  v_add_f32 v12, v16, v17
  v_exp_f32 v18, v162
  v_mfma_f32_16x16x32_bf16 v[172:175], v[60:63], v[156:159], v[172:175]
  ds_read_b128 v[60:63], v4 offset:15360
  s_cbranch_vccnz k2_sb1
k2_sb1_ret:
  s_waitcnt lgkmcnt(4)
  v_mfma_f32_16x16x32_bf16 v[64:67], v[32:35], v[200:203], v[64:67]
  v_exp_f32 v19, v163
  v_add_f32 v8, v8, v14
  v_add_f32 v9, v9, v15
  v_mfma_f32_16x16x32_bf16 v[68:71], v[32:35], v[204:207], v[68:71]
  s_setprio 1
  ds_read_b128 v[32:35], v3 offset:8192
  v_cvt_pk_bf16_f32 v193, v18, v19
  v_mfma_f32_16x16x32_bf16 v[72:75], v[36:39], v[200:203], v[72:75]
  v_add_f32 v18, v18, v19
  v_exp_f32 v20, v164
  v_mfma_f32_16x16x32_bf16 v[76:79], v[36:39], v[204:207], v[76:79]
  ds_read_b128 v[36:39], v3 offset:9216
  v_add_f32 v12, v12, v18
  v_mfma_f32_16x16x32_bf16 v[80:83], v[40:43], v[200:203], v[80:83]
  v_exp_f32 v21, v165
  s_add_u32 s33, s41, 1
  s_cmp_ge_u32 s33, s40
  s_cbranch_scc1 k2_pb1
k2_pb1_ret:
  v_mfma_f32_16x16x32_bf16 v[84:87], v[40:43], v[204:207], v[84:87]
  ds_read_b128 v[40:43], v3 offset:10240
  v_cvt_pk_bf16_f32 v196, v20, v21
  v_mfma_f32_16x16x32_bf16 v[88:91], v[44:47], v[200:203], v[88:91]
  v_add_f32 v13, v20, v21
  v_exp_f32 v22, v166
  v_mfma_f32_16x16x32_bf16 v[92:95], v[44:47], v[204:207], v[92:95]
  ds_read_b128 v[44:47], v3 offset:11264
  s_waitcnt lgkmcnt(4)
  v_mfma_f32_16x16x32_bf16 v[96:99], v[48:51], v[200:203], v[96:99]
  v_exp_f32 v23, v167
  v_mfma_f32_16x16x32_bf16 v[100:103], v[48:51], v[204:207], v[100:103]
  ds_read_b128 v[48:51], v3 offset:12288
  v_cvt_pk_bf16_f32 v197, v22, v23
  v_mfma_f32_16x16x32_bf16 v[104:107], v[52:55], v[200:203], v[104:107]
  v_add_f32 v22, v22, v23
  v_exp_f32 v16, v168
  v_mfma_f32_16x16x32_bf16 v[108:111], v[52:55], v[204:207], v[108:111]
  ds_read_b128 v[52:55], v3 offset:13312
  v_add_f32 v13, v13, v22
  v_mfma_f32_16x16x32_bf16 v[112:115], v[56:59], v[200:203], v[112:115]
  v_exp_f32 v17, v169
  v_mfma_f32_16x16x32_bf16 v[116:119], v[56:59], v[204:207], v[116:119]
  s_setprio 0
  ds_read_b128 v[56:59], v3 offset:14336
  v_cvt_pk_bf16_f32 v194, v16, v17
  v_mfma_f32_16x16x32_bf16 v[120:123], v[60:63], v[200:203], v[120:123]
  v_add_f32 v16, v16, v17
  v_exp_f32 v18, v170
  v_mfma_f32_16x16x32_bf16 v[124:127], v[60:63], v[204:207], v[124:127]
  ds_read_b128 v[60:63], v3 offset:15360
  v_add_f32 v12, v12, v16
  s_waitcnt lgkmcnt(4)
k2_h3_1:
  v_mfma_f32_16x16x32_bf16 v[176:179], v[32:35], v[128:131], v[208:211]
  v_exp_f32 v19, v171
  v_mfma_f32_16x16x32_bf16 v[180:183], v[32:35], v[132:135], v[212:215]
  v_cvt_pk_bf16_f32 v195, v18, v19
  v_add_u32 v4, 0x10000, v3
  v_mfma_f32_16x16x32_bf16 v[176:179], v[36:39], v[136:139], v[176:179]
  v_add_f32 v18, v18, v19
  v_exp_f32 v20, v172
  v_mfma_f32_16x16x32_bf16 v[180:183], v[36:39], v[140:143], v[180:183]
  s_waitcnt vmcnt(0) lgkmcnt(0)
  s_bitcmp0_b32 s60, s38
  s_cbranch_scc1 f_hr_1
  s_call_b64 s[100:101], f_hook
f_hr_1:
  s_barrier
  s_setprio 3
  s_bitcmp0_b32 s75, s38
  s_cbranch_scc1 f_pr_1
  s_call_b64 s[100:101], f_post
f_pr_1:
  ds_read_b128 v[32:35], v4 offset:0
  ds_read_b128 v[36:39], v4 offset:1024
  v_add_f32 v12, v12, v18
  v_mfma_f32_16x16x32_bf16 v[176:179], v[40:43], v[144:147], v[176:179]
  v_exp_f32 v21, v173
  v_mfma_f32_16x16x32_bf16 v[180:183], v[40:43], v[148:151], v[180:183]
  ds_read_b128 v[40:43], v4 offset:2048
  v_cvt_pk_bf16_f32 v198, v20, v21
  v_mfma_f32_16x16x32_bf16 v[176:179], v[44:47], v[152:155], v[176:179]
  v_add_f32 v20, v20, v21
  v_exp_f32 v22, v174
  v_mfma_f32_16x16x32_bf16 v[180:183], v[44:47], v[156:159], v[180:183]
  ds_read_b128 v[44:47], v4 offset:3072
  v_add_f32 v13, v13, v20
  v_mfma_f32_16x16x32_bf16 v[184:187], v[48:51], v[128:131], v[216:219]
  v_exp_f32 v23, v175
  v_mfma_f32_16x16x32_bf16 v[188:191], v[48:51], v[132:135], v[220:223]
  ds_read_b128 v[48:51], v4 offset:4096
  v_cvt_pk_bf16_f32 v199, v22, v23
  v_mfma_f32_16x16x32_bf16 v[184:187], v[52:55], v[136:139], v[184:187]
  v_add_f32 v22, v22, v23
  v_exp_f32 v16, v176
  v_mfma_f32_16x16x32_bf16 v[188:191], v[52:55], v[140:143], v[188:191]
  ds_read_b128 v[52:55], v4 offset:5120
  v_add_f32 v13, v13, v22
  v_mfma_f32_16x16x32_bf16 v[184:187], v[56:59], v[144:147], v[184:187]
  v_exp_f32 v17, v177
  v_add_f32 v7, v12, v13
  v_mfma_f32_16x16x32_bf16 v[188:191], v[56:59], v[148:151], v[188:191]
  ds_read_b128 v[56:59], v4 offset:6144
  v_cvt_pk_bf16_f32 v200, v16, v17
  v_cmp_nge_f32 vcc, s42, v7
  v_mfma_f32_16x16x32_bf16 v[184:187], v[60:63], v[152:155], v[184:187]
  v_add_f32 v14, v16, v17
  v_exp_f32 v18, v178
  s_add_u32 s41, s41, 2
  s_add_u32 s38, s38, 1
  v_mfma_f32_16x16x32_bf16 v[188:191], v[60:63], v[156:159], v[188:191]
  ds_read_b128 v[60:63], v4 offset:7168
  s_cbranch_vccnz k2_sa1
k2_sa1_ret:
  s_cmp_lt_u32 s38, s39
  s_cbranch_scc1 k2_loop1
  s_cmp_lt_u32 s3, 4
  s_cbranch_scc1 k2_x1_skip
  ds_read_b64 v[10:11], v31
  s_add_u32 s41, s41, 2
  s_mov_b32 s40, s43
  v_mov_b32 v128, v224
  v_mov_b32 v129, v225
  v_mov_b32 v130, v226
  v_mov_b32 v131, v227
  v_mov_b32 v132, v228
  v_mov_b32 v133, v229
  v_mov_b32 v134, v230
  v_mov_b32 v135, v231
  v_mov_b32 v136, v232
  v_mov_b32 v137, v233
  v_mov_b32 v138, v234
  v_mov_b32 v139, v235
  v_mov_b32 v140, v236
  v_mov_b32 v141, v237
  v_mov_b32 v142, v238
  v_mov_b32 v143, v239
  v_mov_b32 v144, v240
  v_mov_b32 v145, v241
  v_mov_b32 v146, v242
  v_mov_b32 v147, v243
  v_mov_b32 v148, v244
  v_mov_b32 v149, v245
  v_mov_b32 v150, v246
  v_mov_b32 v151, v247
  v_mov_b32 v152, v248
  v_mov_b32 v153, v249
  v_mov_b32 v154, v250
  v_mov_b32 v155, v251
  v_mov_b32 v156, v252
  v_mov_b32 v157, v253
  v_mov_b32 v158, v254
  v_mov_b32 v159, v255
  s_waitcnt lgkmcnt(0)
  v_mov_b32 v208, v10
  v_mov_b32 v209, v10
  v_mov_b32 v210, v10
  v_mov_b32 v211, v10
  v_mov_b32 v212, v11
  v_mov_b32 v213, v11
  v_mov_b32 v214, v11
  v_mov_b32 v215, v11
  v_mov_b32 v216, v10
  v_mov_b32 v217, v10
  v_mov_b32 v218, v10
  v_mov_b32 v219, v10
  v_mov_b32 v220, v11
  v_mov_b32 v221, v11
  v_mov_b32 v222, v11
  v_mov_b32 v223, v11
k2_x1_skip:
  s_waitcnt lgkmcnt(4)
  v_mfma_f32_16x16x32_bf16 v[64:67], v[32:35], v[192:195], v[64:67]
  v_exp_f32 v19, v179
  s_and_b32 s32, s41, 7
  s_lshl_b32 s32, s32, 13
  v_add_u32 v3, s32, v2
  v_mfma_f32_16x16x32_bf16 v[68:71], v[32:35], v[196:199], v[68:71]
  ds_read_b128 v[32:35], v3 offset:0
  v_cvt_pk_bf16_f32 v201, v18, v19
  v_mfma_f32_16x16x32_bf16 v[72:75], v[36:39], v[192:195], v[72:75]
  v_add_f32 v18, v18, v19
  v_exp_f32 v20, v180
  s_and_b32 m0, s54, 0xffff
  s_bitset1_b32 m0, 16
  s_add_u32 s54, s54, 0x4000
  buffer_load_dwordx4 v5, s[16:19], s55 offen offset:0 lds
  v_mfma_f32_16x16x32_bf16 v[76:79], v[36:39], v[196:199], v[76:79]
  ds_read_b128 v[36:39], v3 offset:1024
  v_add_f32 v14, v14, v18
  v_mfma_f32_16x16x32_bf16 v[80:83], v[40:43], v[192:195], v[80:83]
  v_exp_f32 v21, v181
  v_add_f32 v8, v8, v12
  v_add_f32 v9, v9, v13
  v_mfma_f32_16x16x32_bf16 v[84:87], v[40:43], v[196:199], v[84:87]
  ds_read_b128 v[40:43], v3 offset:2048
  v_cvt_pk_bf16_f32 v204, v20, v21
  v_mfma_f32_16x16x32_bf16 v[88:91], v[44:47], v[192:195], v[88:91]
  v_add_f32 v15, v20, v21
  v_exp_f32 v22, v182
  v_mfma_f32_16x16x32_bf16 v[92:95], v[44:47], v[196:199], v[92:95]
  ds_read_b128 v[44:47], v3 offset:3072
  s_waitcnt lgkmcnt(4)
  v_mfma_f32_16x16x32_bf16 v[96:99], v[48:51], v[192:195], v[96:99]
  v_exp_f32 v23, v183
  s_cmp_ge_u32 s41, s40
  s_cbranch_scc1 k2_pa2f
k2_pa2f_ret:
  v_mfma_f32_16x16x32_bf16 v[100:103], v[48:51], v[196:199], v[100:103]
  ds_read_b128 v[48:51], v3 offset:4096
  v_cvt_pk_bf16_f32 v205, v22, v23
  v_mfma_f32_16x16x32_bf16 v[104:107], v[52:55], v[192:195], v[104:107]
  v_add_f32 v22, v22, v23
  v_exp_f32 v16, v184
  buffer_load_dwordx4 v5, s[16:19], s55 offen offset:1024 lds
  s_add_u32 s55, s55, 0x8000
  v_mfma_f32_16x16x32_bf16 v[108:111], v[52:55], v[196:199], v[108:111]
  ds_read_b128 v[52:55], v3 offset:5120
  v_add_f32 v15, v15, v22
  v_mfma_f32_16x16x32_bf16 v[112:115], v[56:59], v[192:195], v[112:115]
  v_exp_f32 v17, v185
  v_mfma_f32_16x16x32_bf16 v[116:119], v[56:59], v[196:199], v[116:119]
  s_setprio 2
  ds_read_b128 v[56:59], v3 offset:6144
  v_cvt_pk_bf16_f32 v202, v16, v17
  v_mfma_f32_16x16x32_bf16 v[120:123], v[60:63], v[192:195], v[120:123]
  v_add_f32 v16, v16, v17
  v_exp_f32 v18, v186
  v_mfma_f32_16x16x32_bf16 v[124:127], v[60:63], v[196:199], v[124:127]
  ds_read_b128 v[60:63], v3 offset:7168
  v_add_f32 v14, v14, v16
  s_waitcnt lgkmcnt(4)
  v_mfma_f32_16x16x32_bf16 v[160:163], v[32:35], v[128:131], v[208:211]
  v_exp_f32 v19, v187
  v_mfma_f32_16x16x32_bf16 v[164:167], v[32:35], v[132:135], v[212:215]
  ds_read_b128 v[32:35], v4 offset:8192
  v_cvt_pk_bf16_f32 v203, v18, v19
  v_mfma_f32_16x16x32_bf16 v[160:163], v[36:39], v[136:139], v[160:163]
  v_add_f32 v18, v18, v19
  v_exp_f32 v20, v188
  s_cmp_ge_u32 s53, s63
  s_cbranch_scc1 f_g3
  s_and_b32 m0, s52, 0xffff
  s_add_u32 s52, s52, 0x4000
  buffer_load_dwordx4 v5, s[16:19], s53 offen offset:0 lds
f_g3:
  v_mfma_f32_16x16x32_bf16 v[164:167], v[36:39], v[140:143], v[164:167]
  ds_read_b128 v[36:39], v4 offset:9216
  v_add_f32 v14, v14, v18
  v_mfma_f32_16x16x32_bf16 v[160:163], v[40:43], v[144:147], v[160:163]
  v_exp_f32 v21, v189
  v_mfma_f32_16x16x32_bf16 v[164:167], v[40:43], v[148:151], v[164:167]
  ds_read_b128 v[40:43], v4 offset:10240
  v_cvt_pk_bf16_f32 v206, v20, v21
  v_mfma_f32_16x16x32_bf16 v[160:163], v[44:47], v[152:155], v[160:163]
  v_add_f32 v20, v20, v21
  v_exp_f32 v22, v190
  v_mfma_f32_16x16x32_bf16 v[164:167], v[44:47], v[156:159], v[164:167]
  ds_read_b128 v[44:47], v4 offset:11264
  v_add_f32 v15, v15, v20
  s_waitcnt lgkmcnt(4)
  v_mfma_f32_16x16x32_bf16 v[168:171], v[48:51], v[128:131], v[216:219]
  v_exp_f32 v23, v191
  v_mfma_f32_16x16x32_bf16 v[172:175], v[48:51], v[132:135], v[220:223]
  ds_read_b128 v[48:51], v4 offset:12288
  v_cvt_pk_bf16_f32 v207, v22, v23
  v_mfma_f32_16x16x32_bf16 v[168:171], v[52:55], v[136:139], v[168:171]
  v_exp_f32 v16, v160
  v_add_f32 v22, v22, v23
  s_cmp_ge_u32 s53, s63
  s_cbranch_scc1 f_g4
  buffer_load_dwordx4 v5, s[16:19], s53 offen offset:1024 lds
  s_add_u32 s53, s53, 0x8000
f_g4:
  v_mfma_f32_16x16x32_bf16 v[172:175], v[52:55], v[140:143], v[172:175]
  ds_read_b128 v[52:55], v4 offset:13312
  v_add_f32 v15, v15, v22
  v_mfma_f32_16x16x32_bf16 v[168:171], v[56:59], v[144:147], v[168:171]
  v_exp_f32 v17, v161
  v_add_f32 v7, v14, v15
  v_mfma_f32_16x16x32_bf16 v[172:175], v[56:59], v[148:151], v[172:175]
  ds_read_b128 v[56:59], v4 offset:14336
  v_cvt_pk_bf16_f32 v192, v16, v17
  v_cmp_nge_f32 vcc, s42, v7
  v_mfma_f32_16x16x32_bf16 v[168:171], v[60:63], v[152:155], v[168:171]
  v_add_f32 v12, v16, v17
  v_exp_f32 v18, v162
  v_mfma_f32_16x16x32_bf16 v[172:175], v[60:63], v[156:159], v[172:175]
  ds_read_b128 v[60:63], v4 offset:15360
  s_cbranch_vccnz k2_sb2f
k2_sb2f_ret:
  s_waitcnt lgkmcnt(4)
  v_mfma_f32_16x16x32_bf16 v[64:67], v[32:35], v[200:203], v[64:67]
  v_exp_f32 v19, v163
  v_add_f32 v8, v8, v14
  v_add_f32 v9, v9, v15
  v_mfma_f32_16x16x32_bf16 v[68:71], v[32:35], v[204:207], v[68:71]
  s_setprio 1
  ds_read_b128 v[32:35], v3 offset:8192
  v_cvt_pk_bf16_f32 v193, v18, v19
  v_mfma_f32_16x16x32_bf16 v[72:75], v[36:39], v[200:203], v[72:75]
  v_add_f32 v18, v18, v19
  v_exp_f32 v20, v164
  v_mfma_f32_16x16x32_bf16 v[76:79], v[36:39], v[204:207], v[76:79]
  ds_read_b128 v[36:39], v3 offset:9216
  v_add_f32 v12, v12, v18
  v_mfma_f32_16x16x32_bf16 v[80:83], v[40:43], v[200:203], v[80:83]
  v_exp_f32 v21, v165
  s_add_u32 s33, s41, 1
  s_cmp_ge_u32 s33, s40
  s_cbranch_scc1 k2_pb2f
k2_pb2f_ret:
  v_mfma_f32_16x16x32_bf16 v[84:87], v[40:43], v[204:207], v[84:87]
  ds_read_b128 v[40:43], v3 offset:10240
  v_cvt_pk_bf16_f32 v196, v20, v21
  v_mfma_f32_16x16x32_bf16 v[88:91], v[44:47], v[200:203], v[88:91]
  v_add_f32 v13, v20, v21
  v_exp_f32 v22, v166
  v_mfma_f32_16x16x32_bf16 v[92:95], v[44:47], v[204:207], v[92:95]
  ds_read_b128 v[44:47], v3 offset:11264
  s_waitcnt lgkmcnt(4)
  v_mfma_f32_16x16x32_bf16 v[96:99], v[48:51], v[200:203], v[96:99]
  v_exp_f32 v23, v167
  v_mfma_f32_16x16x32_bf16 v[100:103], v[48:51], v[204:207], v[100:103]
  ds_read_b128 v[48:51], v3 offset:12288
  v_cvt_pk_bf16_f32 v197, v22, v23
  v_mfma_f32_16x16x32_bf16 v[104:107], v[52:55], v[200:203], v[104:107]
  v_add_f32 v22, v22, v23
  v_exp_f32 v16, v168
  v_mfma_f32_16x16x32_bf16 v[108:111], v[52:55], v[204:207], v[108:111]
  ds_read_b128 v[52:55], v3 offset:13312
  v_add_f32 v13, v13, v22
  v_mfma_f32_16x16x32_bf16 v[112:115], v[56:59], v[200:203], v[112:115]
  v_exp_f32 v17, v169
  v_mfma_f32_16x16x32_bf16 v[116:119], v[56:59], v[204:207], v[116:119]
  s_setprio 0
  ds_read_b128 v[56:59], v3 offset:14336
  v_cvt_pk_bf16_f32 v194, v16, v17
  v_mfma_f32_16x16x32_bf16 v[120:123], v[60:63], v[200:203], v[120:123]
  v_add_f32 v16, v16, v17
  v_exp_f32 v18, v170
  v_mfma_f32_16x16x32_bf16 v[124:127], v[60:63], v[204:207], v[124:127]
  ds_read_b128 v[60:63], v3 offset:15360
  v_add_f32 v12, v12, v16
  s_waitcnt lgkmcnt(4)
k2_h3_2f:
  v_mfma_f32_16x16x32_bf16 v[176:179], v[32:35], v[128:131], v[208:211]
  v_exp_f32 v19, v171
  v_mfma_f32_16x16x32_bf16 v[180:183], v[32:35], v[132:135], v[212:215]
  v_cvt_pk_bf16_f32 v195, v18, v19
  v_add_u32 v4, 0x10000, v3
  v_mfma_f32_16x16x32_bf16 v[176:179], v[36:39], v[136:139], v[176:179]
  v_add_f32 v18, v18, v19
  v_exp_f32 v20, v172
  v_mfma_f32_16x16x32_bf16 v[180:183], v[36:39], v[140:143], v[180:183]
  s_waitcnt vmcnt(0) lgkmcnt(0)
  s_bitcmp0_b32 s60, s38
  s_cbranch_scc1 f_hr_2f
  s_call_b64 s[100:101], f_hook
f_hr_2f:
  s_barrier
  s_setprio 3
  s_bitcmp0_b32 s75, s38
  s_cbranch_scc1 f_pr_2f
  s_call_b64 s[100:101], f_post
f_pr_2f:
  ds_read_b128 v[32:35], v4 offset:0
  ds_read_b128 v[36:39], v4 offset:1024
  v_add_f32 v12, v12, v18
  v_mfma_f32_16x16x32_bf16 v[176:179], v[40:43], v[144:147], v[176:179]
  v_exp_f32 v21, v173
  s_cmp_lt_u32 s3, 4
  s_cbranch_scc1 k2_x2_skip
  v_mov_b32 v24, v8
  s_nop 1
  v_permlane16_swap_b32 v8, v24
  v_add_f32 v8, v8, v24
  v_mov_b32 v24, v8
  s_nop 1
  v_permlane32_swap_b32 v8, v24
  v_add_f32 v8, v8, v24
  v_rcp_f32 v26, v8
  v_mov_b32 v25, v9
  s_nop 1
  v_permlane16_swap_b32 v9, v25
  v_add_f32 v9, v9, v25
  v_mov_b32 v25, v9
  s_nop 1
  v_permlane32_swap_b32 v9, v25
  v_add_f32 v9, v9, v25
  v_rcp_f32 v27, v9
  v_mov_b32 v8, 0
  v_mov_b32 v9, 0
  s_add_u32 s32, s56, 0x1000
  v_mul_f32 v64, v64, v26
  v_mul_f32 v65, v65, v26
  v_mul_f32 v66, v66, v26
  v_mul_f32 v67, v67, v26
  v_cvt_pk_bf16_f32 v224, v64, v65
  v_cvt_pk_bf16_f32 v225, v66, v67
  v_mov_b32 v64, 0
  v_mov_b32 v65, 0
  v_mov_b32 v66, 0
  v_mov_b32 v67, 0
  v_mul_f32 v72, v72, v26
  v_mul_f32 v73, v73, v26
  v_mul_f32 v74, v74, v26
  v_mul_f32 v75, v75, v26
  v_cvt_pk_bf16_f32 v226, v72, v73
  v_cvt_pk_bf16_f32 v227, v74, v75
  v_mov_b32 v72, 0
  v_mov_b32 v73, 0
  v_mov_b32 v74, 0
  v_mov_b32 v75, 0
  buffer_store_dwordx4 v[224:227], v2, s[4:7], s56 offen offset:0 sc1
  v_mul_f32 v68, v68, v27
  v_mul_f32 v69, v69, v27
  v_mul_f32 v70, v70, v27
  v_mul_f32 v71, v71, v27
  v_cvt_pk_bf16_f32 v228, v68, v69
  v_cvt_pk_bf16_f32 v229, v70, v71
  v_mov_b32 v68, 0
  v_mov_b32 v69, 0
  v_mov_b32 v70, 0
  v_mov_b32 v71, 0
  v_mul_f32 v76, v76, v27
  v_mul_f32 v77, v77, v27
  v_mul_f32 v78, v78, v27
  v_mul_f32 v79, v79, v27
  v_cvt_pk_bf16_f32 v230, v76, v77
  v_cvt_pk_bf16_f32 v231, v78, v79
  v_mov_b32 v76, 0
  v_mov_b32 v77, 0
  v_mov_b32 v78, 0
  v_mov_b32 v79, 0
  buffer_store_dwordx4 v[228:231], v2, s[4:7], s56 offen offset:1024 sc1
  v_mul_f32 v80, v80, v26
  v_mul_f32 v81, v81, v26
  v_mul_f32 v82, v82, v26
  v_mul_f32 v83, v83, v26
  v_cvt_pk_bf16_f32 v232, v80, v81
  v_cvt_pk_bf16_f32 v233, v82, v83
  v_mov_b32 v80, 0
  v_mov_b32 v81, 0
  v_mov_b32 v82, 0
  v_mov_b32 v83, 0
  v_mul_f32 v88, v88, v26
  v_mul_f32 v89, v89, v26
  v_mul_f32 v90, v90, v26
  v_mul_f32 v91, v91, v26
  v_cvt_pk_bf16_f32 v234, v88, v89
  v_cvt_pk_bf16_f32 v235, v90, v91
  v_mov_b32 v88, 0
  v_mov_b32 v89, 0
  v_mov_b32 v90, 0
  v_mov_b32 v91, 0
  buffer_store_dwordx4 v[232:235], v2, s[4:7], s56 offen offset:2048 sc1
  v_mul_f32 v84, v84, v27
  v_mul_f32 v85, v85, v27
  v_mul_f32 v86, v86, v27
  v_mul_f32 v87, v87, v27
  v_cvt_pk_bf16_f32 v236, v84, v85
  v_cvt_pk_bf16_f32 v237, v86, v87
  v_mov_b32 v84, 0
  v_mov_b32 v85, 0
  v_mov_b32 v86, 0
  v_mov_b32 v87, 0
  v_mul_f32 v92, v92, v27
  v_mul_f32 v93, v93, v27
  v_mul_f32 v94, v94, v27
  v_mul_f32 v95, v95, v27
  v_cvt_pk_bf16_f32 v238, v92, v93
  v_cvt_pk_bf16_f32 v239, v94, v95
  v_mov_b32 v92, 0
  v_mov_b32 v93, 0
  v_mov_b32 v94, 0
  v_mov_b32 v95, 0
  buffer_store_dwordx4 v[236:239], v2, s[4:7], s56 offen offset:3072 sc1
  v_mul_f32 v96, v96, v26
  v_mul_f32 v97, v97, v26
  v_mul_f32 v98, v98, v26
  v_mul_f32 v99, v99, v26
  v_cvt_pk_bf16_f32 v240, v96, v97
  v_cvt_pk_bf16_f32 v241, v98, v99
  v_mov_b32 v96, 0
  v_mov_b32 v97, 0
  v_mov_b32 v98, 0
  v_mov_b32 v99, 0
  v_mul_f32 v104, v104, v26
  v_mul_f32 v105, v105, v26
  v_mul_f32 v106, v106, v26
  v_mul_f32 v107, v107, v26
  v_cvt_pk_bf16_f32 v242, v104, v105
  v_cvt_pk_bf16_f32 v243, v106, v107
  v_mov_b32 v104, 0
  v_mov_b32 v105, 0
  v_mov_b32 v106, 0
  v_mov_b32 v107, 0
  buffer_store_dwordx4 v[240:243], v2, s[4:7], s32 offen offset:0 sc1
  v_mul_f32 v100, v100, v27
  v_mul_f32 v101, v101, v27
  v_mul_f32 v102, v102, v27
  v_mul_f32 v103, v103, v27
  v_cvt_pk_bf16_f32 v244, v100, v101
  v_cvt_pk_bf16_f32 v245, v102, v103
  v_mov_b32 v100, 0
  v_mov_b32 v101, 0
  v_mov_b32 v102, 0
  v_mov_b32 v103, 0
  v_mul_f32 v108, v108, v27
  v_mul_f32 v109, v109, v27
  v_mul_f32 v110, v110, v27
  v_mul_f32 v111, v111, v27
  v_cvt_pk_bf16_f32 v246, v108, v109
  v_cvt_pk_bf16_f32 v247, v110, v111
  v_mov_b32 v108, 0
  v_mov_b32 v109, 0
  v_mov_b32 v110, 0
  v_mov_b32 v111, 0
  buffer_store_dwordx4 v[244:247], v2, s[4:7], s32 offen offset:1024 sc1
  v_mul_f32 v112, v112, v26
  v_mul_f32 v113, v113, v26
  v_mul_f32 v114, v114, v26
  v_mul_f32 v115, v115, v26
  v_cvt_pk_bf16_f32 v248, v112, v113
  v_cvt_pk_bf16_f32 v249, v114, v115
  v_mov_b32 v112, 0
  v_mov_b32 v113, 0
  v_mov_b32 v114, 0
  v_mov_b32 v115, 0
  v_mul_f32 v120, v120, v26
  v_mul_f32 v121, v121, v26
  v_mul_f32 v122, v122, v26
  v_mul_f32 v123, v123, v26
  v_cvt_pk_bf16_f32 v250, v120, v121
  v_cvt_pk_bf16_f32 v251, v122, v123
  v_mov_b32 v120, 0
  v_mov_b32 v121, 0
  v_mov_b32 v122, 0
  v_mov_b32 v123, 0
  buffer_store_dwordx4 v[248:251], v2, s[4:7], s32 offen offset:2048 sc1
  v_mul_f32 v116, v116, v27
  v_mul_f32 v117, v117, v27
  v_mul_f32 v118, v118, v27
  v_mul_f32 v119, v119, v27
  v_cvt_pk_bf16_f32 v252, v116, v117
  v_cvt_pk_bf16_f32 v253, v118, v119
  v_mov_b32 v116, 0
  v_mov_b32 v117, 0
  v_mov_b32 v118, 0
  v_mov_b32 v119, 0
  v_mul_f32 v124, v124, v27
  v_mul_f32 v125, v125, v27
  v_mul_f32 v126, v126, v27
  v_mul_f32 v127, v127, v27
  v_cvt_pk_bf16_f32 v254, v124, v125
  v_cvt_pk_bf16_f32 v255, v126, v127
  v_mov_b32 v124, 0
  v_mov_b32 v125, 0
  v_mov_b32 v126, 0
  v_mov_b32 v127, 0
  buffer_store_dwordx4 v[252:255], v2, s[4:7], s32 offen offset:3072 sc1
k2_x2_skip:
  v_mfma_f32_16x16x32_bf16 v[180:183], v[40:43], v[148:151], v[180:183]
  ds_read_b128 v[40:43], v4 offset:2048
  v_cvt_pk_bf16_f32 v198, v20, v21
  s_cmp_ge_u32 s55, s63
  s_cbranch_scc1 f_g5
  s_and_b32 m0, s54, 0xffff
  s_bitset1_b32 m0, 16
  s_add_u32 s54, s54, 0x4000
  buffer_load_dwordx4 v5, s[16:19], s55 offen offset:0 lds
f_g5:
  v_mfma_f32_16x16x32_bf16 v[176:179], v[44:47], v[152:155], v[176:179]
  v_add_f32 v20, v20, v21
  v_exp_f32 v22, v174
  v_mfma_f32_16x16x32_bf16 v[180:183], v[44:47], v[156:159], v[180:183]
  ds_read_b128 v[44:47], v4 offset:3072
  v_add_f32 v13, v13, v20
  v_mfma_f32_16x16x32_bf16 v[184:187], v[48:51], v[128:131], v[216:219]
  v_exp_f32 v23, v175
  v_mfma_f32_16x16x32_bf16 v[188:191], v[48:51], v[132:135], v[220:223]
  ds_read_b128 v[48:51], v4 offset:4096
  v_cvt_pk_bf16_f32 v199, v22, v23
  v_mfma_f32_16x16x32_bf16 v[184:187], v[52:55], v[136:139], v[184:187]
  v_add_f32 v22, v22, v23
  v_exp_f32 v16, v176
  s_cmp_ge_u32 s55, s63
  s_cbranch_scc1 f_g6
  buffer_load_dwordx4 v5, s[16:19], s55 offen offset:1024 lds
  s_add_u32 s55, s55, 0x8000
f_g6:
  v_mfma_f32_16x16x32_bf16 v[188:191], v[52:55], v[140:143], v[188:191]
  ds_read_b128 v[52:55], v4 offset:5120
  v_add_f32 v13, v13, v22
  v_mfma_f32_16x16x32_bf16 v[184:187], v[56:59], v[144:147], v[184:187]
  v_exp_f32 v17, v177
  v_add_f32 v7, v12, v13
  v_mfma_f32_16x16x32_bf16 v[188:191], v[56:59], v[148:151], v[188:191]
  ds_read_b128 v[56:59], v4 offset:6144
  v_cvt_pk_bf16_f32 v200, v16, v17
  v_cmp_nge_f32 vcc, s42, v7
  v_mfma_f32_16x16x32_bf16 v[184:187], v[60:63], v[152:155], v[184:187]
  v_add_f32 v14, v16, v17
  v_exp_f32 v18, v178
  s_add_u32 s41, s41, 4
  s_add_u32 s38, s38, 1
  v_mfma_f32_16x16x32_bf16 v[188:191], v[60:63], v[156:159], v[188:191]
  ds_read_b128 v[60:63], v4 offset:7168
  s_cbranch_vccnz k2_sa2f
k2_sa2f_ret:
  s_cmp_ge_u32 s38, 17
  s_cbranch_scc1 k2_done
k2_loop2:
  s_waitcnt lgkmcnt(4)
  v_mfma_f32_16x16x32_bf16 v[64:67], v[32:35], v[192:195], v[64:67]
  v_exp_f32 v19, v179
  s_and_b32 s32, s41, 7
  s_lshl_b32 s32, s32, 13
  v_add_u32 v3, s32, v2
  s_and_b32 m0, s54, 0xffff
  s_bitset1_b32 m0, 16
  s_add_u32 s54, s54, 0x4000
  buffer_load_dwordx4 v5, s[16:19], s55 offen offset:0 lds
  v_mfma_f32_16x16x32_bf16 v[68:71], v[32:35], v[196:199], v[68:71]
  ds_read_b128 v[32:35], v3 offset:0
  v_cvt_pk_bf16_f32 v201, v18, v19
  v_mfma_f32_16x16x32_bf16 v[72:75], v[36:39], v[192:195], v[72:75]
  v_add_f32 v18, v18, v19
  v_exp_f32 v20, v180
  v_mfma_f32_16x16x32_bf16 v[76:79], v[36:39], v[196:199], v[76:79]
  ds_read_b128 v[36:39], v3 offset:1024
  v_add_f32 v14, v14, v18
  v_mfma_f32_16x16x32_bf16 v[80:83], v[40:43], v[192:195], v[80:83]
  v_exp_f32 v21, v181
  v_add_f32 v8, v8, v12
  v_add_f32 v9, v9, v13
  v_mfma_f32_16x16x32_bf16 v[84:87], v[40:43], v[196:199], v[84:87]
  ds_read_b128 v[40:43], v3 offset:2048
  v_cvt_pk_bf16_f32 v204, v20, v21
  v_mfma_f32_16x16x32_bf16 v[88:91], v[44:47], v[192:195], v[88:91]
  v_add_f32 v15, v20, v21
  v_exp_f32 v22, v182
  buffer_load_dwordx4 v5, s[16:19], s55 offen offset:1024 lds
  s_add_u32 s55, s55, 0x8000
  v_mfma_f32_16x16x32_bf16 v[92:95], v[44:47], v[196:199], v[92:95]
  ds_read_b128 v[44:47], v3 offset:3072
  s_waitcnt lgkmcnt(4)
  v_mfma_f32_16x16x32_bf16 v[96:99], v[48:51], v[192:195], v[96:99]
  v_exp_f32 v23, v183
  s_cmp_ge_u32 s41, s40
  s_cbranch_scc1 k2_pa2
k2_pa2_ret:
  v_mfma_f32_16x16x32_bf16 v[100:103], v[48:51], v[196:199], v[100:103]
  ds_read_b128 v[48:51], v3 offset:4096
  v_cvt_pk_bf16_f32 v205, v22, v23
  v_mfma_f32_16x16x32_bf16 v[104:107], v[52:55], v[192:195], v[104:107]
  v_add_f32 v22, v22, v23
  v_exp_f32 v16, v184
  v_mfma_f32_16x16x32_bf16 v[108:111], v[52:55], v[196:199], v[108:111]
  ds_read_b128 v[52:55], v3 offset:5120
  v_add_f32 v15, v15, v22
  v_mfma_f32_16x16x32_bf16 v[112:115], v[56:59], v[192:195], v[112:115]
  v_exp_f32 v17, v185
  s_cmp_ge_u32 s53, s63
  s_cbranch_scc1 f_g7
  s_and_b32 m0, s52, 0xffff
  s_add_u32 s52, s52, 0x4000
  buffer_load_dwordx4 v5, s[16:19], s53 offen offset:0 lds
f_g7:
  v_mfma_f32_16x16x32_bf16 v[116:119], v[56:59], v[196:199], v[116:119]
  s_setprio 2
  ds_read_b128 v[56:59], v3 offset:6144
  v_cvt_pk_bf16_f32 v202, v16, v17
  v_mfma_f32_16x16x32_bf16 v[120:123], v[60:63], v[192:195], v[120:123]
  v_add_f32 v16, v16, v17
  v_exp_f32 v18, v186
  v_mfma_f32_16x16x32_bf16 v[124:127], v[60:63], v[196:199], v[124:127]
  ds_read_b128 v[60:63], v3 offset:7168
  v_add_f32 v14, v14, v16
  s_waitcnt lgkmcnt(4)
  v_mfma_f32_16x16x32_bf16 v[160:163], v[32:35], v[128:131], v[208:211]
  v_exp_f32 v19, v187
  s_cmp_ge_u32 s53, s63
  s_cbranch_scc1 f_g8
  buffer_load_dwordx4 v5, s[16:19], s53 offen offset:1024 lds
  s_add_u32 s53, s53, 0x8000
f_g8:
  v_mfma_f32_16x16x32_bf16 v[164:167], v[32:35], v[132:135], v[212:215]
  ds_read_b128 v[32:35], v4 offset:8192
  v_cvt_pk_bf16_f32 v203, v18, v19
  v_mfma_f32_16x16x32_bf16 v[160:163], v[36:39], v[136:139], v[160:163]
  v_add_f32 v18, v18, v19
  v_exp_f32 v20, v188
  v_mfma_f32_16x16x32_bf16 v[164:167], v[36:39], v[140:143], v[164:167]
  ds_read_b128 v[36:39], v4 offset:9216
  v_add_f32 v14, v14, v18
  v_mfma_f32_16x16x32_bf16 v[160:163], v[40:43], v[144:147], v[160:163]
  v_exp_f32 v21, v189
  v_mfma_f32_16x16x32_bf16 v[164:167], v[40:43], v[148:151], v[164:167]
  ds_read_b128 v[40:43], v4 offset:10240
  v_cvt_pk_bf16_f32 v206, v20, v21
  v_mfma_f32_16x16x32_bf16 v[160:163], v[44:47], v[152:155], v[160:163]
  v_add_f32 v20, v20, v21
  v_exp_f32 v22, v190
  s_cmp_ge_u32 s53, s63
  s_cbranch_scc1 f_g9
  s_and_b32 m0, s52, 0xffff
  s_add_u32 s52, s52, 0x4000
  buffer_load_dwordx4 v5, s[16:19], s53 offen offset:0 lds
f_g9:
  v_mfma_f32_16x16x32_bf16 v[164:167], v[44:47], v[156:159], v[164:167]
  ds_read_b128 v[44:47], v4 offset:11264
  v_add_f32 v15, v15, v20
  s_waitcnt lgkmcnt(4)
  v_mfma_f32_16x16x32_bf16 v[168:171], v[48:51], v[128:131], v[216:219]
  v_exp_f32 v23, v191
  v_mfma_f32_16x16x32_bf16 v[172:175], v[48:51], v[132:135], v[220:223]
  ds_read_b128 v[48:51], v4 offset:12288
  v_cvt_pk_bf16_f32 v207, v22, v23
  v_mfma_f32_16x16x32_bf16 v[168:171], v[52:55], v[136:139], v[168:171]
  v_exp_f32 v16, v160
  v_add_f32 v22, v22, v23
  v_mfma_f32_16x16x32_bf16 v[172:175], v[52:55], v[140:143], v[172:175]
  ds_read_b128 v[52:55], v4 offset:13312
  v_add_f32 v15, v15, v22
  v_mfma_f32_16x16x32_bf16 v[168:171], v[56:59], v[144:147], v[168:171]
  v_exp_f32 v17, v161
  v_add_f32 v7, v14, v15
  s_cmp_ge_u32 s53, s63
  s_cbranch_scc1 f_g10
  buffer_load_dwordx4 v5, s[16:19], s53 offen offset:1024 lds
  s_add_u32 s53, s53, 0x8000
f_g10:
  v_mfma_f32_16x16x32_bf16 v[172:175], v[56:59], v[148:151], v[172:175]
  ds_read_b128 v[56:59], v4 offset:14336
  v_cvt_pk_bf16_f32 v192, v16, v17
  v_cmp_nge_f32 vcc, s42, v7
  v_mfma_f32_16x16x32_bf16 v[168:171], v[60:63], v[152:155], v[168:171]
  v_add_f32 v12, v16, v17
  v_exp_f32 v18, v162
  v_mfma_f32_16x16x32_bf16 v[172:175], v[60:63], v[156:159], v[172:175]
  ds_read_b128 v[60:63], v4 offset:15360
  s_cbranch_vccnz k2_sb2
k2_sb2_ret:
  s_waitcnt lgkmcnt(4)
  v_mfma_f32_16x16x32_bf16 v[64:67], v[32:35], v[200:203], v[64:67]
  v_exp_f32 v19, v163
  v_add_f32 v8, v8, v14
  v_add_f32 v9, v9, v15
  v_mfma_f32_16x16x32_bf16 v[68:71], v[32:35], v[204:207], v[68:71]
  s_setprio 1
  ds_read_b128 v[32:35], v3 offset:8192
  v_cvt_pk_bf16_f32 v193, v18, v19
  v_mfma_f32_16x16x32_bf16 v[72:75], v[36:39], v[200:203], v[72:75]
  v_add_f32 v18, v18, v19
  v_exp_f32 v20, v164
  v_mfma_f32_16x16x32_bf16 v[76:79], v[36:39], v[204:207], v[76:79]
  ds_read_b128 v[36:39], v3 offset:9216
  v_add_f32 v12, v12, v18
  v_mfma_f32_16x16x32_bf16 v[80:83], v[40:43], v[200:203], v[80:83]
  v_exp_f32 v21, v165
  s_add_u32 s33, s41, 1
  s_cmp_ge_u32 s33, s40
  s_cbranch_scc1 k2_pb2
k2_pb2_ret:
  v_mfma_f32_16x16x32_bf16 v[84:87], v[40:43], v[204:207], v[84:87]
  ds_read_b128 v[40:43], v3 offset:10240
  v_cvt_pk_bf16_f32 v196, v20, v21
  v_mfma_f32_16x16x32_bf16 v[88:91], v[44:47], v[200:203], v[88:91]
  v_add_f32 v13, v20, v21
  v_exp_f32 v22, v166
  v_mfma_f32_16x16x32_bf16 v[92:95], v[44:47], v[204:207], v[92:95]
  ds_read_b128 v[44:47], v3 offset:11264
  s_waitcnt lgkmcnt(4)
  v_mfma_f32_16x16x32_bf16 v[96:99], v[48:51], v[200:203], v[96:99]
  v_exp_f32 v23, v167
  v_mfma_f32_16x16x32_bf16 v[100:103], v[48:51], v[204:207], v[100:103]
  ds_read_b128 v[48:51], v3 offset:12288
  v_cvt_pk_bf16_f32 v197, v22, v23
  v_mfma_f32_16x16x32_bf16 v[104:107], v[52:55], v[200:203], v[104:107]
  v_add_f32 v22, v22, v23
  v_exp_f32 v16, v168
  v_mfma_f32_16x16x32_bf16 v[108:111], v[52:55], v[204:207], v[108:111]
  ds_read_b128 v[52:55], v3 offset:13312
  v_add_f32 v13, v13, v22
  v_mfma_f32_16x16x32_bf16 v[112:115], v[56:59], v[200:203], v[112:115]
  v_exp_f32 v17, v169
  v_mfma_f32_16x16x32_bf16 v[116:119], v[56:59], v[204:207], v[116:119]
  s_setprio 0
  ds_read_b128 v[56:59], v3 offset:14336
  v_cvt_pk_bf16_f32 v194, v16, v17
  v_mfma_f32_16x16x32_bf16 v[120:123], v[60:63], v[200:203], v[120:123]
  v_add_f32 v16, v16, v17
  v_exp_f32 v18, v170
  v_mfma_f32_16x16x32_bf16 v[124:127], v[60:63], v[204:207], v[124:127]
  ds_read_b128 v[60:63], v3 offset:15360
  v_add_f32 v12, v12, v16
  s_waitcnt lgkmcnt(4)
k2_h3_2:
  v_mfma_f32_16x16x32_bf16 v[176:179], v[32:35], v[128:131], v[208:211]
  v_exp_f32 v19, v171
  v_mfma_f32_16x16x32_bf16 v[180:183], v[32:35], v[132:135], v[212:215]
  v_cvt_pk_bf16_f32 v195, v18, v19
  v_add_u32 v4, 0x10000, v3
  v_mfma_f32_16x16x32_bf16 v[176:179], v[36:39], v[136:139], v[176:179]
  v_add_f32 v18, v18, v19
  v_exp_f32 v20, v172
  v_mfma_f32_16x16x32_bf16 v[180:183], v[36:39], v[140:143], v[180:183]
  s_waitcnt vmcnt(0) lgkmcnt(0)
  s_bitcmp0_b32 s60, s38
  s_cbranch_scc1 f_hr_2
  s_call_b64 s[100:101], f_hook
f_hr_2:
  s_barrier
  s_setprio 3
  s_bitcmp0_b32 s75, s38
  s_cbranch_scc1 f_pr_2
  s_call_b64 s[100:101], f_post
f_pr_2:
  ds_read_b128 v[32:35], v4 offset:0
  ds_read_b128 v[36:39], v4 offset:1024
  v_add_f32 v12, v12, v18
  v_mfma_f32_16x16x32_bf16 v[176:179], v[40:43], v[144:147], v[176:179]
  v_exp_f32 v21, v173
  v_mfma_f32_16x16x32_bf16 v[180:183], v[40:43], v[148:151], v[180:183]
  ds_read_b128 v[40:43], v4 offset:2048
  v_cvt_pk_bf16_f32 v198, v20, v21
  s_cmp_ge_u32 s55, s63
  s_cbranch_scc1 f_g11
  s_and_b32 m0, s54, 0xffff
  s_bitset1_b32 m0, 16
  s_add_u32 s54, s54, 0x4000
  buffer_load_dwordx4 v5, s[16:19], s55 offen offset:0 lds
f_g11:
  v_mfma_f32_16x16x32_bf16 v[176:179], v[44:47], v[152:155], v[176:179]
  v_add_f32 v20, v20, v21
  v_exp_f32 v22, v174
  v_mfma_f32_16x16x32_bf16 v[180:183], v[44:47], v[156:159], v[180:183]
  ds_read_b128 v[44:47], v4 offset:3072
  v_add_f32 v13, v13, v20
  v_mfma_f32_16x16x32_bf16 v[184:187], v[48:51], v[128:131], v[216:219]
  v_exp_f32 v23, v175
  v_mfma_f32_16x16x32_bf16 v[188:191], v[48:51], v[132:135], v[220:223]
  ds_read_b128 v[48:51], v4 offset:4096
  v_cvt_pk_bf16_f32 v199, v22, v23
  v_mfma_f32_16x16x32_bf16 v[184:187], v[52:55], v[136:139], v[184:187]
  v_add_f32 v22, v22, v23
  v_exp_f32 v16, v176
  s_cmp_ge_u32 s55, s63
  s_cbranch_scc1 f_g12
  buffer_load_dwordx4 v5, s[16:19], s55 offen offset:1024 lds
  s_add_u32 s55, s55, 0x8000
f_g12:
  v_mfma_f32_16x16x32_bf16 v[188:191], v[52:55], v[140:143], v[188:191]
  ds_read_b128 v[52:55], v4 offset:5120
  v_add_f32 v13, v13, v22
  v_mfma_f32_16x16x32_bf16 v[184:187], v[56:59], v[144:147], v[184:187]
  v_exp_f32 v17, v177
  v_add_f32 v7, v12, v13
  v_mfma_f32_16x16x32_bf16 v[188:191], v[56:59], v[148:151], v[188:191]
  ds_read_b128 v[56:59], v4 offset:6144
  v_cvt_pk_bf16_f32 v200, v16, v17
  v_cmp_nge_f32 vcc, s42, v7
  v_mfma_f32_16x16x32_bf16 v[184:187], v[60:63], v[152:155], v[184:187]
  v_add_f32 v14, v16, v17
  v_exp_f32 v18, v178
  s_add_u32 s41, s41, 4
  s_add_u32 s38, s38, 1
  v_mfma_f32_16x16x32_bf16 v[188:191], v[60:63], v[156:159], v[188:191]
  ds_read_b128 v[60:63], v4 offset:7168
  s_cbranch_vccnz k2_sa2
k2_sa2_ret:
  s_cmp_lt_u32 s38, 17
  s_cbranch_scc1 k2_loop2
k2_done:
  s_waitcnt lgkmcnt(4)
  v_mfma_f32_16x16x32_bf16 v[64:67], v[32:35], v[192:195], v[64:67]
  v_exp_f32 v19, v179
  v_mfma_f32_16x16x32_bf16 v[68:71], v[32:35], v[196:199], v[68:71]
  ds_read_b128 v[32:35], v4 offset:8192
  v_cvt_pk_bf16_f32 v201, v18, v19
  v_mfma_f32_16x16x32_bf16 v[72:75], v[36:39], v[192:195], v[72:75]
  v_add_f32 v18, v18, v19
  v_exp_f32 v20, v180
  v_mfma_f32_16x16x32_bf16 v[76:79], v[36:39], v[196:199], v[76:79]
  ds_read_b128 v[36:39], v4 offset:9216
  v_add_f32 v14, v14, v18
  v_mfma_f32_16x16x32_bf16 v[80:83], v[40:43], v[192:195], v[80:83]
  v_exp_f32 v21, v181
  v_add_f32 v8, v8, v12
  v_add_f32 v9, v9, v13
  v_mfma_f32_16x16x32_bf16 v[84:87], v[40:43], v[196:199], v[84:87]
  ds_read_b128 v[40:43], v4 offset:10240
  v_cvt_pk_bf16_f32 v204, v20, v21
  v_mfma_f32_16x16x32_bf16 v[88:91], v[44:47], v[192:195], v[88:91]
  v_add_f32 v15, v20, v21
  v_exp_f32 v22, v182
  v_mfma_f32_16x16x32_bf16 v[92:95], v[44:47], v[196:199], v[92:95]
  ds_read_b128 v[44:47], v4 offset:11264
  s_waitcnt lgkmcnt(4)
  v_mfma_f32_16x16x32_bf16 v[96:99], v[48:51], v[192:195], v[96:99]
  v_exp_f32 v23, v183
  v_mfma_f32_16x16x32_bf16 v[100:103], v[48:51], v[196:199], v[100:103]
  ds_read_b128 v[48:51], v4 offset:12288
  v_cvt_pk_bf16_f32 v205, v22, v23
  v_mfma_f32_16x16x32_bf16 v[104:107], v[52:55], v[192:195], v[104:107]
  v_add_f32 v22, v22, v23
  v_exp_f32 v16, v184
  v_mfma_f32_16x16x32_bf16 v[108:111], v[52:55], v[196:199], v[108:111]
  ds_read_b128 v[52:55], v4 offset:13312
  v_add_f32 v15, v15, v22
  v_mfma_f32_16x16x32_bf16 v[112:115], v[56:59], v[192:195], v[112:115]
  v_exp_f32 v17, v185
  v_mfma_f32_16x16x32_bf16 v[116:119], v[56:59], v[196:199], v[116:119]
  s_setprio 2
  ds_read_b128 v[56:59], v4 offset:14336
  v_cvt_pk_bf16_f32 v202, v16, v17
  v_mfma_f32_16x16x32_bf16 v[120:123], v[60:63], v[192:195], v[120:123]
  v_add_f32 v16, v16, v17
  v_exp_f32 v18, v186
  v_mfma_f32_16x16x32_bf16 v[124:127], v[60:63], v[196:199], v[124:127]
  ds_read_b128 v[60:63], v4 offset:15360
  v_add_f32 v14, v14, v16
  s_cmp_eq_u32 s66, 17
  s_cbranch_scc1 f_e4
  s_cmp_ge_u32 s3, 4
  s_cbranch_scc1 f_e0
  s_cmp_lg_u32 s85, 0
  s_cbranch_scc0 f_e2
f_e1:
  s_add_u32 s32, s35, 1
  s_and_b32 s32, s32, 3
  s_lshl_b32 s32, s32, 13
  s_add_u32 s32, s32, s83
  s_add_u32 s33, s32, 0x1000
  buffer_load_dwordx4 v[128:131], v2, s[4:7], s32 offen offset:0
  buffer_load_dwordx4 v[132:135], v2, s[4:7], s32 offen offset:1024
  buffer_load_dwordx4 v[136:139], v2, s[4:7], s32 offen offset:2048
  buffer_load_dwordx4 v[140:143], v2, s[4:7], s32 offen offset:3072
  buffer_load_dwordx4 v[144:147], v2, s[4:7], s33 offen offset:0
  buffer_load_dwordx4 v[148:151], v2, s[4:7], s33 offen offset:1024
  buffer_load_dwordx4 v[152:155], v2, s[4:7], s33 offen offset:2048
  buffer_load_dwordx4 v[156:159], v2, s[4:7], s33 offen offset:3072
f_e0:
  v_exp_f32 v19, v187
  s_nop 0
  v_cvt_pk_bf16_f32 v203, v18, v19
  v_add_f32 v18, v18, v19
  v_exp_f32 v20, v188
  v_add_f32 v14, v14, v18
  v_exp_f32 v21, v189
  s_nop 0
  v_cvt_pk_bf16_f32 v206, v20, v21
  v_add_f32 v20, v20, v21
  v_exp_f32 v22, v190
  v_add_f32 v15, v15, v20
  v_exp_f32 v23, v191
  s_nop 0
  v_cvt_pk_bf16_f32 v207, v22, v23
  v_add_f32 v22, v22, v23
  v_add_f32 v15, v15, v22
  v_add_f32 v7, v14, v15
  v_cmp_nge_f32 vcc, s42, v7
  s_nop 4
  s_cbranch_vccnz k2_se
k2_se_ret:
  s_waitcnt lgkmcnt(0)
  v_mfma_f32_16x16x32_bf16 v[64:67], v[32:35], v[200:203], v[64:67]
  v_mfma_f32_16x16x32_bf16 v[68:71], v[32:35], v[204:207], v[68:71]
  v_add_f32 v8, v8, v14
  v_add_f32 v9, v9, v15
  v_mfma_f32_16x16x32_bf16 v[72:75], v[36:39], v[200:203], v[72:75]
  v_mfma_f32_16x16x32_bf16 v[76:79], v[36:39], v[204:207], v[76:79]
  v_mov_b32 v25, v8
  s_nop 1
  v_permlane16_swap_b32 v8, v25
  v_add_f32 v8, v8, v25
  v_mov_b32 v25, v8
  s_nop 1
  v_permlane32_swap_b32 v8, v25
  v_add_f32 v8, v8, v25
  v_mfma_f32_16x16x32_bf16 v[80:83], v[40:43], v[200:203], v[80:83]
  v_mfma_f32_16x16x32_bf16 v[84:87], v[40:43], v[204:207], v[84:87]
  v_mov_b32 v26, v9
  s_nop 1
  v_permlane16_swap_b32 v9, v26
  v_add_f32 v9, v9, v26
  v_mov_b32 v26, v9
  s_nop 1
  v_permlane32_swap_b32 v9, v26
  v_add_f32 v9, v9, v26
  v_mfma_f32_16x16x32_bf16 v[88:91], v[44:47], v[200:203], v[88:91]
  v_mfma_f32_16x16x32_bf16 v[92:95], v[44:47], v[204:207], v[92:95]
  v_mfma_f32_16x16x32_bf16 v[96:99], v[48:51], v[200:203], v[96:99]
  v_mfma_f32_16x16x32_bf16 v[100:103], v[48:51], v[204:207], v[100:103]
  v_mfma_f32_16x16x32_bf16 v[104:107], v[52:55], v[200:203], v[104:107]
  v_mfma_f32_16x16x32_bf16 v[108:111], v[52:55], v[204:207], v[108:111]
  v_mfma_f32_16x16x32_bf16 v[112:115], v[56:59], v[200:203], v[112:115]
  v_mfma_f32_16x16x32_bf16 v[116:119], v[56:59], v[204:207], v[116:119]
  v_mfma_f32_16x16x32_bf16 v[120:123], v[60:63], v[200:203], v[120:123]
  v_mfma_f32_16x16x32_bf16 v[124:127], v[60:63], v[204:207], v[124:127]
  s_mov_b32 s16, s94
  s_and_b32 s17, s95, 0xffff
  s_mov_b32 s18, 0xa00000
  s_mov_b32 s19, 0x00020000
  s_and_b32 s32, s3, 3
  s_lshl_b32 s77, s32, 13
  s_add_u32 s32, s77, s86
  v_add_u32 v6, s32, v2
  s_add_u32 s32, s32, 0x1c00
  v_lshl_add_u32 v7, v1, 3, s32
  v_lshl_add_u32 v3, v1, 2, s32
  v_and_b32 v4, 0xf0, v2
  v_add_u32 v4, s32, v4
  s_add_u32 s32, s35, s3
  s_and_b32 s32, s32, 3
  s_mul_i32 s32, s32, 163840
  s_mul_i32 s33, s35, 320
  s_add_u32 s32, s32, s33
  s_add_u32 s70, s32, 128
  s_mov_b32 s71, s77
  s_cmp_ge_u32 s3, 4
  s_cbranch_scc1 f_B
  s_cmp_eq_u32 s85, 0
  s_cbranch_scc1 f_a1
  s_add_u32 s32, s35, 2
  s_and_b32 s32, s32, 3
  s_lshl_b32 s32, s32, 13
  s_add_u32 s32, s32, s83
  s_add_u32 s33, s32, 0x1000
  buffer_load_dwordx4 v[160:163], v2, s[4:7], s32 offen offset:0
  buffer_load_dwordx4 v[164:167], v2, s[4:7], s32 offen offset:1024
  buffer_load_dwordx4 v[168:171], v2, s[4:7], s32 offen offset:2048
  buffer_load_dwordx4 v[172:175], v2, s[4:7], s32 offen offset:3072
  buffer_load_dwordx4 v[176:179], v2, s[4:7], s33 offen offset:0
  buffer_load_dwordx4 v[180:183], v2, s[4:7], s33 offen offset:1024
  buffer_load_dwordx4 v[184:187], v2, s[4:7], s33 offen offset:2048
  buffer_load_dwordx4 v[188:191], v2, s[4:7], s33 offen offset:3072
  s_add_u32 s32, s35, 3
  s_and_b32 s32, s32, 3
  s_lshl_b32 s32, s32, 13
  s_add_u32 s32, s32, s83
  s_add_u32 s33, s32, 0x1000
  buffer_load_dwordx4 v[192:195], v2, s[4:7], s32 offen offset:0
  buffer_load_dwordx4 v[196:199], v2, s[4:7], s32 offen offset:1024
  buffer_load_dwordx4 v[200:203], v2, s[4:7], s32 offen offset:2048
  buffer_load_dwordx4 v[204:207], v2, s[4:7], s32 offen offset:3072
  buffer_load_dwordx4 v[208:211], v2, s[4:7], s33 offen offset:0
  buffer_load_dwordx4 v[212:215], v2, s[4:7], s33 offen offset:1024
  buffer_load_dwordx4 v[216:219], v2, s[4:7], s33 offen offset:2048
  buffer_load_dwordx4 v[220:223], v2, s[4:7], s33 offen offset:3072
f_a1:
  ds_write_b128 v4, v[8:11] offset:768
  ds_write_b128 v6, v[64:67] offset:32768
  ds_write_b128 v6, v[68:71] offset:33792
  ds_write_b128 v6, v[72:75] offset:34816
  ds_write_b128 v6, v[76:79] offset:35840
  ds_write_b128 v6, v[80:83] offset:36864
  ds_write_b128 v6, v[84:87] offset:37888
  ds_write_b128 v6, v[88:91] offset:38912
  ds_write_b128 v6, v[92:95] offset:39936
  ds_write_b128 v6, v[96:99] offset:0
  ds_write_b128 v6, v[100:103] offset:1024
  ds_write_b128 v6, v[104:107] offset:2048
  ds_write_b128 v6, v[108:111] offset:3072
  ds_write_b128 v6, v[112:115] offset:4096
  ds_write_b128 v6, v[116:119] offset:5120
  ds_write_b128 v6, v[120:123] offset:6144
  v_cvt_pk_bf16_f32 v126, v126, v127
  ds_write_b64 v7, v[124:125]
  ds_write_b32 v3, v126 offset:512
  s_mov_b32 s67, 2
  s_waitcnt vmcnt(24) lgkmcnt(0)
  s_barrier
  s_add_u32 m0, s69, s71
  s_nop 0
  buffer_load_dwordx4 v5, s[8:11], s70 offen offset:0 lds
  s_add_u32 s76, s70, 19456
  buffer_load_dwordx4 v5, s[8:11], s76 offen offset:1024 lds
  s_add_u32 s76, s70, 38912
  buffer_load_dwordx4 v5, s[8:11], s76 offen offset:2048 lds
  s_add_u32 s76, s70, 58368
  buffer_load_dwordx4 v5, s[8:11], s76 offen offset:3072 lds
  s_add_u32 m0, m0, 0x1000
  s_add_u32 s76, s70, 81920
  buffer_load_dwordx4 v5, s[8:11], s76 offen offset:0 lds
  s_add_u32 s76, s70, 101376
  buffer_load_dwordx4 v5, s[8:11], s76 offen offset:1024 lds
  s_add_u32 s76, s70, 120832
  buffer_load_dwordx4 v5, s[8:11], s76 offen offset:2048 lds
  s_add_u32 s76, s70, 140288
  buffer_load_dwordx4 v5, s[8:11], s76 offen offset:3072 lds
  s_add_u32 s70, s70, 64
  s_sub_u32 s69, s69, 0x8000
  s_cselect_b32 s69, 0x20000, s69
  s_cmp_lg_u32 s85, 0
  s_cbranch_scc1 f_oent
  s_waitcnt vmcnt(0)
  s_barrier
  s_branch f_b3
f_B:
  v_and_b32 v14, 3, v1
  v_lshlrev_b32 v14, 9, v14
  buffer_load_dword v14, v14, s[20:23], s79 offen sc1
  s_waitcnt vmcnt(1)
  s_barrier
  s_setprio 3
  ds_read_b128 v[24:27], v4 offset:768
  ds_read_b128 v[128:131], v6 offset:32768
  ds_read_b128 v[132:135], v6 offset:33792
  ds_read_b128 v[136:139], v6 offset:34816
  ds_read_b128 v[140:143], v6 offset:35840
  ds_read_b128 v[144:147], v6 offset:36864
  ds_read_b128 v[148:151], v6 offset:37888
  ds_read_b128 v[152:155], v6 offset:38912
  ds_read_b128 v[156:159], v6 offset:39936
  ds_read_b128 v[160:163], v6 offset:0
  ds_read_b128 v[164:167], v6 offset:1024
  ds_read_b128 v[168:171], v6 offset:2048
  ds_read_b128 v[172:175], v6 offset:3072
  ds_read_b128 v[176:179], v6 offset:4096
  ds_read_b128 v[180:183], v6 offset:5120
  ds_read_b128 v[184:187], v6 offset:6144
  ds_read_b64 v[188:189], v7
  ds_read_b32 v191, v3 offset:512
  s_add_u32 s70, s70, 64
  s_sub_u32 s69, s69, 0x8000
  s_cselect_b32 s69, 0x20000, s69
  s_waitcnt lgkmcnt(15)
  v_min_f32 v20, v10, v26
  v_sub_f32 v16, v20, v10
  v_sub_f32 v18, v20, v26
  v_exp_f32 v16, v16
  v_exp_f32 v18, v18
  v_mul_f32 v20, v8, v16
  v_fmac_f32 v20, v24, v18
  v_rcp_f32 v20, v20
  s_nop 0
  v_mul_f32 v16, v16, v20
  v_mul_f32 v18, v18, v20
  v_min_f32 v21, v11, v27
  v_sub_f32 v17, v21, v11
  v_sub_f32 v19, v21, v27
  v_exp_f32 v17, v17
  v_exp_f32 v19, v19
  v_mul_f32 v21, v9, v17
  v_fmac_f32 v21, v25, v19
  v_rcp_f32 v21, v21
  s_nop 0
  v_mul_f32 v17, v17, v21
  v_mul_f32 v19, v19, v21
  v_mul_f32 v64, v64, v16
  v_mul_f32 v65, v65, v16
  v_mul_f32 v66, v66, v16
  v_mul_f32 v67, v67, v16
  v_mul_f32 v72, v72, v16
  v_mul_f32 v73, v73, v16
  v_mul_f32 v74, v74, v16
  v_mul_f32 v75, v75, v16
  s_add_u32 s32, s57, 0x1000
  v_fmac_f32 v64, v128, v18
  v_fmac_f32 v65, v129, v18
  v_fmac_f32 v66, v130, v18
  v_fmac_f32 v67, v131, v18
  v_cvt_pk_bf16_f32 v224, v64, v65
  v_cvt_pk_bf16_f32 v225, v66, v67
  s_waitcnt lgkmcnt(14)
  v_fmac_f32 v72, v136, v18
  v_fmac_f32 v73, v137, v18
  v_fmac_f32 v74, v138, v18
  v_fmac_f32 v75, v139, v18
  v_cvt_pk_bf16_f32 v226, v72, v73
  v_cvt_pk_bf16_f32 v227, v74, v75
  buffer_store_dwordx4 v[224:227], v2, s[4:7], s57 offen offset:0 sc1
  v_mul_f32 v68, v68, v17
  v_mul_f32 v69, v69, v17
  v_mul_f32 v70, v70, v17
  v_mul_f32 v71, v71, v17
  v_fmac_f32 v68, v132, v19
  v_fmac_f32 v69, v133, v19
  v_fmac_f32 v70, v134, v19
  v_fmac_f32 v71, v135, v19
  v_cvt_pk_bf16_f32 v228, v68, v69
  v_cvt_pk_bf16_f32 v229, v70, v71
  v_mul_f32 v76, v76, v17
  v_mul_f32 v77, v77, v17
  v_mul_f32 v78, v78, v17
  v_mul_f32 v79, v79, v17
  s_waitcnt lgkmcnt(13)
  v_fmac_f32 v76, v140, v19
  v_fmac_f32 v77, v141, v19
  v_fmac_f32 v78, v142, v19
  v_fmac_f32 v79, v143, v19
  v_cvt_pk_bf16_f32 v230, v76, v77
  v_cvt_pk_bf16_f32 v231, v78, v79
  buffer_store_dwordx4 v[228:231], v2, s[4:7], s57 offen offset:1024 sc1
  v_mul_f32 v80, v80, v16
  v_mul_f32 v81, v81, v16
  v_mul_f32 v82, v82, v16
  v_mul_f32 v83, v83, v16
  s_waitcnt lgkmcnt(12)
  v_fmac_f32 v80, v144, v18
  v_fmac_f32 v81, v145, v18
  v_fmac_f32 v82, v146, v18
  v_fmac_f32 v83, v147, v18
  v_cvt_pk_bf16_f32 v232, v80, v81
  v_cvt_pk_bf16_f32 v233, v82, v83
  v_mul_f32 v88, v88, v16
  v_mul_f32 v89, v89, v16
  v_mul_f32 v90, v90, v16
  v_mul_f32 v91, v91, v16
  s_waitcnt lgkmcnt(10)
  v_fmac_f32 v88, v152, v18
  v_fmac_f32 v89, v153, v18
  v_fmac_f32 v90, v154, v18
  v_fmac_f32 v91, v155, v18
  v_cvt_pk_bf16_f32 v234, v88, v89
  v_cvt_pk_bf16_f32 v235, v90, v91
  buffer_store_dwordx4 v[232:235], v2, s[4:7], s57 offen offset:2048 sc1
  v_mul_f32 v84, v84, v17
  v_mul_f32 v85, v85, v17
  v_mul_f32 v86, v86, v17
  v_mul_f32 v87, v87, v17
  v_fmac_f32 v84, v148, v19
  v_fmac_f32 v85, v149, v19
  v_fmac_f32 v86, v150, v19
  v_fmac_f32 v87, v151, v19
  v_cvt_pk_bf16_f32 v236, v84, v85
  v_cvt_pk_bf16_f32 v237, v86, v87
  v_mul_f32 v92, v92, v17
  v_mul_f32 v93, v93, v17
  v_mul_f32 v94, v94, v17
  v_mul_f32 v95, v95, v17
  s_waitcnt lgkmcnt(9)
  v_fmac_f32 v92, v156, v19
  v_fmac_f32 v93, v157, v19
  v_fmac_f32 v94, v158, v19
  v_fmac_f32 v95, v159, v19
  v_cvt_pk_bf16_f32 v238, v92, v93
  v_cvt_pk_bf16_f32 v239, v94, v95
  buffer_store_dwordx4 v[236:239], v2, s[4:7], s57 offen offset:3072 sc1
  v_mul_f32 v96, v96, v16
  v_mul_f32 v97, v97, v16
  v_mul_f32 v98, v98, v16
  v_mul_f32 v99, v99, v16
  s_waitcnt lgkmcnt(8)
  v_fmac_f32 v96, v160, v18
  v_fmac_f32 v97, v161, v18
  v_fmac_f32 v98, v162, v18
  v_fmac_f32 v99, v163, v18
  v_cvt_pk_bf16_f32 v240, v96, v97
  v_cvt_pk_bf16_f32 v241, v98, v99
  v_mul_f32 v104, v104, v16
  v_mul_f32 v105, v105, v16
  v_mul_f32 v106, v106, v16
  v_mul_f32 v107, v107, v16
  s_waitcnt lgkmcnt(6)
  v_fmac_f32 v104, v168, v18
  v_fmac_f32 v105, v169, v18
  v_fmac_f32 v106, v170, v18
  v_fmac_f32 v107, v171, v18
  v_cvt_pk_bf16_f32 v242, v104, v105
  v_cvt_pk_bf16_f32 v243, v106, v107
  buffer_store_dwordx4 v[240:243], v2, s[4:7], s32 offen offset:0 sc1
  v_mul_f32 v100, v100, v17
  v_mul_f32 v101, v101, v17
  v_mul_f32 v102, v102, v17
  v_mul_f32 v103, v103, v17
  v_fmac_f32 v100, v164, v19
  v_fmac_f32 v101, v165, v19
  v_fmac_f32 v102, v166, v19
  v_fmac_f32 v103, v167, v19
  v_cvt_pk_bf16_f32 v244, v100, v101
  v_cvt_pk_bf16_f32 v245, v102, v103
  v_mul_f32 v108, v108, v17
  v_mul_f32 v109, v109, v17
  v_mul_f32 v110, v110, v17
  v_mul_f32 v111, v111, v17
  s_waitcnt lgkmcnt(5)
  v_fmac_f32 v108, v172, v19
  v_fmac_f32 v109, v173, v19
  v_fmac_f32 v110, v174, v19
  v_fmac_f32 v111, v175, v19
  v_cvt_pk_bf16_f32 v246, v108, v109
  v_cvt_pk_bf16_f32 v247, v110, v111
  buffer_store_dwordx4 v[244:247], v2, s[4:7], s32 offen offset:1024 sc1
  v_mul_f32 v112, v112, v16
  v_mul_f32 v113, v113, v16
  v_mul_f32 v114, v114, v16
  v_mul_f32 v115, v115, v16
  s_waitcnt lgkmcnt(4)
  v_fmac_f32 v112, v176, v18
  v_fmac_f32 v113, v177, v18
  v_fmac_f32 v114, v178, v18
  v_fmac_f32 v115, v179, v18
  v_cvt_pk_bf16_f32 v248, v112, v113
  v_cvt_pk_bf16_f32 v249, v114, v115
  v_mul_f32 v120, v120, v16
  v_mul_f32 v121, v121, v16
  v_mul_f32 v122, v122, v16
  v_mul_f32 v123, v123, v16
  s_waitcnt lgkmcnt(2)
  v_fmac_f32 v120, v184, v18
  v_fmac_f32 v121, v185, v18
  v_fmac_f32 v122, v186, v18
  v_fmac_f32 v123, v187, v18
  v_cvt_pk_bf16_f32 v250, v120, v121
  v_cvt_pk_bf16_f32 v251, v122, v123
  buffer_store_dwordx4 v[248:251], v2, s[4:7], s32 offen offset:2048 sc1
  v_mul_f32 v116, v116, v17
  v_mul_f32 v117, v117, v17
  v_mul_f32 v118, v118, v17
  v_mul_f32 v119, v119, v17
  v_fmac_f32 v116, v180, v19
  v_fmac_f32 v117, v181, v19
  v_fmac_f32 v118, v182, v19
  v_fmac_f32 v119, v183, v19
  v_cvt_pk_bf16_f32 v252, v116, v117
  v_cvt_pk_bf16_f32 v253, v118, v119
  v_mul_f32 v124, v124, v17
  v_mul_f32 v125, v125, v17
  v_mul_f32 v126, v126, v17
  v_mul_f32 v127, v127, v17
  s_waitcnt lgkmcnt(0)
  v_lshlrev_b32 v190, 16, v191
  v_and_b32 v191, 0xffff0000, v191
  v_fmac_f32 v124, v188, v19
  v_fmac_f32 v125, v189, v19
  v_fmac_f32 v126, v190, v19
  v_fmac_f32 v127, v191, v19
  v_cvt_pk_bf16_f32 v254, v124, v125
  v_cvt_pk_bf16_f32 v255, v126, v127
  buffer_store_dwordx4 v[252:255], v2, s[4:7], s32 offen offset:3072 sc1
  s_mov_b32 s67, 0
  s_add_u32 m0, s69, s71
  s_nop 0
  buffer_load_dwordx4 v5, s[8:11], s70 offen offset:0 lds
  s_add_u32 s76, s70, 19456
  buffer_load_dwordx4 v5, s[8:11], s76 offen offset:1024 lds
  s_add_u32 s76, s70, 38912
  buffer_load_dwordx4 v5, s[8:11], s76 offen offset:2048 lds
  s_add_u32 s76, s70, 58368
  buffer_load_dwordx4 v5, s[8:11], s76 offen offset:3072 lds
  s_add_u32 m0, m0, 0x1000
  s_add_u32 s76, s70, 81920
  buffer_load_dwordx4 v5, s[8:11], s76 offen offset:0 lds
  s_add_u32 s76, s70, 101376
  buffer_load_dwordx4 v5, s[8:11], s76 offen offset:1024 lds
  s_add_u32 s76, s70, 120832
  buffer_load_dwordx4 v5, s[8:11], s76 offen offset:2048 lds
  s_add_u32 s76, s70, 140288
  buffer_load_dwordx4 v5, s[8:11], s76 offen offset:3072 lds
  s_add_u32 s70, s70, 64
  s_sub_u32 s69, s69, 0x8000
  s_cselect_b32 s69, 0x20000, s69
  s_add_u32 m0, s69, s71
  s_nop 0
  buffer_load_dwordx4 v5, s[8:11], s70 offen offset:0 lds
  s_add_u32 s76, s70, 19456
  buffer_load_dwordx4 v5, s[8:11], s76 offen offset:1024 lds
  s_add_u32 s76, s70, 38912
  buffer_load_dwordx4 v5, s[8:11], s76 offen offset:2048 lds
  s_add_u32 s76, s70, 58368
  buffer_load_dwordx4 v5, s[8:11], s76 offen offset:3072 lds
  s_add_u32 m0, m0, 0x1000
  s_add_u32 s76, s70, 81920
  buffer_load_dwordx4 v5, s[8:11], s76 offen offset:0 lds
  s_add_u32 s76, s70, 101376
  buffer_load_dwordx4 v5, s[8:11], s76 offen offset:1024 lds
  s_add_u32 s76, s70, 120832
  buffer_load_dwordx4 v5, s[8:11], s76 offen offset:2048 lds
  s_add_u32 s76, s70, 140288
  buffer_load_dwordx4 v5, s[8:11], s76 offen offset:3072 lds
  s_add_u32 s70, s70, 64
  s_sub_u32 s69, s69, 0x8000
  s_cselect_b32 s69, 0x20000, s69
  s_waitcnt vmcnt(16)
  s_mov_b32 s32, 20000
  s_branch f_wb_c
f_wb_l:
  v_and_b32 v14, 3, v1
  v_lshlrev_b32 v14, 9, v14
  buffer_load_dword v14, v14, s[20:23], s79 offen sc1
  s_waitcnt vmcnt(0)
f_wb_c:
  v_cmp_gt_i32 vcc, s89, v14
  s_nop 0
  s_and_b32 s33, vcc_lo, s88
  s_cbranch_scc0 f_wb_d
  s_sleep 2
  s_sub_u32 s32, s32, 1
  s_cmp_lg_u32 s32, 0
  s_cbranch_scc1 f_wb_l
f_wb_d:
  s_add_u32 s32, s35, 1
  s_and_b32 s32, s32, 3
  s_lshl_b32 s32, s32, 13
  s_add_u32 s32, s32, s83
  s_add_u32 s33, s32, 0x1000
  buffer_load_dwordx4 v[128:131], v2, s[4:7], s32 offen offset:0
  buffer_load_dwordx4 v[132:135], v2, s[4:7], s32 offen offset:1024
  buffer_load_dwordx4 v[136:139], v2, s[4:7], s32 offen offset:2048
  buffer_load_dwordx4 v[140:143], v2, s[4:7], s32 offen offset:3072
  buffer_load_dwordx4 v[144:147], v2, s[4:7], s33 offen offset:0
  buffer_load_dwordx4 v[148:151], v2, s[4:7], s33 offen offset:1024
  buffer_load_dwordx4 v[152:155], v2, s[4:7], s33 offen offset:2048
  buffer_load_dwordx4 v[156:159], v2, s[4:7], s33 offen offset:3072
  s_waitcnt vmcnt(8)
  s_barrier
  s_branch f_l2
f_b3:
  s_mov_b32 s67, 0
  s_mov_b32 s32, 20000
f_wl_l:
  v_and_b32 v14, 7, v1
  v_lshlrev_b32 v14, 2, v14
  buffer_load_dword v14, v14, s[20:23], s79 offen sc1
  s_waitcnt vmcnt(0)
f_wl_c:
  v_cmp_gt_i32 vcc, s89, v14
  s_nop 0
  s_and_b32 s33, vcc_lo, s88
  s_cbranch_scc0 f_wl_d
  s_sleep 2
  s_sub_u32 s32, s32, 1
  s_cmp_lg_u32 s32, 0
  s_cbranch_scc1 f_wl_l
f_wl_d:
  s_add_u32 s32, s35, 0
  s_and_b32 s32, s32, 3
  s_lshl_b32 s32, s32, 13
  s_add_u32 s32, s32, s83
  s_add_u32 s33, s32, 0x1000
  buffer_load_dwordx4 v[224:227], v2, s[4:7], s32 offen offset:0
  buffer_load_dwordx4 v[228:231], v2, s[4:7], s32 offen offset:1024
  buffer_load_dwordx4 v[232:235], v2, s[4:7], s32 offen offset:2048
  buffer_load_dwordx4 v[236:239], v2, s[4:7], s32 offen offset:3072
  buffer_load_dwordx4 v[240:243], v2, s[4:7], s33 offen offset:0
  buffer_load_dwordx4 v[244:247], v2, s[4:7], s33 offen offset:1024
  buffer_load_dwordx4 v[248:251], v2, s[4:7], s33 offen offset:2048
  buffer_load_dwordx4 v[252:255], v2, s[4:7], s33 offen offset:3072
  s_add_u32 s32, s35, 1
  s_and_b32 s32, s32, 3
  s_lshl_b32 s32, s32, 13
  s_add_u32 s32, s32, s83
  s_add_u32 s33, s32, 0x1000
  buffer_load_dwordx4 v[128:131], v2, s[4:7], s32 offen offset:0
  buffer_load_dwordx4 v[132:135], v2, s[4:7], s32 offen offset:1024
  buffer_load_dwordx4 v[136:139], v2, s[4:7], s32 offen offset:2048
  buffer_load_dwordx4 v[140:143], v2, s[4:7], s32 offen offset:3072
  buffer_load_dwordx4 v[144:147], v2, s[4:7], s33 offen offset:0
  buffer_load_dwordx4 v[148:151], v2, s[4:7], s33 offen offset:1024
  buffer_load_dwordx4 v[152:155], v2, s[4:7], s33 offen offset:2048
  buffer_load_dwordx4 v[156:159], v2, s[4:7], s33 offen offset:3072
f_l2:
  s_call_b64 s[100:101], f_ldB
f_oent:
  v_lshrrev_b32 v8, 2, v1
  v_lshlrev_b32 v8, 6, v8
  v_and_b32 v9, 3, v1
  v_lshl_add_u32 v8, v9, 3, v8
  v_and_b32 v9, 16, v1
  v_lshl_add_u32 v3, v9, 1, v8
  v_xor_b32 v4, 32, v3
  v_add_u32 v6, s68, v3
  v_add_u32 v7, s68, v4
  s_sub_u32 s68, s68, 0x8000
  s_cselect_b32 s68, 0x20000, s68
  ds_read_b64_tr_b16 v[32:33], v6 offset:0
  ds_read_b64_tr_b16 v[34:35], v6 offset:1024
  ds_read_b64_tr_b16 v[36:37], v7 offset:0
  ds_read_b64_tr_b16 v[38:39], v7 offset:1024
  ds_read_b64_tr_b16 v[40:41], v6 offset:2048
  ds_read_b64_tr_b16 v[42:43], v6 offset:3072
  ds_read_b64_tr_b16 v[44:45], v7 offset:2048
  ds_read_b64_tr_b16 v[46:47], v7 offset:3072
  ds_read_b64_tr_b16 v[48:49], v6 offset:4096
  ds_read_b64_tr_b16 v[50:51], v6 offset:5120
  ds_read_b64_tr_b16 v[52:53], v7 offset:4096
  ds_read_b64_tr_b16 v[54:55], v7 offset:5120
  ds_read_b64_tr_b16 v[56:57], v6 offset:6144
  ds_read_b64_tr_b16 v[58:59], v6 offset:7168
  ds_read_b64_tr_b16 v[60:61], v7 offset:6144
  s_mov_b32 s87, 0
  s_add_u32 s77, s82, 39936
  s_setprio 1
  s_cmp_ge_u32 s3, 4
  s_cbranch_scc1 f_oloop
  s_setprio 1
  s_waitcnt vmcnt(32)
f_oloop:
  s_waitcnt lgkmcnt(13)
  v_mfma_f32_16x16x32_bf16 v[64:67], v[224:227], v[32:35], 0
  ds_read_b64_tr_b16 v[62:63], v7 offset:7168
  v_mfma_f32_16x16x32_bf16 v[68:71], v[228:231], v[32:35], 0
  ds_read_b64_tr_b16 v[32:33], v6 offset:8192
  v_cvt_pk_bf16_f32 v84, v72, v73
  v_cvt_pk_bf16_f32 v85, v74, v75
  v_cvt_pk_bf16_f32 v86, v76, v77
  v_cvt_pk_bf16_f32 v87, v78, v79
  s_waitcnt lgkmcnt(13)
  v_mfma_f32_16x16x32_bf16 v[72:75], v[224:227], v[36:39], 0
  ds_read_b64_tr_b16 v[34:35], v6 offset:9216
  v_mfma_f32_16x16x32_bf16 v[76:79], v[228:231], v[36:39], 0
  ds_read_b64_tr_b16 v[36:37], v7 offset:8192
  s_waitcnt lgkmcnt(13)
  v_mfma_f32_16x16x32_bf16 v[64:67], v[232:235], v[40:43], v[64:67]
  ds_read_b64_tr_b16 v[38:39], v7 offset:9216
  s_cmp_eq_u32 s87, 0
  s_cbranch_scc1 f_ol1
  buffer_store_dwordx4 v[84:87], v2, s[20:23], s77 offen sc1
f_ol1:
  v_mfma_f32_16x16x32_bf16 v[68:71], v[236:239], v[40:43], v[68:71]
  ds_read_b64_tr_b16 v[40:41], v6 offset:10240
  s_waitcnt lgkmcnt(13)
  v_mfma_f32_16x16x32_bf16 v[72:75], v[232:235], v[44:47], v[72:75]
  ds_read_b64_tr_b16 v[42:43], v6 offset:11264
  s_add_u32 s77, s77, 1024
  v_mfma_f32_16x16x32_bf16 v[76:79], v[236:239], v[44:47], v[76:79]
  ds_read_b64_tr_b16 v[44:45], v7 offset:10240
  s_waitcnt lgkmcnt(13)
  v_mfma_f32_16x16x32_bf16 v[64:67], v[240:243], v[48:51], v[64:67]
  ds_read_b64_tr_b16 v[46:47], v7 offset:11264
  v_mfma_f32_16x16x32_bf16 v[68:71], v[244:247], v[48:51], v[68:71]
  ds_read_b64_tr_b16 v[48:49], v6 offset:12288
  s_waitcnt lgkmcnt(13)
  v_mfma_f32_16x16x32_bf16 v[72:75], v[240:243], v[52:55], v[72:75]
  ds_read_b64_tr_b16 v[50:51], v6 offset:13312
  v_mfma_f32_16x16x32_bf16 v[76:79], v[244:247], v[52:55], v[76:79]
  ds_read_b64_tr_b16 v[52:53], v7 offset:12288
  s_waitcnt lgkmcnt(13)
  v_mfma_f32_16x16x32_bf16 v[64:67], v[248:251], v[56:59], v[64:67]
  ds_read_b64_tr_b16 v[54:55], v7 offset:13312
  v_mfma_f32_16x16x32_bf16 v[68:71], v[252:255], v[56:59], v[68:71]
  ds_read_b64_tr_b16 v[56:57], v6 offset:14336
  s_waitcnt lgkmcnt(13)
  v_mfma_f32_16x16x32_bf16 v[72:75], v[248:251], v[60:63], v[72:75]
  ds_read_b64_tr_b16 v[58:59], v6 offset:15360
  v_mfma_f32_16x16x32_bf16 v[76:79], v[252:255], v[60:63], v[76:79]
  ds_read_b64_tr_b16 v[60:61], v7 offset:14336
  s_cmp_lg_u32 s87, 0
  s_cbranch_scc1 f_ow4
  s_waitcnt vmcnt(24)
  v_max3_u32 v8, v128, v129, v130
  v_max3_u32 v9, v131, v132, v133
  v_max3_u32 v8, v8, v134, v135
  v_max3_u32 v9, v9, v136, v137
  v_max3_u32 v8, v8, v138, v139
  v_max3_u32 v9, v9, v140, v141
  v_max3_u32 v8, v8, v142, v143
  v_max3_u32 v9, v9, v144, v145
  v_max3_u32 v8, v8, v146, v147
  v_max3_u32 v9, v9, v148, v149
  v_max3_u32 v8, v8, v150, v151
  v_max3_u32 v9, v9, v152, v153
  v_max3_u32 v8, v8, v154, v155
  v_max3_u32 v9, v9, v156, v157
  v_max3_u32 v8, v8, v158, v159
  v_max_u32 v8, v8, v9
  v_cmp_eq_u32 vcc, -1, v8
  s_nop 4
  s_cbranch_vccnz f_rl4
f_ow4:
  s_waitcnt lgkmcnt(13)
  v_mfma_f32_16x16x32_bf16 v[64:67], v[128:131], v[32:35], v[64:67]
  ds_read_b64_tr_b16 v[62:63], v7 offset:15360
  v_mfma_f32_16x16x32_bf16 v[68:71], v[132:135], v[32:35], v[68:71]
  ds_read_b64_tr_b16 v[32:33], v6 offset:16384
  s_waitcnt lgkmcnt(13)
  v_mfma_f32_16x16x32_bf16 v[72:75], v[128:131], v[36:39], v[72:75]
  ds_read_b64_tr_b16 v[34:35], v6 offset:17408
  v_mfma_f32_16x16x32_bf16 v[76:79], v[132:135], v[36:39], v[76:79]
  ds_read_b64_tr_b16 v[36:37], v7 offset:16384
  s_waitcnt lgkmcnt(13)
  v_mfma_f32_16x16x32_bf16 v[64:67], v[136:139], v[40:43], v[64:67]
  ds_read_b64_tr_b16 v[38:39], v7 offset:17408
  v_mfma_f32_16x16x32_bf16 v[68:71], v[140:143], v[40:43], v[68:71]
  ds_read_b64_tr_b16 v[40:41], v6 offset:18432
  s_waitcnt lgkmcnt(13)
  v_mfma_f32_16x16x32_bf16 v[72:75], v[136:139], v[44:47], v[72:75]
  ds_read_b64_tr_b16 v[42:43], v6 offset:19456
  v_mfma_f32_16x16x32_bf16 v[76:79], v[140:143], v[44:47], v[76:79]
  ds_read_b64_tr_b16 v[44:45], v7 offset:18432
  s_waitcnt lgkmcnt(13)
  v_mfma_f32_16x16x32_bf16 v[64:67], v[144:147], v[48:51], v[64:67]
  ds_read_b64_tr_b16 v[46:47], v7 offset:19456
  v_mfma_f32_16x16x32_bf16 v[68:71], v[148:151], v[48:51], v[68:71]
  ds_read_b64_tr_b16 v[48:49], v6 offset:20480
  s_waitcnt lgkmcnt(13)
  v_mfma_f32_16x16x32_bf16 v[72:75], v[144:147], v[52:55], v[72:75]
  ds_read_b64_tr_b16 v[50:51], v6 offset:21504
  v_mfma_f32_16x16x32_bf16 v[76:79], v[148:151], v[52:55], v[76:79]
  ds_read_b64_tr_b16 v[52:53], v7 offset:20480
  s_waitcnt lgkmcnt(13)
  v_mfma_f32_16x16x32_bf16 v[64:67], v[152:155], v[56:59], v[64:67]
  ds_read_b64_tr_b16 v[54:55], v7 offset:21504
  v_mfma_f32_16x16x32_bf16 v[68:71], v[156:159], v[56:59], v[68:71]
  ds_read_b64_tr_b16 v[56:57], v6 offset:22528
  s_waitcnt lgkmcnt(13)
  v_mfma_f32_16x16x32_bf16 v[72:75], v[152:155], v[60:63], v[72:75]
  ds_read_b64_tr_b16 v[58:59], v6 offset:23552
  v_mfma_f32_16x16x32_bf16 v[76:79], v[156:159], v[60:63], v[76:79]
  ds_read_b64_tr_b16 v[60:61], v7 offset:22528
  s_cmp_lg_u32 s87, 0
  s_cbranch_scc1 f_ow8
  s_waitcnt vmcnt(16)
  v_max3_u32 v8, v160, v161, v162
  v_max3_u32 v9, v163, v164, v165
  v_max3_u32 v8, v8, v166, v167
  v_max3_u32 v9, v9, v168, v169
  v_max3_u32 v8, v8, v170, v171
  v_max3_u32 v9, v9, v172, v173
  v_max3_u32 v8, v8, v174, v175
  v_max3_u32 v9, v9, v176, v177
  v_max3_u32 v8, v8, v178, v179
  v_max3_u32 v9, v9, v180, v181
  v_max3_u32 v8, v8, v182, v183
  v_max3_u32 v9, v9, v184, v185
  v_max3_u32 v8, v8, v186, v187
  v_max3_u32 v9, v9, v188, v189
  v_max3_u32 v8, v8, v190, v191
  v_max_u32 v8, v8, v9
  v_cmp_eq_u32 vcc, -1, v8
  s_nop 4
  s_cbranch_vccnz f_rl8
f_ow8:
  s_waitcnt lgkmcnt(13)
  v_mfma_f32_16x16x32_bf16 v[64:67], v[160:163], v[32:35], v[64:67]
  ds_read_b64_tr_b16 v[62:63], v7 offset:23552
  v_mfma_f32_16x16x32_bf16 v[68:71], v[164:167], v[32:35], v[68:71]
  ds_read_b64_tr_b16 v[32:33], v6 offset:24576
  s_waitcnt lgkmcnt(13)
  v_mfma_f32_16x16x32_bf16 v[72:75], v[160:163], v[36:39], v[72:75]
  ds_read_b64_tr_b16 v[34:35], v6 offset:25600
  v_mfma_f32_16x16x32_bf16 v[76:79], v[164:167], v[36:39], v[76:79]
  ds_read_b64_tr_b16 v[36:37], v7 offset:24576
  s_waitcnt lgkmcnt(13)
  v_mfma_f32_16x16x32_bf16 v[64:67], v[168:171], v[40:43], v[64:67]
  ds_read_b64_tr_b16 v[38:39], v7 offset:25600
  v_mfma_f32_16x16x32_bf16 v[68:71], v[172:175], v[40:43], v[68:71]
  ds_read_b64_tr_b16 v[40:41], v6 offset:26624
  s_waitcnt lgkmcnt(13)
  v_mfma_f32_16x16x32_bf16 v[72:75], v[168:171], v[44:47], v[72:75]
  ds_read_b64_tr_b16 v[42:43], v6 offset:27648
  v_mfma_f32_16x16x32_bf16 v[76:79], v[172:175], v[44:47], v[76:79]
  ds_read_b64_tr_b16 v[44:45], v7 offset:26624
  s_waitcnt lgkmcnt(13)
  v_mfma_f32_16x16x32_bf16 v[64:67], v[176:179], v[48:51], v[64:67]
  ds_read_b64_tr_b16 v[46:47], v7 offset:27648
  v_mfma_f32_16x16x32_bf16 v[68:71], v[180:183], v[48:51], v[68:71]
  ds_read_b64_tr_b16 v[48:49], v6 offset:28672
  s_waitcnt lgkmcnt(13)
  v_mfma_f32_16x16x32_bf16 v[72:75], v[176:179], v[52:55], v[72:75]
  ds_read_b64_tr_b16 v[50:51], v6 offset:29696
  v_mfma_f32_16x16x32_bf16 v[76:79], v[180:183], v[52:55], v[76:79]
  ds_read_b64_tr_b16 v[52:53], v7 offset:28672
  s_waitcnt lgkmcnt(13)
  v_mfma_f32_16x16x32_bf16 v[64:67], v[184:187], v[56:59], v[64:67]
  ds_read_b64_tr_b16 v[54:55], v7 offset:29696
  v_mfma_f32_16x16x32_bf16 v[68:71], v[188:191], v[56:59], v[68:71]
  ds_read_b64_tr_b16 v[56:57], v6 offset:30720
  s_waitcnt lgkmcnt(13)
  v_mfma_f32_16x16x32_bf16 v[72:75], v[184:187], v[60:63], v[72:75]
  ds_read_b64_tr_b16 v[58:59], v6 offset:31744
  v_mfma_f32_16x16x32_bf16 v[76:79], v[188:191], v[60:63], v[76:79]
  ds_read_b64_tr_b16 v[60:61], v7 offset:30720
  v_add_u32 v6, s68, v3
  s_cmp_lg_u32 s87, 0
  s_cbranch_scc1 f_ow12
  s_waitcnt vmcnt(8)
  v_max3_u32 v8, v192, v193, v194
  v_max3_u32 v9, v195, v196, v197
  v_max3_u32 v8, v8, v198, v199
  v_max3_u32 v9, v9, v200, v201
  v_max3_u32 v8, v8, v202, v203
  v_max3_u32 v9, v9, v204, v205
  v_max3_u32 v8, v8, v206, v207
  v_max3_u32 v9, v9, v208, v209
  v_max3_u32 v8, v8, v210, v211
  v_max3_u32 v9, v9, v212, v213
  v_max3_u32 v8, v8, v214, v215
  v_max3_u32 v9, v9, v216, v217
  v_max3_u32 v8, v8, v218, v219
  v_max3_u32 v9, v9, v220, v221
  v_max3_u32 v8, v8, v222, v223
  v_max_u32 v8, v8, v9
  v_cmp_eq_u32 vcc, -1, v8
  s_nop 4
  s_cbranch_vccnz f_rl12
f_ow12:
  s_waitcnt lgkmcnt(13)
  v_mfma_f32_16x16x32_bf16 v[64:67], v[192:195], v[32:35], v[64:67]
  ds_read_b64_tr_b16 v[62:63], v7 offset:31744
  s_bitcmp0_b32 s67, s87
  s_cbranch_scc1 f_ol2
  s_waitcnt vmcnt(2)
  s_barrier
f_ol2:
  v_mfma_f32_16x16x32_bf16 v[68:71], v[196:199], v[32:35], v[68:71]
  ds_read_b64_tr_b16 v[32:33], v6 offset:0
  v_add_u32 v7, s68, v4
  s_waitcnt lgkmcnt(13)
  v_mfma_f32_16x16x32_bf16 v[72:75], v[192:195], v[36:39], v[72:75]
  ds_read_b64_tr_b16 v[34:35], v6 offset:1024
  v_mfma_f32_16x16x32_bf16 v[76:79], v[196:199], v[36:39], v[76:79]
  ds_read_b64_tr_b16 v[36:37], v7 offset:0
  s_waitcnt lgkmcnt(13)
  v_mfma_f32_16x16x32_bf16 v[64:67], v[200:203], v[40:43], v[64:67]
  ds_read_b64_tr_b16 v[38:39], v7 offset:1024
  s_sub_u32 s68, s68, 0x8000
  s_cselect_b32 s68, 0x20000, s68
  v_mfma_f32_16x16x32_bf16 v[68:71], v[204:207], v[40:43], v[68:71]
  ds_read_b64_tr_b16 v[40:41], v6 offset:2048
  s_waitcnt lgkmcnt(13)
  v_mfma_f32_16x16x32_bf16 v[72:75], v[200:203], v[44:47], v[72:75]
  ds_read_b64_tr_b16 v[42:43], v6 offset:3072
  v_mfma_f32_16x16x32_bf16 v[76:79], v[204:207], v[44:47], v[76:79]
  ds_read_b64_tr_b16 v[44:45], v7 offset:2048
  s_waitcnt lgkmcnt(13)
  v_mfma_f32_16x16x32_bf16 v[64:67], v[208:211], v[48:51], v[64:67]
  ds_read_b64_tr_b16 v[46:47], v7 offset:3072
  s_add_u32 s87, s87, 1
  v_mfma_f32_16x16x32_bf16 v[68:71], v[212:215], v[48:51], v[68:71]
  ds_read_b64_tr_b16 v[48:49], v6 offset:4096
  s_waitcnt lgkmcnt(13)
  v_mfma_f32_16x16x32_bf16 v[72:75], v[208:211], v[52:55], v[72:75]
  ds_read_b64_tr_b16 v[50:51], v6 offset:5120
  v_mfma_f32_16x16x32_bf16 v[76:79], v[212:215], v[52:55], v[76:79]
  ds_read_b64_tr_b16 v[52:53], v7 offset:4096
  s_waitcnt lgkmcnt(13)
  v_mfma_f32_16x16x32_bf16 v[64:67], v[216:219], v[56:59], v[64:67]
  ds_read_b64_tr_b16 v[54:55], v7 offset:5120
  v_mfma_f32_16x16x32_bf16 v[68:71], v[220:223], v[56:59], v[68:71]
  ds_read_b64_tr_b16 v[56:57], v6 offset:6144
  s_waitcnt lgkmcnt(13)
  v_mfma_f32_16x16x32_bf16 v[72:75], v[216:219], v[60:63], v[72:75]
  ds_read_b64_tr_b16 v[58:59], v6 offset:7168
  v_mfma_f32_16x16x32_bf16 v[76:79], v[220:223], v[60:63], v[76:79]
  ds_read_b64_tr_b16 v[60:61], v7 offset:6144
  v_cvt_pk_bf16_f32 v80, v64, v65
  v_cvt_pk_bf16_f32 v81, v66, v67
  v_cvt_pk_bf16_f32 v82, v68, v69
  v_cvt_pk_bf16_f32 v83, v70, v71
  buffer_store_dwordx4 v[80:83], v2, s[20:23], s82 offen sc1
  s_add_u32 s82, s82, 1024
  s_cmp_lt_u32 s87, 5
  s_cbranch_scc1 f_oloop
  v_cvt_pk_bf16_f32 v84, v72, v73
  v_cvt_pk_bf16_f32 v85, v74, v75
  v_cvt_pk_bf16_f32 v86, v76, v77
  v_cvt_pk_bf16_f32 v87, v78, v79
  buffer_store_dwordx4 v[84:87], v2, s[20:23], s77 offen sc1
  s_waitcnt vmcnt(10)
  s_cmp_ge_u32 s3, 4
  s_cbranch_scc1 f_t2
  s_setprio 0
  v_mov_b32 v15, -1
  s_movk_i32 s32, 0xfe
  s_bitcmp0_b32 s32, s36
  s_cbranch_scc1 f_t1
  s_movk_i32 s32, 0xe2
  s_bitcmp1_b32 s32, s36
  s_cbranch_scc1 f_th
  s_lshr_b32 s91, s2, 3
  s_sub_u32 s91, s91, 8
  s_lshl_b32 s91, s91, 2
  s_add_u32 s91, s91, s3
  s_lshl_b32 s91, s91, 1
  s_mov_b32 s8, s64
  s_and_b32 s9, s65, 0xffff
  s_mov_b32 s10, 0x280000
  s_mov_b32 s11, 0x00020000
  s_add_u32 s72, s91, 0
  s_mul_i32 s32, s72, 13108
  s_lshr_b32 s32, s32, 16
  s_mul_i32 s33, s32, 5
  s_sub_u32 s73, s72, s33
  s_and_b32 s74, s32, 7
  s_lshr_b32 s66, s32, 3
  s_lshl_b32 s33, s34, 5
  s_add_u32 s32, s32, s33
  s_mul_i32 s32, s32, 30720
  s_lshl_b32 s33, s73, 11
  s_add_u32 s32, s32, s33
  s_add_u32 s70, s32, 0x1800000
  s_mul_i32 s32, s66, 160
  s_and_b32 s33, s74, 1
  s_mul_i32 s33, s33, 80
  s_add_u32 s32, s32, s33
  s_lshl_b32 s33, s73, 4
  s_add_u32 s32, s32, s33
  v_and_b32 v8, 15, v1
  v_add_u32 v8, s32, v8
  s_lshl_b32 s32, s34, 8
  s_lshr_b32 s33, s74, 1
  s_lshl_b32 s33, s33, 6
  s_add_u32 s32, s32, s33
  v_lshrrev_b32 v9, 4, v1
  v_lshl_add_u32 v9, v9, 2, s32
  v_mul_u32_u24 v9, 640, v9
  v_add_lshl_u32 v16, v9, v8, 1
  v_lshl_add_u32 v9, v9, 1, v8
  v_lshlrev_b32 v20, 2, v9
  v_lshlrev_b32 v8, 1, v8
  global_load_ushort v18, v8, s[80:81]
  s_mov_b32 s32, 0
  buffer_load_ushort v96, v16, s[8:11], s32 offen offset:0
  buffer_load_ushort v97, v16, s[8:11], s32 offen offset:1280
  buffer_load_ushort v98, v16, s[8:11], s32 offen offset:2560
  buffer_load_ushort v99, v16, s[8:11], s32 offen offset:3840
  s_mov_b32 s32, 20480
  buffer_load_ushort v100, v16, s[8:11], s32 offen offset:0
  buffer_load_ushort v101, v16, s[8:11], s32 offen offset:1280
  buffer_load_ushort v102, v16, s[8:11], s32 offen offset:2560
  buffer_load_ushort v103, v16, s[8:11], s32 offen offset:3840
  s_mov_b32 s32, 40960
  buffer_load_ushort v104, v16, s[8:11], s32 offen offset:0
  buffer_load_ushort v105, v16, s[8:11], s32 offen offset:1280
  buffer_load_ushort v106, v16, s[8:11], s32 offen offset:2560
  buffer_load_ushort v107, v16, s[8:11], s32 offen offset:3840
  s_mov_b32 s32, 61440
  buffer_load_ushort v108, v16, s[8:11], s32 offen offset:0
  buffer_load_ushort v109, v16, s[8:11], s32 offen offset:1280
  buffer_load_ushort v110, v16, s[8:11], s32 offen offset:2560
  buffer_load_ushort v111, v16, s[8:11], s32 offen offset:3840
  s_add_u32 s72, s91, 1
  s_mul_i32 s32, s72, 13108
  s_lshr_b32 s32, s32, 16
  s_mul_i32 s33, s32, 5
  s_sub_u32 s73, s72, s33
  s_and_b32 s74, s32, 7
  s_lshr_b32 s66, s32, 3
  s_lshl_b32 s33, s34, 5
  s_add_u32 s32, s32, s33
  s_mul_i32 s32, s32, 30720
  s_lshl_b32 s33, s73, 11
  s_add_u32 s32, s32, s33
  s_add_u32 s71, s32, 0x1800000
  s_mul_i32 s32, s66, 160
  s_and_b32 s33, s74, 1
  s_mul_i32 s33, s33, 80
  s_add_u32 s32, s32, s33
  s_lshl_b32 s33, s73, 4
  s_add_u32 s32, s32, s33
  v_and_b32 v8, 15, v1
  v_add_u32 v8, s32, v8
  s_lshl_b32 s32, s34, 8
  s_lshr_b32 s33, s74, 1
  s_lshl_b32 s33, s33, 6
  s_add_u32 s32, s32, s33
  v_lshrrev_b32 v9, 4, v1
  v_lshl_add_u32 v9, v9, 2, s32
  v_mul_u32_u24 v9, 640, v9
  v_add_lshl_u32 v17, v9, v8, 1
  v_lshl_add_u32 v9, v9, 1, v8
  v_lshlrev_b32 v21, 2, v9
  v_lshlrev_b32 v8, 1, v8
  global_load_ushort v19, v8, s[80:81]
  s_mov_b32 s32, 0
  buffer_load_ushort v112, v17, s[8:11], s32 offen offset:0
  buffer_load_ushort v113, v17, s[8:11], s32 offen offset:1280
  buffer_load_ushort v114, v17, s[8:11], s32 offen offset:2560
  buffer_load_ushort v115, v17, s[8:11], s32 offen offset:3840
  s_mov_b32 s32, 20480
  buffer_load_ushort v116, v17, s[8:11], s32 offen offset:0
  buffer_load_ushort v117, v17, s[8:11], s32 offen offset:1280
  buffer_load_ushort v118, v17, s[8:11], s32 offen offset:2560
  buffer_load_ushort v119, v17, s[8:11], s32 offen offset:3840
  s_mov_b32 s32, 40960
  buffer_load_ushort v120, v17, s[8:11], s32 offen offset:0
  buffer_load_ushort v121, v17, s[8:11], s32 offen offset:1280
  buffer_load_ushort v122, v17, s[8:11], s32 offen offset:2560
  buffer_load_ushort v123, v17, s[8:11], s32 offen offset:3840
  s_mov_b32 s32, 61440
  buffer_load_ushort v124, v17, s[8:11], s32 offen offset:0
  buffer_load_ushort v125, v17, s[8:11], s32 offen offset:1280
  buffer_load_ushort v126, v17, s[8:11], s32 offen offset:2560
  buffer_load_ushort v127, v17, s[8:11], s32 offen offset:3840
  buffer_load_dwordx4 v[128:131], v2, s[20:23], s70 offen offset:0
  buffer_load_dwordx4 v[132:135], v2, s[20:23], s70 offen offset:1024
  s_add_u32 s70, s70, 10240
  buffer_load_dwordx4 v[136:139], v2, s[20:23], s70 offen offset:0
  buffer_load_dwordx4 v[140:143], v2, s[20:23], s70 offen offset:1024
  s_add_u32 s70, s70, 10240
  buffer_load_dwordx4 v[144:147], v2, s[20:23], s70 offen offset:0
  buffer_load_dwordx4 v[148:151], v2, s[20:23], s70 offen offset:1024
  buffer_load_dwordx4 v[160:163], v2, s[20:23], s71 offen offset:0
  buffer_load_dwordx4 v[164:167], v2, s[20:23], s71 offen offset:1024
  s_add_u32 s71, s71, 10240
  buffer_load_dwordx4 v[168:171], v2, s[20:23], s71 offen offset:0
  buffer_load_dwordx4 v[172:175], v2, s[20:23], s71 offen offset:1024
  s_add_u32 s71, s71, 10240
  buffer_load_dwordx4 v[176:179], v2, s[20:23], s71 offen offset:0
  buffer_load_dwordx4 v[180:183], v2, s[20:23], s71 offen offset:1024
  s_waitcnt vmcnt(46)
  v_lshlrev_b32 v8, 26, v1
  v_mov_b32 v9, 2
  buffer_store_dword v9, v8, s[20:23], s78 offen sc1
  s_waitcnt vmcnt(13)
  v_lshlrev_b32 v18, 16, v18
  v_lshlrev_b32 v96, 16, v96
  v_mul_f32 v96, v96, v18
  v_lshlrev_b32 v97, 16, v97
  v_mul_f32 v97, v97, v18
  v_lshlrev_b32 v98, 16, v98
  v_mul_f32 v98, v98, v18
  v_lshlrev_b32 v99, 16, v99
  v_mul_f32 v99, v99, v18
  v_lshlrev_b32 v100, 16, v100
  v_mul_f32 v100, v100, v18
  v_lshlrev_b32 v101, 16, v101
  v_mul_f32 v101, v101, v18
  v_lshlrev_b32 v102, 16, v102
  v_mul_f32 v102, v102, v18
  v_lshlrev_b32 v103, 16, v103
  v_mul_f32 v103, v103, v18
  v_lshlrev_b32 v104, 16, v104
  v_mul_f32 v104, v104, v18
  v_lshlrev_b32 v105, 16, v105
  v_mul_f32 v105, v105, v18
  v_lshlrev_b32 v106, 16, v106
  v_mul_f32 v106, v106, v18
  v_lshlrev_b32 v107, 16, v107
  v_mul_f32 v107, v107, v18
  v_lshlrev_b32 v108, 16, v108
  v_mul_f32 v108, v108, v18
  v_lshlrev_b32 v109, 16, v109
  v_mul_f32 v109, v109, v18
  v_lshlrev_b32 v110, 16, v110
  v_mul_f32 v110, v110, v18
  v_lshlrev_b32 v111, 16, v111
  v_mul_f32 v111, v111, v18
  v_cvt_pk_bf16_f32 v96, v96, v97
  v_lshlrev_b32 v32, 16, v96
  v_and_b32 v33, 0xffff0000, v96
  v_cvt_pk_bf16_f32 v97, v98, v99
  v_lshlrev_b32 v34, 16, v97
  v_and_b32 v35, 0xffff0000, v97
  v_cvt_pk_bf16_f32 v98, v100, v101
  v_lshlrev_b32 v36, 16, v98
  v_and_b32 v37, 0xffff0000, v98
  v_cvt_pk_bf16_f32 v99, v102, v103
  v_lshlrev_b32 v38, 16, v99
  v_and_b32 v39, 0xffff0000, v99
  v_cvt_pk_bf16_f32 v100, v104, v105
  v_lshlrev_b32 v40, 16, v100
  v_and_b32 v41, 0xffff0000, v100
  v_cvt_pk_bf16_f32 v101, v106, v107
  v_lshlrev_b32 v42, 16, v101
  v_and_b32 v43, 0xffff0000, v101
  v_cvt_pk_bf16_f32 v102, v108, v109
  v_lshlrev_b32 v44, 16, v102
  v_and_b32 v45, 0xffff0000, v102
  v_cvt_pk_bf16_f32 v103, v110, v111
  v_lshlrev_b32 v46, 16, v103
  v_and_b32 v47, 0xffff0000, v103
  v_lshlrev_b32 v19, 16, v19
  v_lshlrev_b32 v112, 16, v112
  v_mul_f32 v112, v112, v19
  v_lshlrev_b32 v113, 16, v113
  v_mul_f32 v113, v113, v19
  v_lshlrev_b32 v114, 16, v114
  v_mul_f32 v114, v114, v19
  v_lshlrev_b32 v115, 16, v115
  v_mul_f32 v115, v115, v19
  v_lshlrev_b32 v116, 16, v116
  v_mul_f32 v116, v116, v19
  v_lshlrev_b32 v117, 16, v117
  v_mul_f32 v117, v117, v19
  v_lshlrev_b32 v118, 16, v118
  v_mul_f32 v118, v118, v19
  v_lshlrev_b32 v119, 16, v119
  v_mul_f32 v119, v119, v19
  v_lshlrev_b32 v120, 16, v120
  v_mul_f32 v120, v120, v19
  v_lshlrev_b32 v121, 16, v121
  v_mul_f32 v121, v121, v19
  v_lshlrev_b32 v122, 16, v122
  v_mul_f32 v122, v122, v19
  v_lshlrev_b32 v123, 16, v123
  v_mul_f32 v123, v123, v19
  v_lshlrev_b32 v124, 16, v124
  v_mul_f32 v124, v124, v19
  v_lshlrev_b32 v125, 16, v125
  v_mul_f32 v125, v125, v19
  v_lshlrev_b32 v126, 16, v126
  v_mul_f32 v126, v126, v19
  v_lshlrev_b32 v127, 16, v127
  v_mul_f32 v127, v127, v19
  v_cvt_pk_bf16_f32 v112, v112, v113
  v_lshlrev_b32 v48, 16, v112
  v_and_b32 v49, 0xffff0000, v112
  v_cvt_pk_bf16_f32 v113, v114, v115
  v_lshlrev_b32 v50, 16, v113
  v_and_b32 v51, 0xffff0000, v113
  v_cvt_pk_bf16_f32 v114, v116, v117
  v_lshlrev_b32 v52, 16, v114
  v_and_b32 v53, 0xffff0000, v114
  v_cvt_pk_bf16_f32 v115, v118, v119
  v_lshlrev_b32 v54, 16, v115
  v_and_b32 v55, 0xffff0000, v115
  v_cvt_pk_bf16_f32 v116, v120, v121
  v_lshlrev_b32 v56, 16, v116
  v_and_b32 v57, 0xffff0000, v116
  v_cvt_pk_bf16_f32 v117, v122, v123
  v_lshlrev_b32 v58, 16, v117
  v_and_b32 v59, 0xffff0000, v117
  v_cvt_pk_bf16_f32 v118, v124, v125
  v_lshlrev_b32 v60, 16, v118
  v_and_b32 v61, 0xffff0000, v118
  v_cvt_pk_bf16_f32 v119, v126, v127
  v_lshlrev_b32 v62, 16, v119
  v_and_b32 v63, 0xffff0000, v119
  s_waitcnt vmcnt(11)
  v_lshlrev_b32 v8, 16, v128
  v_and_b32 v128, 0xffff0000, v128
  v_add_f32 v32, v32, v8
  v_add_f32 v33, v33, v128
  v_lshlrev_b32 v9, 16, v129
  v_and_b32 v129, 0xffff0000, v129
  v_add_f32 v34, v34, v9
  v_add_f32 v35, v35, v129
  v_lshlrev_b32 v8, 16, v130
  v_and_b32 v130, 0xffff0000, v130
  v_add_f32 v36, v36, v8
  v_add_f32 v37, v37, v130
  v_lshlrev_b32 v9, 16, v131
  v_and_b32 v131, 0xffff0000, v131
  v_add_f32 v38, v38, v9
  v_add_f32 v39, v39, v131
  v_lshlrev_b32 v8, 16, v132
  v_and_b32 v132, 0xffff0000, v132
  v_add_f32 v40, v40, v8
  v_add_f32 v41, v41, v132
  v_lshlrev_b32 v9, 16, v133
  v_and_b32 v133, 0xffff0000, v133
  v_add_f32 v42, v42, v9
  v_add_f32 v43, v43, v133
  v_lshlrev_b32 v8, 16, v134
  v_and_b32 v134, 0xffff0000, v134
  v_add_f32 v44, v44, v8
  v_add_f32 v45, v45, v134
  v_lshlrev_b32 v9, 16, v135
  v_and_b32 v135, 0xffff0000, v135
  v_add_f32 v46, v46, v9
  v_add_f32 v47, v47, v135
  s_waitcnt vmcnt(9)
  v_lshlrev_b32 v8, 16, v136
  v_and_b32 v136, 0xffff0000, v136
  v_add_f32 v32, v32, v8
  v_add_f32 v33, v33, v136
  v_lshlrev_b32 v9, 16, v137
  v_and_b32 v137, 0xffff0000, v137
  v_add_f32 v34, v34, v9
  v_add_f32 v35, v35, v137
  v_lshlrev_b32 v8, 16, v138
  v_and_b32 v138, 0xffff0000, v138
  v_add_f32 v36, v36, v8
  v_add_f32 v37, v37, v138
  v_lshlrev_b32 v9, 16, v139
  v_and_b32 v139, 0xffff0000, v139
  v_add_f32 v38, v38, v9
  v_add_f32 v39, v39, v139
  v_lshlrev_b32 v8, 16, v140
  v_and_b32 v140, 0xffff0000, v140
  v_add_f32 v40, v40, v8
  v_add_f32 v41, v41, v140
  v_lshlrev_b32 v9, 16, v141
  v_and_b32 v141, 0xffff0000, v141
  v_add_f32 v42, v42, v9
  v_add_f32 v43, v43, v141
  v_lshlrev_b32 v8, 16, v142
  v_and_b32 v142, 0xffff0000, v142
  v_add_f32 v44, v44, v8
  v_add_f32 v45, v45, v142
  v_lshlrev_b32 v9, 16, v143
  v_and_b32 v143, 0xffff0000, v143
  v_add_f32 v46, v46, v9
  v_add_f32 v47, v47, v143
  s_waitcnt vmcnt(7)
  v_lshlrev_b32 v8, 16, v144
  v_and_b32 v144, 0xffff0000, v144
  v_add_f32 v32, v32, v8
  v_add_f32 v33, v33, v144
  v_lshlrev_b32 v9, 16, v145
  v_and_b32 v145, 0xffff0000, v145
  v_add_f32 v34, v34, v9
  v_add_f32 v35, v35, v145
  v_lshlrev_b32 v8, 16, v146
  v_and_b32 v146, 0xffff0000, v146
  v_add_f32 v36, v36, v8
  v_add_f32 v37, v37, v146
  v_lshlrev_b32 v9, 16, v147
  v_and_b32 v147, 0xffff0000, v147
  v_add_f32 v38, v38, v9
  v_add_f32 v39, v39, v147
  v_lshlrev_b32 v8, 16, v148
  v_and_b32 v148, 0xffff0000, v148
  v_add_f32 v40, v40, v8
  v_add_f32 v41, v41, v148
  v_lshlrev_b32 v9, 16, v149
  v_and_b32 v149, 0xffff0000, v149
  v_add_f32 v42, v42, v9
  v_add_f32 v43, v43, v149
  v_lshlrev_b32 v8, 16, v150
  v_and_b32 v150, 0xffff0000, v150
  v_add_f32 v44, v44, v8
  v_add_f32 v45, v45, v150
  v_lshlrev_b32 v9, 16, v151
  v_and_b32 v151, 0xffff0000, v151
  v_add_f32 v46, v46, v9
  v_add_f32 v47, v47, v151
  s_mov_b32 s32, 0
  buffer_store_dword v32, v20, s[16:19], s32 offen
  s_mov_b32 s32, 5120
  buffer_store_dword v33, v20, s[16:19], s32 offen
  s_mov_b32 s32, 10240
  buffer_store_dword v34, v20, s[16:19], s32 offen
  s_mov_b32 s32, 15360
  buffer_store_dword v35, v20, s[16:19], s32 offen
  s_mov_b32 s32, 81920
  buffer_store_dword v36, v20, s[16:19], s32 offen
  s_mov_b32 s32, 87040
  buffer_store_dword v37, v20, s[16:19], s32 offen
  s_mov_b32 s32, 92160
  buffer_store_dword v38, v20, s[16:19], s32 offen
  s_mov_b32 s32, 97280
  buffer_store_dword v39, v20, s[16:19], s32 offen
  s_mov_b32 s32, 163840
  buffer_store_dword v40, v20, s[16:19], s32 offen
  s_mov_b32 s32, 168960
  buffer_store_dword v41, v20, s[16:19], s32 offen
  s_mov_b32 s32, 174080
  buffer_store_dword v42, v20, s[16:19], s32 offen
  s_mov_b32 s32, 179200
  buffer_store_dword v43, v20, s[16:19], s32 offen
  s_mov_b32 s32, 245760
  buffer_store_dword v44, v20, s[16:19], s32 offen
  s_mov_b32 s32, 250880
  buffer_store_dword v45, v20, s[16:19], s32 offen
  s_mov_b32 s32, 256000
  buffer_store_dword v46, v20, s[16:19], s32 offen
  s_mov_b32 s32, 261120
  buffer_store_dword v47, v20, s[16:19], s32 offen
  s_waitcnt vmcnt(21)
  v_lshlrev_b32 v8, 16, v160
  v_and_b32 v160, 0xffff0000, v160
  v_add_f32 v48, v48, v8
  v_add_f32 v49, v49, v160
  v_lshlrev_b32 v9, 16, v161
  v_and_b32 v161, 0xffff0000, v161
  v_add_f32 v50, v50, v9
  v_add_f32 v51, v51, v161
  v_lshlrev_b32 v8, 16, v162
  v_and_b32 v162, 0xffff0000, v162
  v_add_f32 v52, v52, v8
  v_add_f32 v53, v53, v162
  v_lshlrev_b32 v9, 16, v163
  v_and_b32 v163, 0xffff0000, v163
  v_add_f32 v54, v54, v9
  v_add_f32 v55, v55, v163
  v_lshlrev_b32 v8, 16, v164
  v_and_b32 v164, 0xffff0000, v164
  v_add_f32 v56, v56, v8
  v_add_f32 v57, v57, v164
  v_lshlrev_b32 v9, 16, v165
  v_and_b32 v165, 0xffff0000, v165
  v_add_f32 v58, v58, v9
  v_add_f32 v59, v59, v165
  v_lshlrev_b32 v8, 16, v166
  v_and_b32 v166, 0xffff0000, v166
  v_add_f32 v60, v60, v8
  v_add_f32 v61, v61, v166
  v_lshlrev_b32 v9, 16, v167
  v_and_b32 v167, 0xffff0000, v167
  v_add_f32 v62, v62, v9
  v_add_f32 v63, v63, v167
  s_waitcnt vmcnt(19)
  v_lshlrev_b32 v8, 16, v168
  v_and_b32 v168, 0xffff0000, v168
  v_add_f32 v48, v48, v8
  v_add_f32 v49, v49, v168
  v_lshlrev_b32 v9, 16, v169
  v_and_b32 v169, 0xffff0000, v169
  v_add_f32 v50, v50, v9
  v_add_f32 v51, v51, v169
  v_lshlrev_b32 v8, 16, v170
  v_and_b32 v170, 0xffff0000, v170
  v_add_f32 v52, v52, v8
  v_add_f32 v53, v53, v170
  v_lshlrev_b32 v9, 16, v171
  v_and_b32 v171, 0xffff0000, v171
  v_add_f32 v54, v54, v9
  v_add_f32 v55, v55, v171
  v_lshlrev_b32 v8, 16, v172
  v_and_b32 v172, 0xffff0000, v172
  v_add_f32 v56, v56, v8
  v_add_f32 v57, v57, v172
  v_lshlrev_b32 v9, 16, v173
  v_and_b32 v173, 0xffff0000, v173
  v_add_f32 v58, v58, v9
  v_add_f32 v59, v59, v173
  v_lshlrev_b32 v8, 16, v174
  v_and_b32 v174, 0xffff0000, v174
  v_add_f32 v60, v60, v8
  v_add_f32 v61, v61, v174
  v_lshlrev_b32 v9, 16, v175
  v_and_b32 v175, 0xffff0000, v175
  v_add_f32 v62, v62, v9
  v_add_f32 v63, v63, v175
  s_waitcnt vmcnt(17)
  v_lshlrev_b32 v8, 16, v176
  v_and_b32 v176, 0xffff0000, v176
  v_add_f32 v48, v48, v8
  v_add_f32 v49, v49, v176
  v_lshlrev_b32 v9, 16, v177
  v_and_b32 v177, 0xffff0000, v177
  v_add_f32 v50, v50, v9
  v_add_f32 v51, v51, v177
  v_lshlrev_b32 v8, 16, v178
  v_and_b32 v178, 0xffff0000, v178
  v_add_f32 v52, v52, v8
  v_add_f32 v53, v53, v178
  v_lshlrev_b32 v9, 16, v179
  v_and_b32 v179, 0xffff0000, v179
  v_add_f32 v54, v54, v9
  v_add_f32 v55, v55, v179
  v_lshlrev_b32 v8, 16, v180
  v_and_b32 v180, 0xffff0000, v180
  v_add_f32 v56, v56, v8
  v_add_f32 v57, v57, v180
  v_lshlrev_b32 v9, 16, v181
  v_and_b32 v181, 0xffff0000, v181
  v_add_f32 v58, v58, v9
  v_add_f32 v59, v59, v181
  v_lshlrev_b32 v8, 16, v182
  v_and_b32 v182, 0xffff0000, v182
  v_add_f32 v60, v60, v8
  v_add_f32 v61, v61, v182
  v_lshlrev_b32 v9, 16, v183
  v_and_b32 v183, 0xffff0000, v183
  v_add_f32 v62, v62, v9
  v_add_f32 v63, v63, v183
  s_mov_b32 s32, 0
  buffer_store_dword v48, v21, s[16:19], s32 offen
  s_mov_b32 s32, 5120
  buffer_store_dword v49, v21, s[16:19], s32 offen
  s_mov_b32 s32, 10240
  buffer_store_dword v50, v21, s[16:19], s32 offen
  s_mov_b32 s32, 15360
  buffer_store_dword v51, v21, s[16:19], s32 offen
  s_mov_b32 s32, 81920
  buffer_store_dword v52, v21, s[16:19], s32 offen
  s_mov_b32 s32, 87040
  buffer_store_dword v53, v21, s[16:19], s32 offen
  s_mov_b32 s32, 92160
  buffer_store_dword v54, v21, s[16:19], s32 offen
  s_mov_b32 s32, 97280
  buffer_store_dword v55, v21, s[16:19], s32 offen
  s_mov_b32 s32, 163840
  buffer_store_dword v56, v21, s[16:19], s32 offen
  s_mov_b32 s32, 168960
  buffer_store_dword v57, v21, s[16:19], s32 offen
  s_mov_b32 s32, 174080
  buffer_store_dword v58, v21, s[16:19], s32 offen
  s_mov_b32 s32, 179200
  buffer_store_dword v59, v21, s[16:19], s32 offen
  s_mov_b32 s32, 245760
  buffer_store_dword v60, v21, s[16:19], s32 offen
  s_mov_b32 s32, 250880
  buffer_store_dword v61, v21, s[16:19], s32 offen
  s_mov_b32 s32, 256000
  buffer_store_dword v62, v21, s[16:19], s32 offen
  s_mov_b32 s32, 261120
  buffer_store_dword v63, v21, s[16:19], s32 offen
  s_branch f_t2
f_th:
  s_bfm_b32 s33, s36, 0
  s_and_b32 s32, s32, s33
  s_bcnt1_i32_b32 s32, s32
  s_add_u32 s32, s32, 6
  s_lshl_b32 s32, s32, 2
  s_add_u32 s32, s32, s35
  s_lshl_b32 s32, s32, 2
  s_add_u32 s91, s32, s3
  s_mov_b32 s8, s64
  s_and_b32 s9, s65, 0xffff
  s_mov_b32 s10, 0x280000
  s_mov_b32 s11, 0x00020000
  s_add_u32 s72, s91, 0
  s_mul_i32 s32, s72, 13108
  s_lshr_b32 s32, s32, 16
  s_mul_i32 s33, s32, 5
  s_sub_u32 s73, s72, s33
  s_and_b32 s74, s32, 7
  s_lshr_b32 s66, s32, 3
  s_lshl_b32 s33, s34, 5
  s_add_u32 s32, s32, s33
  s_mul_i32 s32, s32, 30720
  s_lshl_b32 s33, s73, 11
  s_add_u32 s32, s32, s33
  s_add_u32 s70, s32, 0x1800000
  s_mul_i32 s32, s66, 160
  s_and_b32 s33, s74, 1
  s_mul_i32 s33, s33, 80
  s_add_u32 s32, s32, s33
  s_lshl_b32 s33, s73, 4
  s_add_u32 s32, s32, s33
  v_and_b32 v8, 15, v1
  v_add_u32 v8, s32, v8
  s_lshl_b32 s32, s34, 8
  s_lshr_b32 s33, s74, 1
  s_lshl_b32 s33, s33, 6
  s_add_u32 s32, s32, s33
  v_lshrrev_b32 v9, 4, v1
  v_lshl_add_u32 v9, v9, 2, s32
  v_mul_u32_u24 v9, 640, v9
  v_add_lshl_u32 v16, v9, v8, 1
  v_lshl_add_u32 v9, v9, 1, v8
  v_lshlrev_b32 v20, 2, v9
  v_lshlrev_b32 v8, 1, v8
  global_load_ushort v18, v8, s[80:81]
  s_mov_b32 s32, 0
  buffer_load_ushort v96, v16, s[8:11], s32 offen offset:0
  buffer_load_ushort v97, v16, s[8:11], s32 offen offset:1280
  buffer_load_ushort v98, v16, s[8:11], s32 offen offset:2560
  buffer_load_ushort v99, v16, s[8:11], s32 offen offset:3840
  s_mov_b32 s32, 20480
  buffer_load_ushort v100, v16, s[8:11], s32 offen offset:0
  buffer_load_ushort v101, v16, s[8:11], s32 offen offset:1280
  buffer_load_ushort v102, v16, s[8:11], s32 offen offset:2560
  buffer_load_ushort v103, v16, s[8:11], s32 offen offset:3840
  s_mov_b32 s32, 40960
  buffer_load_ushort v104, v16, s[8:11], s32 offen offset:0
  buffer_load_ushort v105, v16, s[8:11], s32 offen offset:1280
  buffer_load_ushort v106, v16, s[8:11], s32 offen offset:2560
  buffer_load_ushort v107, v16, s[8:11], s32 offen offset:3840
  s_mov_b32 s32, 61440
  buffer_load_ushort v108, v16, s[8:11], s32 offen offset:0
  buffer_load_ushort v109, v16, s[8:11], s32 offen offset:1280
  buffer_load_ushort v110, v16, s[8:11], s32 offen offset:2560
  buffer_load_ushort v111, v16, s[8:11], s32 offen offset:3840
  buffer_load_dwordx4 v[128:131], v2, s[20:23], s70 offen offset:0
  buffer_load_dwordx4 v[132:135], v2, s[20:23], s70 offen offset:1024
  s_add_u32 s70, s70, 10240
  buffer_load_dwordx4 v[136:139], v2, s[20:23], s70 offen offset:0
  buffer_load_dwordx4 v[140:143], v2, s[20:23], s70 offen offset:1024
  s_add_u32 s70, s70, 10240
  buffer_load_dwordx4 v[144:147], v2, s[20:23], s70 offen offset:0
  buffer_load_dwordx4 v[148:151], v2, s[20:23], s70 offen offset:1024
  s_waitcnt vmcnt(23)
  v_lshlrev_b32 v8, 26, v1
  v_mov_b32 v9, 2
  buffer_store_dword v9, v8, s[20:23], s78 offen sc1
  s_waitcnt vmcnt(7)
  v_lshlrev_b32 v18, 16, v18
  v_lshlrev_b32 v96, 16, v96
  v_mul_f32 v96, v96, v18
  v_lshlrev_b32 v97, 16, v97
  v_mul_f32 v97, v97, v18
  v_lshlrev_b32 v98, 16, v98
  v_mul_f32 v98, v98, v18
  v_lshlrev_b32 v99, 16, v99
  v_mul_f32 v99, v99, v18
  v_lshlrev_b32 v100, 16, v100
  v_mul_f32 v100, v100, v18
  v_lshlrev_b32 v101, 16, v101
  v_mul_f32 v101, v101, v18
  v_lshlrev_b32 v102, 16, v102
  v_mul_f32 v102, v102, v18
  v_lshlrev_b32 v103, 16, v103
  v_mul_f32 v103, v103, v18
  v_lshlrev_b32 v104, 16, v104
  v_mul_f32 v104, v104, v18
  v_lshlrev_b32 v105, 16, v105
  v_mul_f32 v105, v105, v18
  v_lshlrev_b32 v106, 16, v106
  v_mul_f32 v106, v106, v18
  v_lshlrev_b32 v107, 16, v107
  v_mul_f32 v107, v107, v18
  v_lshlrev_b32 v108, 16, v108
  v_mul_f32 v108, v108, v18
  v_lshlrev_b32 v109, 16, v109
  v_mul_f32 v109, v109, v18
  v_lshlrev_b32 v110, 16, v110
  v_mul_f32 v110, v110, v18
  v_lshlrev_b32 v111, 16, v111
  v_mul_f32 v111, v111, v18
  v_cvt_pk_bf16_f32 v96, v96, v97
  v_lshlrev_b32 v32, 16, v96
  v_and_b32 v33, 0xffff0000, v96
  v_cvt_pk_bf16_f32 v97, v98, v99
  v_lshlrev_b32 v34, 16, v97
  v_and_b32 v35, 0xffff0000, v97
  v_cvt_pk_bf16_f32 v98, v100, v101
  v_lshlrev_b32 v36, 16, v98
  v_and_b32 v37, 0xffff0000, v98
  v_cvt_pk_bf16_f32 v99, v102, v103
  v_lshlrev_b32 v38, 16, v99
  v_and_b32 v39, 0xffff0000, v99
  v_cvt_pk_bf16_f32 v100, v104, v105
  v_lshlrev_b32 v40, 16, v100
  v_and_b32 v41, 0xffff0000, v100
  v_cvt_pk_bf16_f32 v101, v106, v107
  v_lshlrev_b32 v42, 16, v101
  v_and_b32 v43, 0xffff0000, v101
  v_cvt_pk_bf16_f32 v102, v108, v109
  v_lshlrev_b32 v44, 16, v102
  v_and_b32 v45, 0xffff0000, v102
  v_cvt_pk_bf16_f32 v103, v110, v111
  v_lshlrev_b32 v46, 16, v103
  v_and_b32 v47, 0xffff0000, v103
  s_waitcnt vmcnt(5)
  v_lshlrev_b32 v8, 16, v128
  v_and_b32 v128, 0xffff0000, v128
  v_add_f32 v32, v32, v8
  v_add_f32 v33, v33, v128
  v_lshlrev_b32 v9, 16, v129
  v_and_b32 v129, 0xffff0000, v129
  v_add_f32 v34, v34, v9
  v_add_f32 v35, v35, v129
  v_lshlrev_b32 v8, 16, v130
  v_and_b32 v130, 0xffff0000, v130
  v_add_f32 v36, v36, v8
  v_add_f32 v37, v37, v130
  v_lshlrev_b32 v9, 16, v131
  v_and_b32 v131, 0xffff0000, v131
  v_add_f32 v38, v38, v9
  v_add_f32 v39, v39, v131
  v_lshlrev_b32 v8, 16, v132
  v_and_b32 v132, 0xffff0000, v132
  v_add_f32 v40, v40, v8
  v_add_f32 v41, v41, v132
  v_lshlrev_b32 v9, 16, v133
  v_and_b32 v133, 0xffff0000, v133
  v_add_f32 v42, v42, v9
  v_add_f32 v43, v43, v133
  v_lshlrev_b32 v8, 16, v134
  v_and_b32 v134, 0xffff0000, v134
  v_add_f32 v44, v44, v8
  v_add_f32 v45, v45, v134
  v_lshlrev_b32 v9, 16, v135
  v_and_b32 v135, 0xffff0000, v135
  v_add_f32 v46, v46, v9
  v_add_f32 v47, v47, v135
  s_waitcnt vmcnt(3)
  v_lshlrev_b32 v8, 16, v136
  v_and_b32 v136, 0xffff0000, v136
  v_add_f32 v32, v32, v8
  v_add_f32 v33, v33, v136
  v_lshlrev_b32 v9, 16, v137
  v_and_b32 v137, 0xffff0000, v137
  v_add_f32 v34, v34, v9
  v_add_f32 v35, v35, v137
  v_lshlrev_b32 v8, 16, v138
  v_and_b32 v138, 0xffff0000, v138
  v_add_f32 v36, v36, v8
  v_add_f32 v37, v37, v138
  v_lshlrev_b32 v9, 16, v139
  v_and_b32 v139, 0xffff0000, v139
  v_add_f32 v38, v38, v9
  v_add_f32 v39, v39, v139
  v_lshlrev_b32 v8, 16, v140
  v_and_b32 v140, 0xffff0000, v140
  v_add_f32 v40, v40, v8
  v_add_f32 v41, v41, v140
  v_lshlrev_b32 v9, 16, v141
  v_and_b32 v141, 0xffff0000, v141
  v_add_f32 v42, v42, v9
  v_add_f32 v43, v43, v141
  v_lshlrev_b32 v8, 16, v142
  v_and_b32 v142, 0xffff0000, v142
  v_add_f32 v44, v44, v8
  v_add_f32 v45, v45, v142
  v_lshlrev_b32 v9, 16, v143
  v_and_b32 v143, 0xffff0000, v143
  v_add_f32 v46, v46, v9
  v_add_f32 v47, v47, v143
  s_waitcnt vmcnt(1)
  v_lshlrev_b32 v8, 16, v144
  v_and_b32 v144, 0xffff0000, v144
  v_add_f32 v32, v32, v8
  v_add_f32 v33, v33, v144
  v_lshlrev_b32 v9, 16, v145
  v_and_b32 v145, 0xffff0000, v145
  v_add_f32 v34, v34, v9
  v_add_f32 v35, v35, v145
  v_lshlrev_b32 v8, 16, v146
  v_and_b32 v146, 0xffff0000, v146
  v_add_f32 v36, v36, v8
  v_add_f32 v37, v37, v146
  v_lshlrev_b32 v9, 16, v147
  v_and_b32 v147, 0xffff0000, v147
  v_add_f32 v38, v38, v9
  v_add_f32 v39, v39, v147
  v_lshlrev_b32 v8, 16, v148
  v_and_b32 v148, 0xffff0000, v148
  v_add_f32 v40, v40, v8
  v_add_f32 v41, v41, v148
  v_lshlrev_b32 v9, 16, v149
  v_and_b32 v149, 0xffff0000, v149
  v_add_f32 v42, v42, v9
  v_add_f32 v43, v43, v149
  v_lshlrev_b32 v8, 16, v150
  v_and_b32 v150, 0xffff0000, v150
  v_add_f32 v44, v44, v8
  v_add_f32 v45, v45, v150
  v_lshlrev_b32 v9, 16, v151
  v_and_b32 v151, 0xffff0000, v151
  v_add_f32 v46, v46, v9
  v_add_f32 v47, v47, v151
  s_mov_b32 s32, 0
  buffer_store_dword v32, v20, s[16:19], s32 offen
  s_mov_b32 s32, 5120
  buffer_store_dword v33, v20, s[16:19], s32 offen
  s_mov_b32 s32, 10240
  buffer_store_dword v34, v20, s[16:19], s32 offen
  s_mov_b32 s32, 15360
  buffer_store_dword v35, v20, s[16:19], s32 offen
  s_mov_b32 s32, 81920
  buffer_store_dword v36, v20, s[16:19], s32 offen
  s_mov_b32 s32, 87040
  buffer_store_dword v37, v20, s[16:19], s32 offen
  s_mov_b32 s32, 92160
  buffer_store_dword v38, v20, s[16:19], s32 offen
  s_mov_b32 s32, 97280
  buffer_store_dword v39, v20, s[16:19], s32 offen
  s_mov_b32 s32, 163840
  buffer_store_dword v40, v20, s[16:19], s32 offen
  s_mov_b32 s32, 168960
  buffer_store_dword v41, v20, s[16:19], s32 offen
  s_mov_b32 s32, 174080
  buffer_store_dword v42, v20, s[16:19], s32 offen
  s_mov_b32 s32, 179200
  buffer_store_dword v43, v20, s[16:19], s32 offen
  s_mov_b32 s32, 245760
  buffer_store_dword v44, v20, s[16:19], s32 offen
  s_mov_b32 s32, 250880
  buffer_store_dword v45, v20, s[16:19], s32 offen
  s_mov_b32 s32, 256000
  buffer_store_dword v46, v20, s[16:19], s32 offen
  s_mov_b32 s32, 261120
  buffer_store_dword v47, v20, s[16:19], s32 offen
  s_branch f_t2
f_t1:
  s_waitcnt vmcnt(0)
  v_lshlrev_b32 v8, 26, v1
  v_mov_b32 v9, 2
  buffer_store_dword v9, v8, s[20:23], s78 offen sc1
f_t2:
  s_mul_i32 s66, s2, 40960
  s_and_b32 s68, s3, 3
  s_cmp_lt_u32 s3, 4
  s_cselect_b32 s89, 2, 1
  s_add_u32 s32, s66, 0xc00000
  s_sub_u32 s33, 15, s36
  s_cmp_lt_u32 s3, 4
  s_cselect_b32 s66, s66, s32
  s_cselect_b32 s90, s90, s33
  s_lshl_b32 s32, s68, 10
  v_add_u32 v12, s32, v2
  s_lshl_b32 s32, s68, 8
  s_add_u32 s32, s32, 0x1000
  v_lshl_add_u32 v13, v1, 2, s32
  s_mov_b32 s32, 20000
  s_branch f_wa_c
f_wa_l:
  v_and_b32 v15, 7, v1
  v_lshlrev_b32 v15, 2, v15
  buffer_load_dword v15, v15, s[20:23], s84 offen sc1
  s_waitcnt vmcnt(0)
f_wa_c:
  v_cmp_gt_i32 vcc, s89, v15
  s_nop 0
  s_and_b32 s33, vcc_lo, 255
  s_cbranch_scc0 f_wa_d
  s_sleep 2
  s_sub_u32 s32, s32, 1
  s_cmp_lg_u32 s32, 0
  s_cbranch_scc1 f_wa_l
f_wa_d:
  s_mov_b32 s76, 20000
f_ga:
  s_add_u32 s32, s66, 0
  buffer_load_dwordx4 v[32:35], v12, s[20:23], s32 offen sc1
  buffer_load_dword v64, v13, s[20:23], s32 offen sc1
  s_add_u32 s32, s66, 5120
  buffer_load_dwordx4 v[36:39], v12, s[20:23], s32 offen sc1
  buffer_load_dword v65, v13, s[20:23], s32 offen sc1
  s_add_u32 s32, s66, 10240
  buffer_load_dwordx4 v[40:43], v12, s[20:23], s32 offen sc1
  buffer_load_dword v66, v13, s[20:23], s32 offen sc1
  s_add_u32 s32, s66, 15360
  buffer_load_dwordx4 v[44:47], v12, s[20:23], s32 offen sc1
  buffer_load_dword v67, v13, s[20:23], s32 offen sc1
  s_add_u32 s32, s66, 20480
  buffer_load_dwordx4 v[48:51], v12, s[20:23], s32 offen sc1
  buffer_load_dword v68, v13, s[20:23], s32 offen sc1
  s_add_u32 s32, s66, 25600
  buffer_load_dwordx4 v[52:55], v12, s[20:23], s32 offen sc1
  buffer_load_dword v69, v13, s[20:23], s32 offen sc1
  s_add_u32 s32, s66, 30720
  buffer_load_dwordx4 v[56:59], v12, s[20:23], s32 offen sc1
  buffer_load_dword v70, v13, s[20:23], s32 offen sc1
  s_add_u32 s32, s66, 35840
  buffer_load_dwordx4 v[60:63], v12, s[20:23], s32 offen sc1
  buffer_load_dword v71, v13, s[20:23], s32 offen sc1
  v_lshrrev_b32 v8, 4, v1
  v_mul_u32_u24 v8, 20480, v8
  v_and_b32 v9, 15, v1
  s_lshl_b32 s32, s68, 7
  v_lshl_add_u32 v9, v9, 2, s32
  v_add_u32 v10, v8, v9
  v_bfe_u32 v8, v1, 1, 1
  v_and_b32 v9, 1, v1
  v_lshl_add_u32 v8, v8, 3, v9
  s_lshl_b32 s32, s68, 2
  v_lshl_add_u32 v8, v8, 1, s32
  v_mul_u32_u24 v8, 5120, v8
  v_and_b32 v9, 0xfc, v1
  s_movk_i32 s32, 512
  v_add3_u32 v11, v8, v9, s32
  s_lshl_b32 s32, s90, 2
  s_lshr_b32 s33, s34, 1
  s_add_u32 s32, s32, s33
  s_mul_i32 s67, s32, 163840
  s_mul_i32 s32, s35, 640
  s_and_b32 s33, s34, 1
  s_lshl_b32 s33, s33, 6
  s_add_u32 s32, s32, s33
  s_add_u32 s32, s32, 2560
  s_add_u32 s67, s67, s32
  s_waitcnt vmcnt(14)
  v_max3_u32 v9, v32, v33, v34
  v_max3_u32 v9, v9, v35, v64
  v_mov_b32 v8, v9
  v_lshlrev_b32 v96, 16, v32
  v_and_b32 v97, 0xffff0000, v32
  v_lshlrev_b32 v98, 16, v33
  v_and_b32 v99, 0xffff0000, v33
  v_lshlrev_b32 v100, 16, v34
  v_and_b32 v101, 0xffff0000, v34
  v_lshlrev_b32 v102, 16, v35
  v_and_b32 v103, 0xffff0000, v35
  v_lshlrev_b32 v104, 16, v64
  v_and_b32 v105, 0xffff0000, v64
  s_waitcnt vmcnt(12)
  v_max3_u32 v9, v36, v37, v38
  v_max3_u32 v9, v9, v39, v65
  v_max_u32 v8, v8, v9
  v_lshlrev_b32 v16, 16, v36
  v_and_b32 v36, 0xffff0000, v36
  v_add_f32 v96, v96, v16
  v_add_f32 v97, v97, v36
  v_lshlrev_b32 v17, 16, v37
  v_and_b32 v37, 0xffff0000, v37
  v_add_f32 v98, v98, v17
  v_add_f32 v99, v99, v37
  v_lshlrev_b32 v16, 16, v38
  v_and_b32 v38, 0xffff0000, v38
  v_add_f32 v100, v100, v16
  v_add_f32 v101, v101, v38
  v_lshlrev_b32 v17, 16, v39
  v_and_b32 v39, 0xffff0000, v39
  v_add_f32 v102, v102, v17
  v_add_f32 v103, v103, v39
  v_lshlrev_b32 v18, 16, v65
  v_and_b32 v65, 0xffff0000, v65
  v_add_f32 v104, v104, v18
  v_add_f32 v105, v105, v65
  s_waitcnt vmcnt(10)
  v_max3_u32 v9, v40, v41, v42
  v_max3_u32 v9, v9, v43, v66
  v_max_u32 v8, v8, v9
  v_lshlrev_b32 v16, 16, v40
  v_and_b32 v40, 0xffff0000, v40
  v_add_f32 v96, v96, v16
  v_add_f32 v97, v97, v40
  v_lshlrev_b32 v17, 16, v41
  v_and_b32 v41, 0xffff0000, v41
  v_add_f32 v98, v98, v17
  v_add_f32 v99, v99, v41
  v_lshlrev_b32 v16, 16, v42
  v_and_b32 v42, 0xffff0000, v42
  v_add_f32 v100, v100, v16
  v_add_f32 v101, v101, v42
  v_lshlrev_b32 v17, 16, v43
  v_and_b32 v43, 0xffff0000, v43
  v_add_f32 v102, v102, v17
  v_add_f32 v103, v103, v43
  v_lshlrev_b32 v18, 16, v66
  v_and_b32 v66, 0xffff0000, v66
  v_add_f32 v104, v104, v18
  v_add_f32 v105, v105, v66
  s_waitcnt vmcnt(8)
  v_max3_u32 v9, v44, v45, v46
  v_max3_u32 v9, v9, v47, v67
  v_max_u32 v8, v8, v9
  v_lshlrev_b32 v16, 16, v44
  v_and_b32 v44, 0xffff0000, v44
  v_add_f32 v96, v96, v16
  v_add_f32 v97, v97, v44
  v_lshlrev_b32 v17, 16, v45
  v_and_b32 v45, 0xffff0000, v45
  v_add_f32 v98, v98, v17
  v_add_f32 v99, v99, v45
  v_lshlrev_b32 v16, 16, v46
  v_and_b32 v46, 0xffff0000, v46
  v_add_f32 v100, v100, v16
  v_add_f32 v101, v101, v46
  v_lshlrev_b32 v17, 16, v47
  v_and_b32 v47, 0xffff0000, v47
  v_add_f32 v102, v102, v17
  v_add_f32 v103, v103, v47
  v_lshlrev_b32 v18, 16, v67
  v_and_b32 v67, 0xffff0000, v67
  v_add_f32 v104, v104, v18
  v_add_f32 v105, v105, v67
  s_waitcnt vmcnt(6)
  v_max3_u32 v9, v48, v49, v50
  v_max3_u32 v9, v9, v51, v68
  v_max_u32 v8, v8, v9
  v_lshlrev_b32 v16, 16, v48
  v_and_b32 v48, 0xffff0000, v48
  v_add_f32 v96, v96, v16
  v_add_f32 v97, v97, v48
  v_lshlrev_b32 v17, 16, v49
  v_and_b32 v49, 0xffff0000, v49
  v_add_f32 v98, v98, v17
  v_add_f32 v99, v99, v49
  v_lshlrev_b32 v16, 16, v50
  v_and_b32 v50, 0xffff0000, v50
  v_add_f32 v100, v100, v16
  v_add_f32 v101, v101, v50
  v_lshlrev_b32 v17, 16, v51
  v_and_b32 v51, 0xffff0000, v51
  v_add_f32 v102, v102, v17
  v_add_f32 v103, v103, v51
  v_lshlrev_b32 v18, 16, v68
  v_and_b32 v68, 0xffff0000, v68
  v_add_f32 v104, v104, v18
  v_add_f32 v105, v105, v68
  s_waitcnt vmcnt(4)
  v_max3_u32 v9, v52, v53, v54
  v_max3_u32 v9, v9, v55, v69
  v_max_u32 v8, v8, v9
  v_lshlrev_b32 v16, 16, v52
  v_and_b32 v52, 0xffff0000, v52
  v_add_f32 v96, v96, v16
  v_add_f32 v97, v97, v52
  v_lshlrev_b32 v17, 16, v53
  v_and_b32 v53, 0xffff0000, v53
  v_add_f32 v98, v98, v17
  v_add_f32 v99, v99, v53
  v_lshlrev_b32 v16, 16, v54
  v_and_b32 v54, 0xffff0000, v54
  v_add_f32 v100, v100, v16
  v_add_f32 v101, v101, v54
  v_lshlrev_b32 v17, 16, v55
  v_and_b32 v55, 0xffff0000, v55
  v_add_f32 v102, v102, v17
  v_add_f32 v103, v103, v55
  v_lshlrev_b32 v18, 16, v69
  v_and_b32 v69, 0xffff0000, v69
  v_add_f32 v104, v104, v18
  v_add_f32 v105, v105, v69
  s_waitcnt vmcnt(2)
  v_max3_u32 v9, v56, v57, v58
  v_max3_u32 v9, v9, v59, v70
  v_max_u32 v8, v8, v9
  v_lshlrev_b32 v16, 16, v56
  v_and_b32 v56, 0xffff0000, v56
  v_add_f32 v96, v96, v16
  v_add_f32 v97, v97, v56
  v_lshlrev_b32 v17, 16, v57
  v_and_b32 v57, 0xffff0000, v57
  v_add_f32 v98, v98, v17
  v_add_f32 v99, v99, v57
  v_lshlrev_b32 v16, 16, v58
  v_and_b32 v58, 0xffff0000, v58
  v_add_f32 v100, v100, v16
  v_add_f32 v101, v101, v58
  v_lshlrev_b32 v17, 16, v59
  v_and_b32 v59, 0xffff0000, v59
  v_add_f32 v102, v102, v17
  v_add_f32 v103, v103, v59
  v_lshlrev_b32 v18, 16, v70
  v_and_b32 v70, 0xffff0000, v70
  v_add_f32 v104, v104, v18
  v_add_f32 v105, v105, v70
  s_waitcnt vmcnt(0)
  v_max3_u32 v9, v60, v61, v62
  v_max3_u32 v9, v9, v63, v71
  v_max_u32 v8, v8, v9
  v_lshlrev_b32 v16, 16, v60
  v_and_b32 v60, 0xffff0000, v60
  v_add_f32 v96, v96, v16
  v_add_f32 v97, v97, v60
  v_lshlrev_b32 v17, 16, v61
  v_and_b32 v61, 0xffff0000, v61
  v_add_f32 v98, v98, v17
  v_add_f32 v99, v99, v61
  v_lshlrev_b32 v16, 16, v62
  v_and_b32 v62, 0xffff0000, v62
  v_add_f32 v100, v100, v16
  v_add_f32 v101, v101, v62
  v_lshlrev_b32 v17, 16, v63
  v_and_b32 v63, 0xffff0000, v63
  v_add_f32 v102, v102, v17
  v_add_f32 v103, v103, v63
  v_lshlrev_b32 v18, 16, v71
  v_and_b32 v71, 0xffff0000, v71
  v_add_f32 v104, v104, v18
  v_add_f32 v105, v105, v71
  v_cmp_eq_u32 vcc, -1, v8
  s_nop 4
  s_cbranch_vccz f_ga_d
  s_sleep 2
  s_sub_u32 s76, s76, 1
  s_cmp_lg_u32 s76, 0
  s_cbranch_scc1 f_ga
f_ga_d:
  s_add_u32 s32, s67, 0
  buffer_store_dword v96, v10, s[16:19], s32 offen
  s_add_u32 s32, s67, 5120
  buffer_store_dword v97, v10, s[16:19], s32 offen
  s_add_u32 s32, s67, 10240
  buffer_store_dword v98, v10, s[16:19], s32 offen
  s_add_u32 s32, s67, 15360
  buffer_store_dword v99, v10, s[16:19], s32 offen
  s_add_u32 s32, s67, 81920
  buffer_store_dword v100, v10, s[16:19], s32 offen
  s_add_u32 s32, s67, 87040
  buffer_store_dword v101, v10, s[16:19], s32 offen
  s_add_u32 s32, s67, 92160
  buffer_store_dword v102, v10, s[16:19], s32 offen
  s_add_u32 s32, s67, 97280
  buffer_store_dword v103, v10, s[16:19], s32 offen
  s_add_u32 s32, s67, 0
  buffer_store_dword v104, v11, s[16:19], s32 offen
  s_add_u32 s32, s67, 5120
  buffer_store_dword v105, v11, s[16:19], s32 offen
f_end:
  s_endpgm
fU_in:
  s_mov_b32 s32, 20000
fU_in_l:
  s_sleep 8
  buffer_load_dword v23, v22, s[76:79], 0 offen sc1
  s_waitcnt vmcnt(0)
  v_cmp_ne_u32 vcc, 1, v23
  s_nop 4
  s_cbranch_vccz fU_in_ret
  s_sub_u32 s32, s32, 1
  s_cmp_lg_u32 s32, 0
  s_cbranch_scc1 fU_in_l
  s_branch fU_in_ret
fU_es0:
  s_mov_b32 s32, 20000
fU_es0_l:
  s_sleep 8
  buffer_load_dwordx2 v[216:217], v22, s[28:31], 0 offen offset:2176 sc1
  buffer_load_dwordx2 v[218:219], v22, s[28:31], 0 offen offset:2688 sc1
  buffer_load_dwordx2 v[220:221], v22, s[28:31], 0 offen offset:3200 sc1
  buffer_load_dwordx2 v[222:223], v22, s[28:31], 0 offen offset:3712 sc1
  s_waitcnt vmcnt(0)
  v_max3_u32 v31, v216, v217, v218
  v_max3_u32 v31, v31, v219, v220
  v_max3_u32 v31, v31, v221, v222
  v_max_u32 v31, v31, v223
  v_cmp_eq_u32 vcc, -1, v31
  s_nop 4
  s_cbranch_vccz fU_es0_ret
  s_sub_u32 s32, s32, 1
  s_cmp_lg_u32 s32, 0
  s_cbranch_scc1 fU_es0_l
  s_branch fU_es0_ret
fU_es1:
  s_mov_b32 s32, 20000
fU_es1_l:
  s_sleep 8
  buffer_load_dwordx2 v[216:217], v22, s[28:31], 0 offen offset:128 sc1
  buffer_load_dwordx2 v[218:219], v22, s[28:31], 0 offen offset:640 sc1
  buffer_load_dwordx2 v[220:221], v22, s[28:31], 0 offen offset:1152 sc1
  buffer_load_dwordx2 v[222:223], v22, s[28:31], 0 offen offset:1664 sc1
  s_waitcnt vmcnt(0)
  v_max3_u32 v31, v216, v217, v218
  v_max3_u32 v31, v31, v219, v220
  v_max3_u32 v31, v31, v221, v222
  v_max_u32 v31, v31, v223
  v_cmp_eq_u32 vcc, -1, v31
  s_nop 4
  s_cbranch_vccz fU_es1_ret
  s_sub_u32 s32, s32, 1
  s_cmp_lg_u32 s32, 0
  s_cbranch_scc1 fU_es1_l
  s_branch fU_es1_ret
fU_kv:
  s_mov_b32 s100, 20000
fU_kv_l:
  s_sleep 8
  s_lshl_b32 s32, s37, 7
  s_add_u32 s32, s32, 0xc000
  v_lshrrev_b32 v31, 1, v1
  v_add_lshl_u32 v31, v31, s3, 20
  v_lshl_add_u32 v31, v1, 2, v31
  buffer_load_dword v15, v31, s[24:27], s32 offen sc1
  s_waitcnt vmcnt(0)
  v_readlane_b32 s32, v15, 0
  v_readlane_b32 s33, v15, 1
  s_nop 0
  s_ff1_i32_b64 s32, s[32:33]
  s_lshr_b32 s32, s32, 3
  s_min_u32 s32, s32, 8
  s_lshl_b32 s61, s32, 17
  s_cmp_lg_u32 s61, 0
  s_cbranch_scc1 fU_kv_ret
  s_sub_u32 s100, s100, 1
  s_cmp_lg_u32 s100, 0
  s_cbranch_scc1 fU_kv_l
  s_branch fU_kv_ret
fN_in:
  s_mov_b32 s32, 20000
fN_in_l:
  s_sleep 8
  buffer_load_dword v23, v22, s[76:79], 0 offen sc1
  s_waitcnt vmcnt(0)
  v_cmp_ne_u32 vcc, 1, v23
  s_nop 4
  s_cbranch_vccz fN_in_ret
  s_sub_u32 s32, s32, 1
  s_cmp_lg_u32 s32, 0
  s_cbranch_scc1 fN_in_l
  s_branch fN_in_ret
fN_kv:
  s_mov_b32 s100, 20000
fN_kv_l:
  s_sleep 8
  s_lshl_b32 s32, s37, 7
  s_add_u32 s32, s32, 0xc000
  v_lshrrev_b32 v31, 1, v1
  v_add_lshl_u32 v31, v31, s3, 20
  v_lshl_add_u32 v31, v1, 2, v31
  buffer_load_dword v15, v31, s[24:27], s32 offen sc1
  s_waitcnt vmcnt(0)
  v_readlane_b32 s32, v15, 0
  v_readlane_b32 s33, v15, 1
  s_nop 0
  s_ff1_i32_b64 s32, s[32:33]
  s_lshr_b32 s32, s32, 3
  s_min_u32 s32, s32, 8
  s_lshl_b32 s61, s32, 17
  s_cmp_lg_u32 s61, 0
  s_cbranch_scc1 fN_kv_ret
  s_sub_u32 s100, s100, 1
  s_cmp_lg_u32 s100, 0
  s_cbranch_scc1 fN_kv_l
  s_branch fN_kv_ret
fN_ht:
  s_mov_b32 s32, 20000
fN_ht_l:
  s_sleep 8
  buffer_load_dword v14, v31, s[24:27], 0 offen sc1
  s_waitcnt vmcnt(0)
  v_cmp_ne_u32 vcc, 1, v14
  s_nop 4
  s_cbranch_vccz fN_ht_ret
  s_sub_u32 s32, s32, 1
  s_cmp_lg_u32 s32, 0
  s_cbranch_scc1 fN_ht_l
  s_branch fN_ht_ret
f_hook:
  s_cmp_ge_u32 s61, s63
  s_cbranch_scc1 f_hk_kv
  v_readlane_b32 s32, v30, 0
  v_readlane_b32 s33, v30, 1
  s_nop 0
  s_ff1_i32_b64 s32, s[32:33]
  s_lshr_b32 s32, s32, 3
  s_min_u32 s32, s32, 8
  s_lshl_b32 s61, s32, 17
  s_add_u32 s62, s53, 0x10000
  s_min_u32 s62, s62, s63
  s_cmp_ge_u32 s61, s62
  s_cbranch_scc1 f_hk_ok
  s_mov_b32 vcc_lo, 20000
f_hk_l:
  s_sleep 8
  s_lshl_b32 s32, s37, 7
  s_add_u32 s32, s32, 0xc000
  v_lshrrev_b32 v6, 1, v1
  v_add_lshl_u32 v6, v6, s3, 20
  v_lshl_add_u32 v6, v1, 2, v6
  buffer_load_dword v30, v6, s[24:27], s32 offen sc1
  s_waitcnt vmcnt(0)
  v_readlane_b32 s32, v30, 0
  v_readlane_b32 s33, v30, 1
  s_nop 0
  s_ff1_i32_b64 s32, s[32:33]
  s_lshr_b32 s32, s32, 3
  s_min_u32 s32, s32, 8
  s_lshl_b32 s61, s32, 17
  s_cmp_ge_u32 s61, s62
  s_cbranch_scc1 f_hk_ok
  s_sub_u32 vcc_lo, vcc_lo, 1
  s_cmp_lg_u32 vcc_lo, 0
  s_cbranch_scc1 f_hk_l
f_hk_ok:
  s_cmp_ge_u32 s61, s63
  s_cbranch_scc1 f_hk_kv
  s_sub_u32 s32, s61, s53
  s_lshr_b32 s32, s32, 16
  s_sub_u32 s32, s32, 2
  s_max_i32 s32, s32, 1
  s_add_u32 s33, s38, s32
  s_bitset1_b32 s60, s33
  s_cmp_gt_u32 s32, 1
  s_cbranch_scc1 f_hk_kv
  s_lshl_b32 s32, s37, 7
  s_add_u32 s32, s32, 0xc000
  v_lshrrev_b32 v6, 1, v1
  v_add_lshl_u32 v6, v6, s3, 20
  v_lshl_add_u32 v6, v1, 2, v6
  buffer_load_dword v30, v6, s[24:27], s32 offen sc1
f_hk_kv:
  s_cmp_lg_u32 s38, 1
  s_cbranch_scc1 f_hk7
  v_lshlrev_b32 v7, 20, v1
  s_lshr_b32 s33, s2, 3
  s_lshl_b32 s32, s34, 5
  s_add_u32 s33, s33, s32
  s_lshl_b32 s33, s33, 2
  s_add_u32 s33, s33, 0xd000
  v_mov_b32 v6, 1
  buffer_store_dword v6, v7, s[24:27], s33 offen sc1
  s_add_u32 s33, s36, 3
  s_and_b32 s33, s33, 7
  s_lshl_b32 s32, s37, 7
  s_add_u32 s33, s33, s32
  s_add_u32 s33, s33, 0xc000
  v_mov_b32 v6, 0
  buffer_store_byte v6, v7, s[24:27], s33 offen sc1
f_hk7:
  s_cmp_lt_u32 s38, 13
  s_cbranch_scc1 f_hkE
  s_cmp_gt_u32 s38, 14
  s_cbranch_scc1 f_hkE
  s_mov_b32 s32, 20000
  v_and_b32 v6, 31, v1
  v_lshlrev_b32 v6, 2, v6
  s_lshl_b32 s33, s34, 7
  s_add_u32 s33, s33, 0xd000
  s_cmp_eq_u32 s38, 14
  s_cbranch_scc1 f_hk14
  buffer_load_dword v255, v6, s[24:27], s33 offen sc1
  s_branch f_hkE
f_hk14:
  v_cmp_ne_u32 vcc, 1, v255
  s_nop 4
  s_cbranch_vccz f_hkE
  s_sleep 8
  buffer_load_dword v255, v6, s[24:27], s33 offen sc1
  s_waitcnt vmcnt(0)
  s_sub_u32 s32, s32, 1
  s_cmp_lg_u32 s32, 0
  s_cbranch_scc1 f_hk14
f_hkE:
  s_nop 4
  s_setpc_b64 s[100:101]
k2_p0:
  s_cmp_eq_u32 s41, s40
  s_cbranch_scc1 k2_p0_tri
  v_mov_b32 v208, 0xff800000
  v_mov_b32 v209, 0xff800000
  v_mov_b32 v210, 0xff800000
  v_mov_b32 v211, 0xff800000
  v_mov_b32 v212, 0xff800000
  v_mov_b32 v213, 0xff800000
  v_mov_b32 v214, 0xff800000
  v_mov_b32 v215, 0xff800000
  v_mov_b32 v216, 0xff800000
  v_mov_b32 v217, 0xff800000
  v_mov_b32 v218, 0xff800000
  v_mov_b32 v219, 0xff800000
  v_mov_b32 v220, 0xff800000
  v_mov_b32 v221, 0xff800000
  v_mov_b32 v222, 0xff800000
  v_mov_b32 v223, 0xff800000
  s_branch k2_p0_ret
k2_p0_tri:
  v_mov_b32 v6, 0xff800000
  v_mov_b32 v216, 0xff800000
  v_cndmask_b32 v208, v208, v6, s[44:45]
  v_cndmask_b32 v220, v220, v6, s[44:45]
  v_mov_b32 v217, 0xff800000
  v_cndmask_b32 v209, v209, v6, s[46:47]
  v_cndmask_b32 v221, v221, v6, s[46:47]
  v_mov_b32 v218, 0xff800000
  v_cndmask_b32 v210, v210, v6, s[48:49]
  v_cndmask_b32 v222, v222, v6, s[48:49]
  v_mov_b32 v219, 0xff800000
  v_cndmask_b32 v211, v211, v6, s[50:51]
  v_cndmask_b32 v223, v223, v6, s[50:51]
  s_branch k2_p0_ret
k2_p1:
  s_cmp_eq_u32 s33, s40
  s_cbranch_scc1 k2_p1_tri
  v_mov_b32 v208, 0xff800000
  v_mov_b32 v209, 0xff800000
  v_mov_b32 v210, 0xff800000
  v_mov_b32 v211, 0xff800000
  v_mov_b32 v212, 0xff800000
  v_mov_b32 v213, 0xff800000
  v_mov_b32 v214, 0xff800000
  v_mov_b32 v215, 0xff800000
  v_mov_b32 v216, 0xff800000
  v_mov_b32 v217, 0xff800000
  v_mov_b32 v218, 0xff800000
  v_mov_b32 v219, 0xff800000
  v_mov_b32 v220, 0xff800000
  v_mov_b32 v221, 0xff800000
  v_mov_b32 v222, 0xff800000
  v_mov_b32 v223, 0xff800000
  s_branch k2_p1_ret
k2_p1_tri:
  v_mov_b32 v6, 0xff800000
  v_mov_b32 v216, 0xff800000
  v_cndmask_b32 v208, v208, v6, s[44:45]
  v_cndmask_b32 v220, v220, v6, s[44:45]
  v_mov_b32 v217, 0xff800000
  v_cndmask_b32 v209, v209, v6, s[46:47]
  v_cndmask_b32 v221, v221, v6, s[46:47]
  v_mov_b32 v218, 0xff800000
  v_cndmask_b32 v210, v210, v6, s[48:49]
  v_cndmask_b32 v222, v222, v6, s[48:49]
  v_mov_b32 v219, 0xff800000
  v_cndmask_b32 v211, v211, v6, s[50:51]
  v_cndmask_b32 v223, v223, v6, s[50:51]
  s_branch k2_p1_ret
k2_pa1:
  s_cmp_eq_u32 s41, s40
  s_cbranch_scc1 k2_pa1_tri
  v_mov_b32 v208, 0xff800000
  v_mov_b32 v209, 0xff800000
  v_mov_b32 v210, 0xff800000
  v_mov_b32 v211, 0xff800000
  v_mov_b32 v212, 0xff800000
  v_mov_b32 v213, 0xff800000
  v_mov_b32 v214, 0xff800000
  v_mov_b32 v215, 0xff800000
  v_mov_b32 v216, 0xff800000
  v_mov_b32 v217, 0xff800000
  v_mov_b32 v218, 0xff800000
  v_mov_b32 v219, 0xff800000
  v_mov_b32 v220, 0xff800000
  v_mov_b32 v221, 0xff800000
  v_mov_b32 v222, 0xff800000
  v_mov_b32 v223, 0xff800000
  s_branch k2_pa1_ret
k2_pa1_tri:
  v_mov_b32 v6, 0xff800000
  v_mov_b32 v216, 0xff800000
  v_cndmask_b32 v208, v208, v6, s[44:45]
  v_cndmask_b32 v220, v220, v6, s[44:45]
  v_mov_b32 v217, 0xff800000
  v_cndmask_b32 v209, v209, v6, s[46:47]
  v_cndmask_b32 v221, v221, v6, s[46:47]
  v_mov_b32 v218, 0xff800000
  v_cndmask_b32 v210, v210, v6, s[48:49]
  v_cndmask_b32 v222, v222, v6, s[48:49]
  v_mov_b32 v219, 0xff800000
  v_cndmask_b32 v211, v211, v6, s[50:51]
  v_cndmask_b32 v223, v223, v6, s[50:51]
  s_branch k2_pa1_ret
k2_pb1:
  s_cmp_eq_u32 s33, s40
  s_cbranch_scc1 k2_pb1_tri
  v_mov_b32 v208, 0xff800000
  v_mov_b32 v209, 0xff800000
  v_mov_b32 v210, 0xff800000
  v_mov_b32 v211, 0xff800000
  v_mov_b32 v212, 0xff800000
  v_mov_b32 v213, 0xff800000
  v_mov_b32 v214, 0xff800000
  v_mov_b32 v215, 0xff800000
  v_mov_b32 v216, 0xff800000
  v_mov_b32 v217, 0xff800000
  v_mov_b32 v218, 0xff800000
  v_mov_b32 v219, 0xff800000
  v_mov_b32 v220, 0xff800000
  v_mov_b32 v221, 0xff800000
  v_mov_b32 v222, 0xff800000
  v_mov_b32 v223, 0xff800000
  s_branch k2_pb1_ret
k2_pb1_tri:
  v_mov_b32 v6, 0xff800000
  v_mov_b32 v216, 0xff800000
  v_cndmask_b32 v208, v208, v6, s[44:45]
  v_cndmask_b32 v220, v220, v6, s[44:45]
  v_mov_b32 v217, 0xff800000
  v_cndmask_b32 v209, v209, v6, s[46:47]
  v_cndmask_b32 v221, v221, v6, s[46:47]
  v_mov_b32 v218, 0xff800000
  v_cndmask_b32 v210, v210, v6, s[48:49]
  v_cndmask_b32 v222, v222, v6, s[48:49]
  v_mov_b32 v219, 0xff800000
  v_cndmask_b32 v211, v211, v6, s[50:51]
  v_cndmask_b32 v223, v223, v6, s[50:51]
  s_branch k2_pb1_ret
k2_sa1:
  v_max3_f32 v24, v160, v161, v162
  v_max3_f32 v28, v163, v168, v169
  v_max3_f32 v24, v24, v170, v171
  v_max_f32 v24, v24, v28
  v_mov_b32 v28, v24
  s_nop 1
  v_permlane16_swap_b32 v24, v28
  v_max_f32 v24, v24, v28
  v_mov_b32 v28, v24
  s_nop 1
  v_permlane32_swap_b32 v24, v28
  v_max_f32 v24, v24, v28
  v_max_f32 v24, 0, v24
  v_xor_b32 v24, 0x80000000, v24
  v_exp_f32 v26, v24
  v_max3_f32 v25, v164, v165, v166
  v_max3_f32 v29, v167, v172, v173
  v_max3_f32 v25, v25, v174, v175
  v_max_f32 v25, v25, v29
  v_mov_b32 v29, v25
  s_nop 1
  v_permlane16_swap_b32 v25, v29
  v_max_f32 v25, v25, v29
  v_mov_b32 v29, v25
  s_nop 1
  v_permlane32_swap_b32 v25, v29
  v_max_f32 v25, v25, v29
  v_max_f32 v25, 0, v25
  v_xor_b32 v25, 0x80000000, v25
  v_exp_f32 v27, v25
  v_add_f32 v160, v160, v24
  v_add_f32 v161, v161, v24
  v_add_f32 v162, v162, v24
  v_add_f32 v163, v163, v24
  v_add_f32 v164, v164, v25
  v_add_f32 v165, v165, v25
  v_add_f32 v166, v166, v25
  v_add_f32 v167, v167, v25
  v_add_f32 v168, v168, v24
  v_add_f32 v169, v169, v24
  v_add_f32 v170, v170, v24
  v_add_f32 v171, v171, v24
  v_add_f32 v172, v172, v25
  v_add_f32 v173, v173, v25
  v_add_f32 v174, v174, v25
  v_add_f32 v175, v175, v25
  v_mul_f32 v64, v64, v26
  v_mul_f32 v65, v65, v26
  v_mul_f32 v66, v66, v26
  v_mul_f32 v67, v67, v26
  v_mul_f32 v68, v68, v27
  v_mul_f32 v69, v69, v27
  v_mul_f32 v70, v70, v27
  v_mul_f32 v71, v71, v27
  v_mul_f32 v72, v72, v26
  v_mul_f32 v73, v73, v26
  v_mul_f32 v74, v74, v26
  v_mul_f32 v75, v75, v26
  v_mul_f32 v76, v76, v27
  v_mul_f32 v77, v77, v27
  v_mul_f32 v78, v78, v27
  v_mul_f32 v79, v79, v27
  v_mul_f32 v80, v80, v26
  v_mul_f32 v81, v81, v26
  v_mul_f32 v82, v82, v26
  v_mul_f32 v83, v83, v26
  v_mul_f32 v84, v84, v27
  v_mul_f32 v85, v85, v27
  v_mul_f32 v86, v86, v27
  v_mul_f32 v87, v87, v27
  v_mul_f32 v88, v88, v26
  v_mul_f32 v89, v89, v26
  v_mul_f32 v90, v90, v26
  v_mul_f32 v91, v91, v26
  v_mul_f32 v92, v92, v27
  v_mul_f32 v93, v93, v27
  v_mul_f32 v94, v94, v27
  v_mul_f32 v95, v95, v27
  v_mul_f32 v96, v96, v26
  v_mul_f32 v97, v97, v26
  v_mul_f32 v98, v98, v26
  v_mul_f32 v99, v99, v26
  v_mul_f32 v100, v100, v27
  v_mul_f32 v101, v101, v27
  v_mul_f32 v102, v102, v27
  v_mul_f32 v103, v103, v27
  v_mul_f32 v104, v104, v26
  v_mul_f32 v105, v105, v26
  v_mul_f32 v106, v106, v26
  v_mul_f32 v107, v107, v26
  v_mul_f32 v108, v108, v27
  v_mul_f32 v109, v109, v27
  v_mul_f32 v110, v110, v27
  v_mul_f32 v111, v111, v27
  v_mul_f32 v112, v112, v26
  v_mul_f32 v113, v113, v26
  v_mul_f32 v114, v114, v26
  v_mul_f32 v115, v115, v26
  v_mul_f32 v116, v116, v27
  v_mul_f32 v117, v117, v27
  v_mul_f32 v118, v118, v27
  v_mul_f32 v119, v119, v27
  v_mul_f32 v120, v120, v26
  v_mul_f32 v121, v121, v26
  v_mul_f32 v122, v122, v26
  v_mul_f32 v123, v123, v26
  v_mul_f32 v124, v124, v27
  v_mul_f32 v125, v125, v27
  v_mul_f32 v126, v126, v27
  v_mul_f32 v127, v127, v27
  v_mul_f32 v8, v8, v26
  v_mul_f32 v9, v9, v27
  v_exp_f32 v16, v160
  v_exp_f32 v17, v161
  s_nop 0
  v_cvt_pk_bf16_f32 v192, v16, v17
  v_add_f32 v12, v16, v17
  v_exp_f32 v18, v162
  v_exp_f32 v19, v163
  s_nop 0
  v_cvt_pk_bf16_f32 v193, v18, v19
  v_add_f32 v18, v18, v19
  v_exp_f32 v20, v164
  v_add_f32 v12, v12, v18
  v_exp_f32 v21, v165
  s_nop 0
  v_cvt_pk_bf16_f32 v196, v20, v21
  v_add_f32 v13, v20, v21
  v_exp_f32 v22, v166
  v_exp_f32 v23, v167
  s_nop 0
  v_cvt_pk_bf16_f32 v197, v22, v23
  v_add_f32 v22, v22, v23
  v_exp_f32 v16, v168
  v_add_f32 v13, v13, v22
  v_exp_f32 v17, v169
  s_nop 0
  v_cvt_pk_bf16_f32 v194, v16, v17
  v_add_f32 v16, v16, v17
  v_exp_f32 v18, v170
  v_add_f32 v12, v12, v16
  v_exp_f32 v19, v171
  s_nop 0
  v_cvt_pk_bf16_f32 v195, v18, v19
  v_add_f32 v18, v18, v19
  v_exp_f32 v20, v172
  v_add_f32 v12, v12, v18
  v_exp_f32 v21, v173
  s_nop 0
  v_cvt_pk_bf16_f32 v198, v20, v21
  v_add_f32 v20, v20, v21
  v_exp_f32 v22, v174
  v_add_f32 v13, v13, v20
  v_exp_f32 v23, v175
  s_nop 0
  v_cvt_pk_bf16_f32 v199, v22, v23
  v_add_f32 v22, v22, v23
  v_add_f32 v13, v13, v22
  v_add_f32 v176, v176, v24
  v_add_f32 v208, v208, v24
  v_add_f32 v177, v177, v24
  v_add_f32 v209, v209, v24
  v_add_f32 v178, v178, v24
  v_add_f32 v210, v210, v24
  v_add_f32 v179, v179, v24
  v_add_f32 v211, v211, v24
  v_add_f32 v180, v180, v25
  v_add_f32 v212, v212, v25
  v_add_f32 v181, v181, v25
  v_add_f32 v213, v213, v25
  v_add_f32 v182, v182, v25
  v_add_f32 v214, v214, v25
  v_add_f32 v183, v183, v25
  v_add_f32 v215, v215, v25
  v_add_f32 v184, v184, v24
  v_add_f32 v216, v216, v24
  v_add_f32 v185, v185, v24
  v_add_f32 v217, v217, v24
  v_add_f32 v186, v186, v24
  v_add_f32 v218, v218, v24
  v_add_f32 v187, v187, v24
  v_add_f32 v219, v219, v24
  v_add_f32 v188, v188, v25
  v_add_f32 v220, v220, v25
  v_add_f32 v189, v189, v25
  v_add_f32 v221, v221, v25
  v_add_f32 v190, v190, v25
  v_add_f32 v222, v222, v25
  v_add_f32 v191, v191, v25
  v_add_f32 v223, v223, v25
  v_add_f32 v10, v10, v24
  v_add_f32 v11, v11, v25
k2_sa1_r2:
  v_exp_f32 v16, v176
  v_exp_f32 v17, v177
  s_nop 0
  v_cvt_pk_bf16_f32 v200, v16, v17
  v_add_f32 v14, v16, v17
  v_exp_f32 v18, v178
  s_branch k2_sa1_ret
k2_sb1:
  v_max3_f32 v24, v176, v177, v178
  v_max3_f32 v28, v179, v184, v185
  v_max3_f32 v24, v24, v186, v187
  v_max_f32 v24, v24, v28
  v_mov_b32 v28, v24
  s_nop 1
  v_permlane16_swap_b32 v24, v28
  v_max_f32 v24, v24, v28
  v_mov_b32 v28, v24
  s_nop 1
  v_permlane32_swap_b32 v24, v28
  v_max_f32 v24, v24, v28
  v_max_f32 v24, 0, v24
  v_xor_b32 v24, 0x80000000, v24
  v_exp_f32 v26, v24
  v_max3_f32 v25, v180, v181, v182
  v_max3_f32 v29, v183, v188, v189
  v_max3_f32 v25, v25, v190, v191
  v_max_f32 v25, v25, v29
  v_mov_b32 v29, v25
  s_nop 1
  v_permlane16_swap_b32 v25, v29
  v_max_f32 v25, v25, v29
  v_mov_b32 v29, v25
  s_nop 1
  v_permlane32_swap_b32 v25, v29
  v_max_f32 v25, v25, v29
  v_max_f32 v25, 0, v25
  v_xor_b32 v25, 0x80000000, v25
  v_exp_f32 v27, v25
  v_add_f32 v176, v176, v24
  v_add_f32 v177, v177, v24
  v_add_f32 v178, v178, v24
  v_add_f32 v179, v179, v24
  v_add_f32 v180, v180, v25
  v_add_f32 v181, v181, v25
  v_add_f32 v182, v182, v25
  v_add_f32 v183, v183, v25
  v_add_f32 v184, v184, v24
  v_add_f32 v185, v185, v24
  v_add_f32 v186, v186, v24
  v_add_f32 v187, v187, v24
  v_add_f32 v188, v188, v25
  v_add_f32 v189, v189, v25
  v_add_f32 v190, v190, v25
  v_add_f32 v191, v191, v25
  v_mul_f32 v64, v64, v26
  v_mul_f32 v65, v65, v26
  v_mul_f32 v66, v66, v26
  v_mul_f32 v67, v67, v26
  v_mul_f32 v68, v68, v27
  v_mul_f32 v69, v69, v27
  v_mul_f32 v70, v70, v27
  v_mul_f32 v71, v71, v27
  v_mul_f32 v72, v72, v26
  v_mul_f32 v73, v73, v26
  v_mul_f32 v74, v74, v26
  v_mul_f32 v75, v75, v26
  v_mul_f32 v76, v76, v27
  v_mul_f32 v77, v77, v27
  v_mul_f32 v78, v78, v27
  v_mul_f32 v79, v79, v27
  v_mul_f32 v80, v80, v26
  v_mul_f32 v81, v81, v26
  v_mul_f32 v82, v82, v26
  v_mul_f32 v83, v83, v26
  v_mul_f32 v84, v84, v27
  v_mul_f32 v85, v85, v27
  v_mul_f32 v86, v86, v27
  v_mul_f32 v87, v87, v27
  v_mul_f32 v88, v88, v26
  v_mul_f32 v89, v89, v26
  v_mul_f32 v90, v90, v26
  v_mul_f32 v91, v91, v26
  v_mul_f32 v92, v92, v27
  v_mul_f32 v93, v93, v27
  v_mul_f32 v94, v94, v27
  v_mul_f32 v95, v95, v27
  v_mul_f32 v96, v96, v26
  v_mul_f32 v97, v97, v26
  v_mul_f32 v98, v98, v26
  v_mul_f32 v99, v99, v26
  v_mul_f32 v100, v100, v27
  v_mul_f32 v101, v101, v27
  v_mul_f32 v102, v102, v27
  v_mul_f32 v103, v103, v27
  v_mul_f32 v104, v104, v26
  v_mul_f32 v105, v105, v26
  v_mul_f32 v106, v106, v26
  v_mul_f32 v107, v107, v26
  v_mul_f32 v108, v108, v27
  v_mul_f32 v109, v109, v27
  v_mul_f32 v110, v110, v27
  v_mul_f32 v111, v111, v27
  v_mul_f32 v112, v112, v26
  v_mul_f32 v113, v113, v26
  v_mul_f32 v114, v114, v26
  v_mul_f32 v115, v115, v26
  v_mul_f32 v116, v116, v27
  v_mul_f32 v117, v117, v27
  v_mul_f32 v118, v118, v27
  v_mul_f32 v119, v119, v27
  v_mul_f32 v120, v120, v26
  v_mul_f32 v121, v121, v26
  v_mul_f32 v122, v122, v26
  v_mul_f32 v123, v123, v26
  v_mul_f32 v124, v124, v27
  v_mul_f32 v125, v125, v27
  v_mul_f32 v126, v126, v27
  v_mul_f32 v127, v127, v27
  v_mul_f32 v8, v8, v26
  v_mul_f32 v9, v9, v27
  v_exp_f32 v16, v176
  v_exp_f32 v17, v177
  s_nop 0
  v_cvt_pk_bf16_f32 v200, v16, v17
  v_add_f32 v14, v16, v17
  v_exp_f32 v18, v178
  v_exp_f32 v19, v179
  s_nop 0
  v_cvt_pk_bf16_f32 v201, v18, v19
  v_add_f32 v18, v18, v19
  v_exp_f32 v20, v180
  v_add_f32 v14, v14, v18
  v_exp_f32 v21, v181
  s_nop 0
  v_cvt_pk_bf16_f32 v204, v20, v21
  v_add_f32 v15, v20, v21
  v_exp_f32 v22, v182
  v_exp_f32 v23, v183
  s_nop 0
  v_cvt_pk_bf16_f32 v205, v22, v23
  v_add_f32 v22, v22, v23
  v_exp_f32 v16, v184
  v_add_f32 v15, v15, v22
  v_exp_f32 v17, v185
  s_nop 0
  v_cvt_pk_bf16_f32 v202, v16, v17
  v_add_f32 v16, v16, v17
  v_exp_f32 v18, v186
  v_add_f32 v14, v14, v16
  v_exp_f32 v19, v187
  s_nop 0
  v_cvt_pk_bf16_f32 v203, v18, v19
  v_add_f32 v18, v18, v19
  v_exp_f32 v20, v188
  v_add_f32 v14, v14, v18
  v_exp_f32 v21, v189
  s_nop 0
  v_cvt_pk_bf16_f32 v206, v20, v21
  v_add_f32 v20, v20, v21
  v_exp_f32 v22, v190
  v_add_f32 v15, v15, v20
  v_exp_f32 v23, v191
  s_nop 0
  v_cvt_pk_bf16_f32 v207, v22, v23
  v_add_f32 v22, v22, v23
  v_add_f32 v15, v15, v22
  v_add_f32 v160, v160, v24
  v_add_f32 v208, v208, v24
  v_add_f32 v161, v161, v24
  v_add_f32 v209, v209, v24
  v_add_f32 v162, v162, v24
  v_add_f32 v210, v210, v24
  v_add_f32 v163, v163, v24
  v_add_f32 v211, v211, v24
  v_add_f32 v164, v164, v25
  v_add_f32 v212, v212, v25
  v_add_f32 v165, v165, v25
  v_add_f32 v213, v213, v25
  v_add_f32 v166, v166, v25
  v_add_f32 v214, v214, v25
  v_add_f32 v167, v167, v25
  v_add_f32 v215, v215, v25
  v_add_f32 v168, v168, v24
  v_add_f32 v216, v216, v24
  v_add_f32 v169, v169, v24
  v_add_f32 v217, v217, v24
  v_add_f32 v170, v170, v24
  v_add_f32 v218, v218, v24
  v_add_f32 v171, v171, v24
  v_add_f32 v219, v219, v24
  v_add_f32 v172, v172, v25
  v_add_f32 v220, v220, v25
  v_add_f32 v173, v173, v25
  v_add_f32 v221, v221, v25
  v_add_f32 v174, v174, v25
  v_add_f32 v222, v222, v25
  v_add_f32 v175, v175, v25
  v_add_f32 v223, v223, v25
  v_add_f32 v10, v10, v24
  v_add_f32 v11, v11, v25
k2_sb1_r2:
  v_exp_f32 v16, v160
  v_exp_f32 v17, v161
  s_nop 0
  v_cvt_pk_bf16_f32 v192, v16, v17
  v_add_f32 v12, v16, v17
  v_exp_f32 v18, v162
  s_branch k2_sb1_ret
k2_pa2f:
  s_cmp_eq_u32 s41, s40
  s_cbranch_scc1 k2_pa2f_tri
  v_mov_b32 v208, 0xff800000
  v_mov_b32 v209, 0xff800000
  v_mov_b32 v210, 0xff800000
  v_mov_b32 v211, 0xff800000
  v_mov_b32 v212, 0xff800000
  v_mov_b32 v213, 0xff800000
  v_mov_b32 v214, 0xff800000
  v_mov_b32 v215, 0xff800000
  v_mov_b32 v216, 0xff800000
  v_mov_b32 v217, 0xff800000
  v_mov_b32 v218, 0xff800000
  v_mov_b32 v219, 0xff800000
  v_mov_b32 v220, 0xff800000
  v_mov_b32 v221, 0xff800000
  v_mov_b32 v222, 0xff800000
  v_mov_b32 v223, 0xff800000
  s_branch k2_pa2f_ret
k2_pa2f_tri:
  v_mov_b32 v6, 0xff800000
  v_mov_b32 v216, 0xff800000
  v_cndmask_b32 v208, v208, v6, s[44:45]
  v_cndmask_b32 v220, v220, v6, s[44:45]
  v_mov_b32 v217, 0xff800000
  v_cndmask_b32 v209, v209, v6, s[46:47]
  v_cndmask_b32 v221, v221, v6, s[46:47]
  v_mov_b32 v218, 0xff800000
  v_cndmask_b32 v210, v210, v6, s[48:49]
  v_cndmask_b32 v222, v222, v6, s[48:49]
  v_mov_b32 v219, 0xff800000
  v_cndmask_b32 v211, v211, v6, s[50:51]
  v_cndmask_b32 v223, v223, v6, s[50:51]
  s_branch k2_pa2f_ret
k2_pb2f:
  s_cmp_eq_u32 s33, s40
  s_cbranch_scc1 k2_pb2f_tri
  v_mov_b32 v208, 0xff800000
  v_mov_b32 v209, 0xff800000
  v_mov_b32 v210, 0xff800000
  v_mov_b32 v211, 0xff800000
  v_mov_b32 v212, 0xff800000
  v_mov_b32 v213, 0xff800000
  v_mov_b32 v214, 0xff800000
  v_mov_b32 v215, 0xff800000
  v_mov_b32 v216, 0xff800000
  v_mov_b32 v217, 0xff800000
  v_mov_b32 v218, 0xff800000
  v_mov_b32 v219, 0xff800000
  v_mov_b32 v220, 0xff800000
  v_mov_b32 v221, 0xff800000
  v_mov_b32 v222, 0xff800000
  v_mov_b32 v223, 0xff800000
  s_branch k2_pb2f_ret
k2_pb2f_tri:
  v_mov_b32 v6, 0xff800000
  v_mov_b32 v216, 0xff800000
  v_cndmask_b32 v208, v208, v6, s[44:45]
  v_cndmask_b32 v220, v220, v6, s[44:45]
  v_mov_b32 v217, 0xff800000
  v_cndmask_b32 v209, v209, v6, s[46:47]
  v_cndmask_b32 v221, v221, v6, s[46:47]
  v_mov_b32 v218, 0xff800000
  v_cndmask_b32 v210, v210, v6, s[48:49]
  v_cndmask_b32 v222, v222, v6, s[48:49]
  v_mov_b32 v219, 0xff800000
  v_cndmask_b32 v211, v211, v6, s[50:51]
  v_cndmask_b32 v223, v223, v6, s[50:51]
  s_branch k2_pb2f_ret
k2_sa2f:
  v_max3_f32 v24, v160, v161, v162
  v_max3_f32 v28, v163, v168, v169
  v_max3_f32 v24, v24, v170, v171
  v_max_f32 v24, v24, v28
  v_mov_b32 v28, v24
  s_nop 1
  v_permlane16_swap_b32 v24, v28
  v_max_f32 v24, v24, v28
  v_mov_b32 v28, v24
  s_nop 1
  v_permlane32_swap_b32 v24, v28
  v_max_f32 v24, v24, v28
  v_max_f32 v24, 0, v24
  v_xor_b32 v24, 0x80000000, v24
  v_exp_f32 v26, v24
  v_max3_f32 v25, v164, v165, v166
  v_max3_f32 v29, v167, v172, v173
  v_max3_f32 v25, v25, v174, v175
  v_max_f32 v25, v25, v29
  v_mov_b32 v29, v25
  s_nop 1
  v_permlane16_swap_b32 v25, v29
  v_max_f32 v25, v25, v29
  v_mov_b32 v29, v25
  s_nop 1
  v_permlane32_swap_b32 v25, v29
  v_max_f32 v25, v25, v29
  v_max_f32 v25, 0, v25
  v_xor_b32 v25, 0x80000000, v25
  v_exp_f32 v27, v25
  v_add_f32 v160, v160, v24
  v_add_f32 v161, v161, v24
  v_add_f32 v162, v162, v24
  v_add_f32 v163, v163, v24
  v_add_f32 v164, v164, v25
  v_add_f32 v165, v165, v25
  v_add_f32 v166, v166, v25
  v_add_f32 v167, v167, v25
  v_add_f32 v168, v168, v24
  v_add_f32 v169, v169, v24
  v_add_f32 v170, v170, v24
  v_add_f32 v171, v171, v24
  v_add_f32 v172, v172, v25
  v_add_f32 v173, v173, v25
  v_add_f32 v174, v174, v25
  v_add_f32 v175, v175, v25
  v_mul_f32 v64, v64, v26
  v_mul_f32 v65, v65, v26
  v_mul_f32 v66, v66, v26
  v_mul_f32 v67, v67, v26
  v_mul_f32 v68, v68, v27
  v_mul_f32 v69, v69, v27
  v_mul_f32 v70, v70, v27
  v_mul_f32 v71, v71, v27
  v_mul_f32 v72, v72, v26
  v_mul_f32 v73, v73, v26
  v_mul_f32 v74, v74, v26
  v_mul_f32 v75, v75, v26
  v_mul_f32 v76, v76, v27
  v_mul_f32 v77, v77, v27
  v_mul_f32 v78, v78, v27
  v_mul_f32 v79, v79, v27
  v_mul_f32 v80, v80, v26
  v_mul_f32 v81, v81, v26
  v_mul_f32 v82, v82, v26
  v_mul_f32 v83, v83, v26
  v_mul_f32 v84, v84, v27
  v_mul_f32 v85, v85, v27
  v_mul_f32 v86, v86, v27
  v_mul_f32 v87, v87, v27
  v_mul_f32 v88, v88, v26
  v_mul_f32 v89, v89, v26
  v_mul_f32 v90, v90, v26
  v_mul_f32 v91, v91, v26
  v_mul_f32 v92, v92, v27
  v_mul_f32 v93, v93, v27
  v_mul_f32 v94, v94, v27
  v_mul_f32 v95, v95, v27
  v_mul_f32 v96, v96, v26
  v_mul_f32 v97, v97, v26
  v_mul_f32 v98, v98, v26
  v_mul_f32 v99, v99, v26
  v_mul_f32 v100, v100, v27
  v_mul_f32 v101, v101, v27
  v_mul_f32 v102, v102, v27
  v_mul_f32 v103, v103, v27
  v_mul_f32 v104, v104, v26
  v_mul_f32 v105, v105, v26
  v_mul_f32 v106, v106, v26
  v_mul_f32 v107, v107, v26
  v_mul_f32 v108, v108, v27
  v_mul_f32 v109, v109, v27
  v_mul_f32 v110, v110, v27
  v_mul_f32 v111, v111, v27
  v_mul_f32 v112, v112, v26
  v_mul_f32 v113, v113, v26
  v_mul_f32 v114, v114, v26
  v_mul_f32 v115, v115, v26
  v_mul_f32 v116, v116, v27
  v_mul_f32 v117, v117, v27
  v_mul_f32 v118, v118, v27
  v_mul_f32 v119, v119, v27
  v_mul_f32 v120, v120, v26
  v_mul_f32 v121, v121, v26
  v_mul_f32 v122, v122, v26
  v_mul_f32 v123, v123, v26
  v_mul_f32 v124, v124, v27
  v_mul_f32 v125, v125, v27
  v_mul_f32 v126, v126, v27
  v_mul_f32 v127, v127, v27
  v_mul_f32 v8, v8, v26
  v_mul_f32 v9, v9, v27
  v_exp_f32 v16, v160
  v_exp_f32 v17, v161
  s_nop 0
  v_cvt_pk_bf16_f32 v192, v16, v17
  v_add_f32 v12, v16, v17
  v_exp_f32 v18, v162
  v_exp_f32 v19, v163
  s_nop 0
  v_cvt_pk_bf16_f32 v193, v18, v19
  v_add_f32 v18, v18, v19
  v_exp_f32 v20, v164
  v_add_f32 v12, v12, v18
  v_exp_f32 v21, v165
  s_nop 0
  v_cvt_pk_bf16_f32 v196, v20, v21
  v_add_f32 v13, v20, v21
  v_exp_f32 v22, v166
  v_exp_f32 v23, v167
  s_nop 0
  v_cvt_pk_bf16_f32 v197, v22, v23
  v_add_f32 v22, v22, v23
  v_exp_f32 v16, v168
  v_add_f32 v13, v13, v22
  v_exp_f32 v17, v169
  s_nop 0
  v_cvt_pk_bf16_f32 v194, v16, v17
  v_add_f32 v16, v16, v17
  v_exp_f32 v18, v170
  v_add_f32 v12, v12, v16
  v_exp_f32 v19, v171
  s_nop 0
  v_cvt_pk_bf16_f32 v195, v18, v19
  v_add_f32 v18, v18, v19
  v_exp_f32 v20, v172
  v_add_f32 v12, v12, v18
  v_exp_f32 v21, v173
  s_nop 0
  v_cvt_pk_bf16_f32 v198, v20, v21
  v_add_f32 v20, v20, v21
  v_exp_f32 v22, v174
  v_add_f32 v13, v13, v20
  v_exp_f32 v23, v175
  s_nop 0
  v_cvt_pk_bf16_f32 v199, v22, v23
  v_add_f32 v22, v22, v23
  v_add_f32 v13, v13, v22
  v_add_f32 v176, v176, v24
  v_add_f32 v208, v208, v24
  v_add_f32 v177, v177, v24
  v_add_f32 v209, v209, v24
  v_add_f32 v178, v178, v24
  v_add_f32 v210, v210, v24
  v_add_f32 v179, v179, v24
  v_add_f32 v211, v211, v24
  v_add_f32 v180, v180, v25
  v_add_f32 v212, v212, v25
  v_add_f32 v181, v181, v25
  v_add_f32 v213, v213, v25
  v_add_f32 v182, v182, v25
  v_add_f32 v214, v214, v25
  v_add_f32 v183, v183, v25
  v_add_f32 v215, v215, v25
  v_add_f32 v184, v184, v24
  v_add_f32 v216, v216, v24
  v_add_f32 v185, v185, v24
  v_add_f32 v217, v217, v24
  v_add_f32 v186, v186, v24
  v_add_f32 v218, v218, v24
  v_add_f32 v187, v187, v24
  v_add_f32 v219, v219, v24
  v_add_f32 v188, v188, v25
  v_add_f32 v220, v220, v25
  v_add_f32 v189, v189, v25
  v_add_f32 v221, v221, v25
  v_add_f32 v190, v190, v25
  v_add_f32 v222, v222, v25
  v_add_f32 v191, v191, v25
  v_add_f32 v223, v223, v25
  v_add_f32 v10, v10, v24
  v_add_f32 v11, v11, v25
k2_sa2f_r2:
  v_exp_f32 v16, v176
  v_exp_f32 v17, v177
  s_nop 0
  v_cvt_pk_bf16_f32 v200, v16, v17
  v_add_f32 v14, v16, v17
  v_exp_f32 v18, v178
  s_branch k2_sa2f_ret
k2_sb2f:
  v_max3_f32 v24, v176, v177, v178
  v_max3_f32 v28, v179, v184, v185
  v_max3_f32 v24, v24, v186, v187
  v_max_f32 v24, v24, v28
  v_mov_b32 v28, v24
  s_nop 1
  v_permlane16_swap_b32 v24, v28
  v_max_f32 v24, v24, v28
  v_mov_b32 v28, v24
  s_nop 1
  v_permlane32_swap_b32 v24, v28
  v_max_f32 v24, v24, v28
  v_max_f32 v24, 0, v24
  v_xor_b32 v24, 0x80000000, v24
  v_exp_f32 v26, v24
  v_max3_f32 v25, v180, v181, v182
  v_max3_f32 v29, v183, v188, v189
  v_max3_f32 v25, v25, v190, v191
  v_max_f32 v25, v25, v29
  v_mov_b32 v29, v25
  s_nop 1
  v_permlane16_swap_b32 v25, v29
  v_max_f32 v25, v25, v29
  v_mov_b32 v29, v25
  s_nop 1
  v_permlane32_swap_b32 v25, v29
  v_max_f32 v25, v25, v29
  v_max_f32 v25, 0, v25
  v_xor_b32 v25, 0x80000000, v25
  v_exp_f32 v27, v25
  v_add_f32 v176, v176, v24
  v_add_f32 v177, v177, v24
  v_add_f32 v178, v178, v24
  v_add_f32 v179, v179, v24
  v_add_f32 v180, v180, v25
  v_add_f32 v181, v181, v25
  v_add_f32 v182, v182, v25
  v_add_f32 v183, v183, v25
  v_add_f32 v184, v184, v24
  v_add_f32 v185, v185, v24
  v_add_f32 v186, v186, v24
  v_add_f32 v187, v187, v24
  v_add_f32 v188, v188, v25
  v_add_f32 v189, v189, v25
  v_add_f32 v190, v190, v25
  v_add_f32 v191, v191, v25
  v_mul_f32 v64, v64, v26
  v_mul_f32 v65, v65, v26
  v_mul_f32 v66, v66, v26
  v_mul_f32 v67, v67, v26
  v_mul_f32 v68, v68, v27
  v_mul_f32 v69, v69, v27
  v_mul_f32 v70, v70, v27
  v_mul_f32 v71, v71, v27
  v_mul_f32 v72, v72, v26
  v_mul_f32 v73, v73, v26
  v_mul_f32 v74, v74, v26
  v_mul_f32 v75, v75, v26
  v_mul_f32 v76, v76, v27
  v_mul_f32 v77, v77, v27
  v_mul_f32 v78, v78, v27
  v_mul_f32 v79, v79, v27
  v_mul_f32 v80, v80, v26
  v_mul_f32 v81, v81, v26
  v_mul_f32 v82, v82, v26
  v_mul_f32 v83, v83, v26
  v_mul_f32 v84, v84, v27
  v_mul_f32 v85, v85, v27
  v_mul_f32 v86, v86, v27
  v_mul_f32 v87, v87, v27
  v_mul_f32 v88, v88, v26
  v_mul_f32 v89, v89, v26
  v_mul_f32 v90, v90, v26
  v_mul_f32 v91, v91, v26
  v_mul_f32 v92, v92, v27
  v_mul_f32 v93, v93, v27
  v_mul_f32 v94, v94, v27
  v_mul_f32 v95, v95, v27
  v_mul_f32 v96, v96, v26
  v_mul_f32 v97, v97, v26
  v_mul_f32 v98, v98, v26
  v_mul_f32 v99, v99, v26
  v_mul_f32 v100, v100, v27
  v_mul_f32 v101, v101, v27
  v_mul_f32 v102, v102, v27
  v_mul_f32 v103, v103, v27
  v_mul_f32 v104, v104, v26
  v_mul_f32 v105, v105, v26
  v_mul_f32 v106, v106, v26
  v_mul_f32 v107, v107, v26
  v_mul_f32 v108, v108, v27
  v_mul_f32 v109, v109, v27
  v_mul_f32 v110, v110, v27
  v_mul_f32 v111, v111, v27
  v_mul_f32 v112, v112, v26
  v_mul_f32 v113, v113, v26
  v_mul_f32 v114, v114, v26
  v_mul_f32 v115, v115, v26
  v_mul_f32 v116, v116, v27
  v_mul_f32 v117, v117, v27
  v_mul_f32 v118, v118, v27
  v_mul_f32 v119, v119, v27
  v_mul_f32 v120, v120, v26
  v_mul_f32 v121, v121, v26
  v_mul_f32 v122, v122, v26
  v_mul_f32 v123, v123, v26
  v_mul_f32 v124, v124, v27
  v_mul_f32 v125, v125, v27
  v_mul_f32 v126, v126, v27
  v_mul_f32 v127, v127, v27
  v_mul_f32 v8, v8, v26
  v_mul_f32 v9, v9, v27
  v_exp_f32 v16, v176
  v_exp_f32 v17, v177
  s_nop 0
  v_cvt_pk_bf16_f32 v200, v16, v17
  v_add_f32 v14, v16, v17
  v_exp_f32 v18, v178
  v_exp_f32 v19, v179
  s_nop 0
  v_cvt_pk_bf16_f32 v201, v18, v19
  v_add_f32 v18, v18, v19
  v_exp_f32 v20, v180
  v_add_f32 v14, v14, v18
  v_exp_f32 v21, v181
  s_nop 0
  v_cvt_pk_bf16_f32 v204, v20, v21
  v_add_f32 v15, v20, v21
  v_exp_f32 v22, v182
  v_exp_f32 v23, v183
  s_nop 0
  v_cvt_pk_bf16_f32 v205, v22, v23
  v_add_f32 v22, v22, v23
  v_exp_f32 v16, v184
  v_add_f32 v15, v15, v22
  v_exp_f32 v17, v185
  s_nop 0
  v_cvt_pk_bf16_f32 v202, v16, v17
  v_add_f32 v16, v16, v17
  v_exp_f32 v18, v186
  v_add_f32 v14, v14, v16
  v_exp_f32 v19, v187
  s_nop 0
  v_cvt_pk_bf16_f32 v203, v18, v19
  v_add_f32 v18, v18, v19
  v_exp_f32 v20, v188
  v_add_f32 v14, v14, v18
  v_exp_f32 v21, v189
  s_nop 0
  v_cvt_pk_bf16_f32 v206, v20, v21
  v_add_f32 v20, v20, v21
  v_exp_f32 v22, v190
  v_add_f32 v15, v15, v20
  v_exp_f32 v23, v191
  s_nop 0
  v_cvt_pk_bf16_f32 v207, v22, v23
  v_add_f32 v22, v22, v23
  v_add_f32 v15, v15, v22
  s_cmp_ge_u32 s3, 4
  s_cbranch_scc1 k2_sb2f_r2
  v_add_f32 v160, v160, v24
  v_add_f32 v208, v208, v24
  v_add_f32 v161, v161, v24
  v_add_f32 v209, v209, v24
  v_add_f32 v162, v162, v24
  v_add_f32 v210, v210, v24
  v_add_f32 v163, v163, v24
  v_add_f32 v211, v211, v24
  v_add_f32 v164, v164, v25
  v_add_f32 v212, v212, v25
  v_add_f32 v165, v165, v25
  v_add_f32 v213, v213, v25
  v_add_f32 v166, v166, v25
  v_add_f32 v214, v214, v25
  v_add_f32 v167, v167, v25
  v_add_f32 v215, v215, v25
  v_add_f32 v168, v168, v24
  v_add_f32 v216, v216, v24
  v_add_f32 v169, v169, v24
  v_add_f32 v217, v217, v24
  v_add_f32 v170, v170, v24
  v_add_f32 v218, v218, v24
  v_add_f32 v171, v171, v24
  v_add_f32 v219, v219, v24
  v_add_f32 v172, v172, v25
  v_add_f32 v220, v220, v25
  v_add_f32 v173, v173, v25
  v_add_f32 v221, v221, v25
  v_add_f32 v174, v174, v25
  v_add_f32 v222, v222, v25
  v_add_f32 v175, v175, v25
  v_add_f32 v223, v223, v25
  v_add_f32 v10, v10, v24
  v_add_f32 v11, v11, v25
k2_sb2f_r2:
  v_exp_f32 v16, v160
  v_exp_f32 v17, v161
  s_nop 0
  v_cvt_pk_bf16_f32 v192, v16, v17
  v_add_f32 v12, v16, v17
  v_exp_f32 v18, v162
  s_branch k2_sb2f_ret
k2_pa2:
  s_cmp_eq_u32 s41, s40
  s_cbranch_scc1 k2_pa2_tri
  v_mov_b32 v208, 0xff800000
  v_mov_b32 v209, 0xff800000
  v_mov_b32 v210, 0xff800000
  v_mov_b32 v211, 0xff800000
  v_mov_b32 v212, 0xff800000
  v_mov_b32 v213, 0xff800000
  v_mov_b32 v214, 0xff800000
  v_mov_b32 v215, 0xff800000
  v_mov_b32 v216, 0xff800000
  v_mov_b32 v217, 0xff800000
  v_mov_b32 v218, 0xff800000
  v_mov_b32 v219, 0xff800000
  v_mov_b32 v220, 0xff800000
  v_mov_b32 v221, 0xff800000
  v_mov_b32 v222, 0xff800000
  v_mov_b32 v223, 0xff800000
  s_branch k2_pa2_ret
k2_pa2_tri:
  v_mov_b32 v6, 0xff800000
  v_mov_b32 v216, 0xff800000
  v_cndmask_b32 v208, v208, v6, s[44:45]
  v_cndmask_b32 v220, v220, v6, s[44:45]
  v_mov_b32 v217, 0xff800000
  v_cndmask_b32 v209, v209, v6, s[46:47]
  v_cndmask_b32 v221, v221, v6, s[46:47]
  v_mov_b32 v218, 0xff800000
  v_cndmask_b32 v210, v210, v6, s[48:49]
  v_cndmask_b32 v222, v222, v6, s[48:49]
  v_mov_b32 v219, 0xff800000
  v_cndmask_b32 v211, v211, v6, s[50:51]
  v_cndmask_b32 v223, v223, v6, s[50:51]
  s_branch k2_pa2_ret
k2_pb2:
  s_cmp_eq_u32 s33, s40
  s_cbranch_scc1 k2_pb2_tri
  v_mov_b32 v208, 0xff800000
  v_mov_b32 v209, 0xff800000
  v_mov_b32 v210, 0xff800000
  v_mov_b32 v211, 0xff800000
  v_mov_b32 v212, 0xff800000
  v_mov_b32 v213, 0xff800000
  v_mov_b32 v214, 0xff800000
  v_mov_b32 v215, 0xff800000
  v_mov_b32 v216, 0xff800000
  v_mov_b32 v217, 0xff800000
  v_mov_b32 v218, 0xff800000
  v_mov_b32 v219, 0xff800000
  v_mov_b32 v220, 0xff800000
  v_mov_b32 v221, 0xff800000
  v_mov_b32 v222, 0xff800000
  v_mov_b32 v223, 0xff800000
  s_branch k2_pb2_ret
k2_pb2_tri:
  v_mov_b32 v6, 0xff800000
  v_mov_b32 v216, 0xff800000
  v_cndmask_b32 v208, v208, v6, s[44:45]
  v_cndmask_b32 v220, v220, v6, s[44:45]
  v_mov_b32 v217, 0xff800000
  v_cndmask_b32 v209, v209, v6, s[46:47]
  v_cndmask_b32 v221, v221, v6, s[46:47]
  v_mov_b32 v218, 0xff800000
  v_cndmask_b32 v210, v210, v6, s[48:49]
  v_cndmask_b32 v222, v222, v6, s[48:49]
  v_mov_b32 v219, 0xff800000
  v_cndmask_b32 v211, v211, v6, s[50:51]
  v_cndmask_b32 v223, v223, v6, s[50:51]
  s_branch k2_pb2_ret
k2_sa2:
  v_max3_f32 v24, v160, v161, v162
  v_max3_f32 v28, v163, v168, v169
  v_max3_f32 v24, v24, v170, v171
  v_max_f32 v24, v24, v28
  v_mov_b32 v28, v24
  s_nop 1
  v_permlane16_swap_b32 v24, v28
  v_max_f32 v24, v24, v28
  v_mov_b32 v28, v24
  s_nop 1
  v_permlane32_swap_b32 v24, v28
  v_max_f32 v24, v24, v28
  v_max_f32 v24, 0, v24
  v_xor_b32 v24, 0x80000000, v24
  v_exp_f32 v26, v24
  v_max3_f32 v25, v164, v165, v166
  v_max3_f32 v29, v167, v172, v173
  v_max3_f32 v25, v25, v174, v175
  v_max_f32 v25, v25, v29
  v_mov_b32 v29, v25
  s_nop 1
  v_permlane16_swap_b32 v25, v29
  v_max_f32 v25, v25, v29
  v_mov_b32 v29, v25
  s_nop 1
  v_permlane32_swap_b32 v25, v29
  v_max_f32 v25, v25, v29
  v_max_f32 v25, 0, v25
  v_xor_b32 v25, 0x80000000, v25
  v_exp_f32 v27, v25
  v_add_f32 v160, v160, v24
  v_add_f32 v161, v161, v24
  v_add_f32 v162, v162, v24
  v_add_f32 v163, v163, v24
  v_add_f32 v164, v164, v25
  v_add_f32 v165, v165, v25
  v_add_f32 v166, v166, v25
  v_add_f32 v167, v167, v25
  v_add_f32 v168, v168, v24
  v_add_f32 v169, v169, v24
  v_add_f32 v170, v170, v24
  v_add_f32 v171, v171, v24
  v_add_f32 v172, v172, v25
  v_add_f32 v173, v173, v25
  v_add_f32 v174, v174, v25
  v_add_f32 v175, v175, v25
  v_mul_f32 v64, v64, v26
  v_mul_f32 v65, v65, v26
  v_mul_f32 v66, v66, v26
  v_mul_f32 v67, v67, v26
  v_mul_f32 v68, v68, v27
  v_mul_f32 v69, v69, v27
  v_mul_f32 v70, v70, v27
  v_mul_f32 v71, v71, v27
  v_mul_f32 v72, v72, v26
  v_mul_f32 v73, v73, v26
  v_mul_f32 v74, v74, v26
  v_mul_f32 v75, v75, v26
  v_mul_f32 v76, v76, v27
  v_mul_f32 v77, v77, v27
  v_mul_f32 v78, v78, v27
  v_mul_f32 v79, v79, v27
  v_mul_f32 v80, v80, v26
  v_mul_f32 v81, v81, v26
  v_mul_f32 v82, v82, v26
  v_mul_f32 v83, v83, v26
  v_mul_f32 v84, v84, v27
  v_mul_f32 v85, v85, v27
  v_mul_f32 v86, v86, v27
  v_mul_f32 v87, v87, v27
  v_mul_f32 v88, v88, v26
  v_mul_f32 v89, v89, v26
  v_mul_f32 v90, v90, v26
  v_mul_f32 v91, v91, v26
  v_mul_f32 v92, v92, v27
  v_mul_f32 v93, v93, v27
  v_mul_f32 v94, v94, v27
  v_mul_f32 v95, v95, v27
  v_mul_f32 v96, v96, v26
  v_mul_f32 v97, v97, v26
  v_mul_f32 v98, v98, v26
  v_mul_f32 v99, v99, v26
  v_mul_f32 v100, v100, v27
  v_mul_f32 v101, v101, v27
  v_mul_f32 v102, v102, v27
  v_mul_f32 v103, v103, v27
  v_mul_f32 v104, v104, v26
  v_mul_f32 v105, v105, v26
  v_mul_f32 v106, v106, v26
  v_mul_f32 v107, v107, v26
  v_mul_f32 v108, v108, v27
  v_mul_f32 v109, v109, v27
  v_mul_f32 v110, v110, v27
  v_mul_f32 v111, v111, v27
  v_mul_f32 v112, v112, v26
  v_mul_f32 v113, v113, v26
  v_mul_f32 v114, v114, v26
  v_mul_f32 v115, v115, v26
  v_mul_f32 v116, v116, v27
  v_mul_f32 v117, v117, v27
  v_mul_f32 v118, v118, v27
  v_mul_f32 v119, v119, v27
  v_mul_f32 v120, v120, v26
  v_mul_f32 v121, v121, v26
  v_mul_f32 v122, v122, v26
  v_mul_f32 v123, v123, v26
  v_mul_f32 v124, v124, v27
  v_mul_f32 v125, v125, v27
  v_mul_f32 v126, v126, v27
  v_mul_f32 v127, v127, v27
  v_mul_f32 v8, v8, v26
  v_mul_f32 v9, v9, v27
  v_exp_f32 v16, v160
  v_exp_f32 v17, v161
  s_nop 0
  v_cvt_pk_bf16_f32 v192, v16, v17
  v_add_f32 v12, v16, v17
  v_exp_f32 v18, v162
  v_exp_f32 v19, v163
  s_nop 0
  v_cvt_pk_bf16_f32 v193, v18, v19
  v_add_f32 v18, v18, v19
  v_exp_f32 v20, v164
  v_add_f32 v12, v12, v18
  v_exp_f32 v21, v165
  s_nop 0
  v_cvt_pk_bf16_f32 v196, v20, v21
  v_add_f32 v13, v20, v21
  v_exp_f32 v22, v166
  v_exp_f32 v23, v167
  s_nop 0
  v_cvt_pk_bf16_f32 v197, v22, v23
  v_add_f32 v22, v22, v23
  v_exp_f32 v16, v168
  v_add_f32 v13, v13, v22
  v_exp_f32 v17, v169
  s_nop 0
  v_cvt_pk_bf16_f32 v194, v16, v17
  v_add_f32 v16, v16, v17
  v_exp_f32 v18, v170
  v_add_f32 v12, v12, v16
  v_exp_f32 v19, v171
  s_nop 0
  v_cvt_pk_bf16_f32 v195, v18, v19
  v_add_f32 v18, v18, v19
  v_exp_f32 v20, v172
  v_add_f32 v12, v12, v18
  v_exp_f32 v21, v173
  s_nop 0
  v_cvt_pk_bf16_f32 v198, v20, v21
  v_add_f32 v20, v20, v21
  v_exp_f32 v22, v174
  v_add_f32 v13, v13, v20
  v_exp_f32 v23, v175
  s_nop 0
  v_cvt_pk_bf16_f32 v199, v22, v23
  v_add_f32 v22, v22, v23
  v_add_f32 v13, v13, v22
  v_add_f32 v176, v176, v24
  v_add_f32 v208, v208, v24
  v_add_f32 v177, v177, v24
  v_add_f32 v209, v209, v24
  v_add_f32 v178, v178, v24
  v_add_f32 v210, v210, v24
  v_add_f32 v179, v179, v24
  v_add_f32 v211, v211, v24
  v_add_f32 v180, v180, v25
  v_add_f32 v212, v212, v25
  v_add_f32 v181, v181, v25
  v_add_f32 v213, v213, v25
  v_add_f32 v182, v182, v25
  v_add_f32 v214, v214, v25
  v_add_f32 v183, v183, v25
  v_add_f32 v215, v215, v25
  v_add_f32 v184, v184, v24
  v_add_f32 v216, v216, v24
  v_add_f32 v185, v185, v24
  v_add_f32 v217, v217, v24
  v_add_f32 v186, v186, v24
  v_add_f32 v218, v218, v24
  v_add_f32 v187, v187, v24
  v_add_f32 v219, v219, v24
  v_add_f32 v188, v188, v25
  v_add_f32 v220, v220, v25
  v_add_f32 v189, v189, v25
  v_add_f32 v221, v221, v25
  v_add_f32 v190, v190, v25
  v_add_f32 v222, v222, v25
  v_add_f32 v191, v191, v25
  v_add_f32 v223, v223, v25
  v_add_f32 v10, v10, v24
  v_add_f32 v11, v11, v25
k2_sa2_r2:
  v_exp_f32 v16, v176
  v_exp_f32 v17, v177
  s_nop 0
  v_cvt_pk_bf16_f32 v200, v16, v17
  v_add_f32 v14, v16, v17
  v_exp_f32 v18, v178
  s_branch k2_sa2_ret
k2_sb2:
  v_max3_f32 v24, v176, v177, v178
  v_max3_f32 v28, v179, v184, v185
  v_max3_f32 v24, v24, v186, v187
  v_max_f32 v24, v24, v28
  v_mov_b32 v28, v24
  s_nop 1
  v_permlane16_swap_b32 v24, v28
  v_max_f32 v24, v24, v28
  v_mov_b32 v28, v24
  s_nop 1
  v_permlane32_swap_b32 v24, v28
  v_max_f32 v24, v24, v28
  v_max_f32 v24, 0, v24
  v_xor_b32 v24, 0x80000000, v24
  v_exp_f32 v26, v24
  v_max3_f32 v25, v180, v181, v182
  v_max3_f32 v29, v183, v188, v189
  v_max3_f32 v25, v25, v190, v191
  v_max_f32 v25, v25, v29
  v_mov_b32 v29, v25
  s_nop 1
  v_permlane16_swap_b32 v25, v29
  v_max_f32 v25, v25, v29
  v_mov_b32 v29, v25
  s_nop 1
  v_permlane32_swap_b32 v25, v29
  v_max_f32 v25, v25, v29
  v_max_f32 v25, 0, v25
  v_xor_b32 v25, 0x80000000, v25
  v_exp_f32 v27, v25
  v_add_f32 v176, v176, v24
  v_add_f32 v177, v177, v24
  v_add_f32 v178, v178, v24
  v_add_f32 v179, v179, v24
  v_add_f32 v180, v180, v25
  v_add_f32 v181, v181, v25
  v_add_f32 v182, v182, v25
  v_add_f32 v183, v183, v25
  v_add_f32 v184, v184, v24
  v_add_f32 v185, v185, v24
  v_add_f32 v186, v186, v24
  v_add_f32 v187, v187, v24
  v_add_f32 v188, v188, v25
  v_add_f32 v189, v189, v25
  v_add_f32 v190, v190, v25
  v_add_f32 v191, v191, v25
  v_mul_f32 v64, v64, v26
  v_mul_f32 v65, v65, v26
  v_mul_f32 v66, v66, v26
  v_mul_f32 v67, v67, v26
  v_mul_f32 v68, v68, v27
  v_mul_f32 v69, v69, v27
  v_mul_f32 v70, v70, v27
  v_mul_f32 v71, v71, v27
  v_mul_f32 v72, v72, v26
  v_mul_f32 v73, v73, v26
  v_mul_f32 v74, v74, v26
  v_mul_f32 v75, v75, v26
  v_mul_f32 v76, v76, v27
  v_mul_f32 v77, v77, v27
  v_mul_f32 v78, v78, v27
  v_mul_f32 v79, v79, v27
  v_mul_f32 v80, v80, v26
  v_mul_f32 v81, v81, v26
  v_mul_f32 v82, v82, v26
  v_mul_f32 v83, v83, v26
  v_mul_f32 v84, v84, v27
  v_mul_f32 v85, v85, v27
  v_mul_f32 v86, v86, v27
  v_mul_f32 v87, v87, v27
  v_mul_f32 v88, v88, v26
  v_mul_f32 v89, v89, v26
  v_mul_f32 v90, v90, v26
  v_mul_f32 v91, v91, v26
  v_mul_f32 v92, v92, v27
  v_mul_f32 v93, v93, v27
  v_mul_f32 v94, v94, v27
  v_mul_f32 v95, v95, v27
  v_mul_f32 v96, v96, v26
  v_mul_f32 v97, v97, v26
  v_mul_f32 v98, v98, v26
  v_mul_f32 v99, v99, v26
  v_mul_f32 v100, v100, v27
  v_mul_f32 v101, v101, v27
  v_mul_f32 v102, v102, v27
  v_mul_f32 v103, v103, v27
  v_mul_f32 v104, v104, v26
  v_mul_f32 v105, v105, v26
  v_mul_f32 v106, v106, v26
  v_mul_f32 v107, v107, v26
  v_mul_f32 v108, v108, v27
  v_mul_f32 v109, v109, v27
  v_mul_f32 v110, v110, v27
  v_mul_f32 v111, v111, v27
  v_mul_f32 v112, v112, v26
  v_mul_f32 v113, v113, v26
  v_mul_f32 v114, v114, v26
  v_mul_f32 v115, v115, v26
  v_mul_f32 v116, v116, v27
  v_mul_f32 v117, v117, v27
  v_mul_f32 v118, v118, v27
  v_mul_f32 v119, v119, v27
  v_mul_f32 v120, v120, v26
  v_mul_f32 v121, v121, v26
  v_mul_f32 v122, v122, v26
  v_mul_f32 v123, v123, v26
  v_mul_f32 v124, v124, v27
  v_mul_f32 v125, v125, v27
  v_mul_f32 v126, v126, v27
  v_mul_f32 v127, v127, v27
  v_mul_f32 v8, v8, v26
  v_mul_f32 v9, v9, v27
  v_exp_f32 v16, v176
  v_exp_f32 v17, v177
  s_nop 0
  v_cvt_pk_bf16_f32 v200, v16, v17
  v_add_f32 v14, v16, v17
  v_exp_f32 v18, v178
  v_exp_f32 v19, v179
  s_nop 0
  v_cvt_pk_bf16_f32 v201, v18, v19
  v_add_f32 v18, v18, v19
  v_exp_f32 v20, v180
  v_add_f32 v14, v14, v18
  v_exp_f32 v21, v181
  s_nop 0
  v_cvt_pk_bf16_f32 v204, v20, v21
  v_add_f32 v15, v20, v21
  v_exp_f32 v22, v182
  v_exp_f32 v23, v183
  s_nop 0
  v_cvt_pk_bf16_f32 v205, v22, v23
  v_add_f32 v22, v22, v23
  v_exp_f32 v16, v184
  v_add_f32 v15, v15, v22
  v_exp_f32 v17, v185
  s_nop 0
  v_cvt_pk_bf16_f32 v202, v16, v17
  v_add_f32 v16, v16, v17
  v_exp_f32 v18, v186
  v_add_f32 v14, v14, v16
  v_exp_f32 v19, v187
  s_nop 0
  v_cvt_pk_bf16_f32 v203, v18, v19
  v_add_f32 v18, v18, v19
  v_exp_f32 v20, v188
  v_add_f32 v14, v14, v18
  v_exp_f32 v21, v189
  s_nop 0
  v_cvt_pk_bf16_f32 v206, v20, v21
  v_add_f32 v20, v20, v21
  v_exp_f32 v22, v190
  v_add_f32 v15, v15, v20
  v_exp_f32 v23, v191
  s_nop 0
  v_cvt_pk_bf16_f32 v207, v22, v23
  v_add_f32 v22, v22, v23
  v_add_f32 v15, v15, v22
  v_add_f32 v160, v160, v24
  v_add_f32 v208, v208, v24
  v_add_f32 v161, v161, v24
  v_add_f32 v209, v209, v24
  v_add_f32 v162, v162, v24
  v_add_f32 v210, v210, v24
  v_add_f32 v163, v163, v24
  v_add_f32 v211, v211, v24
  v_add_f32 v164, v164, v25
  v_add_f32 v212, v212, v25
  v_add_f32 v165, v165, v25
  v_add_f32 v213, v213, v25
  v_add_f32 v166, v166, v25
  v_add_f32 v214, v214, v25
  v_add_f32 v167, v167, v25
  v_add_f32 v215, v215, v25
  v_add_f32 v168, v168, v24
  v_add_f32 v216, v216, v24
  v_add_f32 v169, v169, v24
  v_add_f32 v217, v217, v24
  v_add_f32 v170, v170, v24
  v_add_f32 v218, v218, v24
  v_add_f32 v171, v171, v24
  v_add_f32 v219, v219, v24
  v_add_f32 v172, v172, v25
  v_add_f32 v220, v220, v25
  v_add_f32 v173, v173, v25
  v_add_f32 v221, v221, v25
  v_add_f32 v174, v174, v25
  v_add_f32 v222, v222, v25
  v_add_f32 v175, v175, v25
  v_add_f32 v223, v223, v25
  v_add_f32 v10, v10, v24
  v_add_f32 v11, v11, v25
k2_sb2_r2:
  v_exp_f32 v16, v160
  v_exp_f32 v17, v161
  s_nop 0
  v_cvt_pk_bf16_f32 v192, v16, v17
  v_add_f32 v12, v16, v17
  v_exp_f32 v18, v162
  s_branch k2_sb2_ret
k2_se:
  v_max3_f32 v24, v176, v177, v178
  v_max3_f32 v28, v179, v184, v185
  v_max3_f32 v24, v24, v186, v187
  v_max_f32 v24, v24, v28
  v_mov_b32 v28, v24
  s_nop 1
  v_permlane16_swap_b32 v24, v28
  v_max_f32 v24, v24, v28
  v_mov_b32 v28, v24
  s_nop 1
  v_permlane32_swap_b32 v24, v28
  v_max_f32 v24, v24, v28
  v_max_f32 v24, 0, v24
  v_xor_b32 v24, 0x80000000, v24
  v_exp_f32 v26, v24
  v_max3_f32 v25, v180, v181, v182
  v_max3_f32 v29, v183, v188, v189
  v_max3_f32 v25, v25, v190, v191
  v_max_f32 v25, v25, v29
  v_mov_b32 v29, v25
  s_nop 1
  v_permlane16_swap_b32 v25, v29
  v_max_f32 v25, v25, v29
  v_mov_b32 v29, v25
  s_nop 1
  v_permlane32_swap_b32 v25, v29
  v_max_f32 v25, v25, v29
  v_max_f32 v25, 0, v25
  v_xor_b32 v25, 0x80000000, v25
  v_exp_f32 v27, v25
  v_add_f32 v176, v176, v24
  v_add_f32 v177, v177, v24
  v_add_f32 v178, v178, v24
  v_add_f32 v179, v179, v24
  v_add_f32 v180, v180, v25
  v_add_f32 v181, v181, v25
  v_add_f32 v182, v182, v25
  v_add_f32 v183, v183, v25
  v_add_f32 v184, v184, v24
  v_add_f32 v185, v185, v24
  v_add_f32 v186, v186, v24
  v_add_f32 v187, v187, v24
  v_add_f32 v188, v188, v25
  v_add_f32 v189, v189, v25
  v_add_f32 v190, v190, v25
  v_add_f32 v191, v191, v25
  v_mul_f32 v64, v64, v26
  v_mul_f32 v65, v65, v26
  v_mul_f32 v66, v66, v26
  v_mul_f32 v67, v67, v26
  v_mul_f32 v68, v68, v27
  v_mul_f32 v69, v69, v27
  v_mul_f32 v70, v70, v27
  v_mul_f32 v71, v71, v27
  v_mul_f32 v72, v72, v26
  v_mul_f32 v73, v73, v26
  v_mul_f32 v74, v74, v26
  v_mul_f32 v75, v75, v26
  v_mul_f32 v76, v76, v27
  v_mul_f32 v77, v77, v27
  v_mul_f32 v78, v78, v27
  v_mul_f32 v79, v79, v27
  v_mul_f32 v80, v80, v26
  v_mul_f32 v81, v81, v26
  v_mul_f32 v82, v82, v26
  v_mul_f32 v83, v83, v26
  v_mul_f32 v84, v84, v27
  v_mul_f32 v85, v85, v27
  v_mul_f32 v86, v86, v27
  v_mul_f32 v87, v87, v27
  v_mul_f32 v88, v88, v26
  v_mul_f32 v89, v89, v26
  v_mul_f32 v90, v90, v26
  v_mul_f32 v91, v91, v26
  v_mul_f32 v92, v92, v27
  v_mul_f32 v93, v93, v27
  v_mul_f32 v94, v94, v27
  v_mul_f32 v95, v95, v27
  v_mul_f32 v96, v96, v26
  v_mul_f32 v97, v97, v26
  v_mul_f32 v98, v98, v26
  v_mul_f32 v99, v99, v26
  v_mul_f32 v100, v100, v27
  v_mul_f32 v101, v101, v27
  v_mul_f32 v102, v102, v27
  v_mul_f32 v103, v103, v27
  v_mul_f32 v104, v104, v26
  v_mul_f32 v105, v105, v26
  v_mul_f32 v106, v106, v26
  v_mul_f32 v107, v107, v26
  v_mul_f32 v108, v108, v27
  v_mul_f32 v109, v109, v27
  v_mul_f32 v110, v110, v27
  v_mul_f32 v111, v111, v27
  v_mul_f32 v112, v112, v26
  v_mul_f32 v113, v113, v26
  v_mul_f32 v114, v114, v26
  v_mul_f32 v115, v115, v26
  v_mul_f32 v116, v116, v27
  v_mul_f32 v117, v117, v27
  v_mul_f32 v118, v118, v27
  v_mul_f32 v119, v119, v27
  v_mul_f32 v120, v120, v26
  v_mul_f32 v121, v121, v26
  v_mul_f32 v122, v122, v26
  v_mul_f32 v123, v123, v26
  v_mul_f32 v124, v124, v27
  v_mul_f32 v125, v125, v27
  v_mul_f32 v126, v126, v27
  v_mul_f32 v127, v127, v27
  v_mul_f32 v8, v8, v26
  v_mul_f32 v9, v9, v27
  v_exp_f32 v16, v176
  v_exp_f32 v17, v177
  s_nop 0
  v_cvt_pk_bf16_f32 v200, v16, v17
  v_add_f32 v14, v16, v17
  v_exp_f32 v18, v178
  v_exp_f32 v19, v179
  s_nop 0
  v_cvt_pk_bf16_f32 v201, v18, v19
  v_add_f32 v18, v18, v19
  v_exp_f32 v20, v180
  v_add_f32 v14, v14, v18
  v_exp_f32 v21, v181
  s_nop 0
  v_cvt_pk_bf16_f32 v204, v20, v21
  v_add_f32 v15, v20, v21
  v_exp_f32 v22, v182
  v_exp_f32 v23, v183
  s_nop 0
  v_cvt_pk_bf16_f32 v205, v22, v23
  v_add_f32 v22, v22, v23
  v_exp_f32 v16, v184
  v_add_f32 v15, v15, v22
  v_exp_f32 v17, v185
  s_nop 0
  v_cvt_pk_bf16_f32 v202, v16, v17
  v_add_f32 v16, v16, v17
  v_exp_f32 v18, v186
  v_add_f32 v14, v14, v16
  v_exp_f32 v19, v187
  s_nop 0
  v_cvt_pk_bf16_f32 v203, v18, v19
  v_add_f32 v18, v18, v19
  v_exp_f32 v20, v188
  v_add_f32 v14, v14, v18
  v_exp_f32 v21, v189
  s_nop 0
  v_cvt_pk_bf16_f32 v206, v20, v21
  v_add_f32 v20, v20, v21
  v_exp_f32 v22, v190
  v_add_f32 v15, v15, v20
  v_exp_f32 v23, v191
  s_nop 0
  v_cvt_pk_bf16_f32 v207, v22, v23
  v_add_f32 v22, v22, v23
  v_add_f32 v15, v15, v22
  v_add_f32 v160, v160, v24
  v_add_f32 v208, v208, v24
  v_add_f32 v161, v161, v24
  v_add_f32 v209, v209, v24
  v_add_f32 v162, v162, v24
  v_add_f32 v210, v210, v24
  v_add_f32 v163, v163, v24
  v_add_f32 v211, v211, v24
  v_add_f32 v164, v164, v25
  v_add_f32 v212, v212, v25
  v_add_f32 v165, v165, v25
  v_add_f32 v213, v213, v25
  v_add_f32 v166, v166, v25
  v_add_f32 v214, v214, v25
  v_add_f32 v167, v167, v25
  v_add_f32 v215, v215, v25
  v_add_f32 v168, v168, v24
  v_add_f32 v216, v216, v24
  v_add_f32 v169, v169, v24
  v_add_f32 v217, v217, v24
  v_add_f32 v170, v170, v24
  v_add_f32 v218, v218, v24
  v_add_f32 v171, v171, v24
  v_add_f32 v219, v219, v24
  v_add_f32 v172, v172, v25
  v_add_f32 v220, v220, v25
  v_add_f32 v173, v173, v25
  v_add_f32 v221, v221, v25
  v_add_f32 v174, v174, v25
  v_add_f32 v222, v222, v25
  v_add_f32 v175, v175, v25
  v_add_f32 v223, v223, v25
  v_add_f32 v10, v10, v24
  v_add_f32 v11, v11, v25
k2_se_r2:
  v_exp_f32 v16, v160
  v_exp_f32 v17, v161
  s_nop 0
  v_cvt_pk_bf16_f32 v192, v16, v17
  v_add_f32 v12, v16, v17
  v_exp_f32 v18, v162
  s_branch k2_se_ret
f_post:
  s_cmp_gt_u32 s38, 7
  s_cbranch_scc1 f_po1
  v_mov_b32 v24, -1
  v_mov_b32 v25, -1
  v_mov_b32 v26, -1
  v_mov_b32 v27, -1
  s_cmp_gt_u32 s38, 5
  s_cbranch_scc1 f_po0
  buffer_store_dwordx4 v[24:27], v2, s[20:23], s87 offen sc1
  s_add_u32 s87, s87, 1024
  s_branch f_po1
f_po0:
  s_lshr_b32 s32, s3, 2
  s_lshl_b32 s32, s32, 1
  s_add_u32 s32, s32, s38
  s_sub_u32 s32, s32, 6
  s_lshl_b32 s32, s32, 11
  s_add_u32 s32, s32, s57
  buffer_store_dwordx4 v[24:27], v2, s[4:7], s32 offen offset:0 sc1
  buffer_store_dwordx4 v[24:27], v2, s[4:7], s32 offen offset:1024 sc1
f_po1:
  s_cmp_lg_u32 s38, s66
  s_cbranch_scc1 f_po2
  v_lshlrev_b32 v6, 26, v1
  v_mov_b32 v7, 1
  buffer_store_dword v7, v6, s[20:23], s78 offen sc1
f_po2:
  s_cmp_lt_u32 s38, 12
  s_cbranch_scc1 f_poE
  s_cmp_eq_u32 s38, 16
  s_cbranch_scc1 f_po16
  s_mov_b32 m0, 0x21000
  s_cmp_lg_u32 s38, 12
  s_cbranch_scc1 f_po3
  s_lshr_b32 s32, s2, 3
  s_lshl_b32 s33, s3, 5
  s_add_u32 s32, s32, s33
  s_lshl_b32 s32, s32, 13
  v_lshl_add_u32 v6, v1, 7, s32
  buffer_load_dword v6, s[28:31], 0 offen lds
  s_branch f_poE
f_po3:
f_po4:
  s_cmp_lg_u32 s38, 15
  s_cbranch_scc1 f_poE
  s_cmp_ge_u32 s3, 4
  s_cbranch_scc1 f_poE
  v_and_b32 v255, 7, v1
  v_lshlrev_b32 v255, 2, v255
  buffer_load_dword v255, v255, s[20:23], s79 offen sc1
  s_branch f_poE
f_po16:
  v_lshrrev_b32 v6, 3, v1
  v_and_b32 v6, 2, v6
  v_xor_b32 v6, v6, v1
  v_and_b32 v6, 3, v6
  v_lshrrev_b32 v5, 2, v1
  v_mul_u32_u24 v5, 1280, v5
  v_lshl_add_u32 v5, v6, 4, v5
  s_add_u32 m0, s69, s59
  s_nop 0
  buffer_load_dwordx4 v5, s[8:11], s70 offen offset:0 lds
  s_add_u32 s76, s70, s74
  buffer_load_dwordx4 v5, s[8:11], s76 offen offset:1024 lds
  s_add_u32 m0, m0, 0x4000
  s_nop 0
  buffer_load_dwordx4 v5, s[12:15], s71 offen offset:0 lds
  s_add_u32 s76, s71, s74
  buffer_load_dwordx4 v5, s[12:15], s76 offen offset:1024 lds
  s_add_u32 s70, s70, s72
  s_add_u32 s71, s71, s73
  s_sub_u32 s69, s69, 0x8000
  s_cselect_b32 s69, 0x20000, s69
  s_add_u32 m0, s69, s59
  s_nop 0
  buffer_load_dwordx4 v5, s[8:11], s70 offen offset:0 lds
  s_add_u32 s76, s70, s74
  buffer_load_dwordx4 v5, s[8:11], s76 offen offset:1024 lds
  s_add_u32 m0, m0, 0x4000
  s_nop 0
  buffer_load_dwordx4 v5, s[12:15], s71 offen offset:0 lds
  s_add_u32 s76, s71, s74
  buffer_load_dwordx4 v5, s[12:15], s76 offen offset:1024 lds
  s_add_u32 s70, s70, s72
  s_add_u32 s71, s71, s73
  s_sub_u32 s69, s69, 0x8000
  s_cselect_b32 s69, 0x20000, s69
  s_cmp_ge_u32 s3, 4
  s_cbranch_scc1 f_poE
  v_cmp_gt_i32 vcc, s89, v255
  s_nop 0
  s_and_b32 s33, vcc_lo, s88
  s_cbranch_scc1 f_po17
  s_mov_b32 s85, 1
  s_add_u32 s32, s35, 0
  s_and_b32 s32, s32, 3
  s_lshl_b32 s32, s32, 13
  s_add_u32 s32, s32, s83
  s_add_u32 s33, s32, 0x1000
  buffer_load_dwordx4 v[224:227], v2, s[4:7], s32 offen offset:0
  buffer_load_dwordx4 v[228:231], v2, s[4:7], s32 offen offset:1024
  buffer_load_dwordx4 v[232:235], v2, s[4:7], s32 offen offset:2048
  buffer_load_dwordx4 v[236:239], v2, s[4:7], s32 offen offset:3072
  buffer_load_dwordx4 v[240:243], v2, s[4:7], s33 offen offset:0
  buffer_load_dwordx4 v[244:247], v2, s[4:7], s33 offen offset:1024
  buffer_load_dwordx4 v[248:251], v2, s[4:7], s33 offen offset:2048
  buffer_load_dwordx4 v[252:255], v2, s[4:7], s33 offen offset:3072
  s_branch f_poE
f_po17:
  v_and_b32 v255, 7, v1
  v_lshlrev_b32 v255, 2, v255
  buffer_load_dword v255, v255, s[20:23], s79 offen sc1
f_poE:
  s_nop 4
  s_setpc_b64 s[100:101]
f_e2:
  s_waitcnt vmcnt(0)
  v_cmp_gt_i32 vcc, s89, v255
  s_nop 0
  s_and_b32 s33, vcc_lo, s88
  s_cbranch_scc1 f_e3
  s_mov_b32 s85, 1
  s_add_u32 s32, s35, 0
  s_and_b32 s32, s32, 3
  s_lshl_b32 s32, s32, 13
  s_add_u32 s32, s32, s83
  s_add_u32 s33, s32, 0x1000
  buffer_load_dwordx4 v[224:227], v2, s[4:7], s32 offen offset:0
  buffer_load_dwordx4 v[228:231], v2, s[4:7], s32 offen offset:1024
  buffer_load_dwordx4 v[232:235], v2, s[4:7], s32 offen offset:2048
  buffer_load_dwordx4 v[236:239], v2, s[4:7], s32 offen offset:3072
  buffer_load_dwordx4 v[240:243], v2, s[4:7], s33 offen offset:0
  buffer_load_dwordx4 v[244:247], v2, s[4:7], s33 offen offset:1024
  buffer_load_dwordx4 v[248:251], v2, s[4:7], s33 offen offset:2048
  buffer_load_dwordx4 v[252:255], v2, s[4:7], s33 offen offset:3072
  s_branch f_e1
f_e3:
  v_and_b32 v255, 7, v1
  v_lshlrev_b32 v255, 2, v255
  buffer_load_dword v255, v255, s[20:23], s79 offen sc1
  s_branch f_e0
f_e4:
  s_waitcnt vmcnt(0)
  v_lshlrev_b32 v6, 26, v1
  v_mov_b32 v7, 1
  buffer_store_dword v7, v6, s[20:23], s78 offen sc1
  s_branch f_e0
f_ldB:
  s_add_u32 s32, s35, 2
  s_and_b32 s32, s32, 3
  s_lshl_b32 s32, s32, 13
  s_add_u32 s32, s32, s83
  s_add_u32 s33, s32, 0x1000
  buffer_load_dwordx4 v[160:163], v2, s[4:7], s32 offen offset:0
  buffer_load_dwordx4 v[164:167], v2, s[4:7], s32 offen offset:1024
  buffer_load_dwordx4 v[168:171], v2, s[4:7], s32 offen offset:2048
  buffer_load_dwordx4 v[172:175], v2, s[4:7], s32 offen offset:3072
  buffer_load_dwordx4 v[176:179], v2, s[4:7], s33 offen offset:0
  buffer_load_dwordx4 v[180:183], v2, s[4:7], s33 offen offset:1024
  buffer_load_dwordx4 v[184:187], v2, s[4:7], s33 offen offset:2048
  buffer_load_dwordx4 v[188:191], v2, s[4:7], s33 offen offset:3072
  s_add_u32 s32, s35, 3
  s_and_b32 s32, s32, 3
  s_lshl_b32 s32, s32, 13
  s_add_u32 s32, s32, s83
  s_add_u32 s33, s32, 0x1000
  buffer_load_dwordx4 v[192:195], v2, s[4:7], s32 offen offset:0
  buffer_load_dwordx4 v[196:199], v2, s[4:7], s32 offen offset:1024
  buffer_load_dwordx4 v[200:203], v2, s[4:7], s32 offen offset:2048
  buffer_load_dwordx4 v[204:207], v2, s[4:7], s32 offen offset:3072
  buffer_load_dwordx4 v[208:211], v2, s[4:7], s33 offen offset:0
  buffer_load_dwordx4 v[212:215], v2, s[4:7], s33 offen offset:1024
  buffer_load_dwordx4 v[216:219], v2, s[4:7], s33 offen offset:2048
  buffer_load_dwordx4 v[220:223], v2, s[4:7], s33 offen offset:3072
  v_and_b32 v15, 7, v1
  v_lshlrev_b32 v15, 2, v15
  buffer_load_dword v15, v15, s[20:23], s84 offen sc1
  s_mov_b32 s32, 0x2000000
  buffer_load_dword v14, v2, s[4:7], s32 offen
  buffer_load_dword v14, v2, s[4:7], s32 offen
  buffer_load_dword v14, v2, s[4:7], s32 offen
  buffer_load_dword v14, v2, s[4:7], s32 offen
  buffer_load_dword v14, v2, s[4:7], s32 offen
  buffer_load_dword v14, v2, s[4:7], s32 offen
  buffer_load_dword v14, v2, s[4:7], s32 offen
  s_setpc_b64 s[100:101]
f_rl4:
  s_mov_b32 s76, 20000
f_rm4:
  s_add_u32 s32, s35, 1
  s_and_b32 s32, s32, 3
  s_lshl_b32 s32, s32, 13
  s_add_u32 s32, s32, s83
  s_add_u32 s33, s32, 0x1000
  buffer_load_dwordx4 v[128:131], v2, s[4:7], s32 offen offset:0 sc1
  buffer_load_dwordx4 v[132:135], v2, s[4:7], s32 offen offset:1024 sc1
  buffer_load_dwordx4 v[136:139], v2, s[4:7], s32 offen offset:2048 sc1
  buffer_load_dwordx4 v[140:143], v2, s[4:7], s32 offen offset:3072 sc1
  buffer_load_dwordx4 v[144:147], v2, s[4:7], s33 offen offset:0 sc1
  buffer_load_dwordx4 v[148:151], v2, s[4:7], s33 offen offset:1024 sc1
  buffer_load_dwordx4 v[152:155], v2, s[4:7], s33 offen offset:2048 sc1
  buffer_load_dwordx4 v[156:159], v2, s[4:7], s33 offen offset:3072 sc1
  s_waitcnt vmcnt(0)
  v_max3_u32 v8, v128, v129, v130
  v_max3_u32 v9, v131, v132, v133
  v_max3_u32 v8, v8, v134, v135
  v_max3_u32 v9, v9, v136, v137
  v_max3_u32 v8, v8, v138, v139
  v_max3_u32 v9, v9, v140, v141
  v_max3_u32 v8, v8, v142, v143
  v_max3_u32 v9, v9, v144, v145
  v_max3_u32 v8, v8, v146, v147
  v_max3_u32 v9, v9, v148, v149
  v_max3_u32 v8, v8, v150, v151
  v_max3_u32 v9, v9, v152, v153
  v_max3_u32 v8, v8, v154, v155
  v_max3_u32 v9, v9, v156, v157
  v_max3_u32 v8, v8, v158, v159
  v_max_u32 v8, v8, v9
  v_cmp_eq_u32 vcc, -1, v8
  s_nop 4
  s_cbranch_vccz f_ow4
  s_sub_u32 s76, s76, 1
  s_cmp_lg_u32 s76, 0
  s_cbranch_scc1 f_rm4
  s_branch f_ow4
f_rl8:
  s_mov_b32 s76, 20000
f_rm8:
  s_add_u32 s32, s35, 2
  s_and_b32 s32, s32, 3
  s_lshl_b32 s32, s32, 13
  s_add_u32 s32, s32, s83
  s_add_u32 s33, s32, 0x1000
  buffer_load_dwordx4 v[160:163], v2, s[4:7], s32 offen offset:0 sc1
  buffer_load_dwordx4 v[164:167], v2, s[4:7], s32 offen offset:1024 sc1
  buffer_load_dwordx4 v[168:171], v2, s[4:7], s32 offen offset:2048 sc1
  buffer_load_dwordx4 v[172:175], v2, s[4:7], s32 offen offset:3072 sc1
  buffer_load_dwordx4 v[176:179], v2, s[4:7], s33 offen offset:0 sc1
  buffer_load_dwordx4 v[180:183], v2, s[4:7], s33 offen offset:1024 sc1
  buffer_load_dwordx4 v[184:187], v2, s[4:7], s33 offen offset:2048 sc1
  buffer_load_dwordx4 v[188:191], v2, s[4:7], s33 offen offset:3072 sc1
  s_waitcnt vmcnt(0)
  v_max3_u32 v8, v160, v161, v162
  v_max3_u32 v9, v163, v164, v165
  v_max3_u32 v8, v8, v166, v167
  v_max3_u32 v9, v9, v168, v169
  v_max3_u32 v8, v8, v170, v171
  v_max3_u32 v9, v9, v172, v173
  v_max3_u32 v8, v8, v174, v175
  v_max3_u32 v9, v9, v176, v177
  v_max3_u32 v8, v8, v178, v179
  v_max3_u32 v9, v9, v180, v181
  v_max3_u32 v8, v8, v182, v183
  v_max3_u32 v9, v9, v184, v185
  v_max3_u32 v8, v8, v186, v187
  v_max3_u32 v9, v9, v188, v189
  v_max3_u32 v8, v8, v190, v191
  v_max_u32 v8, v8, v9
  v_cmp_eq_u32 vcc, -1, v8
  s_nop 4
  s_cbranch_vccz f_ow8
  s_sub_u32 s76, s76, 1
  s_cmp_lg_u32 s76, 0
  s_cbranch_scc1 f_rm8
  s_branch f_ow8
f_rl12:
  s_mov_b32 s76, 20000
f_rm12:
  s_add_u32 s32, s35, 3
  s_and_b32 s32, s32, 3
  s_lshl_b32 s32, s32, 13
  s_add_u32 s32, s32, s83
  s_add_u32 s33, s32, 0x1000
  buffer_load_dwordx4 v[192:195], v2, s[4:7], s32 offen offset:0 sc1
  buffer_load_dwordx4 v[196:199], v2, s[4:7], s32 offen offset:1024 sc1
  buffer_load_dwordx4 v[200:203], v2, s[4:7], s32 offen offset:2048 sc1
  buffer_load_dwordx4 v[204:207], v2, s[4:7], s32 offen offset:3072 sc1
  buffer_load_dwordx4 v[208:211], v2, s[4:7], s33 offen offset:0 sc1
  buffer_load_dwordx4 v[212:215], v2, s[4:7], s33 offen offset:1024 sc1
  buffer_load_dwordx4 v[216:219], v2, s[4:7], s33 offen offset:2048 sc1
  buffer_load_dwordx4 v[220:223], v2, s[4:7], s33 offen offset:3072 sc1
  s_waitcnt vmcnt(0)
  v_max3_u32 v8, v192, v193, v194
  v_max3_u32 v9, v195, v196, v197
  v_max3_u32 v8, v8, v198, v199
  v_max3_u32 v9, v9, v200, v201
  v_max3_u32 v8, v8, v202, v203
  v_max3_u32 v9, v9, v204, v205
  v_max3_u32 v8, v8, v206, v207
  v_max3_u32 v9, v9, v208, v209
  v_max3_u32 v8, v8, v210, v211
  v_max3_u32 v9, v9, v212, v213
  v_max3_u32 v8, v8, v214, v215
  v_max3_u32 v9, v9, v216, v217
  v_max3_u32 v8, v8, v218, v219
  v_max3_u32 v9, v9, v220, v221
  v_max3_u32 v8, v8, v222, v223
  v_max_u32 v8, v8, v9
  v_cmp_eq_u32 vcc, -1, v8
  s_nop 4
  s_cbranch_vccz f_ow12
  s_sub_u32 s76, s76, 1
  s_cmp_lg_u32 s76, 0
  s_cbranch_scc1 f_rm12
  s_branch f_ow12
f_last:
  s_endpgm
.section .rodata,"a"
.p2align 6
.amdhsa_kernel f_kernel
  .amdhsa_next_free_vgpr 256
  .amdhsa_next_free_sgpr 102
  .amdhsa_accum_offset 256
  .amdhsa_group_segment_fixed_size 0
  .amdhsa_kernarg_size 144
  .amdhsa_user_sgpr_count 2
  .amdhsa_user_sgpr_kernarg_segment_ptr 1
  .amdhsa_system_sgpr_workgroup_id_x 1
.end_amdhsa_kernel
```
